```python
import torch

def _softmax(x, axis=-1):
    return torch.softmax(x, dim=axis)
def _gelu(x):
    return torch.nn.functional.gelu(x, approximate="tanh")
def _silu(x):
    return torch.nn.functional.silu(x)
def _sigmoid(x):
    return torch.sigmoid(x)
def _layernorm(x, axis=-1, eps=1e-5):
    m = x.mean(dim=axis, keepdim=True)
    v = x.var(dim=axis, keepdim=True, unbiased=False)
    return (x - m) / torch.sqrt(v + eps)
def _scatter_add(tgt, idx, src, axis=0):
    return tgt.clone().index_add_(axis, idx, src)
def _segment_sum(src, seg, n):
    out = torch.zeros((n,) + src.shape[1:], dtype=src.dtype)
    return out.index_add_(0, seg, src)
def _pad(x, pw):
    flat = tuple(v for pair in reversed(pw) for v in pair)
    return torch.nn.functional.pad(x, flat)

kernel_name = 'sequential_preLN__compressed_kv_cla__glu_gated_swiglu__prompt'

def setup_inputs():

    _w = (lambda a: (lambda t: t.to(torch.bfloat16) if t.is_floating_point() else t)(torch.as_tensor(a)))
    def _A_setup():
        B, H, Sq, Sk, D, M = 1, 32, 2048, 2048, 128, 512
        Dc = 4 * D
        return {
            "x": _w((lambda *s: torch.randn(*s, dtype=torch.bfloat16) * 0.05)(B, Sq, M)),
            "c_kv": _w((lambda *s: torch.randn(*s, dtype=torch.bfloat16) * 0.2)(B, Sk, Dc)),
            "w_q": _w((lambda *s: torch.randn(*s, dtype=torch.bfloat16) * 6.4)(M, H, D) * (M ** -0.5)),
            "w_uk": _w((lambda *s: torch.randn(*s, dtype=torch.bfloat16) * 6.4)(Dc, H, D) * (Dc ** -0.5)),
            "w_uv": _w((lambda *s: torch.randn(*s, dtype=torch.bfloat16) * 0.2)(Dc, H, D) * (Dc ** -0.5)),
            "w_o": _w((lambda *s: torch.randn(*s, dtype=torch.bfloat16) * 0.2)(H, D, M) * ((H * D) ** -0.5)),
        }
    _A_in = _A_setup()

    def _B_setup():
        B, S, D, F = 1, 2048, 512, 1376
        return {
            "x": _w((lambda *s: torch.randn(*s, dtype=torch.bfloat16) * 0.05)(B, S, D)),
            "w1": _w((lambda *s: torch.randn(*s, dtype=torch.bfloat16) * 0.2)(D, F) * (2.0 / D) ** 0.5),
            "w3": _w((lambda *s: torch.randn(*s, dtype=torch.bfloat16) * 0.2)(D, F) * (2.0 / D) ** 0.5),
            "w2": _w((lambda *s: torch.randn(*s, dtype=torch.bfloat16) * 0.2)(F, D) * (2.0 / F) ** 0.5),
        }
    _B_in = _B_setup()

    return {
        "A_x": _A_in["x"],
        "A_c_kv": _A_in["c_kv"],
        "A_w_q": _A_in["w_q"],
        "A_w_uk": _A_in["w_uk"],
        "A_w_uv": _A_in["w_uv"],
        "A_w_o": _A_in["w_o"],
        "B_x": _B_in["x"],
        "B_w1": _B_in["w1"],
        "B_w3": _B_in["w3"],
        "B_w2": _B_in["w2"],
    }

def reference(A_x, A_c_kv, A_w_q, A_w_uk, A_w_uv, A_w_o, B_x, B_w1, B_w3, B_w2):
    def _A_ref(x, c_kv, w_q, w_uk, w_uv, w_o):
        B, Sq, M = x.shape[0], x.shape[1], x.shape[2]
        Sk = c_kv.shape[1]
        H, D = w_q.shape[1], w_q.shape[2]
        q = torch.einsum("bqm,mhd->bhqd", x, w_q)
        k = torch.einsum("bkc,chd->bhkd", c_kv, w_uk)
        v = torch.einsum("bkc,chd->bhkd", c_kv, w_uv)
        scores = torch.einsum("bhqd,bhkd->bhqk", q, k) * (D ** -0.5)
        off = Sk - Sq
        qi = torch.arange(Sq)[:, None]
        kj = torch.arange(Sk)[None, :]
        cmask = kj <= (qi + off)
        scores = torch.where(cmask[None, None], scores, -1e9)
        p = _softmax(scores, axis=-1)
        ctx = torch.einsum("bhqk,bhkd->bhqd", p, v)
        return torch.einsum("bhqd,hdm->bqm", ctx, w_o)

    def _B_ref(x, w1, w3, w2):
        gate = torch.einsum("bsd,df->bsf", x, w1)
        up = torch.einsum("bsd,df->bsf", x, w3)
        h = _silu(gate) * up
        out = torch.einsum("bsf,fd->bsd", h, w2)
        return out

    x = A_x
    h = x + _A_ref(_layernorm(x, axis=-1), A_c_kv, A_w_q, A_w_uk, A_w_uv, A_w_o)
    h2 = h + _B_ref(_layernorm(h, axis=-1), B_w1, B_w3, B_w2)
    return h2
```

```asm
; @launch grid=(256,1,1) block=(256,1,1) lds=163840
.amdgcn_target "amdgcn-amd-amdhsa--gfx950"
.text
.globl sequential_preLN__compressed_kv_cla__glu_gated_swiglu__prompt_kernel
.p2align 8
.type sequential_preLN__compressed_kv_cla__glu_gated_swiglu__prompt_kernel,@function
sequential_preLN__compressed_kv_cla__glu_gated_swiglu__prompt_kernel:
    s_cmp_ge_u32 s2, 256
    s_cbranch_scc1 L_sequential_preLN__compressed_kv_cla__glu_gated_swiglu__prompt_kernel_end
    s_load_dwordx8 s[48:55], s[0:1], 0
    s_load_dwordx2 s[16:17], s[0:1], 32
    s_load_dwordx4 s[56:59], s[0:1], 88
    s_load_dwordx4 s[64:67], s[0:1], 56
    s_getpc_b64 s[60:61]
L_ct_sequential_preLN__compressed_kv_cla__glu_gated_swiglu__prompt_kernel_sequential_preLN__compressed_kv_cla__glu_gated_swiglu__prompt_kernel:
    v_lshlrev_b32 v14, 7, v0
    v_min_u32 v14, L_text_last-L_ct_sequential_preLN__compressed_kv_cla__glu_gated_swiglu__prompt_kernel_sequential_preLN__compressed_kv_cla__glu_gated_swiglu__prompt_kernel, v14
    global_load_dword v14, v14, s[60:61]
    v_lshrrev_b32 v15, 6, v0
    v_lshlrev_b32 v255, 4, v0
    v_and_b32 v0, 63, v0
    v_readfirstlane_b32 s3, v15
    v_lshrrev_b32 v208, 3, v0
    v_and_b32 v209, 7, v0
    v_and_b32 v210, 2, v208
    v_xor_b32 v209, v209, v210
    v_lshlrev_b32 v208, 13, v208
    s_and_b32 s42, s2, 7
    s_lshr_b32 s38, s2, 3
    s_lshl_b32 s32, s42, 2
    s_and_b32 s39, s38, 3
    s_add_u32 s32, s32, s39
    s_lshl_b32 s35, s32, 8
    s_lshl_b32 s39, s3, 18
    s_add_u32 s35, s35, s39
    s_lshl_b32 s68, s3, 12
    v_lshl_add_u32 v248, v209, 4, v208
    v_xor_b32 v210, 4, v209
    v_lshl_add_u32 v249, v210, 4, v208
    v_add_u32 v249, 64512, v249
    v_lshl_add_u32 v250, v209, 4, v208
    v_add_u32 v250, 129024, v250
    v_xor_b32 v210, 4, v209
    v_lshl_add_u32 v251, v210, 4, v208
    v_add_u32 v251, 193536, v251
    s_mov_b32 s14, 4194304
    s_mov_b32 s15, 0x20000
    s_waitcnt lgkmcnt(0)
    s_mov_b32 s12, s54
    s_mov_b32 s13, s55
    s_add_u32 m0, s68, 0
    s_add_u32 s37, s35, 0
    buffer_load_dwordx4 v248, s[12:15], s37 offen offset:0 lds
    buffer_load_dwordx4 v249, s[12:15], s37 offen offset:1024 lds
    buffer_load_dwordx4 v250, s[12:15], s37 offen offset:2048 lds
    buffer_load_dwordx4 v251, s[12:15], s37 offen offset:3072 lds
    s_lshr_b32 s33, s38, 2
    s_lshl_b32 s36, s33, 2
    s_add_u32 s36, s36, s3
    s_lshl_b32 s34, s36, 16
    s_lshl_b32 s40, s3, 14
    s_add_u32 s40, s40, 65536
    s_mov_b32 s8, s50
    s_mov_b32 s9, s51
    v_and_b32 v208, 15, v0
    v_lshrrev_b32 v209, 4, v0
    v_xor_b32 v208, v208, v209
    v_lshlrev_b32 v209, 10, v209
    v_lshl_add_u32 v2, v208, 4, v209
    v_xor_b32 v210, 4, v208
    v_lshl_add_u32 v3, v210, 4, v209
    v_add_u32 v3, 3072, v3
    v_xor_b32 v210, 8, v208
    v_lshl_add_u32 v4, v210, 4, v209
    v_add_u32 v4, 6144, v4
    v_xor_b32 v210, 12, v208
    v_lshl_add_u32 v5, v210, 4, v209
    v_add_u32 v5, 9216, v5
    s_mov_b32 s10, 2097152
    s_mov_b32 s11, 0x20000
    s_add_u32 m0, s40, 0
    s_add_u32 s37, s34, 0
    buffer_load_dwordx4 v2, s[8:11], s37 offen offset:0 lds
    buffer_load_dwordx4 v3, s[8:11], s37 offen offset:1024 lds
    buffer_load_dwordx4 v4, s[8:11], s37 offen offset:2048 lds
    buffer_load_dwordx4 v5, s[8:11], s37 offen offset:3072 lds
    s_add_u32 m0, s40, 4096
    s_add_u32 s37, s34, 16384
    buffer_load_dwordx4 v2, s[8:11], s37 offen offset:0 lds
    buffer_load_dwordx4 v3, s[8:11], s37 offen offset:1024 lds
    buffer_load_dwordx4 v4, s[8:11], s37 offen offset:2048 lds
    buffer_load_dwordx4 v5, s[8:11], s37 offen offset:3072 lds
    v_lshl_add_u32 v15, s2, 2, v15
    v_lshlrev_b32 v15, 7, v15
    v_min_u32 v15, L_text_last-L_ct_sequential_preLN__compressed_kv_cla__glu_gated_swiglu__prompt_kernel_sequential_preLN__compressed_kv_cla__glu_gated_swiglu__prompt_kernel, v15
    s_mul_i32 s36, s36, 37888
    s_lshl_b32 s41, s2, 2
    s_add_u32 s41, s41, s3
    s_lshl_b32 s41, s41, 11
    s_lshl_b32 s37, s42, 10
    s_lshl_b32 s42, s38, 2
    s_add_u32 s42, s42, s3
    s_lshl_b32 s42, s42, 13
    s_add_u32 s42, s42, s37
    v_lshlrev_b32 v1, 4, v0
    s_mov_b32 s20, s48
    s_mov_b32 s21, s49
    s_mov_b32 s28, s52
    s_mov_b32 s29, s53
    s_mov_b32 s24, s56
    s_mov_b32 s25, s57
    s_mov_b32 s4, s58
    s_mov_b32 s5, s59
    s_mul_i32 s37, s32, 1213440
    s_add_u32 s36, s36, s37
    s_cmp_eq_u32 s3, 0
    s_cselect_b32 s69, 0, 0x40000000
    s_cmp_ge_u32 s3, 2
    s_cselect_b32 s100, s66, s64
    s_cselect_b32 s101, s67, s65
    v_lshrrev_b32 v208, 4, v0
    v_bfe_u32 v209, v0, 2, 2
    v_lshl_add_u32 v209, v208, 3, v209
    v_and_b32 v208, 1, v208
    v_bfe_u32 v210, v0, 3, 1
    v_lshl_add_u32 v208, v208, 1, v210
    v_lshlrev_b32 v209, 7, v209
    v_and_b32 v210, 3, v0
    v_lshl_add_u32 v209, v210, 3, v209
    v_xor_b32 v210, 0, v208
    v_lshl_add_u32 v6, v210, 5, v209
    v_add_u32 v240, 0x10000, v6
    v_add_u32 v244, 0x20000, v6
    v_xor_b32 v210, 1, v208
    v_lshl_add_u32 v7, v210, 5, v209
    v_add_u32 v241, 0x10000, v7
    v_add_u32 v245, 0x20000, v7
    v_xor_b32 v210, 2, v208
    v_lshl_add_u32 v8, v210, 5, v209
    v_add_u32 v242, 0x10000, v8
    v_add_u32 v246, 0x20000, v8
    v_xor_b32 v210, 3, v208
    v_lshl_add_u32 v9, v210, 5, v209
    v_add_u32 v243, 0x10000, v9
    v_add_u32 v247, 0x20000, v9
    v_and_b32 v208, 15, v0
    v_lshrrev_b32 v209, 4, v0
    v_xor_b32 v209, v209, v208
    v_lshl_add_u32 v208, v208, 8, s40
    v_xor_b32 v210, 0, v209
    v_lshl_add_u32 v10, v210, 4, v208
    v_xor_b32 v210, 4, v209
    v_lshl_add_u32 v11, v210, 4, v208
    v_xor_b32 v210, 8, v209
    v_lshl_add_u32 v12, v210, 4, v208
    v_xor_b32 v210, 12, v209
    v_lshl_add_u32 v13, v210, 4, v208
    s_mov_b32 s18, 4194304
    s_mov_b32 s19, 0x20000
    s_mov_b32 s6, 83886080
    s_mov_b32 s7, 0x20000
    s_mov_b32 s22, 2097152
    s_mov_b32 s23, 0x20000
    s_mov_b32 s30, 4194304
    s_mov_b32 s31, 0x20000
    s_mov_b32 s26, 256
    s_mov_b32 s27, 0x20000
    s_cmp_eq_u32 s2, 0
    s_cselect_b32 s45, 74448896, 0x40000000
    s_cselect_b32 s38, 0, 0x40000000
    v_mov_b32 v252, 0
    v_mov_b32 v253, 1
    v_lshlrev_b32 v222, 5, v0
    v_lshrrev_b32 v208, 5, v0
    v_and_b32 v209, 31, v0
    v_lshlrev_b32 v209, 5, v209
    v_lshl_add_u32 v223, v208, 20, v209
    s_lshr_b32 s39, s2, 3
    s_lshl_b32 s39, s39, 6
    s_bfe_u32 s37, s2, 0x20001
    s_add_u32 s39, s39, s37
    s_and_b32 s43, s2, 1
    s_lshl_b32 s37, s43, 5
    s_add_u32 s39, s39, s37
    s_lshl_b32 s39, s39, 10
    s_lshl_b32 s37, s3, 8
    s_add_u32 s39, s39, s37
    v_and_b32 v200, 7, v0
    v_lshrrev_b32 v201, 3, v0
    v_lshlrev_b32 v202, 4, v201
    v_lshl_add_u32 v202, v200, 12, v202
    v_mov_b32 v224, 0
    v_mov_b32 v225, 0
    v_mov_b32 v226, 0
    v_mov_b32 v227, 0
    s_add_u32 m0, s40, 8192
    s_add_u32 s37, s34, 32768
    buffer_load_dwordx4 v2, s[8:11], s37 offen offset:0 lds
    buffer_load_dwordx4 v3, s[8:11], s37 offen offset:1024 lds
    buffer_load_dwordx4 v4, s[8:11], s37 offen offset:2048 lds
    buffer_load_dwordx4 v5, s[8:11], s37 offen offset:3072 lds
    s_add_u32 m0, s40, 12288
    s_add_u32 s37, s34, 49152
    buffer_load_dwordx4 v2, s[8:11], s37 offen offset:0 lds
    buffer_load_dwordx4 v3, s[8:11], s37 offen offset:1024 lds
    buffer_load_dwordx4 v4, s[8:11], s37 offen offset:2048 lds
    buffer_load_dwordx4 v5, s[8:11], s37 offen offset:3072 lds
    s_add_u32 m0, s68, 16384
    s_add_u32 s37, s35, 128
    buffer_load_dwordx4 v248, s[12:15], s37 offen offset:0 lds
    buffer_load_dwordx4 v249, s[12:15], s37 offen offset:1024 lds
    buffer_load_dwordx4 v250, s[12:15], s37 offen offset:2048 lds
    buffer_load_dwordx4 v251, s[12:15], s37 offen offset:3072 lds
    s_waitcnt vmcnt(20)
    s_barrier
    ds_read_b64_tr_b16 v[16:17], v6 offset:0
    ds_read_b64_tr_b16 v[18:19], v6 offset:512
    ds_read_b64_tr_b16 v[20:21], v6 offset:4096
    ds_read_b64_tr_b16 v[22:23], v6 offset:4608
    ds_read_b64_tr_b16 v[24:25], v6 offset:8192
    ds_read_b64_tr_b16 v[26:27], v6 offset:8704
    ds_read_b64_tr_b16 v[28:29], v6 offset:12288
    ds_read_b64_tr_b16 v[30:31], v6 offset:12800
    s_waitcnt vmcnt(16)
    ds_read_b128 a[0:3], v10 offset:0
    ds_read_b128 a[4:7], v11 offset:0
    ds_read_b128 a[8:11], v12 offset:0
    ds_read_b128 a[12:15], v13 offset:0
    s_waitcnt vmcnt(12)
    ds_read_b128 a[64:67], v10 offset:4096
    ds_read_b128 a[68:71], v11 offset:4096
    ds_read_b128 a[72:75], v12 offset:4096
    ds_read_b128 a[76:79], v13 offset:4096
    s_waitcnt vmcnt(8)
    ds_read_b128 a[128:131], v10 offset:8192
    ds_read_b128 a[132:135], v11 offset:8192
    ds_read_b128 a[136:139], v12 offset:8192
    ds_read_b128 a[140:143], v13 offset:8192
    s_waitcnt vmcnt(4)
    ds_read_b128 a[192:195], v10 offset:12288
    ds_read_b128 a[196:199], v11 offset:12288
    ds_read_b128 a[200:203], v12 offset:12288
    ds_read_b128 a[204:207], v13 offset:12288
    s_waitcnt lgkmcnt(15)
    v_mfma_f32_16x16x32_bf16 v[48:51], v[16:19], a[0:3], 0
    ds_read_b64_tr_b16 v[32:33], v7 offset:0
    s_waitcnt lgkmcnt(15)
    v_mfma_f32_16x16x32_bf16 v[48:51], v[20:23], a[4:7], v[48:51]
    ds_read_b64_tr_b16 v[34:35], v7 offset:512
    s_waitcnt lgkmcnt(15)
    v_mfma_f32_16x16x32_bf16 v[48:51], v[24:27], a[8:11], v[48:51]
    ds_read_b64_tr_b16 v[36:37], v7 offset:4096
    s_waitcnt lgkmcnt(15)
    v_mfma_f32_16x16x32_bf16 v[48:51], v[28:31], a[12:15], v[48:51]
    buffer_load_dword v220, v222, s[8:11], s41 offen
    s_waitcnt lgkmcnt(14)
    v_mfma_f32_16x16x32_bf16 v[52:55], v[16:19], a[64:67], 0
    ds_read_b64_tr_b16 v[38:39], v7 offset:4608
    s_waitcnt lgkmcnt(14)
    v_mfma_f32_16x16x32_bf16 v[52:55], v[20:23], a[68:71], v[52:55]
    ds_read_b64_tr_b16 v[40:41], v7 offset:8192
    s_waitcnt lgkmcnt(14)
    v_mfma_f32_16x16x32_bf16 v[52:55], v[24:27], a[72:75], v[52:55]
    ds_read_b64_tr_b16 v[42:43], v7 offset:8704
    s_waitcnt lgkmcnt(14)
    v_mfma_f32_16x16x32_bf16 v[52:55], v[28:31], a[76:79], v[52:55]
    s_add_u32 s46, s42, 1048576
    buffer_load_dword v221, v223, s[12:15], s46 offen
    s_waitcnt lgkmcnt(6)
    v_mfma_f32_16x16x32_bf16 v[56:59], v[16:19], a[128:131], 0
    ds_read_b64_tr_b16 v[44:45], v7 offset:12288
    v_mfma_f32_16x16x32_bf16 v[56:59], v[20:23], a[132:135], v[56:59]
    ds_read_b64_tr_b16 v[46:47], v7 offset:12800
    v_mfma_f32_16x16x32_bf16 v[56:59], v[24:27], a[136:139], v[56:59]
    v_mfma_f32_16x16x32_bf16 v[56:59], v[28:31], a[140:143], v[56:59]
    global_load_dword v15, v15, s[60:61]
    v_mfma_f32_16x16x32_bf16 v[60:63], v[16:19], a[192:195], 0
    s_add_u32 m0, s40, 0
    v_mfma_f32_16x16x32_bf16 v[60:63], v[20:23], a[196:199], v[60:63]
    s_add_u32 s37, s34, 256
    v_mfma_f32_16x16x32_bf16 v[60:63], v[24:27], a[200:203], v[60:63]
    buffer_load_dwordx4 v2, s[8:11], s37 offen offset:0 lds
    v_mfma_f32_16x16x32_bf16 v[60:63], v[28:31], a[204:207], v[60:63]
    s_waitcnt lgkmcnt(0)
    v_mfma_f32_16x16x32_bf16 v[64:67], v[32:35], a[0:3], 0
    ds_read_b64_tr_b16 v[16:17], v8 offset:0
    v_mfma_f32_16x16x32_bf16 v[64:67], v[36:39], a[4:7], v[64:67]
    ds_read_b64_tr_b16 v[18:19], v8 offset:512
    v_mfma_f32_16x16x32_bf16 v[64:67], v[40:43], a[8:11], v[64:67]
    ds_read_b64_tr_b16 v[20:21], v8 offset:4096
    v_mfma_f32_16x16x32_bf16 v[64:67], v[44:47], a[12:15], v[64:67]
    buffer_load_dwordx4 v3, s[8:11], s37 offen offset:1024 lds
    v_mfma_f32_16x16x32_bf16 v[68:71], v[32:35], a[64:67], 0
    ds_read_b64_tr_b16 v[22:23], v8 offset:4608
    v_mfma_f32_16x16x32_bf16 v[68:71], v[36:39], a[68:71], v[68:71]
    ds_read_b64_tr_b16 v[24:25], v8 offset:8192
    v_mfma_f32_16x16x32_bf16 v[68:71], v[40:43], a[72:75], v[68:71]
    ds_read_b64_tr_b16 v[26:27], v8 offset:8704
    v_mfma_f32_16x16x32_bf16 v[68:71], v[44:47], a[76:79], v[68:71]
    buffer_load_dwordx4 v4, s[8:11], s37 offen offset:2048 lds
    v_mfma_f32_16x16x32_bf16 v[72:75], v[32:35], a[128:131], 0
    ds_read_b64_tr_b16 v[28:29], v8 offset:12288
    v_mfma_f32_16x16x32_bf16 v[72:75], v[36:39], a[132:135], v[72:75]
    ds_read_b64_tr_b16 v[30:31], v8 offset:12800
    v_mfma_f32_16x16x32_bf16 v[72:75], v[40:43], a[136:139], v[72:75]
    buffer_load_dwordx4 v[176:179], v202, s[20:23], s39 offen
    v_mfma_f32_16x16x32_bf16 v[72:75], v[44:47], a[140:143], v[72:75]
    buffer_load_dwordx4 v5, s[8:11], s37 offen offset:3072 lds
    v_mfma_f32_16x16x32_bf16 v[76:79], v[32:35], a[192:195], 0
    s_add_u32 m0, s68, 32768
    v_mfma_f32_16x16x32_bf16 v[76:79], v[36:39], a[196:199], v[76:79]
    s_add_u32 s37, s35, 1048576
    v_mfma_f32_16x16x32_bf16 v[76:79], v[40:43], a[200:203], v[76:79]
    buffer_load_dwordx4 v248, s[12:15], s37 offen offset:0 lds
    v_mfma_f32_16x16x32_bf16 v[76:79], v[44:47], a[204:207], v[76:79]
    s_waitcnt lgkmcnt(0)
    v_mfma_f32_16x16x32_bf16 v[80:83], v[16:19], a[0:3], 0
    ds_read_b64_tr_b16 v[32:33], v9 offset:0
    v_mfma_f32_16x16x32_bf16 v[80:83], v[20:23], a[4:7], v[80:83]
    ds_read_b64_tr_b16 v[34:35], v9 offset:512
    v_mfma_f32_16x16x32_bf16 v[80:83], v[24:27], a[8:11], v[80:83]
    ds_read_b64_tr_b16 v[36:37], v9 offset:4096
    v_mfma_f32_16x16x32_bf16 v[80:83], v[28:31], a[12:15], v[80:83]
    buffer_load_dwordx4 v249, s[12:15], s37 offen offset:1024 lds
    v_mfma_f32_16x16x32_bf16 v[84:87], v[16:19], a[64:67], 0
    ds_read_b64_tr_b16 v[38:39], v9 offset:4608
    v_mfma_f32_16x16x32_bf16 v[84:87], v[20:23], a[68:71], v[84:87]
    ds_read_b64_tr_b16 v[40:41], v9 offset:8192
    v_mfma_f32_16x16x32_bf16 v[84:87], v[24:27], a[72:75], v[84:87]
    ds_read_b64_tr_b16 v[42:43], v9 offset:8704
    v_mfma_f32_16x16x32_bf16 v[84:87], v[28:31], a[76:79], v[84:87]
    buffer_load_dwordx4 v250, s[12:15], s37 offen offset:2048 lds
    v_mfma_f32_16x16x32_bf16 v[88:91], v[16:19], a[128:131], 0
    ds_read_b64_tr_b16 v[44:45], v9 offset:12288
    v_mfma_f32_16x16x32_bf16 v[88:91], v[20:23], a[132:135], v[88:91]
    ds_read_b64_tr_b16 v[46:47], v9 offset:12800
    v_mfma_f32_16x16x32_bf16 v[88:91], v[24:27], a[136:139], v[88:91]
    buffer_load_dwordx4 v[180:183], v202, s[20:23], s39 offen offset:128
    v_mfma_f32_16x16x32_bf16 v[88:91], v[28:31], a[140:143], v[88:91]
    buffer_load_dwordx4 v251, s[12:15], s37 offen offset:3072 lds
    v_mfma_f32_16x16x32_bf16 v[92:95], v[16:19], a[192:195], 0
    s_add_u32 m0, s40, 4096
    v_mfma_f32_16x16x32_bf16 v[92:95], v[20:23], a[196:199], v[92:95]
    s_add_u32 s37, s34, 16640
    v_mfma_f32_16x16x32_bf16 v[92:95], v[24:27], a[200:203], v[92:95]
    buffer_load_dwordx4 v2, s[8:11], s37 offen offset:0 lds
    v_mfma_f32_16x16x32_bf16 v[92:95], v[28:31], a[204:207], v[92:95]
    s_waitcnt vmcnt(14) lgkmcnt(0)
    s_barrier
    v_mfma_f32_16x16x32_bf16 v[96:99], v[32:35], a[0:3], 0
    ds_read_b64_tr_b16 v[16:17], v6 offset:16384
    buffer_store_dwordx4 v[224:227], v255, s[4:7], s45 offen sc1
    s_add_u32 s45, s45, 4096
    v_mfma_f32_16x16x32_bf16 v[96:99], v[36:39], a[4:7], v[96:99]
    ds_read_b64_tr_b16 v[18:19], v6 offset:16896
    v_mfma_f32_16x16x32_bf16 v[96:99], v[40:43], a[8:11], v[96:99]
    ds_read_b64_tr_b16 v[20:21], v6 offset:20480
    v_mfma_f32_16x16x32_bf16 v[96:99], v[44:47], a[12:15], v[96:99]
    buffer_load_dwordx4 v3, s[8:11], s37 offen offset:1024 lds
    v_mfma_f32_16x16x32_bf16 v[100:103], v[32:35], a[64:67], 0
    ds_read_b64_tr_b16 v[22:23], v6 offset:20992
    v_mfma_f32_16x16x32_bf16 v[100:103], v[36:39], a[68:71], v[100:103]
    ds_read_b64_tr_b16 v[24:25], v6 offset:24576
    v_mfma_f32_16x16x32_bf16 v[100:103], v[40:43], a[72:75], v[100:103]
    ds_read_b64_tr_b16 v[26:27], v6 offset:25088
    v_mfma_f32_16x16x32_bf16 v[100:103], v[44:47], a[76:79], v[100:103]
    buffer_load_dwordx4 v4, s[8:11], s37 offen offset:2048 lds
    v_mfma_f32_16x16x32_bf16 v[104:107], v[32:35], a[128:131], 0
    ds_read_b64_tr_b16 v[28:29], v6 offset:28672
    v_mfma_f32_16x16x32_bf16 v[104:107], v[36:39], a[132:135], v[104:107]
    ds_read_b64_tr_b16 v[30:31], v6 offset:29184
    v_mfma_f32_16x16x32_bf16 v[104:107], v[40:43], a[136:139], v[104:107]
    buffer_store_dwordx4 v[224:227], v255, s[4:7], s45 offen sc1
    s_add_u32 s45, s45, 4096
    v_mfma_f32_16x16x32_bf16 v[104:107], v[44:47], a[140:143], v[104:107]
    buffer_load_dwordx4 v5, s[8:11], s37 offen offset:3072 lds
    v_mfma_f32_16x16x32_bf16 v[108:111], v[32:35], a[192:195], 0
    s_add_u32 m0, s40, 8192
    v_mfma_f32_16x16x32_bf16 v[108:111], v[36:39], a[196:199], v[108:111]
    s_add_u32 s37, s34, 33024
    v_mfma_f32_16x16x32_bf16 v[108:111], v[40:43], a[200:203], v[108:111]
    buffer_load_dwordx4 v2, s[8:11], s37 offen offset:0 lds
    v_mfma_f32_16x16x32_bf16 v[108:111], v[44:47], a[204:207], v[108:111]
    s_waitcnt lgkmcnt(0)
    v_mfma_f32_16x16x32_bf16 v[112:115], v[16:19], a[0:3], 0
    ds_read_b64_tr_b16 v[32:33], v7 offset:16384
    buffer_store_dwordx4 v[224:227], v255, s[4:7], s45 offen sc1
    s_add_u32 s45, s45, 4096
    v_mfma_f32_16x16x32_bf16 v[112:115], v[20:23], a[4:7], v[112:115]
    ds_read_b64_tr_b16 v[34:35], v7 offset:16896
    v_mfma_f32_16x16x32_bf16 v[112:115], v[24:27], a[8:11], v[112:115]
    ds_read_b64_tr_b16 v[36:37], v7 offset:20480
    v_mfma_f32_16x16x32_bf16 v[112:115], v[28:31], a[12:15], v[112:115]
    buffer_load_dwordx4 v3, s[8:11], s37 offen offset:1024 lds
    v_mfma_f32_16x16x32_bf16 v[116:119], v[16:19], a[64:67], 0
    ds_read_b64_tr_b16 v[38:39], v7 offset:20992
    v_mfma_f32_16x16x32_bf16 v[116:119], v[20:23], a[68:71], v[116:119]
    ds_read_b64_tr_b16 v[40:41], v7 offset:24576
    v_mfma_f32_16x16x32_bf16 v[116:119], v[24:27], a[72:75], v[116:119]
    ds_read_b64_tr_b16 v[42:43], v7 offset:25088
    v_mfma_f32_16x16x32_bf16 v[116:119], v[28:31], a[76:79], v[116:119]
    buffer_load_dwordx4 v4, s[8:11], s37 offen offset:2048 lds
    v_mfma_f32_16x16x32_bf16 v[120:123], v[16:19], a[128:131], 0
    ds_read_b64_tr_b16 v[44:45], v7 offset:28672
    v_mfma_f32_16x16x32_bf16 v[120:123], v[20:23], a[132:135], v[120:123]
    ds_read_b64_tr_b16 v[46:47], v7 offset:29184
    v_mfma_f32_16x16x32_bf16 v[120:123], v[24:27], a[136:139], v[120:123]
    buffer_store_dwordx4 v[224:227], v255, s[4:7], s45 offen sc1
    s_add_u32 s45, s45, 4096
    v_mfma_f32_16x16x32_bf16 v[120:123], v[28:31], a[140:143], v[120:123]
    buffer_load_dwordx4 v5, s[8:11], s37 offen offset:3072 lds
    v_mfma_f32_16x16x32_bf16 v[124:127], v[16:19], a[192:195], 0
    s_add_u32 m0, s40, 12288
    v_mfma_f32_16x16x32_bf16 v[124:127], v[20:23], a[196:199], v[124:127]
    s_add_u32 s37, s34, 49408
    v_mfma_f32_16x16x32_bf16 v[124:127], v[24:27], a[200:203], v[124:127]
    buffer_load_dwordx4 v2, s[8:11], s37 offen offset:0 lds
    v_mfma_f32_16x16x32_bf16 v[124:127], v[28:31], a[204:207], v[124:127]
    s_waitcnt lgkmcnt(0)
    v_mfma_f32_16x16x32_bf16 v[128:131], v[32:35], a[0:3], 0
    ds_read_b64_tr_b16 v[16:17], v8 offset:16384
    v_mfma_f32_16x16x32_bf16 v[128:131], v[36:39], a[4:7], v[128:131]
    ds_read_b64_tr_b16 v[18:19], v8 offset:16896
    v_mfma_f32_16x16x32_bf16 v[128:131], v[40:43], a[8:11], v[128:131]
    ds_read_b64_tr_b16 v[20:21], v8 offset:20480
    v_mfma_f32_16x16x32_bf16 v[128:131], v[44:47], a[12:15], v[128:131]
    buffer_load_dwordx4 v3, s[8:11], s37 offen offset:1024 lds
    v_mfma_f32_16x16x32_bf16 v[132:135], v[32:35], a[64:67], 0
    ds_read_b64_tr_b16 v[22:23], v8 offset:20992
    v_mfma_f32_16x16x32_bf16 v[132:135], v[36:39], a[68:71], v[132:135]
    ds_read_b64_tr_b16 v[24:25], v8 offset:24576
    v_mfma_f32_16x16x32_bf16 v[132:135], v[40:43], a[72:75], v[132:135]
    ds_read_b64_tr_b16 v[26:27], v8 offset:25088
    v_mfma_f32_16x16x32_bf16 v[132:135], v[44:47], a[76:79], v[132:135]
    buffer_load_dwordx4 v4, s[8:11], s37 offen offset:2048 lds
    v_mfma_f32_16x16x32_bf16 v[136:139], v[32:35], a[128:131], 0
    ds_read_b64_tr_b16 v[28:29], v8 offset:28672
    v_mfma_f32_16x16x32_bf16 v[136:139], v[36:39], a[132:135], v[136:139]
    ds_read_b64_tr_b16 v[30:31], v8 offset:29184
    v_mfma_f32_16x16x32_bf16 v[136:139], v[40:43], a[136:139], v[136:139]
    s_lshr_b32 s39, s2, 1
    s_mul_i32 s39, s39, 21504
    s_add_u32 s39, s39, s68
    v_mfma_f32_16x16x32_bf16 v[136:139], v[44:47], a[140:143], v[136:139]
    buffer_load_dwordx4 v5, s[8:11], s37 offen offset:3072 lds
    v_mfma_f32_16x16x32_bf16 v[140:143], v[32:35], a[192:195], 0
    s_add_u32 m0, s68, 49152
    v_mfma_f32_16x16x32_bf16 v[140:143], v[36:39], a[196:199], v[140:143]
    s_add_u32 s37, s35, 1048704
    v_mfma_f32_16x16x32_bf16 v[140:143], v[40:43], a[200:203], v[140:143]
    buffer_load_dwordx4 v248, s[12:15], s37 offen offset:0 lds
    v_mfma_f32_16x16x32_bf16 v[140:143], v[44:47], a[204:207], v[140:143]
    s_waitcnt lgkmcnt(0)
    v_mfma_f32_16x16x32_bf16 v[144:147], v[16:19], a[0:3], 0
    ds_read_b64_tr_b16 v[32:33], v9 offset:16384
    v_mfma_f32_16x16x32_bf16 v[144:147], v[20:23], a[4:7], v[144:147]
    ds_read_b64_tr_b16 v[34:35], v9 offset:16896
    v_mfma_f32_16x16x32_bf16 v[144:147], v[24:27], a[8:11], v[144:147]
    ds_read_b64_tr_b16 v[36:37], v9 offset:20480
    v_mfma_f32_16x16x32_bf16 v[144:147], v[28:31], a[12:15], v[144:147]
    buffer_load_dwordx4 v249, s[12:15], s37 offen offset:1024 lds
    v_mfma_f32_16x16x32_bf16 v[148:151], v[16:19], a[64:67], 0
    ds_read_b64_tr_b16 v[38:39], v9 offset:20992
    v_mfma_f32_16x16x32_bf16 v[148:151], v[20:23], a[68:71], v[148:151]
    ds_read_b64_tr_b16 v[40:41], v9 offset:24576
    v_mfma_f32_16x16x32_bf16 v[148:151], v[24:27], a[72:75], v[148:151]
    ds_read_b64_tr_b16 v[42:43], v9 offset:25088
    v_mfma_f32_16x16x32_bf16 v[148:151], v[28:31], a[76:79], v[148:151]
    buffer_load_dwordx4 v250, s[12:15], s37 offen offset:2048 lds
    v_mfma_f32_16x16x32_bf16 v[152:155], v[16:19], a[128:131], 0
    ds_read_b64_tr_b16 v[44:45], v9 offset:28672
    v_mfma_f32_16x16x32_bf16 v[152:155], v[20:23], a[132:135], v[152:155]
    ds_read_b64_tr_b16 v[46:47], v9 offset:29184
    s_waitcnt vmcnt(24)
    v_mfma_f32_16x16x32_bf16 v[152:155], v[24:27], a[136:139], v[152:155]
    ds_read_b128 a[16:19], v10 offset:0
    v_mfma_f32_16x16x32_bf16 v[152:155], v[28:31], a[140:143], v[152:155]
    buffer_load_dwordx4 v251, s[12:15], s37 offen offset:3072 lds
    v_mfma_f32_16x16x32_bf16 v[156:159], v[16:19], a[192:195], 0
    ds_read_b128 a[20:23], v11 offset:0
    v_mfma_f32_16x16x32_bf16 v[156:159], v[20:23], a[196:199], v[156:159]
    ds_read_b128 a[24:27], v12 offset:0
    v_mfma_f32_16x16x32_bf16 v[156:159], v[24:27], a[200:203], v[156:159]
    ds_read_b128 a[28:31], v13 offset:0
    v_mfma_f32_16x16x32_bf16 v[156:159], v[28:31], a[204:207], v[156:159]
    s_waitcnt vmcnt(20) lgkmcnt(0)
    s_barrier
    v_mfma_f32_16x16x32_bf16 v[160:163], v[32:35], a[0:3], 0
    ds_read_b64_tr_b16 v[16:17], v6 offset:32768
    s_add_u32 s46, s42, 3145728
    v_mfma_f32_16x16x32_bf16 v[160:163], v[36:39], a[4:7], v[160:163]
    ds_read_b64_tr_b16 v[18:19], v6 offset:33280
    buffer_load_dword v211, v1, s[12:15], s46 offen
    v_mfma_f32_16x16x32_bf16 v[160:163], v[40:43], a[8:11], v[160:163]
    ds_read_b64_tr_b16 v[20:21], v6 offset:36864
    s_waitcnt vmcnt(9)
    v_lshlrev_b32 v184, 16, v176
    v_mfma_f32_16x16x32_bf16 v[160:163], v[44:47], a[12:15], v[160:163]
    ds_read_b128 a[80:83], v10 offset:4096
    v_and_b32 v185, 0xffff0000, v176
    v_mfma_f32_16x16x32_bf16 v[164:167], v[32:35], a[64:67], 0
    ds_read_b64_tr_b16 v[22:23], v6 offset:37376
    v_lshlrev_b32 v186, 16, v177
    v_mfma_f32_16x16x32_bf16 v[164:167], v[36:39], a[68:71], v[164:167]
    ds_read_b64_tr_b16 v[24:25], v6 offset:40960
    v_and_b32 v187, 0xffff0000, v177
    v_mfma_f32_16x16x32_bf16 v[164:167], v[40:43], a[72:75], v[164:167]
    ds_read_b64_tr_b16 v[26:27], v6 offset:41472
    v_lshlrev_b32 v188, 16, v178
    v_mfma_f32_16x16x32_bf16 v[164:167], v[44:47], a[76:79], v[164:167]
    ds_read_b128 a[84:87], v11 offset:4096
    v_and_b32 v189, 0xffff0000, v178
    v_mfma_f32_16x16x32_bf16 v[168:171], v[32:35], a[128:131], 0
    ds_read_b64_tr_b16 v[28:29], v6 offset:45056
    v_lshlrev_b32 v190, 16, v179
    v_mfma_f32_16x16x32_bf16 v[168:171], v[36:39], a[132:135], v[168:171]
    ds_read_b64_tr_b16 v[30:31], v6 offset:45568
    v_and_b32 v191, 0xffff0000, v179
    v_mfma_f32_16x16x32_bf16 v[168:171], v[40:43], a[136:139], v[168:171]
    ds_read_b128 a[88:91], v12 offset:4096
    v_lshlrev_b32 v192, 16, v180
    v_mfma_f32_16x16x32_bf16 v[168:171], v[44:47], a[140:143], v[168:171]
    ds_read_b128 a[92:95], v13 offset:4096
    v_and_b32 v193, 0xffff0000, v180
    v_mfma_f32_16x16x32_bf16 v[172:175], v[32:35], a[192:195], 0
    ds_read_b128 a[144:147], v10 offset:8192
    v_lshlrev_b32 v194, 16, v181
    v_mfma_f32_16x16x32_bf16 v[172:175], v[36:39], a[196:199], v[172:175]
    ds_read_b128 a[148:151], v11 offset:8192
    v_and_b32 v195, 0xffff0000, v181
    v_mfma_f32_16x16x32_bf16 v[172:175], v[40:43], a[200:203], v[172:175]
    ds_read_b128 a[152:155], v12 offset:8192
    v_lshlrev_b32 v196, 16, v182
    v_mfma_f32_16x16x32_bf16 v[172:175], v[44:47], a[204:207], v[172:175]
    ds_read_b128 a[156:159], v13 offset:8192
    v_and_b32 v197, 0xffff0000, v182
    s_waitcnt lgkmcnt(8)
    v_mfma_f32_16x16x32_bf16 v[48:51], v[16:19], a[16:19], v[48:51]
    ds_read_b64_tr_b16 v[32:33], v7 offset:32768
    v_lshlrev_b32 v198, 16, v183
    v_mfma_f32_16x16x32_bf16 v[48:51], v[20:23], a[20:23], v[48:51]
    ds_read_b64_tr_b16 v[34:35], v7 offset:33280
    v_and_b32 v199, 0xffff0000, v183
    v_mfma_f32_16x16x32_bf16 v[48:51], v[24:27], a[24:27], v[48:51]
    ds_read_b64_tr_b16 v[36:37], v7 offset:36864
    s_waitcnt vmcnt(5)
    v_add_f32 v203, v184, v185
    s_waitcnt lgkmcnt(8)
    v_mfma_f32_16x16x32_bf16 v[48:51], v[28:31], a[28:31], v[48:51]
    ds_read_b128 a[208:211], v10 offset:12288
    v_mul_f32 v204, v184, v184
    v_mfma_f32_16x16x32_bf16 v[52:55], v[16:19], a[80:83], v[52:55]
    ds_read_b64_tr_b16 v[38:39], v7 offset:37376
    v_fmac_f32 v204, v185, v185
    v_mfma_f32_16x16x32_bf16 v[52:55], v[20:23], a[84:87], v[52:55]
    ds_read_b64_tr_b16 v[40:41], v7 offset:40960
    v_add_f32 v203, v203, v186
    v_mfma_f32_16x16x32_bf16 v[52:55], v[24:27], a[88:91], v[52:55]
    ds_read_b64_tr_b16 v[42:43], v7 offset:41472
    v_fmac_f32 v204, v186, v186
    s_waitcnt lgkmcnt(8)
    v_mfma_f32_16x16x32_bf16 v[52:55], v[28:31], a[92:95], v[52:55]
    ds_read_b128 a[212:215], v11 offset:12288
    v_add_f32 v203, v203, v187
    v_mfma_f32_16x16x32_bf16 v[56:59], v[16:19], a[144:147], v[56:59]
    ds_read_b64_tr_b16 v[44:45], v7 offset:45056
    v_fmac_f32 v204, v187, v187
    v_mfma_f32_16x16x32_bf16 v[56:59], v[20:23], a[148:151], v[56:59]
    ds_read_b64_tr_b16 v[46:47], v7 offset:45568
    v_add_f32 v203, v203, v188
    v_mfma_f32_16x16x32_bf16 v[56:59], v[24:27], a[152:155], v[56:59]
    ds_read_b128 a[216:219], v12 offset:12288
    v_fmac_f32 v204, v188, v188
    s_waitcnt lgkmcnt(8)
    v_mfma_f32_16x16x32_bf16 v[56:59], v[28:31], a[156:159], v[56:59]
    ds_read_b128 a[220:223], v13 offset:12288
    v_add_f32 v203, v203, v189
    s_waitcnt lgkmcnt(8)
    v_mfma_f32_16x16x32_bf16 v[60:63], v[16:19], a[208:211], v[60:63]
    s_add_u32 m0, s40, 0
    v_fmac_f32 v204, v189, v189
    v_add_f32 v203, v203, v190
    s_waitcnt lgkmcnt(4)
    v_mfma_f32_16x16x32_bf16 v[60:63], v[20:23], a[212:215], v[60:63]
    s_add_u32 s37, s34, 512
    v_fmac_f32 v204, v190, v190
    v_add_f32 v203, v203, v191
    s_waitcnt lgkmcnt(1)
    v_mfma_f32_16x16x32_bf16 v[60:63], v[24:27], a[216:219], v[60:63]
    buffer_load_dwordx4 v2, s[8:11], s37 offen offset:0 lds
    s_waitcnt lgkmcnt(0)
    v_mfma_f32_16x16x32_bf16 v[60:63], v[28:31], a[220:223], v[60:63]
    v_fmac_f32 v204, v191, v191
    v_add_f32 v203, v203, v192
    v_mfma_f32_16x16x32_bf16 v[64:67], v[32:35], a[16:19], v[64:67]
    ds_read_b64_tr_b16 v[16:17], v8 offset:32768
    v_fmac_f32 v204, v192, v192
    v_mfma_f32_16x16x32_bf16 v[64:67], v[36:39], a[20:23], v[64:67]
    ds_read_b64_tr_b16 v[18:19], v8 offset:33280
    v_add_f32 v203, v203, v193
    v_mfma_f32_16x16x32_bf16 v[64:67], v[40:43], a[24:27], v[64:67]
    ds_read_b64_tr_b16 v[20:21], v8 offset:36864
    v_fmac_f32 v204, v193, v193
    v_mfma_f32_16x16x32_bf16 v[64:67], v[44:47], a[28:31], v[64:67]
    buffer_load_dwordx4 v3, s[8:11], s37 offen offset:1024 lds
    v_mfma_f32_16x16x32_bf16 v[68:71], v[32:35], a[80:83], v[68:71]
    ds_read_b64_tr_b16 v[22:23], v8 offset:37376
    v_add_f32 v203, v203, v194
    v_mfma_f32_16x16x32_bf16 v[68:71], v[36:39], a[84:87], v[68:71]
    ds_read_b64_tr_b16 v[24:25], v8 offset:40960
    v_fmac_f32 v204, v194, v194
    v_mfma_f32_16x16x32_bf16 v[68:71], v[40:43], a[88:91], v[68:71]
    ds_read_b64_tr_b16 v[26:27], v8 offset:41472
    v_add_f32 v203, v203, v195
    v_mfma_f32_16x16x32_bf16 v[68:71], v[44:47], a[92:95], v[68:71]
    buffer_load_dwordx4 v4, s[8:11], s37 offen offset:2048 lds
    v_mfma_f32_16x16x32_bf16 v[72:75], v[32:35], a[144:147], v[72:75]
    ds_read_b64_tr_b16 v[28:29], v8 offset:45056
    v_fmac_f32 v204, v195, v195
    v_mfma_f32_16x16x32_bf16 v[72:75], v[36:39], a[148:151], v[72:75]
    ds_read_b64_tr_b16 v[30:31], v8 offset:45568
    v_add_f32 v203, v203, v196
    v_mfma_f32_16x16x32_bf16 v[72:75], v[40:43], a[152:155], v[72:75]
    v_fmac_f32 v204, v196, v196
    v_add_f32 v203, v203, v197
    v_mfma_f32_16x16x32_bf16 v[72:75], v[44:47], a[156:159], v[72:75]
    buffer_load_dwordx4 v5, s[8:11], s37 offen offset:3072 lds
    v_mfma_f32_16x16x32_bf16 v[76:79], v[32:35], a[208:211], v[76:79]
    s_add_u32 m0, s68, 0
    v_fmac_f32 v204, v197, v197
    v_add_f32 v203, v203, v198
    v_mfma_f32_16x16x32_bf16 v[76:79], v[36:39], a[212:215], v[76:79]
    s_add_u32 s37, s35, 2097152
    v_fmac_f32 v204, v198, v198
    v_add_f32 v203, v203, v199
    v_mfma_f32_16x16x32_bf16 v[76:79], v[40:43], a[216:219], v[76:79]
    buffer_load_dwordx4 v248, s[12:15], s37 offen offset:0 lds
    v_mfma_f32_16x16x32_bf16 v[76:79], v[44:47], a[220:223], v[76:79]
    s_waitcnt lgkmcnt(0)
    v_fmac_f32 v204, v199, v199
    v_lshlrev_b32 v202, 2, v0
    v_mfma_f32_16x16x32_bf16 v[80:83], v[16:19], a[16:19], v[80:83]
    ds_read_b64_tr_b16 v[32:33], v9 offset:32768
    v_lshl_add_u32 v202, s3, 8, v202
    v_mfma_f32_16x16x32_bf16 v[80:83], v[20:23], a[20:23], v[80:83]
    ds_read_b64_tr_b16 v[34:35], v9 offset:33280
    v_permlane32_swap_b32 v203, v204
    v_mfma_f32_16x16x32_bf16 v[80:83], v[24:27], a[24:27], v[80:83]
    ds_read_b64_tr_b16 v[36:37], v9 offset:36864
    v_add_f32 v203, v203, v204
    v_mfma_f32_16x16x32_bf16 v[80:83], v[28:31], a[28:31], v[80:83]
    buffer_load_dwordx4 v249, s[12:15], s37 offen offset:1024 lds
    v_mfma_f32_16x16x32_bf16 v[84:87], v[16:19], a[80:83], v[84:87]
    ds_read_b64_tr_b16 v[38:39], v9 offset:37376
    v_mov_b32 v205, v203
    v_mfma_f32_16x16x32_bf16 v[84:87], v[20:23], a[84:87], v[84:87]
    ds_read_b64_tr_b16 v[40:41], v9 offset:40960
    v_add_u32 v202, 131072, v202
    v_mfma_f32_16x16x32_bf16 v[84:87], v[24:27], a[88:91], v[84:87]
    ds_read_b64_tr_b16 v[42:43], v9 offset:41472
    v_lshlrev_b32 v201, 8, v201
    v_mfma_f32_16x16x32_bf16 v[84:87], v[28:31], a[92:95], v[84:87]
    buffer_load_dwordx4 v250, s[12:15], s37 offen offset:2048 lds
    v_mfma_f32_16x16x32_bf16 v[88:91], v[16:19], a[144:147], v[88:91]
    ds_read_b64_tr_b16 v[44:45], v9 offset:45056
    v_permlane16_swap_b32 v203, v205
    v_mfma_f32_16x16x32_bf16 v[88:91], v[20:23], a[148:151], v[88:91]
    ds_read_b64_tr_b16 v[46:47], v9 offset:45568
    v_add_f32 v203, v203, v205
    v_mfma_f32_16x16x32_bf16 v[88:91], v[24:27], a[152:155], v[88:91]
    v_lshl_add_u32 v201, v200, 4, v201
    v_lshlrev_b32 v200, 2, v200
    v_mfma_f32_16x16x32_bf16 v[88:91], v[28:31], a[156:159], v[88:91]
    buffer_load_dwordx4 v251, s[12:15], s37 offen offset:3072 lds
    v_mfma_f32_16x16x32_bf16 v[92:95], v[16:19], a[208:211], v[92:95]
    s_add_u32 m0, s40, 4096
    v_add_f32_dpp v203, v203, v203 row_ror:8 row_mask:0xf bank_mask:0xf
    v_add_u32 v200, 131072, v200
    v_mfma_f32_16x16x32_bf16 v[92:95], v[20:23], a[212:215], v[92:95]
    s_add_u32 s37, s34, 16896
    v_mfma_f32_16x16x32_bf16 v[92:95], v[24:27], a[216:219], v[92:95]
    buffer_load_dwordx4 v2, s[8:11], s37 offen offset:0 lds
    v_mfma_f32_16x16x32_bf16 v[92:95], v[28:31], a[220:223], v[92:95]
    s_waitcnt vmcnt(10) lgkmcnt(0)
    s_barrier
    v_mfma_f32_16x16x32_bf16 v[96:99], v[32:35], a[16:19], v[96:99]
    ds_read_b64_tr_b16 v[16:17], v6 offset:49152
    s_add_u32 s38, s38, s69
    buffer_store_dword v253, v252, s[24:27], s38 offen sc1
    v_mfma_f32_16x16x32_bf16 v[96:99], v[36:39], a[20:23], v[96:99]
    ds_read_b64_tr_b16 v[18:19], v6 offset:49664
    v_mfma_f32_16x16x32_bf16 v[96:99], v[40:43], a[24:27], v[96:99]
    ds_read_b64_tr_b16 v[20:21], v6 offset:53248
    v_mfma_f32_16x16x32_bf16 v[96:99], v[44:47], a[28:31], v[96:99]
    buffer_load_dwordx4 v3, s[8:11], s37 offen offset:1024 lds
    v_mfma_f32_16x16x32_bf16 v[100:103], v[32:35], a[80:83], v[100:103]
    ds_read_b64_tr_b16 v[22:23], v6 offset:53760
    v_mfma_f32_16x16x32_bf16 v[100:103], v[36:39], a[84:87], v[100:103]
    ds_read_b64_tr_b16 v[24:25], v6 offset:57344
    v_mfma_f32_16x16x32_bf16 v[100:103], v[40:43], a[88:91], v[100:103]
    ds_read_b64_tr_b16 v[26:27], v6 offset:57856
    v_mfma_f32_16x16x32_bf16 v[100:103], v[44:47], a[92:95], v[100:103]
    buffer_load_dwordx4 v4, s[8:11], s37 offen offset:2048 lds
    v_mfma_f32_16x16x32_bf16 v[104:107], v[32:35], a[144:147], v[104:107]
    ds_read_b64_tr_b16 v[28:29], v6 offset:61440
    v_mfma_f32_16x16x32_bf16 v[104:107], v[36:39], a[148:151], v[104:107]
    ds_read_b64_tr_b16 v[30:31], v6 offset:61952
    v_mfma_f32_16x16x32_bf16 v[104:107], v[40:43], a[152:155], v[104:107]
    v_mfma_f32_16x16x32_bf16 v[104:107], v[44:47], a[156:159], v[104:107]
    buffer_load_dwordx4 v5, s[8:11], s37 offen offset:3072 lds
    v_mfma_f32_16x16x32_bf16 v[108:111], v[32:35], a[208:211], v[108:111]
    s_add_u32 m0, s40, 8192
    v_mfma_f32_16x16x32_bf16 v[108:111], v[36:39], a[212:215], v[108:111]
    s_add_u32 s37, s34, 33280
    v_mfma_f32_16x16x32_bf16 v[108:111], v[40:43], a[216:219], v[108:111]
    buffer_load_dwordx4 v2, s[8:11], s37 offen offset:0 lds
    v_mfma_f32_16x16x32_bf16 v[108:111], v[44:47], a[220:223], v[108:111]
    s_waitcnt lgkmcnt(0)
    v_mfma_f32_16x16x32_bf16 v[112:115], v[16:19], a[16:19], v[112:115]
    ds_read_b64_tr_b16 v[32:33], v7 offset:49152
    v_mfma_f32_16x16x32_bf16 v[112:115], v[20:23], a[20:23], v[112:115]
    ds_read_b64_tr_b16 v[34:35], v7 offset:49664
    v_mfma_f32_16x16x32_bf16 v[112:115], v[24:27], a[24:27], v[112:115]
    ds_read_b64_tr_b16 v[36:37], v7 offset:53248
    v_mfma_f32_16x16x32_bf16 v[112:115], v[28:31], a[28:31], v[112:115]
    buffer_load_dwordx4 v3, s[8:11], s37 offen offset:1024 lds
    v_mfma_f32_16x16x32_bf16 v[116:119], v[16:19], a[80:83], v[116:119]
    ds_read_b64_tr_b16 v[38:39], v7 offset:53760
    v_mfma_f32_16x16x32_bf16 v[116:119], v[20:23], a[84:87], v[116:119]
    ds_read_b64_tr_b16 v[40:41], v7 offset:57344
    v_mfma_f32_16x16x32_bf16 v[116:119], v[24:27], a[88:91], v[116:119]
    ds_read_b64_tr_b16 v[42:43], v7 offset:57856
    v_mfma_f32_16x16x32_bf16 v[116:119], v[28:31], a[92:95], v[116:119]
    buffer_load_dwordx4 v4, s[8:11], s37 offen offset:2048 lds
    v_mfma_f32_16x16x32_bf16 v[120:123], v[16:19], a[144:147], v[120:123]
    ds_read_b64_tr_b16 v[44:45], v7 offset:61440
    v_mfma_f32_16x16x32_bf16 v[120:123], v[20:23], a[148:151], v[120:123]
    ds_read_b64_tr_b16 v[46:47], v7 offset:61952
    v_mfma_f32_16x16x32_bf16 v[120:123], v[24:27], a[152:155], v[120:123]
    v_mfma_f32_16x16x32_bf16 v[120:123], v[28:31], a[156:159], v[120:123]
    buffer_load_dwordx4 v5, s[8:11], s37 offen offset:3072 lds
    v_mfma_f32_16x16x32_bf16 v[124:127], v[16:19], a[208:211], v[124:127]
    s_add_u32 m0, s40, 12288
    v_mfma_f32_16x16x32_bf16 v[124:127], v[20:23], a[212:215], v[124:127]
    s_add_u32 s37, s34, 49664
    v_mfma_f32_16x16x32_bf16 v[124:127], v[24:27], a[216:219], v[124:127]
    buffer_load_dwordx4 v2, s[8:11], s37 offen offset:0 lds
    v_mfma_f32_16x16x32_bf16 v[124:127], v[28:31], a[220:223], v[124:127]
    s_waitcnt lgkmcnt(0)
    v_mfma_f32_16x16x32_bf16 v[128:131], v[32:35], a[16:19], v[128:131]
    ds_read_b64_tr_b16 v[16:17], v8 offset:49152
    v_mfma_f32_16x16x32_bf16 v[128:131], v[36:39], a[20:23], v[128:131]
    ds_read_b64_tr_b16 v[18:19], v8 offset:49664
    v_mfma_f32_16x16x32_bf16 v[128:131], v[40:43], a[24:27], v[128:131]
    ds_read_b64_tr_b16 v[20:21], v8 offset:53248
    v_mfma_f32_16x16x32_bf16 v[128:131], v[44:47], a[28:31], v[128:131]
    buffer_load_dwordx4 v3, s[8:11], s37 offen offset:1024 lds
    v_mfma_f32_16x16x32_bf16 v[132:135], v[32:35], a[80:83], v[132:135]
    ds_read_b64_tr_b16 v[22:23], v8 offset:53760
    v_mfma_f32_16x16x32_bf16 v[132:135], v[36:39], a[84:87], v[132:135]
    ds_read_b64_tr_b16 v[24:25], v8 offset:57344
    v_mfma_f32_16x16x32_bf16 v[132:135], v[40:43], a[88:91], v[132:135]
    ds_read_b64_tr_b16 v[26:27], v8 offset:57856
    v_mfma_f32_16x16x32_bf16 v[132:135], v[44:47], a[92:95], v[132:135]
    buffer_load_dwordx4 v4, s[8:11], s37 offen offset:2048 lds
    v_mfma_f32_16x16x32_bf16 v[136:139], v[32:35], a[144:147], v[136:139]
    ds_read_b64_tr_b16 v[28:29], v8 offset:61440
    v_mfma_f32_16x16x32_bf16 v[136:139], v[36:39], a[148:151], v[136:139]
    ds_read_b64_tr_b16 v[30:31], v8 offset:61952
    v_mfma_f32_16x16x32_bf16 v[136:139], v[40:43], a[152:155], v[136:139]
    s_lshl_b32 s47, s43, 7
    s_add_u32 s39, s39, s47
    s_add_u32 s39, s39, 39845888
    v_mfma_f32_16x16x32_bf16 v[136:139], v[44:47], a[156:159], v[136:139]
    buffer_load_dwordx4 v5, s[8:11], s37 offen offset:3072 lds
    v_mfma_f32_16x16x32_bf16 v[140:143], v[32:35], a[208:211], v[140:143]
    s_add_u32 m0, s68, 16384
    v_mfma_f32_16x16x32_bf16 v[140:143], v[36:39], a[212:215], v[140:143]
    s_add_u32 s37, s35, 2097280
    v_mfma_f32_16x16x32_bf16 v[140:143], v[40:43], a[216:219], v[140:143]
    buffer_load_dwordx4 v248, s[12:15], s37 offen offset:0 lds
    v_mfma_f32_16x16x32_bf16 v[140:143], v[44:47], a[220:223], v[140:143]
    s_waitcnt lgkmcnt(0)
    v_mfma_f32_16x16x32_bf16 v[144:147], v[16:19], a[16:19], v[144:147]
    ds_read_b64_tr_b16 v[32:33], v9 offset:49152
    v_mfma_f32_16x16x32_bf16 v[144:147], v[20:23], a[20:23], v[144:147]
    ds_read_b64_tr_b16 v[34:35], v9 offset:49664
    v_mfma_f32_16x16x32_bf16 v[144:147], v[24:27], a[24:27], v[144:147]
    ds_read_b64_tr_b16 v[36:37], v9 offset:53248
    v_mfma_f32_16x16x32_bf16 v[144:147], v[28:31], a[28:31], v[144:147]
    buffer_load_dwordx4 v249, s[12:15], s37 offen offset:1024 lds
    v_mfma_f32_16x16x32_bf16 v[148:151], v[16:19], a[80:83], v[148:151]
    ds_read_b64_tr_b16 v[38:39], v9 offset:53760
    v_mfma_f32_16x16x32_bf16 v[148:151], v[20:23], a[84:87], v[148:151]
    ds_read_b64_tr_b16 v[40:41], v9 offset:57344
    v_mfma_f32_16x16x32_bf16 v[148:151], v[24:27], a[88:91], v[148:151]
    ds_read_b64_tr_b16 v[42:43], v9 offset:57856
    v_mfma_f32_16x16x32_bf16 v[148:151], v[28:31], a[92:95], v[148:151]
    buffer_load_dwordx4 v250, s[12:15], s37 offen offset:2048 lds
    v_mfma_f32_16x16x32_bf16 v[152:155], v[16:19], a[144:147], v[152:155]
    ds_read_b64_tr_b16 v[44:45], v9 offset:61440
    ds_write_b32 v202, v203
    v_mfma_f32_16x16x32_bf16 v[152:155], v[20:23], a[148:151], v[152:155]
    ds_read_b64_tr_b16 v[46:47], v9 offset:61952
    s_waitcnt vmcnt(20)
    v_mfma_f32_16x16x32_bf16 v[152:155], v[24:27], a[152:155], v[152:155]
    ds_read_b128 a[32:35], v10 offset:0
    v_mfma_f32_16x16x32_bf16 v[152:155], v[28:31], a[156:159], v[152:155]
    buffer_load_dwordx4 v251, s[12:15], s37 offen offset:3072 lds
    v_mfma_f32_16x16x32_bf16 v[156:159], v[16:19], a[208:211], v[156:159]
    ds_read_b128 a[36:39], v11 offset:0
    v_mfma_f32_16x16x32_bf16 v[156:159], v[20:23], a[212:215], v[156:159]
    ds_read_b128 a[40:43], v12 offset:0
    v_mfma_f32_16x16x32_bf16 v[156:159], v[24:27], a[216:219], v[156:159]
    ds_read_b128 a[44:47], v13 offset:0
    v_mfma_f32_16x16x32_bf16 v[156:159], v[28:31], a[220:223], v[156:159]
    s_waitcnt vmcnt(17) lgkmcnt(0)
    s_barrier
    v_mfma_f32_16x16x32_bf16 v[160:163], v[32:35], a[16:19], v[160:163]
    ds_read_b64_tr_b16 v[16:17], v6 offset:0
    v_mfma_f32_16x16x32_bf16 v[160:163], v[36:39], a[20:23], v[160:163]
    ds_read_b64_tr_b16 v[18:19], v6 offset:512
    buffer_load_dword v212, v223, s[16:19], s42 offen
    v_mfma_f32_16x16x32_bf16 v[160:163], v[40:43], a[24:27], v[160:163]
    ds_read_b64_tr_b16 v[20:21], v6 offset:4096
    s_waitcnt vmcnt(9)
    v_mfma_f32_16x16x32_bf16 v[160:163], v[44:47], a[28:31], v[160:163]
    ds_read_b128 a[96:99], v10 offset:4096
    v_mfma_f32_16x16x32_bf16 v[164:167], v[32:35], a[80:83], v[164:167]
    ds_read_b64_tr_b16 v[22:23], v6 offset:4608
    ds_read2_b32 v[176:177], v200 offset0:0 offset1:32
    ds_read2_b32 v[178:179], v200 offset0:64 offset1:96
    ds_read2_b32 v[180:181], v200 offset0:128 offset1:160
    ds_read2_b32 v[182:183], v200 offset0:192 offset1:224
    v_mfma_f32_16x16x32_bf16 v[164:167], v[36:39], a[84:87], v[164:167]
    ds_read_b64_tr_b16 v[24:25], v6 offset:8192
    v_mfma_f32_16x16x32_bf16 v[164:167], v[40:43], a[88:91], v[164:167]
    ds_read_b64_tr_b16 v[26:27], v6 offset:8704
    v_mfma_f32_16x16x32_bf16 v[164:167], v[44:47], a[92:95], v[164:167]
    ds_read_b128 a[100:103], v11 offset:4096
    v_mfma_f32_16x16x32_bf16 v[168:171], v[32:35], a[144:147], v[168:171]
    ds_read_b64_tr_b16 v[28:29], v6 offset:12288
    v_mfma_f32_16x16x32_bf16 v[168:171], v[36:39], a[148:151], v[168:171]
    ds_read_b64_tr_b16 v[30:31], v6 offset:12800
    v_mfma_f32_16x16x32_bf16 v[168:171], v[40:43], a[152:155], v[168:171]
    ds_read_b128 a[104:107], v12 offset:4096
    v_mfma_f32_16x16x32_bf16 v[168:171], v[44:47], a[156:159], v[168:171]
    ds_read_b128 a[108:111], v13 offset:4096
    v_mfma_f32_16x16x32_bf16 v[172:175], v[32:35], a[208:211], v[172:175]
    ds_read_b128 a[160:163], v10 offset:8192
    v_mfma_f32_16x16x32_bf16 v[172:175], v[36:39], a[212:215], v[172:175]
    ds_read_b128 a[164:167], v11 offset:8192
    v_mfma_f32_16x16x32_bf16 v[172:175], v[40:43], a[216:219], v[172:175]
    ds_read_b128 a[168:171], v12 offset:8192
    v_mfma_f32_16x16x32_bf16 v[172:175], v[44:47], a[220:223], v[172:175]
    ds_read_b128 a[172:175], v13 offset:8192
    s_waitcnt lgkmcnt(8)
    v_mfma_f32_16x16x32_bf16 v[48:51], v[16:19], a[32:35], v[48:51]
    ds_read_b64_tr_b16 v[32:33], v7 offset:0
    v_mfma_f32_16x16x32_bf16 v[48:51], v[20:23], a[36:39], v[48:51]
    ds_read_b64_tr_b16 v[34:35], v7 offset:512
    v_mfma_f32_16x16x32_bf16 v[48:51], v[24:27], a[40:43], v[48:51]
    ds_read_b64_tr_b16 v[36:37], v7 offset:4096
    s_waitcnt vmcnt(5)
    s_waitcnt lgkmcnt(8)
    v_mfma_f32_16x16x32_bf16 v[48:51], v[28:31], a[44:47], v[48:51]
    ds_read_b128 a[224:227], v10 offset:12288
    v_add_f32 v203, v176, v178
    v_mfma_f32_16x16x32_bf16 v[52:55], v[16:19], a[96:99], v[52:55]
    ds_read_b64_tr_b16 v[38:39], v7 offset:4608
    v_add_f32 v204, v177, v179
    v_mfma_f32_16x16x32_bf16 v[52:55], v[20:23], a[100:103], v[52:55]
    ds_read_b64_tr_b16 v[40:41], v7 offset:8192
    v_add_f32 v203, v203, v180
    v_mfma_f32_16x16x32_bf16 v[52:55], v[24:27], a[104:107], v[52:55]
    ds_read_b64_tr_b16 v[42:43], v7 offset:8704
    v_add_f32 v204, v204, v181
    s_waitcnt lgkmcnt(8)
    v_mfma_f32_16x16x32_bf16 v[52:55], v[28:31], a[108:111], v[52:55]
    ds_read_b128 a[228:231], v11 offset:12288
    v_add_f32 v203, v203, v182
    v_mfma_f32_16x16x32_bf16 v[56:59], v[16:19], a[160:163], v[56:59]
    ds_read_b64_tr_b16 v[44:45], v7 offset:12288
    v_add_f32 v204, v204, v183
    v_mfma_f32_16x16x32_bf16 v[56:59], v[20:23], a[164:167], v[56:59]
    ds_read_b64_tr_b16 v[46:47], v7 offset:12800
    v_mul_f32 v203, 0x3b000000, v203
    v_mfma_f32_16x16x32_bf16 v[56:59], v[24:27], a[168:171], v[56:59]
    ds_read_b128 a[232:235], v12 offset:12288
    v_mul_f32 v204, 0x3b000000, v204
    s_waitcnt lgkmcnt(8)
    v_mfma_f32_16x16x32_bf16 v[56:59], v[28:31], a[172:175], v[56:59]
    ds_read_b128 a[236:239], v13 offset:12288
    v_fma_f32 v204, -v203, v203, v204
    s_waitcnt lgkmcnt(8)
    v_mfma_f32_16x16x32_bf16 v[60:63], v[16:19], a[224:227], v[60:63]
    s_add_u32 m0, s40, 0
    v_max_f32 v204, 0, v204
    v_add_f32 v204, 0x3727c5ac, v204
    s_waitcnt lgkmcnt(4)
    v_mfma_f32_16x16x32_bf16 v[60:63], v[20:23], a[228:231], v[60:63]
    s_add_u32 s37, s34, 768
    v_rsq_f32 v204, v204
    s_waitcnt lgkmcnt(1)
    v_mfma_f32_16x16x32_bf16 v[60:63], v[24:27], a[232:235], v[60:63]
    buffer_load_dwordx4 v2, s[8:11], s37 offen offset:0 lds
    s_waitcnt lgkmcnt(0)
    v_mfma_f32_16x16x32_bf16 v[60:63], v[28:31], a[236:239], v[60:63]
    v_mul_f32 v204, 0x3e0293ee, v204
    v_mul_f32 v203, v203, v204
    v_mfma_f32_16x16x32_bf16 v[64:67], v[32:35], a[32:35], v[64:67]
    ds_read_b64_tr_b16 v[16:17], v8 offset:0
    v_fma_f32 v184, v184, v204, -v203
    v_mfma_f32_16x16x32_bf16 v[64:67], v[36:39], a[36:39], v[64:67]
    ds_read_b64_tr_b16 v[18:19], v8 offset:512
    v_fma_f32 v185, v185, v204, -v203
    v_mfma_f32_16x16x32_bf16 v[64:67], v[40:43], a[40:43], v[64:67]
    ds_read_b64_tr_b16 v[20:21], v8 offset:4096
    v_fma_f32 v186, v186, v204, -v203
    v_mfma_f32_16x16x32_bf16 v[64:67], v[44:47], a[44:47], v[64:67]
    buffer_load_dwordx4 v3, s[8:11], s37 offen offset:1024 lds
    v_mfma_f32_16x16x32_bf16 v[68:71], v[32:35], a[96:99], v[68:71]
    ds_read_b64_tr_b16 v[22:23], v8 offset:4608
    v_fma_f32 v187, v187, v204, -v203
    v_mfma_f32_16x16x32_bf16 v[68:71], v[36:39], a[100:103], v[68:71]
    ds_read_b64_tr_b16 v[24:25], v8 offset:8192
    v_fma_f32 v188, v188, v204, -v203
    v_mfma_f32_16x16x32_bf16 v[68:71], v[40:43], a[104:107], v[68:71]
    ds_read_b64_tr_b16 v[26:27], v8 offset:8704
    v_fma_f32 v189, v189, v204, -v203
    v_mfma_f32_16x16x32_bf16 v[68:71], v[44:47], a[108:111], v[68:71]
    buffer_load_dwordx4 v4, s[8:11], s37 offen offset:2048 lds
    v_mfma_f32_16x16x32_bf16 v[72:75], v[32:35], a[160:163], v[72:75]
    ds_read_b64_tr_b16 v[28:29], v8 offset:12288
    v_fma_f32 v190, v190, v204, -v203
    v_mfma_f32_16x16x32_bf16 v[72:75], v[36:39], a[164:167], v[72:75]
    ds_read_b64_tr_b16 v[30:31], v8 offset:12800
    v_fma_f32 v191, v191, v204, -v203
    v_mfma_f32_16x16x32_bf16 v[72:75], v[40:43], a[168:171], v[72:75]
    v_fma_f32 v192, v192, v204, -v203
    v_fma_f32 v193, v193, v204, -v203
    v_mfma_f32_16x16x32_bf16 v[72:75], v[44:47], a[172:175], v[72:75]
    buffer_load_dwordx4 v5, s[8:11], s37 offen offset:3072 lds
    v_mfma_f32_16x16x32_bf16 v[76:79], v[32:35], a[224:227], v[76:79]
    s_add_u32 m0, s68, 32768
    v_fma_f32 v194, v194, v204, -v203
    v_fma_f32 v195, v195, v204, -v203
    v_mfma_f32_16x16x32_bf16 v[76:79], v[36:39], a[228:231], v[76:79]
    s_add_u32 s37, s35, 3145728
    v_fma_f32 v196, v196, v204, -v203
    v_fma_f32 v197, v197, v204, -v203
    v_mfma_f32_16x16x32_bf16 v[76:79], v[40:43], a[232:235], v[76:79]
    buffer_load_dwordx4 v248, s[12:15], s37 offen offset:0 lds
    v_mfma_f32_16x16x32_bf16 v[76:79], v[44:47], a[236:239], v[76:79]
    s_waitcnt lgkmcnt(0)
    v_fma_f32 v198, v198, v204, -v203
    v_fma_f32 v199, v199, v204, -v203
    v_mfma_f32_16x16x32_bf16 v[80:83], v[16:19], a[32:35], v[80:83]
    ds_read_b64_tr_b16 v[32:33], v9 offset:0
    v_cvt_pk_bf16_f32 v176, v184, v185
    v_mfma_f32_16x16x32_bf16 v[80:83], v[20:23], a[36:39], v[80:83]
    ds_read_b64_tr_b16 v[34:35], v9 offset:512
    v_cvt_pk_bf16_f32 v177, v186, v187
    v_mfma_f32_16x16x32_bf16 v[80:83], v[24:27], a[40:43], v[80:83]
    ds_read_b64_tr_b16 v[36:37], v9 offset:4096
    v_cvt_pk_bf16_f32 v178, v188, v189
    v_mfma_f32_16x16x32_bf16 v[80:83], v[28:31], a[44:47], v[80:83]
    buffer_load_dwordx4 v249, s[12:15], s37 offen offset:1024 lds
    v_mfma_f32_16x16x32_bf16 v[84:87], v[16:19], a[96:99], v[84:87]
    ds_read_b64_tr_b16 v[38:39], v9 offset:4608
    v_cvt_pk_bf16_f32 v179, v190, v191
    v_mfma_f32_16x16x32_bf16 v[84:87], v[20:23], a[100:103], v[84:87]
    ds_read_b64_tr_b16 v[40:41], v9 offset:8192
    v_cvt_pk_bf16_f32 v180, v192, v193
    v_mfma_f32_16x16x32_bf16 v[84:87], v[24:27], a[104:107], v[84:87]
    ds_read_b64_tr_b16 v[42:43], v9 offset:8704
    v_cvt_pk_bf16_f32 v181, v194, v195
    v_mfma_f32_16x16x32_bf16 v[84:87], v[28:31], a[108:111], v[84:87]
    buffer_load_dwordx4 v250, s[12:15], s37 offen offset:2048 lds
    v_mfma_f32_16x16x32_bf16 v[88:91], v[16:19], a[160:163], v[88:91]
    ds_read_b64_tr_b16 v[44:45], v9 offset:12288
    v_cvt_pk_bf16_f32 v182, v196, v197
    v_mfma_f32_16x16x32_bf16 v[88:91], v[20:23], a[164:167], v[88:91]
    ds_read_b64_tr_b16 v[46:47], v9 offset:12800
    v_cvt_pk_bf16_f32 v183, v198, v199
    v_mfma_f32_16x16x32_bf16 v[88:91], v[24:27], a[168:171], v[88:91]
    v_mfma_f32_16x16x32_bf16 v[88:91], v[28:31], a[172:175], v[88:91]
    buffer_load_dwordx4 v251, s[12:15], s37 offen offset:3072 lds
    v_mfma_f32_16x16x32_bf16 v[92:95], v[16:19], a[224:227], v[92:95]
    s_add_u32 m0, s40, 4096
    v_mfma_f32_16x16x32_bf16 v[92:95], v[20:23], a[228:231], v[92:95]
    s_add_u32 s37, s34, 17152
    v_mfma_f32_16x16x32_bf16 v[92:95], v[24:27], a[232:235], v[92:95]
    buffer_load_dwordx4 v2, s[8:11], s37 offen offset:0 lds
    v_mfma_f32_16x16x32_bf16 v[92:95], v[28:31], a[236:239], v[92:95]
    s_waitcnt vmcnt(10) lgkmcnt(0)
    s_barrier
    v_mfma_f32_16x16x32_bf16 v[96:99], v[32:35], a[32:35], v[96:99]
    ds_read_b64_tr_b16 v[16:17], v6 offset:16384
    v_mfma_f32_16x16x32_bf16 v[96:99], v[36:39], a[36:39], v[96:99]
    ds_read_b64_tr_b16 v[18:19], v6 offset:16896
    v_mfma_f32_16x16x32_bf16 v[96:99], v[40:43], a[40:43], v[96:99]
    ds_read_b64_tr_b16 v[20:21], v6 offset:20480
    v_mfma_f32_16x16x32_bf16 v[96:99], v[44:47], a[44:47], v[96:99]
    buffer_load_dwordx4 v3, s[8:11], s37 offen offset:1024 lds
    v_mfma_f32_16x16x32_bf16 v[100:103], v[32:35], a[96:99], v[100:103]
    ds_read_b64_tr_b16 v[22:23], v6 offset:20992
    v_mfma_f32_16x16x32_bf16 v[100:103], v[36:39], a[100:103], v[100:103]
    ds_read_b64_tr_b16 v[24:25], v6 offset:24576
    v_mfma_f32_16x16x32_bf16 v[100:103], v[40:43], a[104:107], v[100:103]
    ds_read_b64_tr_b16 v[26:27], v6 offset:25088
    v_mfma_f32_16x16x32_bf16 v[100:103], v[44:47], a[108:111], v[100:103]
    buffer_load_dwordx4 v4, s[8:11], s37 offen offset:2048 lds
    v_mfma_f32_16x16x32_bf16 v[104:107], v[32:35], a[160:163], v[104:107]
    ds_read_b64_tr_b16 v[28:29], v6 offset:28672
    v_mfma_f32_16x16x32_bf16 v[104:107], v[36:39], a[164:167], v[104:107]
    ds_read_b64_tr_b16 v[30:31], v6 offset:29184
    v_mfma_f32_16x16x32_bf16 v[104:107], v[40:43], a[168:171], v[104:107]
    v_mfma_f32_16x16x32_bf16 v[104:107], v[44:47], a[172:175], v[104:107]
    buffer_load_dwordx4 v5, s[8:11], s37 offen offset:3072 lds
    v_mfma_f32_16x16x32_bf16 v[108:111], v[32:35], a[224:227], v[108:111]
    s_add_u32 m0, s40, 8192
    v_mfma_f32_16x16x32_bf16 v[108:111], v[36:39], a[228:231], v[108:111]
    s_add_u32 s37, s34, 33536
    v_mfma_f32_16x16x32_bf16 v[108:111], v[40:43], a[232:235], v[108:111]
    buffer_load_dwordx4 v2, s[8:11], s37 offen offset:0 lds
    v_mfma_f32_16x16x32_bf16 v[108:111], v[44:47], a[236:239], v[108:111]
    s_waitcnt lgkmcnt(0)
    v_mfma_f32_16x16x32_bf16 v[112:115], v[16:19], a[32:35], v[112:115]
    ds_read_b64_tr_b16 v[32:33], v7 offset:16384
    v_mfma_f32_16x16x32_bf16 v[112:115], v[20:23], a[36:39], v[112:115]
    ds_read_b64_tr_b16 v[34:35], v7 offset:16896
    v_mfma_f32_16x16x32_bf16 v[112:115], v[24:27], a[40:43], v[112:115]
    ds_read_b64_tr_b16 v[36:37], v7 offset:20480
    v_mfma_f32_16x16x32_bf16 v[112:115], v[28:31], a[44:47], v[112:115]
    buffer_load_dwordx4 v3, s[8:11], s37 offen offset:1024 lds
    v_mfma_f32_16x16x32_bf16 v[116:119], v[16:19], a[96:99], v[116:119]
    ds_read_b64_tr_b16 v[38:39], v7 offset:20992
    v_mfma_f32_16x16x32_bf16 v[116:119], v[20:23], a[100:103], v[116:119]
    ds_read_b64_tr_b16 v[40:41], v7 offset:24576
    v_mfma_f32_16x16x32_bf16 v[116:119], v[24:27], a[104:107], v[116:119]
    ds_read_b64_tr_b16 v[42:43], v7 offset:25088
    v_mfma_f32_16x16x32_bf16 v[116:119], v[28:31], a[108:111], v[116:119]
    buffer_load_dwordx4 v4, s[8:11], s37 offen offset:2048 lds
    v_mfma_f32_16x16x32_bf16 v[120:123], v[16:19], a[160:163], v[120:123]
    ds_read_b64_tr_b16 v[44:45], v7 offset:28672
    v_mfma_f32_16x16x32_bf16 v[120:123], v[20:23], a[164:167], v[120:123]
    ds_read_b64_tr_b16 v[46:47], v7 offset:29184
    v_mfma_f32_16x16x32_bf16 v[120:123], v[24:27], a[168:171], v[120:123]
    v_mfma_f32_16x16x32_bf16 v[120:123], v[28:31], a[172:175], v[120:123]
    buffer_load_dwordx4 v5, s[8:11], s37 offen offset:3072 lds
    v_mfma_f32_16x16x32_bf16 v[124:127], v[16:19], a[224:227], v[124:127]
    s_add_u32 m0, s40, 12288
    v_mfma_f32_16x16x32_bf16 v[124:127], v[20:23], a[228:231], v[124:127]
    s_add_u32 s37, s34, 49920
    v_mfma_f32_16x16x32_bf16 v[124:127], v[24:27], a[232:235], v[124:127]
    buffer_load_dwordx4 v2, s[8:11], s37 offen offset:0 lds
    v_mfma_f32_16x16x32_bf16 v[124:127], v[28:31], a[236:239], v[124:127]
    s_waitcnt lgkmcnt(0)
    v_mfma_f32_16x16x32_bf16 v[128:131], v[32:35], a[32:35], v[128:131]
    ds_read_b64_tr_b16 v[16:17], v8 offset:16384
    v_mfma_f32_16x16x32_bf16 v[128:131], v[36:39], a[36:39], v[128:131]
    ds_read_b64_tr_b16 v[18:19], v8 offset:16896
    v_mfma_f32_16x16x32_bf16 v[128:131], v[40:43], a[40:43], v[128:131]
    ds_read_b64_tr_b16 v[20:21], v8 offset:20480
    v_mfma_f32_16x16x32_bf16 v[128:131], v[44:47], a[44:47], v[128:131]
    buffer_load_dwordx4 v3, s[8:11], s37 offen offset:1024 lds
    v_mfma_f32_16x16x32_bf16 v[132:135], v[32:35], a[96:99], v[132:135]
    ds_read_b64_tr_b16 v[22:23], v8 offset:20992
    v_mfma_f32_16x16x32_bf16 v[132:135], v[36:39], a[100:103], v[132:135]
    ds_read_b64_tr_b16 v[24:25], v8 offset:24576
    v_mfma_f32_16x16x32_bf16 v[132:135], v[40:43], a[104:107], v[132:135]
    ds_read_b64_tr_b16 v[26:27], v8 offset:25088
    v_mfma_f32_16x16x32_bf16 v[132:135], v[44:47], a[108:111], v[132:135]
    buffer_load_dwordx4 v4, s[8:11], s37 offen offset:2048 lds
    v_mfma_f32_16x16x32_bf16 v[136:139], v[32:35], a[160:163], v[136:139]
    ds_read_b64_tr_b16 v[28:29], v8 offset:28672
    v_mfma_f32_16x16x32_bf16 v[136:139], v[36:39], a[164:167], v[136:139]
    ds_read_b64_tr_b16 v[30:31], v8 offset:29184
    v_mfma_f32_16x16x32_bf16 v[136:139], v[40:43], a[168:171], v[136:139]
    s_lshr_b32 s44, s2, 4
    s_lshl_b32 s44, s44, 7
    s_and_b32 s47, s2, 15
    v_mfma_f32_16x16x32_bf16 v[136:139], v[44:47], a[172:175], v[136:139]
    buffer_load_dwordx4 v5, s[8:11], s37 offen offset:3072 lds
    v_mfma_f32_16x16x32_bf16 v[140:143], v[32:35], a[224:227], v[140:143]
    s_add_u32 m0, s68, 49152
    v_mfma_f32_16x16x32_bf16 v[140:143], v[36:39], a[228:231], v[140:143]
    s_add_u32 s37, s35, 3145856
    v_mfma_f32_16x16x32_bf16 v[140:143], v[40:43], a[232:235], v[140:143]
    buffer_load_dwordx4 v248, s[12:15], s37 offen offset:0 lds
    v_mfma_f32_16x16x32_bf16 v[140:143], v[44:47], a[236:239], v[140:143]
    s_waitcnt lgkmcnt(0)
    v_mfma_f32_16x16x32_bf16 v[144:147], v[16:19], a[32:35], v[144:147]
    ds_read_b64_tr_b16 v[32:33], v9 offset:16384
    buffer_load_dword v254, v252, s[24:27], 0 offen sc1
    v_mfma_f32_16x16x32_bf16 v[144:147], v[20:23], a[36:39], v[144:147]
    ds_read_b64_tr_b16 v[34:35], v9 offset:16896
    v_mfma_f32_16x16x32_bf16 v[144:147], v[24:27], a[40:43], v[144:147]
    ds_read_b64_tr_b16 v[36:37], v9 offset:20480
    v_mfma_f32_16x16x32_bf16 v[144:147], v[28:31], a[44:47], v[144:147]
    buffer_load_dwordx4 v249, s[12:15], s37 offen offset:1024 lds
    v_mfma_f32_16x16x32_bf16 v[148:151], v[16:19], a[96:99], v[148:151]
    ds_read_b64_tr_b16 v[38:39], v9 offset:20992
    v_mfma_f32_16x16x32_bf16 v[148:151], v[20:23], a[100:103], v[148:151]
    ds_read_b64_tr_b16 v[40:41], v9 offset:24576
    v_mfma_f32_16x16x32_bf16 v[148:151], v[24:27], a[104:107], v[148:151]
    ds_read_b64_tr_b16 v[42:43], v9 offset:25088
    v_mfma_f32_16x16x32_bf16 v[148:151], v[28:31], a[108:111], v[148:151]
    buffer_load_dwordx4 v250, s[12:15], s37 offen offset:2048 lds
    v_mfma_f32_16x16x32_bf16 v[152:155], v[16:19], a[160:163], v[152:155]
    ds_read_b64_tr_b16 v[44:45], v9 offset:28672
    v_mfma_f32_16x16x32_bf16 v[152:155], v[20:23], a[164:167], v[152:155]
    ds_read_b64_tr_b16 v[46:47], v9 offset:29184
    s_waitcnt vmcnt(20)
    v_mfma_f32_16x16x32_bf16 v[152:155], v[24:27], a[168:171], v[152:155]
    ds_read_b128 a[48:51], v10 offset:0
    v_mfma_f32_16x16x32_bf16 v[152:155], v[28:31], a[172:175], v[152:155]
    buffer_load_dwordx4 v251, s[12:15], s37 offen offset:3072 lds
    v_mfma_f32_16x16x32_bf16 v[156:159], v[16:19], a[224:227], v[156:159]
    ds_read_b128 a[52:55], v11 offset:0
    v_mfma_f32_16x16x32_bf16 v[156:159], v[20:23], a[228:231], v[156:159]
    ds_read_b128 a[56:59], v12 offset:0
    v_mfma_f32_16x16x32_bf16 v[156:159], v[24:27], a[232:235], v[156:159]
    ds_read_b128 a[60:63], v13 offset:0
    v_mfma_f32_16x16x32_bf16 v[156:159], v[28:31], a[236:239], v[156:159]
    s_waitcnt vmcnt(17) lgkmcnt(0)
    s_barrier
    v_mfma_f32_16x16x32_bf16 v[160:163], v[32:35], a[32:35], v[160:163]
    ds_read_b64_tr_b16 v[16:17], v6 offset:32768
    s_add_u32 s46, s42, 2097152
    v_mfma_f32_16x16x32_bf16 v[160:163], v[36:39], a[36:39], v[160:163]
    ds_read_b64_tr_b16 v[18:19], v6 offset:33280
    buffer_load_dword v213, v223, s[16:19], s46 offen
    v_mfma_f32_16x16x32_bf16 v[160:163], v[40:43], a[40:43], v[160:163]
    ds_read_b64_tr_b16 v[20:21], v6 offset:36864
    s_waitcnt vmcnt(10)
    buffer_store_dwordx4 v[176:179], v201, s[4:7], s39 offen sc1
    v_mfma_f32_16x16x32_bf16 v[160:163], v[44:47], a[44:47], v[160:163]
    ds_read_b128 a[112:115], v10 offset:4096
    v_mfma_f32_16x16x32_bf16 v[164:167], v[32:35], a[96:99], v[164:167]
    ds_read_b64_tr_b16 v[22:23], v6 offset:37376
    buffer_store_dwordx4 v[180:183], v201, s[4:7], s39 offen offset:2048 sc1
    v_mfma_f32_16x16x32_bf16 v[164:167], v[36:39], a[100:103], v[164:167]
    ds_read_b64_tr_b16 v[24:25], v6 offset:40960
    v_mfma_f32_16x16x32_bf16 v[164:167], v[40:43], a[104:107], v[164:167]
    ds_read_b64_tr_b16 v[26:27], v6 offset:41472
    v_mfma_f32_16x16x32_bf16 v[164:167], v[44:47], a[108:111], v[164:167]
    ds_read_b128 a[116:119], v11 offset:4096
    v_mfma_f32_16x16x32_bf16 v[168:171], v[32:35], a[160:163], v[168:171]
    ds_read_b64_tr_b16 v[28:29], v6 offset:45056
    v_mfma_f32_16x16x32_bf16 v[168:171], v[36:39], a[164:167], v[168:171]
    ds_read_b64_tr_b16 v[30:31], v6 offset:45568
    v_mfma_f32_16x16x32_bf16 v[168:171], v[40:43], a[168:171], v[168:171]
    ds_read_b128 a[120:123], v12 offset:4096
    v_mfma_f32_16x16x32_bf16 v[168:171], v[44:47], a[172:175], v[168:171]
    ds_read_b128 a[124:127], v13 offset:4096
    v_mfma_f32_16x16x32_bf16 v[172:175], v[32:35], a[224:227], v[172:175]
    ds_read_b128 a[176:179], v10 offset:8192
    v_mfma_f32_16x16x32_bf16 v[172:175], v[36:39], a[228:231], v[172:175]
    ds_read_b128 a[180:183], v11 offset:8192
    v_mfma_f32_16x16x32_bf16 v[172:175], v[40:43], a[232:235], v[172:175]
    ds_read_b128 a[184:187], v12 offset:8192
    v_mfma_f32_16x16x32_bf16 v[172:175], v[44:47], a[236:239], v[172:175]
    ds_read_b128 a[188:191], v13 offset:8192
    s_waitcnt lgkmcnt(8)
    v_mfma_f32_16x16x32_bf16 v[48:51], v[16:19], a[48:51], v[48:51]
    ds_read_b64_tr_b16 v[32:33], v7 offset:32768
    v_mfma_f32_16x16x32_bf16 v[48:51], v[20:23], a[52:55], v[48:51]
    ds_read_b64_tr_b16 v[34:35], v7 offset:33280
    buffer_load_dword v214, v223, s[28:31], s42 offen
    v_mfma_f32_16x16x32_bf16 v[48:51], v[24:27], a[56:59], v[48:51]
    ds_read_b64_tr_b16 v[36:37], v7 offset:36864
    s_waitcnt vmcnt(9)
    s_waitcnt lgkmcnt(8)
    v_mfma_f32_16x16x32_bf16 v[48:51], v[28:31], a[60:63], v[48:51]
    ds_read_b128 a[240:243], v10 offset:12288
    v_mfma_f32_16x16x32_bf16 v[52:55], v[16:19], a[112:115], v[52:55]
    ds_read_b64_tr_b16 v[38:39], v7 offset:37376
    v_mfma_f32_16x16x32_bf16 v[52:55], v[20:23], a[116:119], v[52:55]
    ds_read_b64_tr_b16 v[40:41], v7 offset:40960
    v_mfma_f32_16x16x32_bf16 v[52:55], v[24:27], a[120:123], v[52:55]
    ds_read_b64_tr_b16 v[42:43], v7 offset:41472
    s_waitcnt lgkmcnt(8)
    v_mfma_f32_16x16x32_bf16 v[52:55], v[28:31], a[124:127], v[52:55]
    ds_read_b128 a[244:247], v11 offset:12288
    v_mfma_f32_16x16x32_bf16 v[56:59], v[16:19], a[176:179], v[56:59]
    ds_read_b64_tr_b16 v[44:45], v7 offset:45056
    v_mfma_f32_16x16x32_bf16 v[56:59], v[20:23], a[180:183], v[56:59]
    ds_read_b64_tr_b16 v[46:47], v7 offset:45568
    v_mfma_f32_16x16x32_bf16 v[56:59], v[24:27], a[184:187], v[56:59]
    ds_read_b128 a[248:251], v12 offset:12288
    s_waitcnt lgkmcnt(8)
    v_mfma_f32_16x16x32_bf16 v[56:59], v[28:31], a[188:191], v[56:59]
    ds_read_b128 a[252:255], v13 offset:12288
    s_waitcnt lgkmcnt(8)
    v_mfma_f32_16x16x32_bf16 v[60:63], v[16:19], a[240:243], v[60:63]
    s_add_u32 m0, s68, 0
    s_lshl_b32 s47, s47, 2
    s_waitcnt lgkmcnt(4)
    v_mfma_f32_16x16x32_bf16 v[60:63], v[20:23], a[244:247], v[60:63]
    s_add_u32 s37, s35, 128
    s_waitcnt lgkmcnt(1)
    v_mfma_f32_16x16x32_bf16 v[60:63], v[24:27], a[248:251], v[60:63]
    buffer_load_dwordx4 v248, s[16:19], s37 offen offset:0 lds
    s_waitcnt lgkmcnt(0)
    v_mfma_f32_16x16x32_bf16 v[60:63], v[28:31], a[252:255], v[60:63]
    v_mfma_f32_16x16x32_bf16 v[64:67], v[32:35], a[48:51], v[64:67]
    ds_read_b64_tr_b16 v[16:17], v8 offset:32768
    v_mfma_f32_16x16x32_bf16 v[64:67], v[36:39], a[52:55], v[64:67]
    ds_read_b64_tr_b16 v[18:19], v8 offset:33280
    v_mfma_f32_16x16x32_bf16 v[64:67], v[40:43], a[56:59], v[64:67]
    ds_read_b64_tr_b16 v[20:21], v8 offset:36864
    v_mfma_f32_16x16x32_bf16 v[64:67], v[44:47], a[60:63], v[64:67]
    buffer_load_dwordx4 v249, s[16:19], s37 offen offset:1024 lds
    v_mfma_f32_16x16x32_bf16 v[68:71], v[32:35], a[112:115], v[68:71]
    ds_read_b64_tr_b16 v[22:23], v8 offset:37376
    v_mfma_f32_16x16x32_bf16 v[68:71], v[36:39], a[116:119], v[68:71]
    ds_read_b64_tr_b16 v[24:25], v8 offset:40960
    v_mfma_f32_16x16x32_bf16 v[68:71], v[40:43], a[120:123], v[68:71]
    ds_read_b64_tr_b16 v[26:27], v8 offset:41472
    v_mfma_f32_16x16x32_bf16 v[68:71], v[44:47], a[124:127], v[68:71]
    buffer_load_dwordx4 v250, s[16:19], s37 offen offset:2048 lds
    v_mfma_f32_16x16x32_bf16 v[72:75], v[32:35], a[176:179], v[72:75]
    ds_read_b64_tr_b16 v[28:29], v8 offset:45056
    v_mfma_f32_16x16x32_bf16 v[72:75], v[36:39], a[180:183], v[72:75]
    ds_read_b64_tr_b16 v[30:31], v8 offset:45568
    v_mfma_f32_16x16x32_bf16 v[72:75], v[40:43], a[184:187], v[72:75]
    s_add_u32 s44, s44, s47
    s_add_u32 s44, s44, 74448896
    v_mfma_f32_16x16x32_bf16 v[72:75], v[44:47], a[188:191], v[72:75]
    buffer_load_dwordx4 v251, s[16:19], s37 offen offset:3072 lds
    v_mfma_f32_16x16x32_bf16 v[76:79], v[32:35], a[240:243], v[76:79]
    s_add_u32 m0, s68, 16384
    v_mfma_f32_16x16x32_bf16 v[76:79], v[36:39], a[244:247], v[76:79]
    s_add_u32 s37, s35, 1048704
    v_mfma_f32_16x16x32_bf16 v[76:79], v[40:43], a[248:251], v[76:79]
    buffer_load_dwordx4 v248, s[16:19], s37 offen offset:0 lds
    v_mfma_f32_16x16x32_bf16 v[76:79], v[44:47], a[252:255], v[76:79]
    s_waitcnt lgkmcnt(0)
    v_mfma_f32_16x16x32_bf16 v[80:83], v[16:19], a[48:51], v[80:83]
    ds_read_b64_tr_b16 v[32:33], v9 offset:32768
    v_mfma_f32_16x16x32_bf16 v[80:83], v[20:23], a[52:55], v[80:83]
    ds_read_b64_tr_b16 v[34:35], v9 offset:33280
    v_mfma_f32_16x16x32_bf16 v[80:83], v[24:27], a[56:59], v[80:83]
    ds_read_b64_tr_b16 v[36:37], v9 offset:36864
    v_mfma_f32_16x16x32_bf16 v[80:83], v[28:31], a[60:63], v[80:83]
    buffer_load_dwordx4 v249, s[16:19], s37 offen offset:1024 lds
    v_mfma_f32_16x16x32_bf16 v[84:87], v[16:19], a[112:115], v[84:87]
    ds_read_b64_tr_b16 v[38:39], v9 offset:37376
    v_mfma_f32_16x16x32_bf16 v[84:87], v[20:23], a[116:119], v[84:87]
    ds_read_b64_tr_b16 v[40:41], v9 offset:40960
    v_mfma_f32_16x16x32_bf16 v[84:87], v[24:27], a[120:123], v[84:87]
    ds_read_b64_tr_b16 v[42:43], v9 offset:41472
    v_mfma_f32_16x16x32_bf16 v[84:87], v[28:31], a[124:127], v[84:87]
    buffer_load_dwordx4 v250, s[16:19], s37 offen offset:2048 lds
    v_mfma_f32_16x16x32_bf16 v[88:91], v[16:19], a[176:179], v[88:91]
    ds_read_b64_tr_b16 v[44:45], v9 offset:45056
    v_mfma_f32_16x16x32_bf16 v[88:91], v[20:23], a[180:183], v[88:91]
    ds_read_b64_tr_b16 v[46:47], v9 offset:45568
    v_mfma_f32_16x16x32_bf16 v[88:91], v[24:27], a[184:187], v[88:91]
    v_mfma_f32_16x16x32_bf16 v[88:91], v[28:31], a[188:191], v[88:91]
    buffer_load_dwordx4 v251, s[16:19], s37 offen offset:3072 lds
    v_mfma_f32_16x16x32_bf16 v[92:95], v[16:19], a[240:243], v[92:95]
    v_mfma_f32_16x16x32_bf16 v[92:95], v[20:23], a[244:247], v[92:95]
    v_mfma_f32_16x16x32_bf16 v[92:95], v[24:27], a[248:251], v[92:95]
    v_mfma_f32_16x16x32_bf16 v[92:95], v[28:31], a[252:255], v[92:95]
    s_waitcnt vmcnt(9) lgkmcnt(0)
    s_barrier
    v_cmp_ne_u32 vcc, 1, v254
    s_cbranch_vccnz L_spin_clr
L_ok_clr:
    v_mfma_f32_16x16x32_bf16 v[96:99], v[32:35], a[48:51], v[96:99]
    ds_read_b64_tr_b16 v[16:17], v6 offset:49152
    s_add_u32 s46, s42, 2097152
    v_mfma_f32_16x16x32_bf16 v[96:99], v[36:39], a[52:55], v[96:99]
    ds_read_b64_tr_b16 v[18:19], v6 offset:49664
    buffer_load_dword v215, v223, s[28:31], s46 offen
    v_mfma_f32_16x16x32_bf16 v[96:99], v[40:43], a[56:59], v[96:99]
    ds_read_b64_tr_b16 v[20:21], v6 offset:53248
    v_mfma_f32_16x16x32_bf16 v[96:99], v[44:47], a[60:63], v[96:99]
    s_add_u32 s47, s44, s69
    buffer_store_dword v253, v252, s[4:7], s47 offen sc1
    v_mfma_f32_16x16x32_bf16 v[100:103], v[32:35], a[112:115], v[100:103]
    ds_read_b64_tr_b16 v[22:23], v6 offset:53760
    v_mfma_f32_16x16x32_bf16 v[100:103], v[36:39], a[116:119], v[100:103]
    ds_read_b64_tr_b16 v[24:25], v6 offset:57344
    v_mfma_f32_16x16x32_bf16 v[100:103], v[40:43], a[120:123], v[100:103]
    ds_read_b64_tr_b16 v[26:27], v6 offset:57856
    v_mfma_f32_16x16x32_bf16 v[100:103], v[44:47], a[124:127], v[100:103]
    v_mfma_f32_16x16x32_bf16 v[104:107], v[32:35], a[176:179], v[104:107]
    ds_read_b64_tr_b16 v[28:29], v6 offset:61440
    v_mfma_f32_16x16x32_bf16 v[104:107], v[36:39], a[180:183], v[104:107]
    ds_read_b64_tr_b16 v[30:31], v6 offset:61952
    v_mfma_f32_16x16x32_bf16 v[104:107], v[40:43], a[184:187], v[104:107]
    v_mfma_f32_16x16x32_bf16 v[104:107], v[44:47], a[188:191], v[104:107]
    v_mfma_f32_16x16x32_bf16 v[108:111], v[32:35], a[240:243], v[108:111]
    s_add_u32 m0, s68, 65536
    v_mfma_f32_16x16x32_bf16 v[108:111], v[36:39], a[244:247], v[108:111]
    s_add_u32 s37, s35, 0
    v_mfma_f32_16x16x32_bf16 v[108:111], v[40:43], a[248:251], v[108:111]
    buffer_load_dwordx4 v248, s[16:19], s37 offen offset:0 lds
    v_mfma_f32_16x16x32_bf16 v[108:111], v[44:47], a[252:255], v[108:111]
    s_waitcnt lgkmcnt(0)
    v_mfma_f32_16x16x32_bf16 v[112:115], v[16:19], a[48:51], v[112:115]
    ds_read_b64_tr_b16 v[32:33], v7 offset:49152
    v_mfma_f32_16x16x32_bf16 v[112:115], v[20:23], a[52:55], v[112:115]
    ds_read_b64_tr_b16 v[34:35], v7 offset:49664
    v_mfma_f32_16x16x32_bf16 v[112:115], v[24:27], a[56:59], v[112:115]
    ds_read_b64_tr_b16 v[36:37], v7 offset:53248
    v_mfma_f32_16x16x32_bf16 v[112:115], v[28:31], a[60:63], v[112:115]
    buffer_load_dwordx4 v249, s[16:19], s37 offen offset:1024 lds
    v_mfma_f32_16x16x32_bf16 v[116:119], v[16:19], a[112:115], v[116:119]
    ds_read_b64_tr_b16 v[38:39], v7 offset:53760
    v_mfma_f32_16x16x32_bf16 v[116:119], v[20:23], a[116:119], v[116:119]
    ds_read_b64_tr_b16 v[40:41], v7 offset:57344
    v_mfma_f32_16x16x32_bf16 v[116:119], v[24:27], a[120:123], v[116:119]
    ds_read_b64_tr_b16 v[42:43], v7 offset:57856
    v_mfma_f32_16x16x32_bf16 v[116:119], v[28:31], a[124:127], v[116:119]
    buffer_load_dwordx4 v250, s[16:19], s37 offen offset:2048 lds
    v_mfma_f32_16x16x32_bf16 v[120:123], v[16:19], a[176:179], v[120:123]
    ds_read_b64_tr_b16 v[44:45], v7 offset:61440
    v_mfma_f32_16x16x32_bf16 v[120:123], v[20:23], a[180:183], v[120:123]
    ds_read_b64_tr_b16 v[46:47], v7 offset:61952
    v_mfma_f32_16x16x32_bf16 v[120:123], v[24:27], a[184:187], v[120:123]
    v_mfma_f32_16x16x32_bf16 v[120:123], v[28:31], a[188:191], v[120:123]
    buffer_load_dwordx4 v251, s[16:19], s37 offen offset:3072 lds
    v_mfma_f32_16x16x32_bf16 v[124:127], v[16:19], a[240:243], v[124:127]
    s_add_u32 m0, s68, 81920
    v_mfma_f32_16x16x32_bf16 v[124:127], v[20:23], a[244:247], v[124:127]
    s_add_u32 s37, s35, 1048576
    v_mfma_f32_16x16x32_bf16 v[124:127], v[24:27], a[248:251], v[124:127]
    buffer_load_dwordx4 v248, s[16:19], s37 offen offset:0 lds
    v_mfma_f32_16x16x32_bf16 v[124:127], v[28:31], a[252:255], v[124:127]
    s_waitcnt lgkmcnt(0)
    v_mfma_f32_16x16x32_bf16 v[128:131], v[32:35], a[48:51], v[128:131]
    ds_read_b64_tr_b16 v[16:17], v8 offset:49152
    v_mfma_f32_16x16x32_bf16 v[128:131], v[36:39], a[52:55], v[128:131]
    ds_read_b64_tr_b16 v[18:19], v8 offset:49664
    v_mfma_f32_16x16x32_bf16 v[128:131], v[40:43], a[56:59], v[128:131]
    ds_read_b64_tr_b16 v[20:21], v8 offset:53248
    v_mfma_f32_16x16x32_bf16 v[128:131], v[44:47], a[60:63], v[128:131]
    buffer_load_dwordx4 v249, s[16:19], s37 offen offset:1024 lds
    v_mfma_f32_16x16x32_bf16 v[132:135], v[32:35], a[112:115], v[132:135]
    ds_read_b64_tr_b16 v[22:23], v8 offset:53760
    v_mfma_f32_16x16x32_bf16 v[132:135], v[36:39], a[116:119], v[132:135]
    ds_read_b64_tr_b16 v[24:25], v8 offset:57344
    v_mfma_f32_16x16x32_bf16 v[132:135], v[40:43], a[120:123], v[132:135]
    ds_read_b64_tr_b16 v[26:27], v8 offset:57856
    v_mfma_f32_16x16x32_bf16 v[132:135], v[44:47], a[124:127], v[132:135]
    buffer_load_dwordx4 v250, s[16:19], s37 offen offset:2048 lds
    v_mfma_f32_16x16x32_bf16 v[136:139], v[32:35], a[176:179], v[136:139]
    ds_read_b64_tr_b16 v[28:29], v8 offset:61440
    v_mfma_f32_16x16x32_bf16 v[136:139], v[36:39], a[180:183], v[136:139]
    ds_read_b64_tr_b16 v[30:31], v8 offset:61952
    v_mfma_f32_16x16x32_bf16 v[136:139], v[40:43], a[184:187], v[136:139]
    v_mfma_f32_16x16x32_bf16 v[136:139], v[44:47], a[188:191], v[136:139]
    buffer_load_dwordx4 v251, s[16:19], s37 offen offset:3072 lds
    v_mfma_f32_16x16x32_bf16 v[140:143], v[32:35], a[240:243], v[140:143]
    s_add_u32 m0, s68, 98304
    v_mfma_f32_16x16x32_bf16 v[140:143], v[36:39], a[244:247], v[140:143]
    s_add_u32 s37, s35, 2097152
    v_mfma_f32_16x16x32_bf16 v[140:143], v[40:43], a[248:251], v[140:143]
    buffer_load_dwordx4 v248, s[16:19], s37 offen offset:0 lds
    v_mfma_f32_16x16x32_bf16 v[140:143], v[44:47], a[252:255], v[140:143]
    s_waitcnt lgkmcnt(0)
    v_mfma_f32_16x16x32_bf16 v[144:147], v[16:19], a[48:51], v[144:147]
    ds_read_b64_tr_b16 v[32:33], v9 offset:49152
    v_mfma_f32_16x16x32_bf16 v[144:147], v[20:23], a[52:55], v[144:147]
    ds_read_b64_tr_b16 v[34:35], v9 offset:49664
    v_mfma_f32_16x16x32_bf16 v[144:147], v[24:27], a[56:59], v[144:147]
    ds_read_b64_tr_b16 v[36:37], v9 offset:53248
    v_mfma_f32_16x16x32_bf16 v[144:147], v[28:31], a[60:63], v[144:147]
    buffer_load_dwordx4 v249, s[16:19], s37 offen offset:1024 lds
    v_mfma_f32_16x16x32_bf16 v[148:151], v[16:19], a[112:115], v[148:151]
    ds_read_b64_tr_b16 v[38:39], v9 offset:53760
    v_mfma_f32_16x16x32_bf16 v[148:151], v[20:23], a[116:119], v[148:151]
    ds_read_b64_tr_b16 v[40:41], v9 offset:57344
    v_mfma_f32_16x16x32_bf16 v[148:151], v[24:27], a[120:123], v[148:151]
    ds_read_b64_tr_b16 v[42:43], v9 offset:57856
    v_mfma_f32_16x16x32_bf16 v[148:151], v[28:31], a[124:127], v[148:151]
    buffer_load_dwordx4 v250, s[16:19], s37 offen offset:2048 lds
    v_mfma_f32_16x16x32_bf16 v[152:155], v[16:19], a[176:179], v[152:155]
    ds_read_b64_tr_b16 v[44:45], v9 offset:61440
    v_mfma_f32_16x16x32_bf16 v[152:155], v[20:23], a[180:183], v[152:155]
    ds_read_b64_tr_b16 v[46:47], v9 offset:61952
    v_mfma_f32_16x16x32_bf16 v[152:155], v[24:27], a[184:187], v[152:155]
    v_mfma_f32_16x16x32_bf16 v[152:155], v[28:31], a[188:191], v[152:155]
    buffer_load_dwordx4 v251, s[16:19], s37 offen offset:3072 lds
    v_mfma_f32_16x16x32_bf16 v[156:159], v[16:19], a[240:243], v[156:159]
    s_add_u32 m0, s68, 114688
    v_mfma_f32_16x16x32_bf16 v[156:159], v[20:23], a[244:247], v[156:159]
    s_add_u32 s37, s35, 3145728
    v_mfma_f32_16x16x32_bf16 v[156:159], v[24:27], a[248:251], v[156:159]
    buffer_load_dwordx4 v248, s[16:19], s37 offen offset:0 lds
    v_mfma_f32_16x16x32_bf16 v[156:159], v[28:31], a[252:255], v[156:159]
    s_waitcnt vmcnt(9) lgkmcnt(0)
    s_barrier
    v_mfma_f32_16x16x32_bf16 v[160:163], v[32:35], a[48:51], v[160:163]
    ds_read_b64_tr_b16 v[16:17], v240 offset:0
    v_mfma_f32_16x16x32_bf16 v[160:163], v[36:39], a[52:55], v[160:163]
    ds_read_b64_tr_b16 v[18:19], v240 offset:512
    v_mfma_f32_16x16x32_bf16 v[160:163], v[40:43], a[56:59], v[160:163]
    ds_read_b64_tr_b16 v[20:21], v240 offset:4096
    v_mfma_f32_16x16x32_bf16 v[160:163], v[44:47], a[60:63], v[160:163]
    buffer_load_dwordx4 v249, s[16:19], s37 offen offset:1024 lds
    v_mfma_f32_16x16x32_bf16 v[164:167], v[32:35], a[112:115], v[164:167]
    ds_read_b64_tr_b16 v[22:23], v240 offset:4608
    v_mfma_f32_16x16x32_bf16 v[164:167], v[36:39], a[116:119], v[164:167]
    ds_read_b64_tr_b16 v[24:25], v240 offset:8192
    v_mfma_f32_16x16x32_bf16 v[164:167], v[40:43], a[120:123], v[164:167]
    ds_read_b64_tr_b16 v[26:27], v240 offset:8704
    v_mfma_f32_16x16x32_bf16 v[164:167], v[44:47], a[124:127], v[164:167]
    buffer_load_dwordx4 v250, s[16:19], s37 offen offset:2048 lds
    v_mfma_f32_16x16x32_bf16 v[168:171], v[32:35], a[176:179], v[168:171]
    ds_read_b64_tr_b16 v[28:29], v240 offset:12288
    v_mfma_f32_16x16x32_bf16 v[168:171], v[36:39], a[180:183], v[168:171]
    ds_read_b64_tr_b16 v[30:31], v240 offset:12800
    v_mfma_f32_16x16x32_bf16 v[168:171], v[40:43], a[184:187], v[168:171]
    v_mfma_f32_16x16x32_bf16 v[168:171], v[44:47], a[188:191], v[168:171]
    buffer_load_dwordx4 v251, s[16:19], s37 offen offset:3072 lds
    v_mfma_f32_16x16x32_bf16 v[172:175], v[32:35], a[240:243], v[172:175]
    s_add_u32 m0, s68, 32768
    v_mfma_f32_16x16x32_bf16 v[172:175], v[36:39], a[244:247], v[172:175]
    s_add_u32 s37, s35, 2097280
    v_mfma_f32_16x16x32_bf16 v[172:175], v[40:43], a[248:251], v[172:175]
    buffer_load_dwordx4 v248, s[16:19], s37 offen offset:0 lds
    v_mfma_f32_16x16x32_bf16 v[172:175], v[44:47], a[252:255], v[172:175]
    s_waitcnt vmcnt(9) lgkmcnt(0)
    s_barrier
    v_mfma_f32_16x16x32_bf16 v[176:179], a[0:3], v[16:19], 0
    ds_read_b64_tr_b16 v[32:33], v240 offset:16384
    v_mfma_f32_16x16x32_bf16 v[176:179], a[4:7], v[20:23], v[176:179]
    ds_read_b64_tr_b16 v[34:35], v240 offset:16896
    v_mfma_f32_16x16x32_bf16 v[176:179], a[8:11], v[24:27], v[176:179]
    ds_read_b64_tr_b16 v[36:37], v240 offset:20480
    v_mfma_f32_16x16x32_bf16 v[176:179], a[12:15], v[28:31], v[176:179]
    buffer_load_dwordx4 v249, s[16:19], s37 offen offset:1024 lds
    v_mfma_f32_16x16x32_bf16 v[180:183], a[64:67], v[16:19], 0
    ds_read_b64_tr_b16 v[38:39], v240 offset:20992
    v_mfma_f32_16x16x32_bf16 v[180:183], a[68:71], v[20:23], v[180:183]
    ds_read_b64_tr_b16 v[40:41], v240 offset:24576
    v_mfma_f32_16x16x32_bf16 v[180:183], a[72:75], v[24:27], v[180:183]
    ds_read_b64_tr_b16 v[42:43], v240 offset:25088
    v_mfma_f32_16x16x32_bf16 v[180:183], a[76:79], v[28:31], v[180:183]
    buffer_load_dwordx4 v250, s[16:19], s37 offen offset:2048 lds
    v_mfma_f32_16x16x32_bf16 v[184:187], a[128:131], v[16:19], 0
    ds_read_b64_tr_b16 v[44:45], v240 offset:28672
    v_mfma_f32_16x16x32_bf16 v[184:187], a[132:135], v[20:23], v[184:187]
    ds_read_b64_tr_b16 v[46:47], v240 offset:29184
    v_mfma_f32_16x16x32_bf16 v[184:187], a[136:139], v[24:27], v[184:187]
    v_mfma_f32_16x16x32_bf16 v[184:187], a[140:143], v[28:31], v[184:187]
    buffer_load_dwordx4 v251, s[16:19], s37 offen offset:3072 lds
    v_mfma_f32_16x16x32_bf16 v[188:191], a[192:195], v[16:19], 0
    s_add_u32 m0, s68, 49152
    v_mfma_f32_16x16x32_bf16 v[188:191], a[196:199], v[20:23], v[188:191]
    s_add_u32 s37, s35, 3145856
    v_mfma_f32_16x16x32_bf16 v[188:191], a[200:203], v[24:27], v[188:191]
    buffer_load_dwordx4 v248, s[16:19], s37 offen offset:0 lds
    v_mfma_f32_16x16x32_bf16 v[188:191], a[204:207], v[28:31], v[188:191]
    s_waitcnt vmcnt(9) lgkmcnt(0)
    s_barrier
    v_mfma_f32_16x16x32_bf16 v[176:179], a[16:19], v[32:35], v[176:179]
    ds_read_b64_tr_b16 v[16:17], v240 offset:32768
    v_mfma_f32_16x16x32_bf16 v[176:179], a[20:23], v[36:39], v[176:179]
    ds_read_b64_tr_b16 v[18:19], v240 offset:33280
    v_mfma_f32_16x16x32_bf16 v[176:179], a[24:27], v[40:43], v[176:179]
    ds_read_b64_tr_b16 v[20:21], v240 offset:36864
    v_mfma_f32_16x16x32_bf16 v[176:179], a[28:31], v[44:47], v[176:179]
    buffer_load_dwordx4 v249, s[16:19], s37 offen offset:1024 lds
    v_mfma_f32_16x16x32_bf16 v[180:183], a[80:83], v[32:35], v[180:183]
    ds_read_b64_tr_b16 v[22:23], v240 offset:37376
    v_mfma_f32_16x16x32_bf16 v[180:183], a[84:87], v[36:39], v[180:183]
    ds_read_b64_tr_b16 v[24:25], v240 offset:40960
    v_mfma_f32_16x16x32_bf16 v[180:183], a[88:91], v[40:43], v[180:183]
    ds_read_b64_tr_b16 v[26:27], v240 offset:41472
    v_mfma_f32_16x16x32_bf16 v[180:183], a[92:95], v[44:47], v[180:183]
    buffer_load_dwordx4 v250, s[16:19], s37 offen offset:2048 lds
    v_mfma_f32_16x16x32_bf16 v[184:187], a[144:147], v[32:35], v[184:187]
    ds_read_b64_tr_b16 v[28:29], v240 offset:45056
    v_mfma_f32_16x16x32_bf16 v[184:187], a[148:151], v[36:39], v[184:187]
    ds_read_b64_tr_b16 v[30:31], v240 offset:45568
    v_mfma_f32_16x16x32_bf16 v[184:187], a[152:155], v[40:43], v[184:187]
    v_mfma_f32_16x16x32_bf16 v[184:187], a[156:159], v[44:47], v[184:187]
    buffer_load_dwordx4 v251, s[16:19], s37 offen offset:3072 lds
    v_mfma_f32_16x16x32_bf16 v[188:191], a[208:211], v[32:35], v[188:191]
    v_mfma_f32_16x16x32_bf16 v[188:191], a[212:215], v[36:39], v[188:191]
    v_mfma_f32_16x16x32_bf16 v[188:191], a[216:219], v[40:43], v[188:191]
    v_mfma_f32_16x16x32_bf16 v[188:191], a[220:223], v[44:47], v[188:191]
    s_waitcnt vmcnt(8) lgkmcnt(0)
    s_barrier
    v_mfma_f32_16x16x32_bf16 v[176:179], a[32:35], v[16:19], v[176:179]
    ds_read_b64_tr_b16 v[32:33], v240 offset:49152
    v_cvt_pk_bf16_f32 v224, v48, v49
    v_mfma_f32_16x16x32_bf16 v[176:179], a[36:39], v[20:23], v[176:179]
    ds_read_b64_tr_b16 v[34:35], v240 offset:49664
    v_cvt_pk_bf16_f32 v225, v50, v51
    v_mfma_f32_16x16x32_bf16 v[176:179], a[40:43], v[24:27], v[176:179]
    ds_read_b64_tr_b16 v[36:37], v240 offset:53248
    v_mfma_f32_16x16x32_bf16 v[176:179], a[44:47], v[28:31], v[176:179]
    s_add_u32 s38, s36, 0
    v_cvt_pk_bf16_f32 v226, v64, v65
    v_cvt_pk_bf16_f32 v227, v66, v67
    v_mfma_f32_16x16x32_bf16 v[180:183], a[96:99], v[16:19], v[180:183]
    ds_read_b64_tr_b16 v[38:39], v240 offset:53760
    v_mfma_f32_16x16x32_bf16 v[180:183], a[100:103], v[20:23], v[180:183]
    ds_read_b64_tr_b16 v[40:41], v240 offset:57344
    v_mfma_f32_16x16x32_bf16 v[180:183], a[104:107], v[24:27], v[180:183]
    ds_read_b64_tr_b16 v[42:43], v240 offset:57856
    v_mfma_f32_16x16x32_bf16 v[180:183], a[108:111], v[28:31], v[180:183]
    buffer_store_dwordx4 v[224:227], v1, s[4:7], s38 offen sc1
    v_mfma_f32_16x16x32_bf16 v[184:187], a[160:163], v[16:19], v[184:187]
    ds_read_b64_tr_b16 v[44:45], v240 offset:61440
    v_mfma_f32_16x16x32_bf16 v[184:187], a[164:167], v[20:23], v[184:187]
    ds_read_b64_tr_b16 v[46:47], v240 offset:61952
    v_mfma_f32_16x16x32_bf16 v[184:187], a[168:171], v[24:27], v[184:187]
    s_mov_b32 s49, s32
    v_mfma_f32_16x16x32_bf16 v[184:187], a[172:175], v[28:31], v[184:187]
    s_mov_b32 s50, s33
    v_mfma_f32_16x16x32_bf16 v[188:191], a[224:227], v[16:19], v[188:191]
    s_mov_b32 s48, s35
    v_mfma_f32_16x16x32_bf16 v[188:191], a[228:231], v[20:23], v[188:191]
    s_mov_b32 s12, s28
    v_mfma_f32_16x16x32_bf16 v[188:191], a[232:235], v[24:27], v[188:191]
    s_mov_b32 s13, s29
    v_mfma_f32_16x16x32_bf16 v[188:191], a[236:239], v[28:31], v[188:191]
    s_mov_b32 s14, 4194304
    s_waitcnt lgkmcnt(2)
    v_mfma_f32_16x16x32_bf16 v[176:179], a[48:51], v[32:35], v[176:179]
    ds_read_b64_tr_b16 v[16:17], v241 offset:0
    v_cvt_pk_bf16_f32 v228, v80, v81
    v_mfma_f32_16x16x32_bf16 v[176:179], a[52:55], v[36:39], v[176:179]
    ds_read_b64_tr_b16 v[18:19], v241 offset:512
    v_cvt_pk_bf16_f32 v229, v82, v83
    v_mfma_f32_16x16x32_bf16 v[176:179], a[56:59], v[40:43], v[176:179]
    ds_read_b64_tr_b16 v[20:21], v241 offset:4096
    s_waitcnt lgkmcnt(3)
    v_mfma_f32_16x16x32_bf16 v[176:179], a[60:63], v[44:47], v[176:179]
    s_add_u32 s38, s36, 1024
    v_cvt_pk_bf16_f32 v230, v96, v97
    v_cvt_pk_bf16_f32 v231, v98, v99
    v_mfma_f32_16x16x32_bf16 v[180:183], a[112:115], v[32:35], v[180:183]
    ds_read_b64_tr_b16 v[22:23], v241 offset:4608
    v_mfma_f32_16x16x32_bf16 v[180:183], a[116:119], v[36:39], v[180:183]
    ds_read_b64_tr_b16 v[24:25], v241 offset:8192
    v_mfma_f32_16x16x32_bf16 v[180:183], a[120:123], v[40:43], v[180:183]
    ds_read_b64_tr_b16 v[26:27], v241 offset:8704
    v_mfma_f32_16x16x32_bf16 v[180:183], a[124:127], v[44:47], v[180:183]
    buffer_store_dwordx4 v[228:231], v1, s[4:7], s38 offen sc1
    v_mfma_f32_16x16x32_bf16 v[184:187], a[176:179], v[32:35], v[184:187]
    ds_read_b64_tr_b16 v[28:29], v241 offset:12288
    v_mfma_f32_16x16x32_bf16 v[184:187], a[180:183], v[36:39], v[184:187]
    ds_read_b64_tr_b16 v[30:31], v241 offset:12800
    v_mfma_f32_16x16x32_bf16 v[184:187], a[184:187], v[40:43], v[184:187]
    s_mov_b32 s15, 0x20000
    v_mfma_f32_16x16x32_bf16 v[184:187], a[188:191], v[44:47], v[184:187]
    s_lshl_b32 s51, s50, 3
    v_mfma_f32_16x16x32_bf16 v[188:191], a[240:243], v[32:35], v[188:191]
    s_sub_u32 s60, 120, s51
    v_mfma_f32_16x16x32_bf16 v[188:191], a[244:247], v[36:39], v[188:191]
    s_add_u32 s60, s60, s3
    v_mfma_f32_16x16x32_bf16 v[188:191], a[248:251], v[40:43], v[188:191]
    s_add_u32 s62, s51, s3
    v_mfma_f32_16x16x32_bf16 v[188:191], a[252:255], v[44:47], v[188:191]
    s_add_u32 s61, s60, 4
    s_waitcnt lgkmcnt(2)
    v_mfma_f32_16x16x32_bf16 v[192:195], a[0:3], v[16:19], 0
    ds_read_b64_tr_b16 v[32:33], v241 offset:16384
    v_mfma_f32_16x16x32_bf16 v[192:195], a[4:7], v[20:23], v[192:195]
    ds_read_b64_tr_b16 v[34:35], v241 offset:16896
    v_mfma_f32_16x16x32_bf16 v[192:195], a[8:11], v[24:27], v[192:195]
    ds_read_b64_tr_b16 v[36:37], v241 offset:20480
    s_waitcnt lgkmcnt(3)
    v_mfma_f32_16x16x32_bf16 v[192:195], a[12:15], v[28:31], v[192:195]
    s_add_u32 s63, s62, 4
    v_mfma_f32_16x16x32_bf16 v[196:199], a[64:67], v[16:19], 0
    ds_read_b64_tr_b16 v[38:39], v241 offset:20992
    v_mfma_f32_16x16x32_bf16 v[196:199], a[68:71], v[20:23], v[196:199]
    ds_read_b64_tr_b16 v[40:41], v241 offset:24576
    v_mfma_f32_16x16x32_bf16 v[196:199], a[72:75], v[24:27], v[196:199]
    ds_read_b64_tr_b16 v[42:43], v241 offset:25088
    v_mfma_f32_16x16x32_bf16 v[196:199], a[76:79], v[28:31], v[196:199]
    v_cvt_pk_bf16_f32 v232, v176, v177
    v_cvt_pk_bf16_f32 v233, v178, v179
    v_mfma_f32_16x16x32_bf16 v[200:203], a[128:131], v[16:19], 0
    ds_read_b64_tr_b16 v[44:45], v241 offset:28672
    v_mfma_f32_16x16x32_bf16 v[200:203], a[132:135], v[20:23], v[200:203]
    ds_read_b64_tr_b16 v[46:47], v241 offset:29184
    v_mfma_f32_16x16x32_bf16 v[200:203], a[136:139], v[24:27], v[200:203]
    s_add_u32 s38, s36, 16384
    v_cvt_pk_bf16_f32 v234, v180, v181
    v_cvt_pk_bf16_f32 v235, v182, v183
    v_mfma_f32_16x16x32_bf16 v[200:203], a[140:143], v[28:31], v[200:203]
    buffer_store_dwordx4 v[232:235], v1, s[4:7], s38 offen sc1
    v_mfma_f32_16x16x32_bf16 v[204:207], a[192:195], v[16:19], 0
    s_mul_i32 s64, s60, 21504
    v_mfma_f32_16x16x32_bf16 v[204:207], a[196:199], v[20:23], v[204:207]
    s_mul_i32 s66, s62, 21504
    v_mfma_f32_16x16x32_bf16 v[204:207], a[200:203], v[24:27], v[204:207]
    s_add_u32 s65, s64, 86016
    v_mfma_f32_16x16x32_bf16 v[204:207], a[204:207], v[28:31], v[204:207]
    s_add_u32 s67, s66, 86016
    s_waitcnt lgkmcnt(2)
    v_mfma_f32_16x16x32_bf16 v[192:195], a[16:19], v[32:35], v[192:195]
    ds_read_b64_tr_b16 v[16:17], v241 offset:32768
    v_mfma_f32_16x16x32_bf16 v[192:195], a[20:23], v[36:39], v[192:195]
    ds_read_b64_tr_b16 v[18:19], v241 offset:33280
    v_mfma_f32_16x16x32_bf16 v[192:195], a[24:27], v[40:43], v[192:195]
    ds_read_b64_tr_b16 v[20:21], v241 offset:36864
    s_waitcnt lgkmcnt(3)
    v_mfma_f32_16x16x32_bf16 v[192:195], a[28:31], v[44:47], v[192:195]
    v_cvt_pk_bf16_f32 v224, v184, v185
    v_cvt_pk_bf16_f32 v225, v186, v187
    v_mfma_f32_16x16x32_bf16 v[196:199], a[80:83], v[32:35], v[196:199]
    ds_read_b64_tr_b16 v[22:23], v241 offset:37376
    v_mfma_f32_16x16x32_bf16 v[196:199], a[84:87], v[36:39], v[196:199]
    ds_read_b64_tr_b16 v[24:25], v241 offset:40960
    v_mfma_f32_16x16x32_bf16 v[196:199], a[88:91], v[40:43], v[196:199]
    ds_read_b64_tr_b16 v[26:27], v241 offset:41472
    v_mfma_f32_16x16x32_bf16 v[196:199], a[92:95], v[44:47], v[196:199]
    s_add_u32 s38, s36, 17408
    v_cvt_pk_bf16_f32 v226, v188, v189
    v_cvt_pk_bf16_f32 v227, v190, v191
    v_mfma_f32_16x16x32_bf16 v[200:203], a[144:147], v[32:35], v[200:203]
    ds_read_b64_tr_b16 v[28:29], v241 offset:45056
    v_mfma_f32_16x16x32_bf16 v[200:203], a[148:151], v[36:39], v[200:203]
    ds_read_b64_tr_b16 v[30:31], v241 offset:45568
    v_mfma_f32_16x16x32_bf16 v[200:203], a[152:155], v[40:43], v[200:203]
    buffer_store_dwordx4 v[224:227], v1, s[4:7], s38 offen sc1
    v_mfma_f32_16x16x32_bf16 v[200:203], a[156:159], v[44:47], v[200:203]
    s_sub_u32 s58, 15, s50
    v_mfma_f32_16x16x32_bf16 v[204:207], a[208:211], v[32:35], v[204:207]
    s_lshl_b32 s58, s58, 7
    v_mfma_f32_16x16x32_bf16 v[204:207], a[212:215], v[36:39], v[204:207]
    s_lshl_b32 s51, s50, 7
    v_mfma_f32_16x16x32_bf16 v[204:207], a[216:219], v[40:43], v[204:207]
    s_sub_u32 s51, s51, s58
    v_mfma_f32_16x16x32_bf16 v[204:207], a[220:223], v[44:47], v[204:207]
    s_add_u32 s58, s58, 74448896
    v_bfe_u32 v254, v0, 4, 1
    v_and_b32 v255, 15, v0
    s_waitcnt lgkmcnt(2)
    v_mfma_f32_16x16x32_bf16 v[192:195], a[32:35], v[16:19], v[192:195]
    ds_read_b64_tr_b16 v[32:33], v241 offset:49152
    v_mul_lo_u32 v254, v254, s51
    v_mfma_f32_16x16x32_bf16 v[192:195], a[36:39], v[20:23], v[192:195]
    ds_read_b64_tr_b16 v[34:35], v241 offset:49664
    v_lshl_add_u32 v255, v255, 2, s58
    v_mfma_f32_16x16x32_bf16 v[192:195], a[40:43], v[24:27], v[192:195]
    ds_read_b64_tr_b16 v[36:37], v241 offset:53248
    v_add_u32 v255, v255, v254
    s_waitcnt lgkmcnt(3)
    v_mfma_f32_16x16x32_bf16 v[192:195], a[44:47], v[28:31], v[192:195]
    v_cvt_pk_bf16_f32 v228, v52, v53
    v_cvt_pk_bf16_f32 v229, v54, v55
    v_mfma_f32_16x16x32_bf16 v[196:199], a[96:99], v[16:19], v[196:199]
    ds_read_b64_tr_b16 v[38:39], v241 offset:53760
    v_mfma_f32_16x16x32_bf16 v[196:199], a[100:103], v[20:23], v[196:199]
    ds_read_b64_tr_b16 v[40:41], v241 offset:57344
    v_mfma_f32_16x16x32_bf16 v[196:199], a[104:107], v[24:27], v[196:199]
    ds_read_b64_tr_b16 v[42:43], v241 offset:57856
    v_mfma_f32_16x16x32_bf16 v[196:199], a[108:111], v[28:31], v[196:199]
    s_add_u32 s38, s36, 4096
    v_cvt_pk_bf16_f32 v230, v68, v69
    v_cvt_pk_bf16_f32 v231, v70, v71
    v_mfma_f32_16x16x32_bf16 v[200:203], a[160:163], v[16:19], v[200:203]
    ds_read_b64_tr_b16 v[44:45], v241 offset:61440
    v_mfma_f32_16x16x32_bf16 v[200:203], a[164:167], v[20:23], v[200:203]
    ds_read_b64_tr_b16 v[46:47], v241 offset:61952
    v_mfma_f32_16x16x32_bf16 v[200:203], a[168:171], v[24:27], v[200:203]
    buffer_store_dwordx4 v[228:231], v1, s[4:7], s38 offen sc1
    v_mfma_f32_16x16x32_bf16 v[200:203], a[172:175], v[28:31], v[200:203]
    v_mfma_f32_16x16x32_bf16 v[204:207], a[224:227], v[16:19], v[204:207]
    v_mfma_f32_16x16x32_bf16 v[204:207], a[228:231], v[20:23], v[204:207]
    v_mfma_f32_16x16x32_bf16 v[204:207], a[232:235], v[24:27], v[204:207]
    v_mfma_f32_16x16x32_bf16 v[204:207], a[236:239], v[28:31], v[204:207]
    s_waitcnt lgkmcnt(0)
    v_mfma_f32_16x16x32_bf16 v[192:195], a[48:51], v[32:35], v[192:195]
    ds_read_b64_tr_b16 v[16:17], v242 offset:0
    v_mfma_f32_16x16x32_bf16 v[192:195], a[52:55], v[36:39], v[192:195]
    ds_read_b64_tr_b16 v[18:19], v242 offset:512
    v_mfma_f32_16x16x32_bf16 v[192:195], a[56:59], v[40:43], v[192:195]
    ds_read_b64_tr_b16 v[20:21], v242 offset:4096
    v_mfma_f32_16x16x32_bf16 v[192:195], a[60:63], v[44:47], v[192:195]
    v_cvt_pk_bf16_f32 v232, v84, v85
    v_cvt_pk_bf16_f32 v233, v86, v87
    v_mfma_f32_16x16x32_bf16 v[196:199], a[112:115], v[32:35], v[196:199]
    ds_read_b64_tr_b16 v[22:23], v242 offset:4608
    v_mfma_f32_16x16x32_bf16 v[196:199], a[116:119], v[36:39], v[196:199]
    ds_read_b64_tr_b16 v[24:25], v242 offset:8192
    v_mfma_f32_16x16x32_bf16 v[196:199], a[120:123], v[40:43], v[196:199]
    ds_read_b64_tr_b16 v[26:27], v242 offset:8704
    v_mfma_f32_16x16x32_bf16 v[196:199], a[124:127], v[44:47], v[196:199]
    s_add_u32 s38, s36, 5120
    v_cvt_pk_bf16_f32 v234, v100, v101
    v_cvt_pk_bf16_f32 v235, v102, v103
    v_mfma_f32_16x16x32_bf16 v[200:203], a[176:179], v[32:35], v[200:203]
    ds_read_b64_tr_b16 v[28:29], v242 offset:12288
    v_mfma_f32_16x16x32_bf16 v[200:203], a[180:183], v[36:39], v[200:203]
    ds_read_b64_tr_b16 v[30:31], v242 offset:12800
    v_mfma_f32_16x16x32_bf16 v[200:203], a[184:187], v[40:43], v[200:203]
    buffer_store_dwordx4 v[232:235], v1, s[4:7], s38 offen sc1
    v_mfma_f32_16x16x32_bf16 v[200:203], a[188:191], v[44:47], v[200:203]
    buffer_load_dword v254, v255, s[4:7], 0 offen sc1
    v_mfma_f32_16x16x32_bf16 v[204:207], a[240:243], v[32:35], v[204:207]
    v_mfma_f32_16x16x32_bf16 v[204:207], a[244:247], v[36:39], v[204:207]
    v_mfma_f32_16x16x32_bf16 v[204:207], a[248:251], v[40:43], v[204:207]
    v_mfma_f32_16x16x32_bf16 v[204:207], a[252:255], v[44:47], v[204:207]
    s_waitcnt lgkmcnt(0)
    v_mfma_f32_16x16x32_bf16 v[176:179], a[0:3], v[16:19], 0
    ds_read_b64_tr_b16 v[32:33], v242 offset:16384
    v_mfma_f32_16x16x32_bf16 v[176:179], a[4:7], v[20:23], v[176:179]
    ds_read_b64_tr_b16 v[34:35], v242 offset:16896
    v_mfma_f32_16x16x32_bf16 v[176:179], a[8:11], v[24:27], v[176:179]
    ds_read_b64_tr_b16 v[36:37], v242 offset:20480
    v_mfma_f32_16x16x32_bf16 v[176:179], a[12:15], v[28:31], v[176:179]
    v_mfma_f32_16x16x32_bf16 v[180:183], a[64:67], v[16:19], 0
    ds_read_b64_tr_b16 v[38:39], v242 offset:20992
    v_mfma_f32_16x16x32_bf16 v[180:183], a[68:71], v[20:23], v[180:183]
    ds_read_b64_tr_b16 v[40:41], v242 offset:24576
    v_mfma_f32_16x16x32_bf16 v[180:183], a[72:75], v[24:27], v[180:183]
    ds_read_b64_tr_b16 v[42:43], v242 offset:25088
    v_mfma_f32_16x16x32_bf16 v[180:183], a[76:79], v[28:31], v[180:183]
    v_cvt_pk_bf16_f32 v224, v192, v193
    v_cvt_pk_bf16_f32 v225, v194, v195
    v_mfma_f32_16x16x32_bf16 v[184:187], a[128:131], v[16:19], 0
    ds_read_b64_tr_b16 v[44:45], v242 offset:28672
    v_mfma_f32_16x16x32_bf16 v[184:187], a[132:135], v[20:23], v[184:187]
    ds_read_b64_tr_b16 v[46:47], v242 offset:29184
    v_mfma_f32_16x16x32_bf16 v[184:187], a[136:139], v[24:27], v[184:187]
    s_add_u32 s38, s36, 18432
    v_cvt_pk_bf16_f32 v226, v196, v197
    v_cvt_pk_bf16_f32 v227, v198, v199
    v_mfma_f32_16x16x32_bf16 v[184:187], a[140:143], v[28:31], v[184:187]
    buffer_store_dwordx4 v[224:227], v1, s[4:7], s38 offen sc1
    v_mfma_f32_16x16x32_bf16 v[188:191], a[192:195], v[16:19], 0
    v_mfma_f32_16x16x32_bf16 v[188:191], a[196:199], v[20:23], v[188:191]
    v_mfma_f32_16x16x32_bf16 v[188:191], a[200:203], v[24:27], v[188:191]
    v_mfma_f32_16x16x32_bf16 v[188:191], a[204:207], v[28:31], v[188:191]
    s_waitcnt lgkmcnt(0)
    v_mfma_f32_16x16x32_bf16 v[176:179], a[16:19], v[32:35], v[176:179]
    ds_read_b64_tr_b16 v[16:17], v242 offset:32768
    v_mfma_f32_16x16x32_bf16 v[176:179], a[20:23], v[36:39], v[176:179]
    ds_read_b64_tr_b16 v[18:19], v242 offset:33280
    v_mfma_f32_16x16x32_bf16 v[176:179], a[24:27], v[40:43], v[176:179]
    ds_read_b64_tr_b16 v[20:21], v242 offset:36864
    v_mfma_f32_16x16x32_bf16 v[176:179], a[28:31], v[44:47], v[176:179]
    v_cvt_pk_bf16_f32 v228, v200, v201
    v_cvt_pk_bf16_f32 v229, v202, v203
    v_mfma_f32_16x16x32_bf16 v[180:183], a[80:83], v[32:35], v[180:183]
    ds_read_b64_tr_b16 v[22:23], v242 offset:37376
    v_mfma_f32_16x16x32_bf16 v[180:183], a[84:87], v[36:39], v[180:183]
    ds_read_b64_tr_b16 v[24:25], v242 offset:40960
    v_mfma_f32_16x16x32_bf16 v[180:183], a[88:91], v[40:43], v[180:183]
    ds_read_b64_tr_b16 v[26:27], v242 offset:41472
    v_mfma_f32_16x16x32_bf16 v[180:183], a[92:95], v[44:47], v[180:183]
    s_add_u32 s38, s36, 19456
    v_cvt_pk_bf16_f32 v230, v204, v205
    v_cvt_pk_bf16_f32 v231, v206, v207
    v_mfma_f32_16x16x32_bf16 v[184:187], a[144:147], v[32:35], v[184:187]
    ds_read_b64_tr_b16 v[28:29], v242 offset:45056
    v_mfma_f32_16x16x32_bf16 v[184:187], a[148:151], v[36:39], v[184:187]
    ds_read_b64_tr_b16 v[30:31], v242 offset:45568
    v_mfma_f32_16x16x32_bf16 v[184:187], a[152:155], v[40:43], v[184:187]
    buffer_store_dwordx4 v[228:231], v1, s[4:7], s38 offen sc1
    v_mfma_f32_16x16x32_bf16 v[184:187], a[156:159], v[44:47], v[184:187]
    v_mfma_f32_16x16x32_bf16 v[188:191], a[208:211], v[32:35], v[188:191]
    v_mfma_f32_16x16x32_bf16 v[188:191], a[212:215], v[36:39], v[188:191]
    v_mfma_f32_16x16x32_bf16 v[188:191], a[216:219], v[40:43], v[188:191]
    v_mfma_f32_16x16x32_bf16 v[188:191], a[220:223], v[44:47], v[188:191]
    s_waitcnt lgkmcnt(0)
    v_mfma_f32_16x16x32_bf16 v[176:179], a[32:35], v[16:19], v[176:179]
    ds_read_b64_tr_b16 v[32:33], v242 offset:49152
    v_mfma_f32_16x16x32_bf16 v[176:179], a[36:39], v[20:23], v[176:179]
    ds_read_b64_tr_b16 v[34:35], v242 offset:49664
    v_mfma_f32_16x16x32_bf16 v[176:179], a[40:43], v[24:27], v[176:179]
    ds_read_b64_tr_b16 v[36:37], v242 offset:53248
    v_mfma_f32_16x16x32_bf16 v[176:179], a[44:47], v[28:31], v[176:179]
    v_cvt_pk_bf16_f32 v232, v56, v57
    v_cvt_pk_bf16_f32 v233, v58, v59
    v_mfma_f32_16x16x32_bf16 v[180:183], a[96:99], v[16:19], v[180:183]
    ds_read_b64_tr_b16 v[38:39], v242 offset:53760
    v_mfma_f32_16x16x32_bf16 v[180:183], a[100:103], v[20:23], v[180:183]
    ds_read_b64_tr_b16 v[40:41], v242 offset:57344
    v_mfma_f32_16x16x32_bf16 v[180:183], a[104:107], v[24:27], v[180:183]
    ds_read_b64_tr_b16 v[42:43], v242 offset:57856
    v_mfma_f32_16x16x32_bf16 v[180:183], a[108:111], v[28:31], v[180:183]
    s_add_u32 s38, s36, 8192
    v_cvt_pk_bf16_f32 v234, v72, v73
    v_cvt_pk_bf16_f32 v235, v74, v75
    v_mfma_f32_16x16x32_bf16 v[184:187], a[160:163], v[16:19], v[184:187]
    ds_read_b64_tr_b16 v[44:45], v242 offset:61440
    v_mfma_f32_16x16x32_bf16 v[184:187], a[164:167], v[20:23], v[184:187]
    ds_read_b64_tr_b16 v[46:47], v242 offset:61952
    v_mfma_f32_16x16x32_bf16 v[184:187], a[168:171], v[24:27], v[184:187]
    buffer_store_dwordx4 v[232:235], v1, s[4:7], s38 offen sc1
    v_mfma_f32_16x16x32_bf16 v[184:187], a[172:175], v[28:31], v[184:187]
    v_mfma_f32_16x16x32_bf16 v[188:191], a[224:227], v[16:19], v[188:191]
    v_mfma_f32_16x16x32_bf16 v[188:191], a[228:231], v[20:23], v[188:191]
    v_mfma_f32_16x16x32_bf16 v[188:191], a[232:235], v[24:27], v[188:191]
    v_mfma_f32_16x16x32_bf16 v[188:191], a[236:239], v[28:31], v[188:191]
    s_waitcnt lgkmcnt(0)
    v_mfma_f32_16x16x32_bf16 v[176:179], a[48:51], v[32:35], v[176:179]
    ds_read_b64_tr_b16 v[16:17], v243 offset:0
    v_mfma_f32_16x16x32_bf16 v[176:179], a[52:55], v[36:39], v[176:179]
    ds_read_b64_tr_b16 v[18:19], v243 offset:512
    v_mfma_f32_16x16x32_bf16 v[176:179], a[56:59], v[40:43], v[176:179]
    ds_read_b64_tr_b16 v[20:21], v243 offset:4096
    v_mfma_f32_16x16x32_bf16 v[176:179], a[60:63], v[44:47], v[176:179]
    v_cvt_pk_bf16_f32 v224, v88, v89
    v_cvt_pk_bf16_f32 v225, v90, v91
    v_mfma_f32_16x16x32_bf16 v[180:183], a[112:115], v[32:35], v[180:183]
    ds_read_b64_tr_b16 v[22:23], v243 offset:4608
    v_mfma_f32_16x16x32_bf16 v[180:183], a[116:119], v[36:39], v[180:183]
    ds_read_b64_tr_b16 v[24:25], v243 offset:8192
    v_mfma_f32_16x16x32_bf16 v[180:183], a[120:123], v[40:43], v[180:183]
    ds_read_b64_tr_b16 v[26:27], v243 offset:8704
    v_mfma_f32_16x16x32_bf16 v[180:183], a[124:127], v[44:47], v[180:183]
    s_add_u32 s38, s36, 9216
    v_cvt_pk_bf16_f32 v226, v104, v105
    v_cvt_pk_bf16_f32 v227, v106, v107
    v_mfma_f32_16x16x32_bf16 v[184:187], a[176:179], v[32:35], v[184:187]
    ds_read_b64_tr_b16 v[28:29], v243 offset:12288
    v_mfma_f32_16x16x32_bf16 v[184:187], a[180:183], v[36:39], v[184:187]
    ds_read_b64_tr_b16 v[30:31], v243 offset:12800
    v_mfma_f32_16x16x32_bf16 v[184:187], a[184:187], v[40:43], v[184:187]
    buffer_store_dwordx4 v[224:227], v1, s[4:7], s38 offen sc1
    v_mfma_f32_16x16x32_bf16 v[184:187], a[188:191], v[44:47], v[184:187]
    s_mul_i32 s54, s49, 1213440
    v_mfma_f32_16x16x32_bf16 v[188:191], a[240:243], v[32:35], v[188:191]
    s_nop 0
    s_add_u32 s8, s4, s54
    s_addc_u32 s9, s5, 0
    v_mfma_f32_16x16x32_bf16 v[188:191], a[244:247], v[36:39], v[188:191]
    s_mul_i32 s54, s50, 75776
    v_mfma_f32_16x16x32_bf16 v[188:191], a[248:251], v[40:43], v[188:191]
    s_sub_u32 s10, 1212416, s54
    v_mfma_f32_16x16x32_bf16 v[188:191], a[252:255], v[44:47], v[188:191]
    s_mov_b32 s11, 0x20000
    s_waitcnt lgkmcnt(2)
    v_mfma_f32_16x16x32_bf16 v[192:195], a[0:3], v[16:19], 0
    ds_read_b64_tr_b16 v[32:33], v243 offset:16384
    v_mfma_f32_16x16x32_bf16 v[192:195], a[4:7], v[20:23], v[192:195]
    ds_read_b64_tr_b16 v[34:35], v243 offset:16896
    v_mfma_f32_16x16x32_bf16 v[192:195], a[8:11], v[24:27], v[192:195]
    ds_read_b64_tr_b16 v[36:37], v243 offset:20480
    s_waitcnt lgkmcnt(3)
    v_mfma_f32_16x16x32_bf16 v[192:195], a[12:15], v[28:31], v[192:195]
    s_lshl_b32 s52, s49, 7
    v_mfma_f32_16x16x32_bf16 v[196:199], a[64:67], v[16:19], 0
    ds_read_b64_tr_b16 v[38:39], v243 offset:20992
    v_mfma_f32_16x16x32_bf16 v[196:199], a[68:71], v[20:23], v[196:199]
    ds_read_b64_tr_b16 v[40:41], v243 offset:24576
    v_mfma_f32_16x16x32_bf16 v[196:199], a[72:75], v[24:27], v[196:199]
    ds_read_b64_tr_b16 v[42:43], v243 offset:25088
    v_mfma_f32_16x16x32_bf16 v[196:199], a[76:79], v[28:31], v[196:199]
    v_cvt_pk_bf16_f32 v228, v176, v177
    v_cvt_pk_bf16_f32 v229, v178, v179
    v_mfma_f32_16x16x32_bf16 v[200:203], a[128:131], v[16:19], 0
    ds_read_b64_tr_b16 v[44:45], v243 offset:28672
    v_mfma_f32_16x16x32_bf16 v[200:203], a[132:135], v[20:23], v[200:203]
    ds_read_b64_tr_b16 v[46:47], v243 offset:29184
    v_mfma_f32_16x16x32_bf16 v[200:203], a[136:139], v[24:27], v[200:203]
    s_add_u32 s38, s36, 20480
    v_cvt_pk_bf16_f32 v230, v180, v181
    v_cvt_pk_bf16_f32 v231, v182, v183
    v_mfma_f32_16x16x32_bf16 v[200:203], a[140:143], v[28:31], v[200:203]
    buffer_store_dwordx4 v[228:231], v1, s[4:7], s38 offen sc1
    v_mfma_f32_16x16x32_bf16 v[204:207], a[192:195], v[16:19], 0
    s_lshl_b32 s54, s50, 2
    v_mfma_f32_16x16x32_bf16 v[204:207], a[196:199], v[20:23], v[204:207]
    s_add_u32 s53, s52, s54
    v_mfma_f32_16x16x32_bf16 v[204:207], a[200:203], v[24:27], v[204:207]
    s_add_u32 s53, s53, 74450944
    v_mfma_f32_16x16x32_bf16 v[204:207], a[204:207], v[28:31], v[204:207]
    s_add_u32 s52, s52, 74450944
    s_waitcnt lgkmcnt(2)
    v_mfma_f32_16x16x32_bf16 v[192:195], a[16:19], v[32:35], v[192:195]
    ds_read_b64_tr_b16 v[16:17], v243 offset:32768
    v_mfma_f32_16x16x32_bf16 v[192:195], a[20:23], v[36:39], v[192:195]
    ds_read_b64_tr_b16 v[18:19], v243 offset:33280
    v_mfma_f32_16x16x32_bf16 v[192:195], a[24:27], v[40:43], v[192:195]
    ds_read_b64_tr_b16 v[20:21], v243 offset:36864
    s_waitcnt lgkmcnt(3)
    v_mfma_f32_16x16x32_bf16 v[192:195], a[28:31], v[44:47], v[192:195]
    v_cvt_pk_bf16_f32 v232, v184, v185
    v_cvt_pk_bf16_f32 v233, v186, v187
    v_mfma_f32_16x16x32_bf16 v[196:199], a[80:83], v[32:35], v[196:199]
    ds_read_b64_tr_b16 v[22:23], v243 offset:37376
    v_mfma_f32_16x16x32_bf16 v[196:199], a[84:87], v[36:39], v[196:199]
    ds_read_b64_tr_b16 v[24:25], v243 offset:40960
    v_mfma_f32_16x16x32_bf16 v[196:199], a[88:91], v[40:43], v[196:199]
    ds_read_b64_tr_b16 v[26:27], v243 offset:41472
    v_mfma_f32_16x16x32_bf16 v[196:199], a[92:95], v[44:47], v[196:199]
    s_add_u32 s38, s36, 21504
    v_cvt_pk_bf16_f32 v234, v188, v189
    v_cvt_pk_bf16_f32 v235, v190, v191
    v_mfma_f32_16x16x32_bf16 v[200:203], a[144:147], v[32:35], v[200:203]
    ds_read_b64_tr_b16 v[28:29], v243 offset:45056
    v_mfma_f32_16x16x32_bf16 v[200:203], a[148:151], v[36:39], v[200:203]
    ds_read_b64_tr_b16 v[30:31], v243 offset:45568
    v_mfma_f32_16x16x32_bf16 v[200:203], a[152:155], v[40:43], v[200:203]
    buffer_store_dwordx4 v[232:235], v1, s[4:7], s38 offen sc1
    v_mfma_f32_16x16x32_bf16 v[200:203], a[156:159], v[44:47], v[200:203]
    v_mfma_f32_16x16x32_bf16 v[204:207], a[208:211], v[32:35], v[204:207]
    v_mfma_f32_16x16x32_bf16 v[204:207], a[212:215], v[36:39], v[204:207]
    v_mfma_f32_16x16x32_bf16 v[204:207], a[216:219], v[40:43], v[204:207]
    v_mfma_f32_16x16x32_bf16 v[204:207], a[220:223], v[44:47], v[204:207]
    s_waitcnt lgkmcnt(0)
    v_mfma_f32_16x16x32_bf16 v[192:195], a[32:35], v[16:19], v[192:195]
    ds_read_b64_tr_b16 v[32:33], v243 offset:49152
    v_mfma_f32_16x16x32_bf16 v[192:195], a[36:39], v[20:23], v[192:195]
    ds_read_b64_tr_b16 v[34:35], v243 offset:49664
    v_mfma_f32_16x16x32_bf16 v[192:195], a[40:43], v[24:27], v[192:195]
    ds_read_b64_tr_b16 v[36:37], v243 offset:53248
    v_mfma_f32_16x16x32_bf16 v[192:195], a[44:47], v[28:31], v[192:195]
    v_cvt_pk_bf16_f32 v224, v60, v61
    v_cvt_pk_bf16_f32 v225, v62, v63
    v_mfma_f32_16x16x32_bf16 v[196:199], a[96:99], v[16:19], v[196:199]
    ds_read_b64_tr_b16 v[38:39], v243 offset:53760
    v_mfma_f32_16x16x32_bf16 v[196:199], a[100:103], v[20:23], v[196:199]
    ds_read_b64_tr_b16 v[40:41], v243 offset:57344
    v_mfma_f32_16x16x32_bf16 v[196:199], a[104:107], v[24:27], v[196:199]
    ds_read_b64_tr_b16 v[42:43], v243 offset:57856
    v_mfma_f32_16x16x32_bf16 v[196:199], a[108:111], v[28:31], v[196:199]
    s_add_u32 s38, s36, 12288
    v_cvt_pk_bf16_f32 v226, v76, v77
    v_cvt_pk_bf16_f32 v227, v78, v79
    v_mfma_f32_16x16x32_bf16 v[200:203], a[160:163], v[16:19], v[200:203]
    ds_read_b64_tr_b16 v[44:45], v243 offset:61440
    v_mfma_f32_16x16x32_bf16 v[200:203], a[164:167], v[20:23], v[200:203]
    ds_read_b64_tr_b16 v[46:47], v243 offset:61952
    v_mfma_f32_16x16x32_bf16 v[200:203], a[168:171], v[24:27], v[200:203]
    buffer_store_dwordx4 v[224:227], v1, s[4:7], s38 offen sc1
    v_mfma_f32_16x16x32_bf16 v[200:203], a[172:175], v[28:31], v[200:203]
    v_mfma_f32_16x16x32_bf16 v[204:207], a[224:227], v[16:19], v[204:207]
    v_mfma_f32_16x16x32_bf16 v[204:207], a[228:231], v[20:23], v[204:207]
    v_mfma_f32_16x16x32_bf16 v[204:207], a[232:235], v[24:27], v[204:207]
    v_mfma_f32_16x16x32_bf16 v[204:207], a[236:239], v[28:31], v[204:207]
    s_waitcnt vmcnt(14) lgkmcnt(0)
    s_barrier
    v_mfma_f32_16x16x32_bf16 v[192:195], a[48:51], v[32:35], v[192:195]
    ds_read_b64_tr_b16 v[16:17], v6 offset:0
    v_mfma_f32_16x16x32_bf16 v[192:195], a[52:55], v[36:39], v[192:195]
    ds_read_b64_tr_b16 v[18:19], v6 offset:512
    v_mfma_f32_16x16x32_bf16 v[192:195], a[56:59], v[40:43], v[192:195]
    ds_read_b64_tr_b16 v[20:21], v6 offset:4096
    v_mfma_f32_16x16x32_bf16 v[192:195], a[60:63], v[44:47], v[192:195]
    v_cvt_pk_bf16_f32 v228, v92, v93
    v_cvt_pk_bf16_f32 v229, v94, v95
    v_mfma_f32_16x16x32_bf16 v[196:199], a[112:115], v[32:35], v[196:199]
    ds_read_b64_tr_b16 v[22:23], v6 offset:4608
    v_mfma_f32_16x16x32_bf16 v[196:199], a[116:119], v[36:39], v[196:199]
    ds_read_b64_tr_b16 v[24:25], v6 offset:8192
    v_mfma_f32_16x16x32_bf16 v[196:199], a[120:123], v[40:43], v[196:199]
    ds_read_b64_tr_b16 v[26:27], v6 offset:8704
    v_mfma_f32_16x16x32_bf16 v[196:199], a[124:127], v[44:47], v[196:199]
    s_add_u32 s38, s36, 13312
    v_cvt_pk_bf16_f32 v230, v108, v109
    v_cvt_pk_bf16_f32 v231, v110, v111
    v_mfma_f32_16x16x32_bf16 v[200:203], a[176:179], v[32:35], v[200:203]
    ds_read_b64_tr_b16 v[28:29], v6 offset:12288
    v_mfma_f32_16x16x32_bf16 v[200:203], a[180:183], v[36:39], v[200:203]
    ds_read_b64_tr_b16 v[30:31], v6 offset:12800
    v_mfma_f32_16x16x32_bf16 v[200:203], a[184:187], v[40:43], v[200:203]
    buffer_store_dwordx4 v[228:231], v1, s[4:7], s38 offen sc1
    v_mfma_f32_16x16x32_bf16 v[200:203], a[188:191], v[44:47], v[200:203]
    v_mfma_f32_16x16x32_bf16 v[204:207], a[240:243], v[32:35], v[204:207]
    v_mfma_f32_16x16x32_bf16 v[204:207], a[244:247], v[36:39], v[204:207]
    v_mfma_f32_16x16x32_bf16 v[204:207], a[248:251], v[40:43], v[204:207]
    v_mfma_f32_16x16x32_bf16 v[204:207], a[252:255], v[44:47], v[204:207]
    s_waitcnt vmcnt(8)
    v_cmp_ne_u32 vcc, 1, v254
    s_cbranch_vccnz L_spin_xn
L_ok_xn:
    s_waitcnt lgkmcnt(2)
    v_mfma_f32_16x16x32_bf16 v[176:179], a[0:3], v[16:19], 0
    ds_read_b64_tr_b16 v[32:33], v6 offset:16384
    v_mfma_f32_16x16x32_bf16 v[176:179], a[4:7], v[20:23], v[176:179]
    ds_read_b64_tr_b16 v[34:35], v6 offset:16896
    v_mfma_f32_16x16x32_bf16 v[176:179], a[8:11], v[24:27], v[176:179]
    ds_read_b64_tr_b16 v[36:37], v6 offset:20480
    s_waitcnt lgkmcnt(3)
    v_mfma_f32_16x16x32_bf16 v[176:179], a[12:15], v[28:31], v[176:179]
    v_mfma_f32_16x16x32_bf16 v[180:183], a[64:67], v[16:19], 0
    ds_read_b64_tr_b16 v[38:39], v6 offset:20992
    v_mfma_f32_16x16x32_bf16 v[180:183], a[68:71], v[20:23], v[180:183]
    ds_read_b64_tr_b16 v[40:41], v6 offset:24576
    v_mfma_f32_16x16x32_bf16 v[180:183], a[72:75], v[24:27], v[180:183]
    ds_read_b64_tr_b16 v[42:43], v6 offset:25088
    v_mfma_f32_16x16x32_bf16 v[180:183], a[76:79], v[28:31], v[180:183]
    v_cvt_pk_bf16_f32 v232, v192, v193
    v_cvt_pk_bf16_f32 v233, v194, v195
    v_mfma_f32_16x16x32_bf16 v[184:187], a[128:131], v[16:19], 0
    ds_read_b64_tr_b16 v[44:45], v6 offset:28672
    v_mfma_f32_16x16x32_bf16 v[184:187], a[132:135], v[20:23], v[184:187]
    ds_read_b64_tr_b16 v[46:47], v6 offset:29184
    v_mfma_f32_16x16x32_bf16 v[184:187], a[136:139], v[24:27], v[184:187]
    s_add_u32 s38, s36, 22528
    v_cvt_pk_bf16_f32 v234, v196, v197
    v_cvt_pk_bf16_f32 v235, v198, v199
    v_mfma_f32_16x16x32_bf16 v[184:187], a[140:143], v[28:31], v[184:187]
    buffer_store_dwordx4 v[232:235], v1, s[4:7], s38 offen sc1
    v_mfma_f32_16x16x32_bf16 v[188:191], a[192:195], v[16:19], 0
    v_mfma_f32_16x16x32_bf16 v[188:191], a[196:199], v[20:23], v[188:191]
    v_mfma_f32_16x16x32_bf16 v[188:191], a[200:203], v[24:27], v[188:191]
    v_mfma_f32_16x16x32_bf16 v[188:191], a[204:207], v[28:31], v[188:191]
    s_waitcnt lgkmcnt(0)
    s_barrier
    v_mfma_f32_16x16x32_bf16 v[176:179], a[16:19], v[32:35], v[176:179]
    ds_read_b64_tr_b16 v[16:17], v6 offset:32768
    v_mfma_f32_16x16x32_bf16 v[176:179], a[20:23], v[36:39], v[176:179]
    ds_read_b64_tr_b16 v[18:19], v6 offset:33280
    v_mfma_f32_16x16x32_bf16 v[176:179], a[24:27], v[40:43], v[176:179]
    ds_read_b64_tr_b16 v[20:21], v6 offset:36864
    v_mfma_f32_16x16x32_bf16 v[176:179], a[28:31], v[44:47], v[176:179]
    v_cvt_pk_bf16_f32 v224, v200, v201
    v_cvt_pk_bf16_f32 v225, v202, v203
    v_mfma_f32_16x16x32_bf16 v[180:183], a[80:83], v[32:35], v[180:183]
    ds_read_b64_tr_b16 v[22:23], v6 offset:37376
    v_mfma_f32_16x16x32_bf16 v[180:183], a[84:87], v[36:39], v[180:183]
    ds_read_b64_tr_b16 v[24:25], v6 offset:40960
    v_mfma_f32_16x16x32_bf16 v[180:183], a[88:91], v[40:43], v[180:183]
    ds_read_b64_tr_b16 v[26:27], v6 offset:41472
    v_mfma_f32_16x16x32_bf16 v[180:183], a[92:95], v[44:47], v[180:183]
    s_add_u32 s38, s36, 23552
    v_cvt_pk_bf16_f32 v226, v204, v205
    v_cvt_pk_bf16_f32 v227, v206, v207
    v_mfma_f32_16x16x32_bf16 v[184:187], a[144:147], v[32:35], v[184:187]
    ds_read_b64_tr_b16 v[28:29], v6 offset:45056
    v_mfma_f32_16x16x32_bf16 v[184:187], a[148:151], v[36:39], v[184:187]
    ds_read_b64_tr_b16 v[30:31], v6 offset:45568
    v_mfma_f32_16x16x32_bf16 v[184:187], a[152:155], v[40:43], v[184:187]
    buffer_store_dwordx4 v[224:227], v1, s[4:7], s38 offen sc1
    v_mfma_f32_16x16x32_bf16 v[184:187], a[156:159], v[44:47], v[184:187]
    s_nop 0
    s_add_u32 m0, s40, 0
    s_add_u32 s51, s64, 39845888
    v_mfma_f32_16x16x32_bf16 v[188:191], a[208:211], v[32:35], v[188:191]
    buffer_load_dwordx4 v1, s[4:7], s51 offen offset:0 sc1 lds
    v_mfma_f32_16x16x32_bf16 v[188:191], a[212:215], v[36:39], v[188:191]
    buffer_load_dwordx4 v1, s[4:7], s51 offen offset:1024 sc1 lds
    v_mfma_f32_16x16x32_bf16 v[188:191], a[216:219], v[40:43], v[188:191]
    buffer_load_dwordx4 v1, s[4:7], s51 offen offset:2048 sc1 lds
    v_mfma_f32_16x16x32_bf16 v[188:191], a[220:223], v[44:47], v[188:191]
    buffer_load_dwordx4 v1, s[4:7], s51 offen offset:3072 sc1 lds
    s_waitcnt lgkmcnt(2)
    v_mfma_f32_16x16x32_bf16 v[176:179], a[32:35], v[16:19], v[176:179]
    ds_read_b64_tr_b16 v[32:33], v6 offset:49152
    v_mfma_f32_16x16x32_bf16 v[176:179], a[36:39], v[20:23], v[176:179]
    ds_read_b64_tr_b16 v[34:35], v6 offset:49664
    v_mfma_f32_16x16x32_bf16 v[176:179], a[40:43], v[24:27], v[176:179]
    ds_read_b64_tr_b16 v[36:37], v6 offset:53248
    s_waitcnt lgkmcnt(3)
    v_mfma_f32_16x16x32_bf16 v[176:179], a[44:47], v[28:31], v[176:179]
    v_cvt_pk_bf16_f32 v228, v112, v113
    v_cvt_pk_bf16_f32 v229, v114, v115
    v_mfma_f32_16x16x32_bf16 v[180:183], a[96:99], v[16:19], v[180:183]
    ds_read_b64_tr_b16 v[38:39], v6 offset:53760
    v_mfma_f32_16x16x32_bf16 v[180:183], a[100:103], v[20:23], v[180:183]
    ds_read_b64_tr_b16 v[40:41], v6 offset:57344
    v_mfma_f32_16x16x32_bf16 v[180:183], a[104:107], v[24:27], v[180:183]
    ds_read_b64_tr_b16 v[42:43], v6 offset:57856
    v_mfma_f32_16x16x32_bf16 v[180:183], a[108:111], v[28:31], v[180:183]
    s_add_u32 s38, s36, 2048
    v_cvt_pk_bf16_f32 v230, v128, v129
    v_cvt_pk_bf16_f32 v231, v130, v131
    v_mfma_f32_16x16x32_bf16 v[184:187], a[160:163], v[16:19], v[184:187]
    ds_read_b64_tr_b16 v[44:45], v6 offset:61440
    v_mfma_f32_16x16x32_bf16 v[184:187], a[164:167], v[20:23], v[184:187]
    ds_read_b64_tr_b16 v[46:47], v6 offset:61952
    v_mfma_f32_16x16x32_bf16 v[184:187], a[168:171], v[24:27], v[184:187]
    buffer_store_dwordx4 v[228:231], v1, s[4:7], s38 offen sc1
    v_mfma_f32_16x16x32_bf16 v[184:187], a[172:175], v[28:31], v[184:187]
    v_mfma_f32_16x16x32_bf16 v[188:191], a[224:227], v[16:19], v[188:191]
    v_mfma_f32_16x16x32_bf16 v[188:191], a[228:231], v[20:23], v[188:191]
    v_mfma_f32_16x16x32_bf16 v[188:191], a[232:235], v[24:27], v[188:191]
    v_mfma_f32_16x16x32_bf16 v[188:191], a[236:239], v[28:31], v[188:191]
    s_waitcnt lgkmcnt(0)
    v_mfma_f32_16x16x32_bf16 v[176:179], a[48:51], v[32:35], v[176:179]
    ds_read_b64_tr_b16 v[16:17], v7 offset:0
    v_mfma_f32_16x16x32_bf16 v[176:179], a[52:55], v[36:39], v[176:179]
    ds_read_b64_tr_b16 v[18:19], v7 offset:512
    v_mfma_f32_16x16x32_bf16 v[176:179], a[56:59], v[40:43], v[176:179]
    ds_read_b64_tr_b16 v[20:21], v7 offset:4096
    v_mfma_f32_16x16x32_bf16 v[176:179], a[60:63], v[44:47], v[176:179]
    v_cvt_pk_bf16_f32 v232, v144, v145
    v_cvt_pk_bf16_f32 v233, v146, v147
    v_mfma_f32_16x16x32_bf16 v[180:183], a[112:115], v[32:35], v[180:183]
    ds_read_b64_tr_b16 v[22:23], v7 offset:4608
    v_mfma_f32_16x16x32_bf16 v[180:183], a[116:119], v[36:39], v[180:183]
    ds_read_b64_tr_b16 v[24:25], v7 offset:8192
    v_mfma_f32_16x16x32_bf16 v[180:183], a[120:123], v[40:43], v[180:183]
    ds_read_b64_tr_b16 v[26:27], v7 offset:8704
    v_mfma_f32_16x16x32_bf16 v[180:183], a[124:127], v[44:47], v[180:183]
    s_add_u32 s38, s36, 3072
    v_cvt_pk_bf16_f32 v234, v160, v161
    v_cvt_pk_bf16_f32 v235, v162, v163
    v_mfma_f32_16x16x32_bf16 v[184:187], a[176:179], v[32:35], v[184:187]
    ds_read_b64_tr_b16 v[28:29], v7 offset:12288
    v_mfma_f32_16x16x32_bf16 v[184:187], a[180:183], v[36:39], v[184:187]
    ds_read_b64_tr_b16 v[30:31], v7 offset:12800
    v_mfma_f32_16x16x32_bf16 v[184:187], a[184:187], v[40:43], v[184:187]
    buffer_store_dwordx4 v[232:235], v1, s[4:7], s38 offen sc1
    v_mfma_f32_16x16x32_bf16 v[184:187], a[188:191], v[44:47], v[184:187]
    s_nop 0
    s_add_u32 m0, s40, 4096
    s_add_u32 s51, s65, 39845888
    v_mfma_f32_16x16x32_bf16 v[188:191], a[240:243], v[32:35], v[188:191]
    buffer_load_dwordx4 v1, s[4:7], s51 offen offset:0 sc1 lds
    v_mfma_f32_16x16x32_bf16 v[188:191], a[244:247], v[36:39], v[188:191]
    buffer_load_dwordx4 v1, s[4:7], s51 offen offset:1024 sc1 lds
    v_mfma_f32_16x16x32_bf16 v[188:191], a[248:251], v[40:43], v[188:191]
    buffer_load_dwordx4 v1, s[4:7], s51 offen offset:2048 sc1 lds
    v_mfma_f32_16x16x32_bf16 v[188:191], a[252:255], v[44:47], v[188:191]
    buffer_load_dwordx4 v1, s[4:7], s51 offen offset:3072 sc1 lds
    s_waitcnt lgkmcnt(2)
    v_mfma_f32_16x16x32_bf16 v[192:195], a[0:3], v[16:19], 0
    ds_read_b64_tr_b16 v[32:33], v7 offset:16384
    v_mfma_f32_16x16x32_bf16 v[192:195], a[4:7], v[20:23], v[192:195]
    ds_read_b64_tr_b16 v[34:35], v7 offset:16896
    v_mfma_f32_16x16x32_bf16 v[192:195], a[8:11], v[24:27], v[192:195]
    ds_read_b64_tr_b16 v[36:37], v7 offset:20480
    s_waitcnt lgkmcnt(3)
    v_mfma_f32_16x16x32_bf16 v[192:195], a[12:15], v[28:31], v[192:195]
    v_mfma_f32_16x16x32_bf16 v[196:199], a[64:67], v[16:19], 0
    ds_read_b64_tr_b16 v[38:39], v7 offset:20992
    v_mfma_f32_16x16x32_bf16 v[196:199], a[68:71], v[20:23], v[196:199]
    ds_read_b64_tr_b16 v[40:41], v7 offset:24576
    v_mfma_f32_16x16x32_bf16 v[196:199], a[72:75], v[24:27], v[196:199]
    ds_read_b64_tr_b16 v[42:43], v7 offset:25088
    v_mfma_f32_16x16x32_bf16 v[196:199], a[76:79], v[28:31], v[196:199]
    v_cvt_pk_bf16_f32 v224, v176, v177
    v_cvt_pk_bf16_f32 v225, v178, v179
    v_mfma_f32_16x16x32_bf16 v[200:203], a[128:131], v[16:19], 0
    ds_read_b64_tr_b16 v[44:45], v7 offset:28672
    v_mfma_f32_16x16x32_bf16 v[200:203], a[132:135], v[20:23], v[200:203]
    ds_read_b64_tr_b16 v[46:47], v7 offset:29184
    v_mfma_f32_16x16x32_bf16 v[200:203], a[136:139], v[24:27], v[200:203]
    s_add_u32 s38, s36, 24576
    v_cvt_pk_bf16_f32 v226, v180, v181
    v_cvt_pk_bf16_f32 v227, v182, v183
    v_mfma_f32_16x16x32_bf16 v[200:203], a[140:143], v[28:31], v[200:203]
    buffer_store_dwordx4 v[224:227], v1, s[4:7], s38 offen sc1
    v_mfma_f32_16x16x32_bf16 v[204:207], a[192:195], v[16:19], 0
    v_mfma_f32_16x16x32_bf16 v[204:207], a[196:199], v[20:23], v[204:207]
    v_mfma_f32_16x16x32_bf16 v[204:207], a[200:203], v[24:27], v[204:207]
    v_mfma_f32_16x16x32_bf16 v[204:207], a[204:207], v[28:31], v[204:207]
    s_waitcnt lgkmcnt(0)
    v_mfma_f32_16x16x32_bf16 v[192:195], a[16:19], v[32:35], v[192:195]
    ds_read_b64_tr_b16 v[16:17], v7 offset:32768
    v_mfma_f32_16x16x32_bf16 v[192:195], a[20:23], v[36:39], v[192:195]
    ds_read_b64_tr_b16 v[18:19], v7 offset:33280
    v_mfma_f32_16x16x32_bf16 v[192:195], a[24:27], v[40:43], v[192:195]
    ds_read_b64_tr_b16 v[20:21], v7 offset:36864
    v_mfma_f32_16x16x32_bf16 v[192:195], a[28:31], v[44:47], v[192:195]
    v_cvt_pk_bf16_f32 v228, v184, v185
    v_cvt_pk_bf16_f32 v229, v186, v187
    v_mfma_f32_16x16x32_bf16 v[196:199], a[80:83], v[32:35], v[196:199]
    ds_read_b64_tr_b16 v[22:23], v7 offset:37376
    v_mfma_f32_16x16x32_bf16 v[196:199], a[84:87], v[36:39], v[196:199]
    ds_read_b64_tr_b16 v[24:25], v7 offset:40960
    v_mfma_f32_16x16x32_bf16 v[196:199], a[88:91], v[40:43], v[196:199]
    ds_read_b64_tr_b16 v[26:27], v7 offset:41472
    v_mfma_f32_16x16x32_bf16 v[196:199], a[92:95], v[44:47], v[196:199]
    s_add_u32 s38, s36, 25600
    v_cvt_pk_bf16_f32 v230, v188, v189
    v_cvt_pk_bf16_f32 v231, v190, v191
    v_mfma_f32_16x16x32_bf16 v[200:203], a[144:147], v[32:35], v[200:203]
    ds_read_b64_tr_b16 v[28:29], v7 offset:45056
    v_mfma_f32_16x16x32_bf16 v[200:203], a[148:151], v[36:39], v[200:203]
    ds_read_b64_tr_b16 v[30:31], v7 offset:45568
    v_mfma_f32_16x16x32_bf16 v[200:203], a[152:155], v[40:43], v[200:203]
    buffer_store_dwordx4 v[228:231], v1, s[4:7], s38 offen sc1
    v_mfma_f32_16x16x32_bf16 v[200:203], a[156:159], v[44:47], v[200:203]
    s_nop 0
    s_add_u32 m0, s40, 8192
    s_add_u32 s51, s66, 39845888
    v_mfma_f32_16x16x32_bf16 v[204:207], a[208:211], v[32:35], v[204:207]
    buffer_load_dwordx4 v1, s[4:7], s51 offen offset:0 sc1 lds
    v_mfma_f32_16x16x32_bf16 v[204:207], a[212:215], v[36:39], v[204:207]
    buffer_load_dwordx4 v1, s[4:7], s51 offen offset:1024 sc1 lds
    v_mfma_f32_16x16x32_bf16 v[204:207], a[216:219], v[40:43], v[204:207]
    buffer_load_dwordx4 v1, s[4:7], s51 offen offset:2048 sc1 lds
    v_mfma_f32_16x16x32_bf16 v[204:207], a[220:223], v[44:47], v[204:207]
    buffer_load_dwordx4 v1, s[4:7], s51 offen offset:3072 sc1 lds
    s_waitcnt lgkmcnt(2)
    v_mfma_f32_16x16x32_bf16 v[192:195], a[32:35], v[16:19], v[192:195]
    ds_read_b64_tr_b16 v[32:33], v7 offset:49152
    v_mfma_f32_16x16x32_bf16 v[192:195], a[36:39], v[20:23], v[192:195]
    ds_read_b64_tr_b16 v[34:35], v7 offset:49664
    v_mfma_f32_16x16x32_bf16 v[192:195], a[40:43], v[24:27], v[192:195]
    ds_read_b64_tr_b16 v[36:37], v7 offset:53248
    s_waitcnt lgkmcnt(3)
    v_mfma_f32_16x16x32_bf16 v[192:195], a[44:47], v[28:31], v[192:195]
    v_cvt_pk_bf16_f32 v232, v116, v117
    v_cvt_pk_bf16_f32 v233, v118, v119
    v_mfma_f32_16x16x32_bf16 v[196:199], a[96:99], v[16:19], v[196:199]
    ds_read_b64_tr_b16 v[38:39], v7 offset:53760
    v_mfma_f32_16x16x32_bf16 v[196:199], a[100:103], v[20:23], v[196:199]
    ds_read_b64_tr_b16 v[40:41], v7 offset:57344
    v_mfma_f32_16x16x32_bf16 v[196:199], a[104:107], v[24:27], v[196:199]
    ds_read_b64_tr_b16 v[42:43], v7 offset:57856
    v_mfma_f32_16x16x32_bf16 v[196:199], a[108:111], v[28:31], v[196:199]
    s_add_u32 s38, s36, 6144
    v_cvt_pk_bf16_f32 v234, v132, v133
    v_cvt_pk_bf16_f32 v235, v134, v135
    v_mfma_f32_16x16x32_bf16 v[200:203], a[160:163], v[16:19], v[200:203]
    ds_read_b64_tr_b16 v[44:45], v7 offset:61440
    v_mfma_f32_16x16x32_bf16 v[200:203], a[164:167], v[20:23], v[200:203]
    ds_read_b64_tr_b16 v[46:47], v7 offset:61952
    v_mfma_f32_16x16x32_bf16 v[200:203], a[168:171], v[24:27], v[200:203]
    buffer_store_dwordx4 v[232:235], v1, s[4:7], s38 offen sc1
    v_mfma_f32_16x16x32_bf16 v[200:203], a[172:175], v[28:31], v[200:203]
    v_mfma_f32_16x16x32_bf16 v[204:207], a[224:227], v[16:19], v[204:207]
    v_mfma_f32_16x16x32_bf16 v[204:207], a[228:231], v[20:23], v[204:207]
    v_mfma_f32_16x16x32_bf16 v[204:207], a[232:235], v[24:27], v[204:207]
    v_mfma_f32_16x16x32_bf16 v[204:207], a[236:239], v[28:31], v[204:207]
    s_waitcnt lgkmcnt(0)
    v_mfma_f32_16x16x32_bf16 v[192:195], a[48:51], v[32:35], v[192:195]
    ds_read_b64_tr_b16 v[16:17], v8 offset:0
    v_mfma_f32_16x16x32_bf16 v[192:195], a[52:55], v[36:39], v[192:195]
    ds_read_b64_tr_b16 v[18:19], v8 offset:512
    v_mfma_f32_16x16x32_bf16 v[192:195], a[56:59], v[40:43], v[192:195]
    ds_read_b64_tr_b16 v[20:21], v8 offset:4096
    v_mfma_f32_16x16x32_bf16 v[192:195], a[60:63], v[44:47], v[192:195]
    v_cvt_pk_bf16_f32 v224, v148, v149
    v_cvt_pk_bf16_f32 v225, v150, v151
    v_mfma_f32_16x16x32_bf16 v[196:199], a[112:115], v[32:35], v[196:199]
    ds_read_b64_tr_b16 v[22:23], v8 offset:4608
    v_mfma_f32_16x16x32_bf16 v[196:199], a[116:119], v[36:39], v[196:199]
    ds_read_b64_tr_b16 v[24:25], v8 offset:8192
    v_mfma_f32_16x16x32_bf16 v[196:199], a[120:123], v[40:43], v[196:199]
    ds_read_b64_tr_b16 v[26:27], v8 offset:8704
    v_mfma_f32_16x16x32_bf16 v[196:199], a[124:127], v[44:47], v[196:199]
    s_add_u32 s38, s36, 7168
    v_cvt_pk_bf16_f32 v226, v164, v165
    v_cvt_pk_bf16_f32 v227, v166, v167
    v_mfma_f32_16x16x32_bf16 v[200:203], a[176:179], v[32:35], v[200:203]
    ds_read_b64_tr_b16 v[28:29], v8 offset:12288
    v_mfma_f32_16x16x32_bf16 v[200:203], a[180:183], v[36:39], v[200:203]
    ds_read_b64_tr_b16 v[30:31], v8 offset:12800
    v_mfma_f32_16x16x32_bf16 v[200:203], a[184:187], v[40:43], v[200:203]
    buffer_store_dwordx4 v[224:227], v1, s[4:7], s38 offen sc1
    v_mfma_f32_16x16x32_bf16 v[200:203], a[188:191], v[44:47], v[200:203]
    s_nop 0
    s_add_u32 m0, s40, 12288
    s_add_u32 s51, s67, 39845888
    v_mfma_f32_16x16x32_bf16 v[204:207], a[240:243], v[32:35], v[204:207]
    buffer_load_dwordx4 v1, s[4:7], s51 offen offset:0 sc1 lds
    v_mfma_f32_16x16x32_bf16 v[204:207], a[244:247], v[36:39], v[204:207]
    buffer_load_dwordx4 v1, s[4:7], s51 offen offset:1024 sc1 lds
    v_mfma_f32_16x16x32_bf16 v[204:207], a[248:251], v[40:43], v[204:207]
    buffer_load_dwordx4 v1, s[4:7], s51 offen offset:2048 sc1 lds
    v_mfma_f32_16x16x32_bf16 v[204:207], a[252:255], v[44:47], v[204:207]
    buffer_load_dwordx4 v1, s[4:7], s51 offen offset:3072 sc1 lds
    s_waitcnt lgkmcnt(2)
    v_mfma_f32_16x16x32_bf16 v[176:179], a[0:3], v[16:19], 0
    ds_read_b64_tr_b16 v[32:33], v8 offset:16384
    v_mfma_f32_16x16x32_bf16 v[176:179], a[4:7], v[20:23], v[176:179]
    ds_read_b64_tr_b16 v[34:35], v8 offset:16896
    v_mfma_f32_16x16x32_bf16 v[176:179], a[8:11], v[24:27], v[176:179]
    ds_read_b64_tr_b16 v[36:37], v8 offset:20480
    s_waitcnt lgkmcnt(3)
    v_mfma_f32_16x16x32_bf16 v[176:179], a[12:15], v[28:31], v[176:179]
    v_mfma_f32_16x16x32_bf16 v[180:183], a[64:67], v[16:19], 0
    ds_read_b64_tr_b16 v[38:39], v8 offset:20992
    v_mfma_f32_16x16x32_bf16 v[180:183], a[68:71], v[20:23], v[180:183]
    ds_read_b64_tr_b16 v[40:41], v8 offset:24576
    v_mfma_f32_16x16x32_bf16 v[180:183], a[72:75], v[24:27], v[180:183]
    ds_read_b64_tr_b16 v[42:43], v8 offset:25088
    v_mfma_f32_16x16x32_bf16 v[180:183], a[76:79], v[28:31], v[180:183]
    v_cvt_pk_bf16_f32 v228, v192, v193
    v_cvt_pk_bf16_f32 v229, v194, v195
    v_mfma_f32_16x16x32_bf16 v[184:187], a[128:131], v[16:19], 0
    ds_read_b64_tr_b16 v[44:45], v8 offset:28672
    v_mfma_f32_16x16x32_bf16 v[184:187], a[132:135], v[20:23], v[184:187]
    ds_read_b64_tr_b16 v[46:47], v8 offset:29184
    v_mfma_f32_16x16x32_bf16 v[184:187], a[136:139], v[24:27], v[184:187]
    s_add_u32 s38, s36, 26624
    v_cvt_pk_bf16_f32 v230, v196, v197
    v_cvt_pk_bf16_f32 v231, v198, v199
    v_mfma_f32_16x16x32_bf16 v[184:187], a[140:143], v[28:31], v[184:187]
    buffer_store_dwordx4 v[228:231], v1, s[4:7], s38 offen sc1
    v_mfma_f32_16x16x32_bf16 v[188:191], a[192:195], v[16:19], 0
    v_mfma_f32_16x16x32_bf16 v[188:191], a[196:199], v[20:23], v[188:191]
    v_mfma_f32_16x16x32_bf16 v[188:191], a[200:203], v[24:27], v[188:191]
    v_mfma_f32_16x16x32_bf16 v[188:191], a[204:207], v[28:31], v[188:191]
    s_waitcnt lgkmcnt(0)
    v_mfma_f32_16x16x32_bf16 v[176:179], a[16:19], v[32:35], v[176:179]
    ds_read_b64_tr_b16 v[16:17], v8 offset:32768
    v_mfma_f32_16x16x32_bf16 v[176:179], a[20:23], v[36:39], v[176:179]
    ds_read_b64_tr_b16 v[18:19], v8 offset:33280
    v_mfma_f32_16x16x32_bf16 v[176:179], a[24:27], v[40:43], v[176:179]
    ds_read_b64_tr_b16 v[20:21], v8 offset:36864
    v_mfma_f32_16x16x32_bf16 v[176:179], a[28:31], v[44:47], v[176:179]
    v_cvt_pk_bf16_f32 v232, v200, v201
    v_cvt_pk_bf16_f32 v233, v202, v203
    v_mfma_f32_16x16x32_bf16 v[180:183], a[80:83], v[32:35], v[180:183]
    ds_read_b64_tr_b16 v[22:23], v8 offset:37376
    v_mfma_f32_16x16x32_bf16 v[180:183], a[84:87], v[36:39], v[180:183]
    ds_read_b64_tr_b16 v[24:25], v8 offset:40960
    v_mfma_f32_16x16x32_bf16 v[180:183], a[88:91], v[40:43], v[180:183]
    ds_read_b64_tr_b16 v[26:27], v8 offset:41472
    v_mfma_f32_16x16x32_bf16 v[180:183], a[92:95], v[44:47], v[180:183]
    s_add_u32 s38, s36, 27648
    v_cvt_pk_bf16_f32 v234, v204, v205
    v_cvt_pk_bf16_f32 v235, v206, v207
    v_mfma_f32_16x16x32_bf16 v[184:187], a[144:147], v[32:35], v[184:187]
    ds_read_b64_tr_b16 v[28:29], v8 offset:45056
    v_mfma_f32_16x16x32_bf16 v[184:187], a[148:151], v[36:39], v[184:187]
    ds_read_b64_tr_b16 v[30:31], v8 offset:45568
    v_mfma_f32_16x16x32_bf16 v[184:187], a[152:155], v[40:43], v[184:187]
    buffer_store_dwordx4 v[232:235], v1, s[4:7], s38 offen sc1
    v_mfma_f32_16x16x32_bf16 v[184:187], a[156:159], v[44:47], v[184:187]
    v_mfma_f32_16x16x32_bf16 v[188:191], a[208:211], v[32:35], v[188:191]
    v_mfma_f32_16x16x32_bf16 v[188:191], a[212:215], v[36:39], v[188:191]
    v_mfma_f32_16x16x32_bf16 v[188:191], a[216:219], v[40:43], v[188:191]
    v_mfma_f32_16x16x32_bf16 v[188:191], a[220:223], v[44:47], v[188:191]
    s_waitcnt lgkmcnt(0)
    v_mfma_f32_16x16x32_bf16 v[176:179], a[32:35], v[16:19], v[176:179]
    ds_read_b64_tr_b16 v[32:33], v8 offset:49152
    v_mfma_f32_16x16x32_bf16 v[176:179], a[36:39], v[20:23], v[176:179]
    ds_read_b64_tr_b16 v[34:35], v8 offset:49664
    v_mfma_f32_16x16x32_bf16 v[176:179], a[40:43], v[24:27], v[176:179]
    ds_read_b64_tr_b16 v[36:37], v8 offset:53248
    v_mfma_f32_16x16x32_bf16 v[176:179], a[44:47], v[28:31], v[176:179]
    v_cvt_pk_bf16_f32 v224, v120, v121
    v_cvt_pk_bf16_f32 v225, v122, v123
    v_mfma_f32_16x16x32_bf16 v[180:183], a[96:99], v[16:19], v[180:183]
    ds_read_b64_tr_b16 v[38:39], v8 offset:53760
    v_mfma_f32_16x16x32_bf16 v[180:183], a[100:103], v[20:23], v[180:183]
    ds_read_b64_tr_b16 v[40:41], v8 offset:57344
    v_mfma_f32_16x16x32_bf16 v[180:183], a[104:107], v[24:27], v[180:183]
    ds_read_b64_tr_b16 v[42:43], v8 offset:57856
    v_mfma_f32_16x16x32_bf16 v[180:183], a[108:111], v[28:31], v[180:183]
    s_add_u32 s38, s36, 10240
    v_cvt_pk_bf16_f32 v226, v136, v137
    v_cvt_pk_bf16_f32 v227, v138, v139
    v_mfma_f32_16x16x32_bf16 v[184:187], a[160:163], v[16:19], v[184:187]
    ds_read_b64_tr_b16 v[44:45], v8 offset:61440
    v_mfma_f32_16x16x32_bf16 v[184:187], a[164:167], v[20:23], v[184:187]
    ds_read_b64_tr_b16 v[46:47], v8 offset:61952
    v_mfma_f32_16x16x32_bf16 v[184:187], a[168:171], v[24:27], v[184:187]
    buffer_store_dwordx4 v[224:227], v1, s[4:7], s38 offen sc1
    v_mfma_f32_16x16x32_bf16 v[184:187], a[172:175], v[28:31], v[184:187]
    s_nop 0
    s_add_u32 m0, s68, 131072
    s_add_u32 s51, s48, 0
    v_mfma_f32_16x16x32_bf16 v[188:191], a[224:227], v[16:19], v[188:191]
    buffer_load_dwordx4 v248, s[12:15], s51 offen offset:0 lds
    v_mfma_f32_16x16x32_bf16 v[188:191], a[228:231], v[20:23], v[188:191]
    buffer_load_dwordx4 v249, s[12:15], s51 offen offset:1024 lds
    v_mfma_f32_16x16x32_bf16 v[188:191], a[232:235], v[24:27], v[188:191]
    buffer_load_dwordx4 v250, s[12:15], s51 offen offset:2048 lds
    v_mfma_f32_16x16x32_bf16 v[188:191], a[236:239], v[28:31], v[188:191]
    buffer_load_dwordx4 v251, s[12:15], s51 offen offset:3072 lds
    s_waitcnt lgkmcnt(2)
    v_mfma_f32_16x16x32_bf16 v[176:179], a[48:51], v[32:35], v[176:179]
    ds_read_b64_tr_b16 v[16:17], v9 offset:0
    v_mfma_f32_16x16x32_bf16 v[176:179], a[52:55], v[36:39], v[176:179]
    ds_read_b64_tr_b16 v[18:19], v9 offset:512
    v_mfma_f32_16x16x32_bf16 v[176:179], a[56:59], v[40:43], v[176:179]
    ds_read_b64_tr_b16 v[20:21], v9 offset:4096
    s_waitcnt lgkmcnt(3)
    v_mfma_f32_16x16x32_bf16 v[176:179], a[60:63], v[44:47], v[176:179]
    v_cvt_pk_bf16_f32 v228, v152, v153
    v_cvt_pk_bf16_f32 v229, v154, v155
    v_mfma_f32_16x16x32_bf16 v[180:183], a[112:115], v[32:35], v[180:183]
    ds_read_b64_tr_b16 v[22:23], v9 offset:4608
    v_mfma_f32_16x16x32_bf16 v[180:183], a[116:119], v[36:39], v[180:183]
    ds_read_b64_tr_b16 v[24:25], v9 offset:8192
    v_mfma_f32_16x16x32_bf16 v[180:183], a[120:123], v[40:43], v[180:183]
    ds_read_b64_tr_b16 v[26:27], v9 offset:8704
    v_mfma_f32_16x16x32_bf16 v[180:183], a[124:127], v[44:47], v[180:183]
    s_add_u32 s38, s36, 11264
    v_cvt_pk_bf16_f32 v230, v168, v169
    v_cvt_pk_bf16_f32 v231, v170, v171
    v_mfma_f32_16x16x32_bf16 v[184:187], a[176:179], v[32:35], v[184:187]
    ds_read_b64_tr_b16 v[28:29], v9 offset:12288
    v_mfma_f32_16x16x32_bf16 v[184:187], a[180:183], v[36:39], v[184:187]
    ds_read_b64_tr_b16 v[30:31], v9 offset:12800
    v_mfma_f32_16x16x32_bf16 v[184:187], a[184:187], v[40:43], v[184:187]
    buffer_store_dwordx4 v[228:231], v1, s[4:7], s38 offen sc1
    v_mfma_f32_16x16x32_bf16 v[184:187], a[188:191], v[44:47], v[184:187]
    v_mfma_f32_16x16x32_bf16 v[188:191], a[240:243], v[32:35], v[188:191]
    v_mfma_f32_16x16x32_bf16 v[188:191], a[244:247], v[36:39], v[188:191]
    v_mfma_f32_16x16x32_bf16 v[188:191], a[248:251], v[40:43], v[188:191]
    v_mfma_f32_16x16x32_bf16 v[188:191], a[252:255], v[44:47], v[188:191]
    s_waitcnt lgkmcnt(0)
    v_mfma_f32_16x16x32_bf16 v[192:195], a[0:3], v[16:19], 0
    ds_read_b64_tr_b16 v[32:33], v9 offset:16384
    v_mfma_f32_16x16x32_bf16 v[192:195], a[4:7], v[20:23], v[192:195]
    ds_read_b64_tr_b16 v[34:35], v9 offset:16896
    v_mfma_f32_16x16x32_bf16 v[192:195], a[8:11], v[24:27], v[192:195]
    ds_read_b64_tr_b16 v[36:37], v9 offset:20480
    v_mfma_f32_16x16x32_bf16 v[192:195], a[12:15], v[28:31], v[192:195]
    v_mfma_f32_16x16x32_bf16 v[196:199], a[64:67], v[16:19], 0
    ds_read_b64_tr_b16 v[38:39], v9 offset:20992
    v_mfma_f32_16x16x32_bf16 v[196:199], a[68:71], v[20:23], v[196:199]
    ds_read_b64_tr_b16 v[40:41], v9 offset:24576
    v_mfma_f32_16x16x32_bf16 v[196:199], a[72:75], v[24:27], v[196:199]
    ds_read_b64_tr_b16 v[42:43], v9 offset:25088
    v_mfma_f32_16x16x32_bf16 v[196:199], a[76:79], v[28:31], v[196:199]
    v_cvt_pk_bf16_f32 v232, v176, v177
    v_cvt_pk_bf16_f32 v233, v178, v179
    v_mfma_f32_16x16x32_bf16 v[200:203], a[128:131], v[16:19], 0
    ds_read_b64_tr_b16 v[44:45], v9 offset:28672
    v_mfma_f32_16x16x32_bf16 v[200:203], a[132:135], v[20:23], v[200:203]
    ds_read_b64_tr_b16 v[46:47], v9 offset:29184
    v_mfma_f32_16x16x32_bf16 v[200:203], a[136:139], v[24:27], v[200:203]
    s_add_u32 s38, s36, 28672
    v_cvt_pk_bf16_f32 v234, v180, v181
    v_cvt_pk_bf16_f32 v235, v182, v183
    v_mfma_f32_16x16x32_bf16 v[200:203], a[140:143], v[28:31], v[200:203]
    buffer_store_dwordx4 v[232:235], v1, s[4:7], s38 offen sc1
    v_mfma_f32_16x16x32_bf16 v[204:207], a[192:195], v[16:19], 0
    v_mfma_f32_16x16x32_bf16 v[204:207], a[196:199], v[20:23], v[204:207]
    v_mfma_f32_16x16x32_bf16 v[204:207], a[200:203], v[24:27], v[204:207]
    v_mfma_f32_16x16x32_bf16 v[204:207], a[204:207], v[28:31], v[204:207]
    s_waitcnt lgkmcnt(0)
    v_mfma_f32_16x16x32_bf16 v[192:195], a[16:19], v[32:35], v[192:195]
    ds_read_b64_tr_b16 v[16:17], v9 offset:32768
    v_mfma_f32_16x16x32_bf16 v[192:195], a[20:23], v[36:39], v[192:195]
    ds_read_b64_tr_b16 v[18:19], v9 offset:33280
    v_mfma_f32_16x16x32_bf16 v[192:195], a[24:27], v[40:43], v[192:195]
    ds_read_b64_tr_b16 v[20:21], v9 offset:36864
    v_mfma_f32_16x16x32_bf16 v[192:195], a[28:31], v[44:47], v[192:195]
    v_cvt_pk_bf16_f32 v224, v184, v185
    v_cvt_pk_bf16_f32 v225, v186, v187
    v_mfma_f32_16x16x32_bf16 v[196:199], a[80:83], v[32:35], v[196:199]
    ds_read_b64_tr_b16 v[22:23], v9 offset:37376
    v_mfma_f32_16x16x32_bf16 v[196:199], a[84:87], v[36:39], v[196:199]
    ds_read_b64_tr_b16 v[24:25], v9 offset:40960
    v_mfma_f32_16x16x32_bf16 v[196:199], a[88:91], v[40:43], v[196:199]
    ds_read_b64_tr_b16 v[26:27], v9 offset:41472
    v_mfma_f32_16x16x32_bf16 v[196:199], a[92:95], v[44:47], v[196:199]
    s_add_u32 s38, s36, 29696
    v_cvt_pk_bf16_f32 v226, v188, v189
    v_cvt_pk_bf16_f32 v227, v190, v191
    v_mfma_f32_16x16x32_bf16 v[200:203], a[144:147], v[32:35], v[200:203]
    ds_read_b64_tr_b16 v[28:29], v9 offset:45056
    v_mfma_f32_16x16x32_bf16 v[200:203], a[148:151], v[36:39], v[200:203]
    ds_read_b64_tr_b16 v[30:31], v9 offset:45568
    v_mfma_f32_16x16x32_bf16 v[200:203], a[152:155], v[40:43], v[200:203]
    buffer_store_dwordx4 v[224:227], v1, s[4:7], s38 offen sc1
    v_mfma_f32_16x16x32_bf16 v[200:203], a[156:159], v[44:47], v[200:203]
    s_nop 0
    s_add_u32 m0, s68, 147456
    s_add_u32 s51, s48, 128
    v_mfma_f32_16x16x32_bf16 v[204:207], a[208:211], v[32:35], v[204:207]
    buffer_load_dwordx4 v248, s[12:15], s51 offen offset:0 lds
    v_mfma_f32_16x16x32_bf16 v[204:207], a[212:215], v[36:39], v[204:207]
    buffer_load_dwordx4 v249, s[12:15], s51 offen offset:1024 lds
    v_mfma_f32_16x16x32_bf16 v[204:207], a[216:219], v[40:43], v[204:207]
    buffer_load_dwordx4 v250, s[12:15], s51 offen offset:2048 lds
    v_mfma_f32_16x16x32_bf16 v[204:207], a[220:223], v[44:47], v[204:207]
    buffer_load_dwordx4 v251, s[12:15], s51 offen offset:3072 lds
    s_waitcnt lgkmcnt(2)
    v_mfma_f32_16x16x32_bf16 v[192:195], a[32:35], v[16:19], v[192:195]
    ds_read_b64_tr_b16 v[32:33], v9 offset:49152
    v_mfma_f32_16x16x32_bf16 v[192:195], a[36:39], v[20:23], v[192:195]
    ds_read_b64_tr_b16 v[34:35], v9 offset:49664
    v_mfma_f32_16x16x32_bf16 v[192:195], a[40:43], v[24:27], v[192:195]
    ds_read_b64_tr_b16 v[36:37], v9 offset:53248
    s_waitcnt lgkmcnt(3)
    v_mfma_f32_16x16x32_bf16 v[192:195], a[44:47], v[28:31], v[192:195]
    v_cvt_pk_bf16_f32 v228, v124, v125
    v_cvt_pk_bf16_f32 v229, v126, v127
    v_mfma_f32_16x16x32_bf16 v[196:199], a[96:99], v[16:19], v[196:199]
    ds_read_b64_tr_b16 v[38:39], v9 offset:53760
    v_mfma_f32_16x16x32_bf16 v[196:199], a[100:103], v[20:23], v[196:199]
    ds_read_b64_tr_b16 v[40:41], v9 offset:57344
    v_mfma_f32_16x16x32_bf16 v[196:199], a[104:107], v[24:27], v[196:199]
    ds_read_b64_tr_b16 v[42:43], v9 offset:57856
    v_mfma_f32_16x16x32_bf16 v[196:199], a[108:111], v[28:31], v[196:199]
    s_add_u32 s38, s36, 14336
    v_cvt_pk_bf16_f32 v230, v140, v141
    v_cvt_pk_bf16_f32 v231, v142, v143
    v_mfma_f32_16x16x32_bf16 v[200:203], a[160:163], v[16:19], v[200:203]
    ds_read_b64_tr_b16 v[44:45], v9 offset:61440
    v_mfma_f32_16x16x32_bf16 v[200:203], a[164:167], v[20:23], v[200:203]
    ds_read_b64_tr_b16 v[46:47], v9 offset:61952
    v_mfma_f32_16x16x32_bf16 v[200:203], a[168:171], v[24:27], v[200:203]
    buffer_store_dwordx4 v[228:231], v1, s[4:7], s38 offen sc1
    v_mfma_f32_16x16x32_bf16 v[200:203], a[172:175], v[28:31], v[200:203]
    v_mfma_f32_16x16x32_bf16 v[204:207], a[224:227], v[16:19], v[204:207]
    v_mfma_f32_16x16x32_bf16 v[204:207], a[228:231], v[20:23], v[204:207]
    v_mfma_f32_16x16x32_bf16 v[204:207], a[232:235], v[24:27], v[204:207]
    v_mfma_f32_16x16x32_bf16 v[204:207], a[236:239], v[28:31], v[204:207]
    s_waitcnt lgkmcnt(2)
    v_mfma_f32_16x16x32_bf16 v[192:195], a[48:51], v[32:35], v[192:195]
    v_mfma_f32_16x16x32_bf16 v[192:195], a[52:55], v[36:39], v[192:195]
    v_mfma_f32_16x16x32_bf16 v[192:195], a[56:59], v[40:43], v[192:195]
    s_waitcnt lgkmcnt(0)
    v_mfma_f32_16x16x32_bf16 v[192:195], a[60:63], v[44:47], v[192:195]
    v_cvt_pk_bf16_f32 v232, v156, v157
    v_cvt_pk_bf16_f32 v233, v158, v159
    v_mfma_f32_16x16x32_bf16 v[196:199], a[112:115], v[32:35], v[196:199]
    s_add_u32 s38, s36, 15360
    v_cvt_pk_bf16_f32 v234, v172, v173
    v_cvt_pk_bf16_f32 v235, v174, v175
    v_mfma_f32_16x16x32_bf16 v[196:199], a[116:119], v[36:39], v[196:199]
    buffer_store_dwordx4 v[232:235], v1, s[4:7], s38 offen sc1
    v_mfma_f32_16x16x32_bf16 v[196:199], a[120:123], v[40:43], v[196:199]
    v_mfma_f32_16x16x32_bf16 v[196:199], a[124:127], v[44:47], v[196:199]
    v_mfma_f32_16x16x32_bf16 v[200:203], a[176:179], v[32:35], v[200:203]
    v_mfma_f32_16x16x32_bf16 v[200:203], a[180:183], v[36:39], v[200:203]
    v_mfma_f32_16x16x32_bf16 v[200:203], a[184:187], v[40:43], v[200:203]
    v_mfma_f32_16x16x32_bf16 v[200:203], a[188:191], v[44:47], v[200:203]
    v_mfma_f32_16x16x32_bf16 v[204:207], a[240:243], v[32:35], v[204:207]
    v_mfma_f32_16x16x32_bf16 v[204:207], a[244:247], v[36:39], v[204:207]
    v_mfma_f32_16x16x32_bf16 v[204:207], a[248:251], v[40:43], v[204:207]
    v_mfma_f32_16x16x32_bf16 v[204:207], a[252:255], v[44:47], v[204:207]
    v_add_u32 v9, s40, v1
    s_waitcnt vmcnt(16)
    ds_read_b128 a[0:3], v9 offset:0
    ds_read_b128 a[4:7], v9 offset:1024
    ds_read_b128 a[8:11], v9 offset:2048
    ds_read_b128 a[12:15], v9 offset:3072
    ds_read_b128 a[16:19], v9 offset:4096
    ds_read_b128 a[20:23], v9 offset:5120
    ds_read_b128 a[24:27], v9 offset:6144
    ds_read_b128 a[28:31], v9 offset:7168
    ds_read_b128 a[32:35], v9 offset:8192
    ds_read_b128 a[36:39], v9 offset:9216
    ds_read_b128 a[40:43], v9 offset:10240
    ds_read_b128 a[44:47], v9 offset:11264
    ds_read_b128 a[48:51], v9 offset:12288
    ds_read_b128 a[52:55], v9 offset:13312
    ds_read_b128 a[56:59], v9 offset:14336
    ds_read_b128 a[60:63], v9 offset:15360
    v_cvt_pk_bf16_f32 v224, v192, v193
    v_cvt_pk_bf16_f32 v225, v194, v195
    s_add_u32 s38, s36, 30720
    v_cvt_pk_bf16_f32 v226, v196, v197
    v_cvt_pk_bf16_f32 v227, v198, v199
    buffer_store_dwordx4 v[224:227], v1, s[4:7], s38 offen sc1
    v_cvt_pk_bf16_f32 v228, v200, v201
    v_cvt_pk_bf16_f32 v229, v202, v203
    s_add_u32 s38, s36, 31744
    v_cvt_pk_bf16_f32 v230, v204, v205
    v_cvt_pk_bf16_f32 v231, v206, v207
    buffer_store_dwordx4 v[228:231], v1, s[4:7], s38 offen sc1
    v_and_b32 v255, 7, v0
    v_lshl_add_u32 v255, v255, 2, s52
    s_waitcnt vmcnt(11) lgkmcnt(0)
    s_barrier
    ds_read_b64_tr_b16 v[208:209], v244 offset:0
    ds_read_b64_tr_b16 v[210:211], v244 offset:512
    ds_read_b64_tr_b16 v[212:213], v244 offset:4096
    ds_read_b64_tr_b16 v[214:215], v244 offset:4608
    ds_read_b64_tr_b16 v[216:217], v244 offset:8192
    ds_read_b64_tr_b16 v[218:219], v244 offset:8704
    ds_read_b64_tr_b16 v[220:221], v244 offset:12288
    ds_read_b64_tr_b16 v[222:223], v244 offset:12800
    s_waitcnt lgkmcnt(6)
    v_mfma_f32_16x16x32_bf16 v[80:83], v[208:211], a[0:3], 0
    ds_read_b64_tr_b16 v[224:225], v245 offset:0
    s_waitcnt lgkmcnt(5)
    v_mfma_f32_16x16x32_bf16 v[80:83], v[212:215], a[4:7], v[80:83]
    ds_read_b64_tr_b16 v[226:227], v245 offset:512
    s_waitcnt lgkmcnt(4)
    v_mfma_f32_16x16x32_bf16 v[80:83], v[216:219], a[8:11], v[80:83]
    ds_read_b64_tr_b16 v[228:229], v245 offset:4096
    s_waitcnt lgkmcnt(3)
    v_mfma_f32_16x16x32_bf16 v[80:83], v[220:223], a[12:15], v[80:83]
    s_lshr_b32 s54, s2, 3
    v_mfma_f32_16x16x32_bf16 v[84:87], v[208:211], a[16:19], 0
    ds_read_b64_tr_b16 v[230:231], v245 offset:4608
    v_mfma_f32_16x16x32_bf16 v[84:87], v[212:215], a[20:23], v[84:87]
    ds_read_b64_tr_b16 v[232:233], v245 offset:8192
    v_mfma_f32_16x16x32_bf16 v[84:87], v[216:219], a[24:27], v[84:87]
    ds_read_b64_tr_b16 v[234:235], v245 offset:8704
    v_mfma_f32_16x16x32_bf16 v[84:87], v[220:223], a[28:31], v[84:87]
    s_lshl_b32 s54, s54, 2
    v_mfma_f32_16x16x32_bf16 v[88:91], v[208:211], a[32:35], 0
    ds_read_b64_tr_b16 v[236:237], v245 offset:12288
    v_mfma_f32_16x16x32_bf16 v[88:91], v[212:215], a[36:39], v[88:91]
    ds_read_b64_tr_b16 v[238:239], v245 offset:12800
    v_mfma_f32_16x16x32_bf16 v[88:91], v[216:219], a[40:43], v[88:91]
    s_add_u32 s54, s54, s3
    v_mfma_f32_16x16x32_bf16 v[88:91], v[220:223], a[44:47], v[88:91]
    s_lshl_b32 s54, s54, 9
    v_lshrrev_b32 v3, 4, v0
    v_lshl_add_u32 v3, v3, 7, s54
    v_mfma_f32_16x16x32_bf16 v[92:95], v[208:211], a[48:51], 0
    v_min_u32 v3, L_text_last-L_att_P0, v3
    v_mfma_f32_16x16x32_bf16 v[92:95], v[212:215], a[52:55], v[92:95]
    s_add_u32 s51, s64, 39849984
    v_mfma_f32_16x16x32_bf16 v[92:95], v[216:219], a[56:59], v[92:95]
    buffer_load_dwordx4 a[64:67], v1, s[4:7], s51 offen offset:0 sc1
    v_mfma_f32_16x16x32_bf16 v[92:95], v[220:223], a[60:63], v[92:95]
    s_waitcnt lgkmcnt(0)
    v_mfma_f32_16x16x32_bf16 v[96:99], v[224:227], a[0:3], 0
    ds_read_b64_tr_b16 v[208:209], v246 offset:0
    v_mfma_f32_16x16x32_bf16 v[96:99], v[228:231], a[4:7], v[96:99]
    ds_read_b64_tr_b16 v[210:211], v246 offset:512
    v_mfma_f32_16x16x32_bf16 v[96:99], v[232:235], a[8:11], v[96:99]
    ds_read_b64_tr_b16 v[212:213], v246 offset:4096
    v_mfma_f32_16x16x32_bf16 v[96:99], v[236:239], a[12:15], v[96:99]
    buffer_load_dwordx4 a[68:71], v1, s[4:7], s51 offen offset:1024 sc1
    v_mfma_f32_16x16x32_bf16 v[100:103], v[224:227], a[16:19], 0
    ds_read_b64_tr_b16 v[214:215], v246 offset:4608
    v_mfma_f32_16x16x32_bf16 v[100:103], v[228:231], a[20:23], v[100:103]
    ds_read_b64_tr_b16 v[216:217], v246 offset:8192
    v_mfma_f32_16x16x32_bf16 v[100:103], v[232:235], a[24:27], v[100:103]
    ds_read_b64_tr_b16 v[218:219], v246 offset:8704
    v_mfma_f32_16x16x32_bf16 v[100:103], v[236:239], a[28:31], v[100:103]
    buffer_load_dwordx4 a[72:75], v1, s[4:7], s51 offen offset:2048 sc1
    v_mfma_f32_16x16x32_bf16 v[104:107], v[224:227], a[32:35], 0
    ds_read_b64_tr_b16 v[220:221], v246 offset:12288
    v_mfma_f32_16x16x32_bf16 v[104:107], v[228:231], a[36:39], v[104:107]
    ds_read_b64_tr_b16 v[222:223], v246 offset:12800
    v_mfma_f32_16x16x32_bf16 v[104:107], v[232:235], a[40:43], v[104:107]
    v_mfma_f32_16x16x32_bf16 v[104:107], v[236:239], a[44:47], v[104:107]
    buffer_load_dwordx4 a[76:79], v1, s[4:7], s51 offen offset:3072 sc1
    v_mfma_f32_16x16x32_bf16 v[108:111], v[224:227], a[48:51], 0
    s_add_u32 m0, s68, 114688
    v_mfma_f32_16x16x32_bf16 v[108:111], v[228:231], a[52:55], v[108:111]
    s_add_u32 s51, s48, 1048576
    v_mfma_f32_16x16x32_bf16 v[108:111], v[232:235], a[56:59], v[108:111]
    buffer_load_dwordx4 v248, s[12:15], s51 offen offset:0 lds
    v_mfma_f32_16x16x32_bf16 v[108:111], v[236:239], a[60:63], v[108:111]
    s_waitcnt lgkmcnt(0)
    v_mfma_f32_16x16x32_bf16 v[112:115], v[208:211], a[0:3], 0
    ds_read_b64_tr_b16 v[224:225], v247 offset:0
    v_mfma_f32_16x16x32_bf16 v[112:115], v[212:215], a[4:7], v[112:115]
    ds_read_b64_tr_b16 v[226:227], v247 offset:512
    v_mfma_f32_16x16x32_bf16 v[112:115], v[216:219], a[8:11], v[112:115]
    ds_read_b64_tr_b16 v[228:229], v247 offset:4096
    v_mfma_f32_16x16x32_bf16 v[112:115], v[220:223], a[12:15], v[112:115]
    buffer_load_dwordx4 v249, s[12:15], s51 offen offset:1024 lds
    v_mfma_f32_16x16x32_bf16 v[116:119], v[208:211], a[16:19], 0
    ds_read_b64_tr_b16 v[230:231], v247 offset:4608
    v_mfma_f32_16x16x32_bf16 v[116:119], v[212:215], a[20:23], v[116:119]
    ds_read_b64_tr_b16 v[232:233], v247 offset:8192
    v_mfma_f32_16x16x32_bf16 v[116:119], v[216:219], a[24:27], v[116:119]
    ds_read_b64_tr_b16 v[234:235], v247 offset:8704
    v_mfma_f32_16x16x32_bf16 v[116:119], v[220:223], a[28:31], v[116:119]
    buffer_load_dwordx4 v250, s[12:15], s51 offen offset:2048 lds
    v_mfma_f32_16x16x32_bf16 v[120:123], v[208:211], a[32:35], 0
    ds_read_b64_tr_b16 v[236:237], v247 offset:12288
    v_mfma_f32_16x16x32_bf16 v[120:123], v[212:215], a[36:39], v[120:123]
    ds_read_b64_tr_b16 v[238:239], v247 offset:12800
    v_mfma_f32_16x16x32_bf16 v[120:123], v[216:219], a[40:43], v[120:123]
    v_mfma_f32_16x16x32_bf16 v[120:123], v[220:223], a[44:47], v[120:123]
    buffer_load_dwordx4 v251, s[12:15], s51 offen offset:3072 lds
    v_mfma_f32_16x16x32_bf16 v[124:127], v[208:211], a[48:51], 0
    v_mfma_f32_16x16x32_bf16 v[124:127], v[212:215], a[52:55], v[124:127]
    s_add_u32 s51, s65, 39849984
    v_mfma_f32_16x16x32_bf16 v[124:127], v[216:219], a[56:59], v[124:127]
    buffer_load_dwordx4 a[80:83], v1, s[4:7], s51 offen offset:0 sc1
    v_mfma_f32_16x16x32_bf16 v[124:127], v[220:223], a[60:63], v[124:127]
    s_waitcnt vmcnt(13) lgkmcnt(0)
    s_barrier
    v_mfma_f32_16x16x32_bf16 v[128:131], v[224:227], a[0:3], 0
    ds_read_b64_tr_b16 v[208:209], v244 offset:16384
    v_mfma_f32_16x16x32_bf16 v[128:131], v[228:231], a[4:7], v[128:131]
    ds_read_b64_tr_b16 v[210:211], v244 offset:16896
    v_mfma_f32_16x16x32_bf16 v[128:131], v[232:235], a[8:11], v[128:131]
    ds_read_b64_tr_b16 v[212:213], v244 offset:20480
    v_mfma_f32_16x16x32_bf16 v[128:131], v[236:239], a[12:15], v[128:131]
    buffer_load_dwordx4 a[84:87], v1, s[4:7], s51 offen offset:1024 sc1
    v_mfma_f32_16x16x32_bf16 v[132:135], v[224:227], a[16:19], 0
    ds_read_b64_tr_b16 v[214:215], v244 offset:20992
    v_mfma_f32_16x16x32_bf16 v[132:135], v[228:231], a[20:23], v[132:135]
    ds_read_b64_tr_b16 v[216:217], v244 offset:24576
    v_mfma_f32_16x16x32_bf16 v[132:135], v[232:235], a[24:27], v[132:135]
    ds_read_b64_tr_b16 v[218:219], v244 offset:25088
    v_mfma_f32_16x16x32_bf16 v[132:135], v[236:239], a[28:31], v[132:135]
    buffer_load_dwordx4 a[88:91], v1, s[4:7], s51 offen offset:2048 sc1
    v_mfma_f32_16x16x32_bf16 v[136:139], v[224:227], a[32:35], 0
    ds_read_b64_tr_b16 v[220:221], v244 offset:28672
    v_mfma_f32_16x16x32_bf16 v[136:139], v[228:231], a[36:39], v[136:139]
    ds_read_b64_tr_b16 v[222:223], v244 offset:29184
    v_mfma_f32_16x16x32_bf16 v[136:139], v[232:235], a[40:43], v[136:139]
    v_mfma_f32_16x16x32_bf16 v[136:139], v[236:239], a[44:47], v[136:139]
    buffer_load_dwordx4 a[92:95], v1, s[4:7], s51 offen offset:3072 sc1
    v_mfma_f32_16x16x32_bf16 v[140:143], v[224:227], a[48:51], 0
    v_mfma_f32_16x16x32_bf16 v[140:143], v[228:231], a[52:55], v[140:143]
    s_add_u32 s51, s66, 39849984
    v_mfma_f32_16x16x32_bf16 v[140:143], v[232:235], a[56:59], v[140:143]
    buffer_load_dwordx4 a[96:99], v1, s[4:7], s51 offen offset:0 sc1
    v_mfma_f32_16x16x32_bf16 v[140:143], v[236:239], a[60:63], v[140:143]
    s_waitcnt lgkmcnt(0)
    v_mfma_f32_16x16x32_bf16 v[144:147], v[208:211], a[0:3], 0
    ds_read_b64_tr_b16 v[224:225], v245 offset:16384
    v_mfma_f32_16x16x32_bf16 v[144:147], v[212:215], a[4:7], v[144:147]
    ds_read_b64_tr_b16 v[226:227], v245 offset:16896
    v_mfma_f32_16x16x32_bf16 v[144:147], v[216:219], a[8:11], v[144:147]
    ds_read_b64_tr_b16 v[228:229], v245 offset:20480
    v_mfma_f32_16x16x32_bf16 v[144:147], v[220:223], a[12:15], v[144:147]
    buffer_load_dwordx4 a[100:103], v1, s[4:7], s51 offen offset:1024 sc1
    v_mfma_f32_16x16x32_bf16 v[148:151], v[208:211], a[16:19], 0
    ds_read_b64_tr_b16 v[230:231], v245 offset:20992
    v_mfma_f32_16x16x32_bf16 v[148:151], v[212:215], a[20:23], v[148:151]
    ds_read_b64_tr_b16 v[232:233], v245 offset:24576
    v_mfma_f32_16x16x32_bf16 v[148:151], v[216:219], a[24:27], v[148:151]
    ds_read_b64_tr_b16 v[234:235], v245 offset:25088
    v_mfma_f32_16x16x32_bf16 v[148:151], v[220:223], a[28:31], v[148:151]
    buffer_load_dwordx4 a[104:107], v1, s[4:7], s51 offen offset:2048 sc1
    v_mfma_f32_16x16x32_bf16 v[152:155], v[208:211], a[32:35], 0
    ds_read_b64_tr_b16 v[236:237], v245 offset:28672
    v_mfma_f32_16x16x32_bf16 v[152:155], v[212:215], a[36:39], v[152:155]
    ds_read_b64_tr_b16 v[238:239], v245 offset:29184
    v_mfma_f32_16x16x32_bf16 v[152:155], v[216:219], a[40:43], v[152:155]
    v_mfma_f32_16x16x32_bf16 v[152:155], v[220:223], a[44:47], v[152:155]
    buffer_load_dwordx4 a[108:111], v1, s[4:7], s51 offen offset:3072 sc1
    v_mfma_f32_16x16x32_bf16 v[156:159], v[208:211], a[48:51], 0
    v_mfma_f32_16x16x32_bf16 v[156:159], v[212:215], a[52:55], v[156:159]
    s_add_u32 s51, s67, 39849984
    v_mfma_f32_16x16x32_bf16 v[156:159], v[216:219], a[56:59], v[156:159]
    buffer_load_dwordx4 a[112:115], v1, s[4:7], s51 offen offset:0 sc1
    v_mfma_f32_16x16x32_bf16 v[156:159], v[220:223], a[60:63], v[156:159]
    s_waitcnt lgkmcnt(0)
    v_mfma_f32_16x16x32_bf16 v[160:163], v[224:227], a[0:3], 0
    ds_read_b64_tr_b16 v[208:209], v246 offset:16384
    v_mfma_f32_16x16x32_bf16 v[160:163], v[228:231], a[4:7], v[160:163]
    ds_read_b64_tr_b16 v[210:211], v246 offset:16896
    v_mfma_f32_16x16x32_bf16 v[160:163], v[232:235], a[8:11], v[160:163]
    ds_read_b64_tr_b16 v[212:213], v246 offset:20480
    v_mfma_f32_16x16x32_bf16 v[160:163], v[236:239], a[12:15], v[160:163]
    buffer_load_dwordx4 a[116:119], v1, s[4:7], s51 offen offset:1024 sc1
    v_mfma_f32_16x16x32_bf16 v[164:167], v[224:227], a[16:19], 0
    ds_read_b64_tr_b16 v[214:215], v246 offset:20992
    v_mfma_f32_16x16x32_bf16 v[164:167], v[228:231], a[20:23], v[164:167]
    ds_read_b64_tr_b16 v[216:217], v246 offset:24576
    v_mfma_f32_16x16x32_bf16 v[164:167], v[232:235], a[24:27], v[164:167]
    ds_read_b64_tr_b16 v[218:219], v246 offset:25088
    v_mfma_f32_16x16x32_bf16 v[164:167], v[236:239], a[28:31], v[164:167]
    buffer_load_dwordx4 a[120:123], v1, s[4:7], s51 offen offset:2048 sc1
    v_mfma_f32_16x16x32_bf16 v[168:171], v[224:227], a[32:35], 0
    ds_read_b64_tr_b16 v[220:221], v246 offset:28672
    v_mfma_f32_16x16x32_bf16 v[168:171], v[228:231], a[36:39], v[168:171]
    ds_read_b64_tr_b16 v[222:223], v246 offset:29184
    v_mfma_f32_16x16x32_bf16 v[168:171], v[232:235], a[40:43], v[168:171]
    v_mfma_f32_16x16x32_bf16 v[168:171], v[236:239], a[44:47], v[168:171]
    buffer_load_dwordx4 a[124:127], v1, s[4:7], s51 offen offset:3072 sc1
    v_mfma_f32_16x16x32_bf16 v[172:175], v[224:227], a[48:51], 0
    s_add_u32 m0, s68, 98304
    v_mfma_f32_16x16x32_bf16 v[172:175], v[228:231], a[52:55], v[172:175]
    s_add_u32 s51, s48, 1048704
    v_mfma_f32_16x16x32_bf16 v[172:175], v[232:235], a[56:59], v[172:175]
    buffer_load_dwordx4 v248, s[12:15], s51 offen offset:0 lds
    v_mfma_f32_16x16x32_bf16 v[172:175], v[236:239], a[60:63], v[172:175]
    s_waitcnt lgkmcnt(0)
    v_mfma_f32_16x16x32_bf16 v[176:179], v[208:211], a[0:3], 0
    ds_read_b64_tr_b16 v[224:225], v247 offset:16384
    v_mfma_f32_16x16x32_bf16 v[176:179], v[212:215], a[4:7], v[176:179]
    ds_read_b64_tr_b16 v[226:227], v247 offset:16896
    v_mfma_f32_16x16x32_bf16 v[176:179], v[216:219], a[8:11], v[176:179]
    ds_read_b64_tr_b16 v[228:229], v247 offset:20480
    v_mfma_f32_16x16x32_bf16 v[176:179], v[220:223], a[12:15], v[176:179]
    buffer_load_dwordx4 v249, s[12:15], s51 offen offset:1024 lds
    v_mfma_f32_16x16x32_bf16 v[180:183], v[208:211], a[16:19], 0
    ds_read_b64_tr_b16 v[230:231], v247 offset:20992
    v_mfma_f32_16x16x32_bf16 v[180:183], v[212:215], a[20:23], v[180:183]
    ds_read_b64_tr_b16 v[232:233], v247 offset:24576
    v_mfma_f32_16x16x32_bf16 v[180:183], v[216:219], a[24:27], v[180:183]
    ds_read_b64_tr_b16 v[234:235], v247 offset:25088
    v_mfma_f32_16x16x32_bf16 v[180:183], v[220:223], a[28:31], v[180:183]
    buffer_load_dwordx4 v250, s[12:15], s51 offen offset:2048 lds
    v_mfma_f32_16x16x32_bf16 v[184:187], v[208:211], a[32:35], 0
    ds_read_b64_tr_b16 v[236:237], v247 offset:28672
    v_mfma_f32_16x16x32_bf16 v[184:187], v[212:215], a[36:39], v[184:187]
    ds_read_b64_tr_b16 v[238:239], v247 offset:29184
    v_mfma_f32_16x16x32_bf16 v[184:187], v[216:219], a[40:43], v[184:187]
    v_mfma_f32_16x16x32_bf16 v[184:187], v[220:223], a[44:47], v[184:187]
    buffer_load_dwordx4 v251, s[12:15], s51 offen offset:3072 lds
    v_mfma_f32_16x16x32_bf16 v[188:191], v[208:211], a[48:51], 0
    v_mfma_f32_16x16x32_bf16 v[188:191], v[212:215], a[52:55], v[188:191]
    v_mfma_f32_16x16x32_bf16 v[188:191], v[216:219], a[56:59], v[188:191]
    v_mfma_f32_16x16x32_bf16 v[188:191], v[220:223], a[60:63], v[188:191]
    s_waitcnt vmcnt(16) lgkmcnt(0)
    s_barrier
    v_mfma_f32_16x16x32_bf16 v[192:195], v[224:227], a[0:3], 0
    ds_read_b64_tr_b16 v[208:209], v240 offset:49152
    v_mfma_f32_16x16x32_bf16 v[192:195], v[228:231], a[4:7], v[192:195]
    ds_read_b64_tr_b16 v[210:211], v240 offset:49664
    v_mfma_f32_16x16x32_bf16 v[192:195], v[232:235], a[8:11], v[192:195]
    ds_read_b64_tr_b16 v[212:213], v240 offset:53248
    v_mfma_f32_16x16x32_bf16 v[192:195], v[236:239], a[12:15], v[192:195]
    s_add_u32 s58, s53, s69
    buffer_store_dword v253, v252, s[4:7], s58 offen sc1
    v_mfma_f32_16x16x32_bf16 v[196:199], v[224:227], a[16:19], 0
    ds_read_b64_tr_b16 v[214:215], v240 offset:53760
    v_mfma_f32_16x16x32_bf16 v[196:199], v[228:231], a[20:23], v[196:199]
    ds_read_b64_tr_b16 v[216:217], v240 offset:57344
    v_mfma_f32_16x16x32_bf16 v[196:199], v[232:235], a[24:27], v[196:199]
    ds_read_b64_tr_b16 v[218:219], v240 offset:57856
    v_mfma_f32_16x16x32_bf16 v[196:199], v[236:239], a[28:31], v[196:199]
    s_getpc_b64 s[54:55]
L_cs_a:
    s_add_u32 s54, s54, L_att_P0-L_cs_a
    s_addc_u32 s55, s55, 0
    global_load_dword v3, v3, s[54:55]
    v_mfma_f32_16x16x32_bf16 v[200:203], v[224:227], a[32:35], 0
    ds_read_b64_tr_b16 v[220:221], v240 offset:61440
    v_mfma_f32_16x16x32_bf16 v[200:203], v[228:231], a[36:39], v[200:203]
    ds_read_b64_tr_b16 v[222:223], v240 offset:61952
    v_mfma_f32_16x16x32_bf16 v[200:203], v[232:235], a[40:43], v[200:203]
    v_mfma_f32_16x16x32_bf16 v[200:203], v[236:239], a[44:47], v[200:203]
    v_mfma_f32_16x16x32_bf16 v[204:207], v[224:227], a[48:51], 0
    v_mfma_f32_16x16x32_bf16 v[204:207], v[228:231], a[52:55], v[204:207]
    v_mfma_f32_16x16x32_bf16 v[204:207], v[232:235], a[56:59], v[204:207]
    s_waitcnt lgkmcnt(2)
    v_mfma_f32_16x16x32_bf16 v[204:207], v[236:239], a[60:63], v[204:207]
    v_mfma_f32_16x16x32_bf16 v[80:83], v[208:211], a[64:67], v[80:83]
    ds_read_b64_tr_b16 v[224:225], v241 offset:49152
    v_mfma_f32_16x16x32_bf16 v[80:83], v[212:215], a[68:71], v[80:83]
    ds_read_b64_tr_b16 v[226:227], v241 offset:49664
    v_mfma_f32_16x16x32_bf16 v[80:83], v[216:219], a[72:75], v[80:83]
    ds_read_b64_tr_b16 v[228:229], v241 offset:53248
    s_waitcnt vmcnt(14)
    s_waitcnt lgkmcnt(3)
    v_mfma_f32_16x16x32_bf16 v[80:83], v[220:223], a[76:79], v[80:83]
    s_and_b32 s53, s2, 15
    v_mfma_f32_16x16x32_bf16 v[84:87], v[208:211], a[80:83], v[84:87]
    ds_read_b64_tr_b16 v[230:231], v241 offset:53760
    v_mfma_f32_16x16x32_bf16 v[84:87], v[212:215], a[84:87], v[84:87]
    ds_read_b64_tr_b16 v[232:233], v241 offset:57344
    v_mfma_f32_16x16x32_bf16 v[84:87], v[216:219], a[88:91], v[84:87]
    ds_read_b64_tr_b16 v[234:235], v241 offset:57856
    s_waitcnt vmcnt(10)
    v_mfma_f32_16x16x32_bf16 v[84:87], v[220:223], a[92:95], v[84:87]
    s_mul_i32 s53, s53, 88064
    v_mfma_f32_16x16x32_bf16 v[88:91], v[208:211], a[96:99], v[88:91]
    ds_read_b64_tr_b16 v[236:237], v241 offset:61440
    v_mfma_f32_16x16x32_bf16 v[88:91], v[212:215], a[100:103], v[88:91]
    ds_read_b64_tr_b16 v[238:239], v241 offset:61952
    v_mfma_f32_16x16x32_bf16 v[88:91], v[216:219], a[104:107], v[88:91]
    s_waitcnt vmcnt(6)
    v_mfma_f32_16x16x32_bf16 v[88:91], v[220:223], a[108:111], v[88:91]
    s_lshr_b32 s59, s2, 4
    v_mfma_f32_16x16x32_bf16 v[92:95], v[208:211], a[112:115], v[92:95]
    s_mul_i32 s59, s59, 192
    v_mfma_f32_16x16x32_bf16 v[92:95], v[212:215], a[116:119], v[92:95]
    s_add_u32 s51, s64, 39854080
    v_mfma_f32_16x16x32_bf16 v[92:95], v[216:219], a[120:123], v[92:95]
    buffer_load_dwordx4 a[128:131], v1, s[4:7], s51 offen offset:0 sc1
    v_mfma_f32_16x16x32_bf16 v[92:95], v[220:223], a[124:127], v[92:95]
    s_add_u32 s53, s53, s59
    s_waitcnt lgkmcnt(2)
    v_mfma_f32_16x16x32_bf16 v[96:99], v[224:227], a[64:67], v[96:99]
    ds_read_b64_tr_b16 v[208:209], v242 offset:49152
    v_mfma_f32_16x16x32_bf16 v[96:99], v[228:231], a[68:71], v[96:99]
    ds_read_b64_tr_b16 v[210:211], v242 offset:49664
    v_mfma_f32_16x16x32_bf16 v[96:99], v[232:235], a[72:75], v[96:99]
    ds_read_b64_tr_b16 v[212:213], v242 offset:53248
    s_waitcnt lgkmcnt(3)
    v_mfma_f32_16x16x32_bf16 v[96:99], v[236:239], a[76:79], v[96:99]
    buffer_load_dwordx4 a[132:135], v1, s[4:7], s51 offen offset:1024 sc1
    v_mfma_f32_16x16x32_bf16 v[100:103], v[224:227], a[80:83], v[100:103]
    ds_read_b64_tr_b16 v[214:215], v242 offset:53760
    v_mfma_f32_16x16x32_bf16 v[100:103], v[228:231], a[84:87], v[100:103]
    ds_read_b64_tr_b16 v[216:217], v242 offset:57344
    v_mfma_f32_16x16x32_bf16 v[100:103], v[232:235], a[88:91], v[100:103]
    ds_read_b64_tr_b16 v[218:219], v242 offset:57856
    v_mfma_f32_16x16x32_bf16 v[100:103], v[236:239], a[92:95], v[100:103]
    buffer_load_dwordx4 a[136:139], v1, s[4:7], s51 offen offset:2048 sc1
    v_mfma_f32_16x16x32_bf16 v[104:107], v[224:227], a[96:99], v[104:107]
    ds_read_b64_tr_b16 v[220:221], v242 offset:61440
    v_mfma_f32_16x16x32_bf16 v[104:107], v[228:231], a[100:103], v[104:107]
    ds_read_b64_tr_b16 v[222:223], v242 offset:61952
    v_mfma_f32_16x16x32_bf16 v[104:107], v[232:235], a[104:107], v[104:107]
    s_mul_i32 s59, s3, 3072
    v_mfma_f32_16x16x32_bf16 v[104:107], v[236:239], a[108:111], v[104:107]
    buffer_load_dwordx4 a[140:143], v1, s[4:7], s51 offen offset:3072 sc1
    v_mfma_f32_16x16x32_bf16 v[108:111], v[224:227], a[112:115], v[108:111]
    s_add_u32 m0, s68, 131072
    v_mfma_f32_16x16x32_bf16 v[108:111], v[228:231], a[116:119], v[108:111]
    s_add_u32 s51, s48, 2097152
    v_mfma_f32_16x16x32_bf16 v[108:111], v[232:235], a[120:123], v[108:111]
    buffer_load_dwordx4 v248, s[12:15], s51 offen offset:0 lds
    v_mfma_f32_16x16x32_bf16 v[108:111], v[236:239], a[124:127], v[108:111]
    s_and_b32 s54, s3, 1
    s_waitcnt lgkmcnt(2)
    v_mfma_f32_16x16x32_bf16 v[112:115], v[208:211], a[64:67], v[112:115]
    ds_read_b64_tr_b16 v[224:225], v243 offset:49152
    v_mfma_f32_16x16x32_bf16 v[112:115], v[212:215], a[68:71], v[112:115]
    ds_read_b64_tr_b16 v[226:227], v243 offset:49664
    v_mfma_f32_16x16x32_bf16 v[112:115], v[216:219], a[72:75], v[112:115]
    ds_read_b64_tr_b16 v[228:229], v243 offset:53248
    s_waitcnt lgkmcnt(3)
    v_mfma_f32_16x16x32_bf16 v[112:115], v[220:223], a[76:79], v[112:115]
    buffer_load_dwordx4 v249, s[12:15], s51 offen offset:1024 lds
    v_mfma_f32_16x16x32_bf16 v[116:119], v[208:211], a[80:83], v[116:119]
    ds_read_b64_tr_b16 v[230:231], v243 offset:53760
    v_mfma_f32_16x16x32_bf16 v[116:119], v[212:215], a[84:87], v[116:119]
    ds_read_b64_tr_b16 v[232:233], v243 offset:57344
    v_mfma_f32_16x16x32_bf16 v[116:119], v[216:219], a[88:91], v[116:119]
    ds_read_b64_tr_b16 v[234:235], v243 offset:57856
    v_mfma_f32_16x16x32_bf16 v[116:119], v[220:223], a[92:95], v[116:119]
    buffer_load_dwordx4 v250, s[12:15], s51 offen offset:2048 lds
    v_mfma_f32_16x16x32_bf16 v[120:123], v[208:211], a[96:99], v[120:123]
    ds_read_b64_tr_b16 v[236:237], v243 offset:61440
    v_mfma_f32_16x16x32_bf16 v[120:123], v[212:215], a[100:103], v[120:123]
    ds_read_b64_tr_b16 v[238:239], v243 offset:61952
    v_mfma_f32_16x16x32_bf16 v[120:123], v[216:219], a[104:107], v[120:123]
    s_mul_i32 s54, s54, 192
    v_add_u32 v28, s54, v0
    v_mul_u32_u24 v29, 0x1556, v28
    v_mfma_f32_16x16x32_bf16 v[120:123], v[220:223], a[108:111], v[120:123]
    buffer_load_dwordx4 v251, s[12:15], s51 offen offset:3072 lds
    v_mfma_f32_16x16x32_bf16 v[124:127], v[208:211], a[112:115], v[124:127]
    v_lshrrev_b32 v29, 16, v29
    v_mul_u32_u24 v30, 12, v29
    v_mfma_f32_16x16x32_bf16 v[124:127], v[212:215], a[116:119], v[124:127]
    s_add_u32 s51, s65, 39854080
    v_sub_u32 v28, v28, v30
    v_lshrrev_b32 v30, 1, v29
    v_mfma_f32_16x16x32_bf16 v[124:127], v[216:219], a[120:123], v[124:127]
    buffer_load_dwordx4 a[144:147], v1, s[4:7], s51 offen offset:0 sc1
    v_mfma_f32_16x16x32_bf16 v[124:127], v[220:223], a[124:127], v[124:127]
    s_waitcnt vmcnt(11) lgkmcnt(0)
    s_barrier
    v_mfma_f32_16x16x32_bf16 v[128:131], v[224:227], a[64:67], v[128:131]
    ds_read_b64_tr_b16 v[208:209], v240 offset:32768
    v_and_b32 v30, 2, v30
    v_mfma_f32_16x16x32_bf16 v[128:131], v[228:231], a[68:71], v[128:131]
    ds_read_b64_tr_b16 v[210:211], v240 offset:33280
    v_xor_b32 v28, v28, v30
    v_mfma_f32_16x16x32_bf16 v[128:131], v[232:235], a[72:75], v[128:131]
    ds_read_b64_tr_b16 v[212:213], v240 offset:36864
    v_mul_u32_u24 v29, 2752, v29
    v_mfma_f32_16x16x32_bf16 v[128:131], v[236:239], a[76:79], v[128:131]
    buffer_load_dwordx4 a[148:151], v1, s[4:7], s51 offen offset:1024 sc1
    v_mfma_f32_16x16x32_bf16 v[132:135], v[224:227], a[80:83], v[132:135]
    ds_read_b64_tr_b16 v[214:215], v240 offset:37376
    v_lshl_add_u32 v24, v28, 4, v29
    v_mfma_f32_16x16x32_bf16 v[132:135], v[228:231], a[84:87], v[132:135]
    ds_read_b64_tr_b16 v[216:217], v240 offset:40960
    v_add_u32 v28, s54, v0
    v_mfma_f32_16x16x32_bf16 v[132:135], v[232:235], a[88:91], v[132:135]
    ds_read_b64_tr_b16 v[218:219], v240 offset:41472
    v_add_u32 v28, 64, v28
    v_mfma_f32_16x16x32_bf16 v[132:135], v[236:239], a[92:95], v[132:135]
    buffer_load_dwordx4 a[152:155], v1, s[4:7], s51 offen offset:2048 sc1
    v_mfma_f32_16x16x32_bf16 v[136:139], v[224:227], a[96:99], v[136:139]
    ds_read_b64_tr_b16 v[220:221], v240 offset:45056
    v_mul_u32_u24 v29, 0x1556, v28
    v_mfma_f32_16x16x32_bf16 v[136:139], v[228:231], a[100:103], v[136:139]
    ds_read_b64_tr_b16 v[222:223], v240 offset:45568
    v_lshrrev_b32 v29, 16, v29
    v_mfma_f32_16x16x32_bf16 v[136:139], v[232:235], a[104:107], v[136:139]
    v_mul_u32_u24 v30, 12, v29
    v_sub_u32 v28, v28, v30
    v_mfma_f32_16x16x32_bf16 v[136:139], v[236:239], a[108:111], v[136:139]
    buffer_load_dwordx4 a[156:159], v1, s[4:7], s51 offen offset:3072 sc1
    v_mfma_f32_16x16x32_bf16 v[140:143], v[224:227], a[112:115], v[140:143]
    v_lshrrev_b32 v30, 1, v29
    v_and_b32 v30, 2, v30
    v_mfma_f32_16x16x32_bf16 v[140:143], v[228:231], a[116:119], v[140:143]
    s_add_u32 s51, s66, 39854080
    v_xor_b32 v28, v28, v30
    v_mul_u32_u24 v29, 2752, v29
    v_mfma_f32_16x16x32_bf16 v[140:143], v[232:235], a[120:123], v[140:143]
    buffer_load_dwordx4 a[160:163], v1, s[4:7], s51 offen offset:0 sc1
    v_mfma_f32_16x16x32_bf16 v[140:143], v[236:239], a[124:127], v[140:143]
    s_waitcnt lgkmcnt(0)
    v_lshl_add_u32 v25, v28, 4, v29
    v_subrev_u32 v25, 1024, v25
    v_mfma_f32_16x16x32_bf16 v[144:147], v[208:211], a[64:67], v[144:147]
    ds_read_b64_tr_b16 v[224:225], v241 offset:32768
    v_add_u32 v28, s54, v0
    v_mfma_f32_16x16x32_bf16 v[144:147], v[212:215], a[68:71], v[144:147]
    ds_read_b64_tr_b16 v[226:227], v241 offset:33280
    v_add_u32 v28, 128, v28
    v_mfma_f32_16x16x32_bf16 v[144:147], v[216:219], a[72:75], v[144:147]
    ds_read_b64_tr_b16 v[228:229], v241 offset:36864
    v_mul_u32_u24 v29, 0x1556, v28
    v_mfma_f32_16x16x32_bf16 v[144:147], v[220:223], a[76:79], v[144:147]
    buffer_load_dwordx4 a[164:167], v1, s[4:7], s51 offen offset:1024 sc1
    v_mfma_f32_16x16x32_bf16 v[148:151], v[208:211], a[80:83], v[148:151]
    ds_read_b64_tr_b16 v[230:231], v241 offset:37376
    v_lshrrev_b32 v29, 16, v29
    v_mfma_f32_16x16x32_bf16 v[148:151], v[212:215], a[84:87], v[148:151]
    ds_read_b64_tr_b16 v[232:233], v241 offset:40960
    v_mul_u32_u24 v30, 12, v29
    v_mfma_f32_16x16x32_bf16 v[148:151], v[216:219], a[88:91], v[148:151]
    ds_read_b64_tr_b16 v[234:235], v241 offset:41472
    v_sub_u32 v28, v28, v30
    v_mfma_f32_16x16x32_bf16 v[148:151], v[220:223], a[92:95], v[148:151]
    buffer_load_dwordx4 a[168:171], v1, s[4:7], s51 offen offset:2048 sc1
    v_mfma_f32_16x16x32_bf16 v[152:155], v[208:211], a[96:99], v[152:155]
    ds_read_b64_tr_b16 v[236:237], v241 offset:45056
    v_lshrrev_b32 v30, 1, v29
    v_mfma_f32_16x16x32_bf16 v[152:155], v[212:215], a[100:103], v[152:155]
    ds_read_b64_tr_b16 v[238:239], v241 offset:45568
    v_and_b32 v30, 2, v30
    v_mfma_f32_16x16x32_bf16 v[152:155], v[216:219], a[104:107], v[152:155]
    v_xor_b32 v28, v28, v30
    v_mul_u32_u24 v29, 2752, v29
    v_mfma_f32_16x16x32_bf16 v[152:155], v[220:223], a[108:111], v[152:155]
    buffer_load_dwordx4 a[172:175], v1, s[4:7], s51 offen offset:3072 sc1
    v_mfma_f32_16x16x32_bf16 v[156:159], v[208:211], a[112:115], v[156:159]
    v_lshl_add_u32 v26, v28, 4, v29
    v_subrev_u32 v26, 2048, v26
    v_mfma_f32_16x16x32_bf16 v[156:159], v[212:215], a[116:119], v[156:159]
    s_add_u32 s51, s67, 39854080
    v_and_b32 v9, 15, v0
    v_lshrrev_b32 v10, 4, v0
    v_mfma_f32_16x16x32_bf16 v[156:159], v[216:219], a[120:123], v[156:159]
    buffer_load_dwordx4 a[176:179], v1, s[4:7], s51 offen offset:0 sc1
    v_mfma_f32_16x16x32_bf16 v[156:159], v[220:223], a[124:127], v[156:159]
    s_waitcnt lgkmcnt(0)
    v_sub_u32 v9, v9, v10
    v_lshl_add_u32 v9, v9, 2, s3
    v_mfma_f32_16x16x32_bf16 v[160:163], v[224:227], a[64:67], v[160:163]
    ds_read_b64_tr_b16 v[208:209], v242 offset:32768
    v_mov_b32 v8, 0xff800000
    v_mfma_f32_16x16x32_bf16 v[160:163], v[228:231], a[68:71], v[160:163]
    ds_read_b64_tr_b16 v[210:211], v242 offset:33280
    v_add_u32 v11, 59392, v1
    v_mfma_f32_16x16x32_bf16 v[160:163], v[232:235], a[72:75], v[160:163]
    ds_read_b64_tr_b16 v[212:213], v242 offset:36864
    v_add_u32 v12, 65536, v1
    v_mfma_f32_16x16x32_bf16 v[160:163], v[236:239], a[76:79], v[160:163]
    buffer_load_dwordx4 a[180:183], v1, s[4:7], s51 offen offset:1024 sc1
    v_mfma_f32_16x16x32_bf16 v[164:167], v[224:227], a[80:83], v[164:167]
    ds_read_b64_tr_b16 v[214:215], v242 offset:37376
    v_cmp_gt_i32 s[16:17], 0, v9
    v_mfma_f32_16x16x32_bf16 v[164:167], v[228:231], a[84:87], v[164:167]
    ds_read_b64_tr_b16 v[216:217], v242 offset:40960
    v_cmp_gt_i32 s[18:19], 1, v9
    v_mfma_f32_16x16x32_bf16 v[164:167], v[232:235], a[88:91], v[164:167]
    ds_read_b64_tr_b16 v[218:219], v242 offset:41472
    v_cmp_gt_i32 s[20:21], 2, v9
    v_mfma_f32_16x16x32_bf16 v[164:167], v[236:239], a[92:95], v[164:167]
    buffer_load_dwordx4 a[184:187], v1, s[4:7], s51 offen offset:2048 sc1
    v_mfma_f32_16x16x32_bf16 v[168:171], v[224:227], a[96:99], v[168:171]
    ds_read_b64_tr_b16 v[220:221], v242 offset:45056
    v_cmp_gt_i32 s[22:23], 3, v9
    v_mfma_f32_16x16x32_bf16 v[168:171], v[228:231], a[100:103], v[168:171]
    ds_read_b64_tr_b16 v[222:223], v242 offset:45568
    v_cmp_gt_i32 s[24:25], 16, v9
    v_mfma_f32_16x16x32_bf16 v[168:171], v[232:235], a[104:107], v[168:171]
    v_cmp_gt_i32 s[26:27], 17, v9
    v_cmp_gt_i32 s[28:29], 18, v9
    v_mfma_f32_16x16x32_bf16 v[168:171], v[236:239], a[108:111], v[168:171]
    buffer_load_dwordx4 a[188:191], v1, s[4:7], s51 offen offset:3072 sc1
    v_mfma_f32_16x16x32_bf16 v[172:175], v[224:227], a[112:115], v[172:175]
    s_add_u32 m0, s68, 147456
    v_cmp_gt_i32 s[30:31], 19, v9
    v_cmp_gt_i32 s[32:33], 32, v9
    v_mfma_f32_16x16x32_bf16 v[172:175], v[228:231], a[116:119], v[172:175]
    s_add_u32 s51, s48, 2097280
    v_cmp_gt_i32 s[34:35], 33, v9
    v_cmp_gt_i32 s[36:37], 34, v9
    v_mfma_f32_16x16x32_bf16 v[172:175], v[232:235], a[120:123], v[172:175]
    buffer_load_dwordx4 v248, s[12:15], s51 offen offset:0 lds
    v_mfma_f32_16x16x32_bf16 v[172:175], v[236:239], a[124:127], v[172:175]
    s_waitcnt lgkmcnt(0)
    v_cmp_gt_i32 s[38:39], 35, v9
    v_cmp_gt_i32 s[40:41], 48, v9
    v_mfma_f32_16x16x32_bf16 v[176:179], v[208:211], a[64:67], v[176:179]
    ds_read_b64_tr_b16 v[224:225], v243 offset:32768
    v_cmp_gt_i32 s[42:43], 49, v9
    v_mfma_f32_16x16x32_bf16 v[176:179], v[212:215], a[68:71], v[176:179]
    ds_read_b64_tr_b16 v[226:227], v243 offset:33280
    v_cmp_gt_i32 s[44:45], 50, v9
    v_mfma_f32_16x16x32_bf16 v[176:179], v[216:219], a[72:75], v[176:179]
    ds_read_b64_tr_b16 v[228:229], v243 offset:36864
    v_cmp_gt_i32 s[46:47], 51, v9
    v_mfma_f32_16x16x32_bf16 v[176:179], v[220:223], a[76:79], v[176:179]
    buffer_load_dwordx4 v249, s[12:15], s51 offen offset:1024 lds
    v_mfma_f32_16x16x32_bf16 v[180:183], v[208:211], a[80:83], v[180:183]
    ds_read_b64_tr_b16 v[230:231], v243 offset:37376
    v_mov_b32 v4, 0x3f803f80
    v_mfma_f32_16x16x32_bf16 v[180:183], v[212:215], a[84:87], v[180:183]
    ds_read_b64_tr_b16 v[232:233], v243 offset:40960
    v_mov_b32 v5, 0x3f803f80
    v_mfma_f32_16x16x32_bf16 v[180:183], v[216:219], a[88:91], v[180:183]
    ds_read_b64_tr_b16 v[234:235], v243 offset:41472
    v_mov_b32 v6, 0x3f803f80
    v_mfma_f32_16x16x32_bf16 v[180:183], v[220:223], a[92:95], v[180:183]
    buffer_load_dwordx4 v250, s[12:15], s51 offen offset:2048 lds
    v_mfma_f32_16x16x32_bf16 v[184:187], v[208:211], a[96:99], v[184:187]
    ds_read_b64_tr_b16 v[236:237], v243 offset:45056
    v_mov_b32 v7, 0x3f803f80
    v_mfma_f32_16x16x32_bf16 v[184:187], v[212:215], a[100:103], v[184:187]
    ds_read_b64_tr_b16 v[238:239], v243 offset:45568
    v_mfma_f32_16x16x32_bf16 v[184:187], v[216:219], a[104:107], v[184:187]
    s_lshl_b32 s57, s2, 2
    v_mfma_f32_16x16x32_bf16 v[184:187], v[220:223], a[108:111], v[184:187]
    buffer_load_dwordx4 v251, s[12:15], s51 offen offset:3072 lds
    v_mfma_f32_16x16x32_bf16 v[188:191], v[208:211], a[112:115], v[188:191]
    s_add_u32 s57, s57, s3
    v_mfma_f32_16x16x32_bf16 v[188:191], v[212:215], a[116:119], v[188:191]
    s_lshl_b32 s55, s57, 12
    v_mfma_f32_16x16x32_bf16 v[188:191], v[216:219], a[120:123], v[188:191]
    s_mul_i32 s57, s57, 1376
    v_lshlrev_b32 v14, 5, v0
    v_lshl_add_u32 v13, v0, 6, s55
    v_mfma_f32_16x16x32_bf16 v[188:191], v[220:223], a[124:127], v[188:191]
    s_waitcnt vmcnt(16) lgkmcnt(0)
    s_barrier
    v_mfma_f32_16x16x32_bf16 v[192:195], v[224:227], a[64:67], v[192:195]
    ds_read_b64_tr_b16 v[208:209], v244 offset:0
    v_min_u32 v14, 1372, v14
    v_mfma_f32_16x16x32_bf16 v[192:195], v[228:231], a[68:71], v[192:195]
    ds_read_b64_tr_b16 v[210:211], v244 offset:512
    v_add_u32 v14, s57, v14
    v_mfma_f32_16x16x32_bf16 v[192:195], v[232:235], a[72:75], v[192:195]
    ds_read_b64_tr_b16 v[212:213], v244 offset:4096
    v_mfma_f32_16x16x32_bf16 v[192:195], v[236:239], a[76:79], v[192:195]
    s_lshr_b32 s55, s2, 3
    v_mfma_f32_16x16x32_bf16 v[196:199], v[224:227], a[80:83], v[196:199]
    ds_read_b64_tr_b16 v[214:215], v244 offset:4608
    v_mfma_f32_16x16x32_bf16 v[196:199], v[228:231], a[84:87], v[196:199]
    ds_read_b64_tr_b16 v[216:217], v244 offset:8192
    v_mfma_f32_16x16x32_bf16 v[196:199], v[232:235], a[88:91], v[196:199]
    ds_read_b64_tr_b16 v[218:219], v244 offset:8704
    v_mfma_f32_16x16x32_bf16 v[196:199], v[236:239], a[92:95], v[196:199]
    buffer_load_dword v254, v255, s[4:7], 0 offen sc1
    v_mfma_f32_16x16x32_bf16 v[200:203], v[224:227], a[96:99], v[200:203]
    ds_read_b64_tr_b16 v[220:221], v244 offset:12288
    v_mfma_f32_16x16x32_bf16 v[200:203], v[228:231], a[100:103], v[200:203]
    ds_read_b64_tr_b16 v[222:223], v244 offset:12800
    v_mfma_f32_16x16x32_bf16 v[200:203], v[232:235], a[104:107], v[200:203]
    s_lshl_b32 s55, s55, 2
    v_mfma_f32_16x16x32_bf16 v[200:203], v[236:239], a[108:111], v[200:203]
    s_add_u32 s55, s55, s3
    v_mfma_f32_16x16x32_bf16 v[204:207], v[224:227], a[112:115], v[204:207]
    s_lshr_b32 s57, s55, 5
    v_mfma_f32_16x16x32_bf16 v[204:207], v[228:231], a[116:119], v[204:207]
    s_lshl_b32 s57, s57, 20
    v_mfma_f32_16x16x32_bf16 v[204:207], v[232:235], a[120:123], v[204:207]
    s_and_b32 s55, s55, 31
    v_mfma_f32_16x16x32_bf16 v[204:207], v[236:239], a[124:127], v[204:207]
    s_waitcnt lgkmcnt(2)
    v_mfma_f32_16x16x32_bf16 v[80:83], v[208:211], a[128:131], v[80:83]
    ds_read_b64_tr_b16 v[224:225], v245 offset:0
    v_accvgpr_write_b32 a0, 0
    v_mfma_f32_16x16x32_bf16 v[80:83], v[212:215], a[132:135], v[80:83]
    ds_read_b64_tr_b16 v[226:227], v245 offset:512
    v_accvgpr_write_b32 a1, 0
    v_mfma_f32_16x16x32_bf16 v[80:83], v[216:219], a[136:139], v[80:83]
    ds_read_b64_tr_b16 v[228:229], v245 offset:4096
    s_waitcnt vmcnt(13)
    v_accvgpr_write_b32 a2, 0
    s_waitcnt lgkmcnt(3)
    v_mfma_f32_16x16x32_bf16 v[80:83], v[220:223], a[140:143], v[80:83]
    s_lshl_b32 s55, s55, 13
    v_accvgpr_write_b32 a3, 0
    v_accvgpr_write_b32 a4, 0
    v_mfma_f32_16x16x32_bf16 v[84:87], v[208:211], a[144:147], v[84:87]
    ds_read_b64_tr_b16 v[230:231], v245 offset:4608
    v_accvgpr_write_b32 a5, 0
    v_mfma_f32_16x16x32_bf16 v[84:87], v[212:215], a[148:151], v[84:87]
    ds_read_b64_tr_b16 v[232:233], v245 offset:8192
    v_accvgpr_write_b32 a6, 0
    v_mfma_f32_16x16x32_bf16 v[84:87], v[216:219], a[152:155], v[84:87]
    ds_read_b64_tr_b16 v[234:235], v245 offset:8704
    s_waitcnt vmcnt(9)
    v_accvgpr_write_b32 a7, 0
    v_mfma_f32_16x16x32_bf16 v[84:87], v[220:223], a[156:159], v[84:87]
    s_add_u32 s55, s55, s57
    v_accvgpr_write_b32 a8, 0
    v_accvgpr_write_b32 a9, 0
    v_mfma_f32_16x16x32_bf16 v[88:91], v[208:211], a[160:163], v[88:91]
    ds_read_b64_tr_b16 v[236:237], v245 offset:12288
    v_accvgpr_write_b32 a10, 0
    v_mfma_f32_16x16x32_bf16 v[88:91], v[212:215], a[164:167], v[88:91]
    ds_read_b64_tr_b16 v[238:239], v245 offset:12800
    v_accvgpr_write_b32 a11, 0
    v_mfma_f32_16x16x32_bf16 v[88:91], v[216:219], a[168:171], v[88:91]
    s_waitcnt vmcnt(5)
    v_accvgpr_write_b32 a12, 0
    v_accvgpr_write_b32 a13, 0
    v_mfma_f32_16x16x32_bf16 v[88:91], v[220:223], a[172:175], v[88:91]
    s_add_u32 s55, s55, 384
    v_bfe_u32 v15, v0, 2, 3
    v_lshl_add_u32 v15, v15, 10, s55
    v_mfma_f32_16x16x32_bf16 v[92:95], v[208:211], a[176:179], v[92:95]
    v_lshrrev_b32 v9, 5, v0
    v_lshl_add_u32 v15, v9, 18, v15
    v_mfma_f32_16x16x32_bf16 v[92:95], v[212:215], a[180:183], v[92:95]
    s_add_u32 s51, s64, 39858176
    v_accvgpr_write_b32 a14, 0
    v_accvgpr_write_b32 a15, 0
    v_mfma_f32_16x16x32_bf16 v[92:95], v[216:219], a[184:187], v[92:95]
    buffer_load_dwordx4 a[192:195], v1, s[4:7], s51 offen offset:0 sc1
    v_mfma_f32_16x16x32_bf16 v[92:95], v[220:223], a[188:191], v[92:95]
    s_waitcnt lgkmcnt(0)
    v_accvgpr_write_b32 a16, 0
    v_accvgpr_write_b32 a17, 0
    v_mfma_f32_16x16x32_bf16 v[96:99], v[224:227], a[128:131], v[96:99]
    ds_read_b64_tr_b16 v[208:209], v246 offset:0
    v_accvgpr_write_b32 a18, 0
    v_mfma_f32_16x16x32_bf16 v[96:99], v[228:231], a[132:135], v[96:99]
    ds_read_b64_tr_b16 v[210:211], v246 offset:512
    v_accvgpr_write_b32 a19, 0
    v_mfma_f32_16x16x32_bf16 v[96:99], v[232:235], a[136:139], v[96:99]
    ds_read_b64_tr_b16 v[212:213], v246 offset:4096
    v_accvgpr_write_b32 a20, 0
    v_mfma_f32_16x16x32_bf16 v[96:99], v[236:239], a[140:143], v[96:99]
    buffer_load_dwordx4 a[196:199], v1, s[4:7], s51 offen offset:1024 sc1
    v_mfma_f32_16x16x32_bf16 v[100:103], v[224:227], a[144:147], v[100:103]
    ds_read_b64_tr_b16 v[214:215], v246 offset:4608
    v_accvgpr_write_b32 a21, 0
    v_mfma_f32_16x16x32_bf16 v[100:103], v[228:231], a[148:151], v[100:103]
    ds_read_b64_tr_b16 v[216:217], v246 offset:8192
    v_accvgpr_write_b32 a22, 0
    v_mfma_f32_16x16x32_bf16 v[100:103], v[232:235], a[152:155], v[100:103]
    ds_read_b64_tr_b16 v[218:219], v246 offset:8704
    v_accvgpr_write_b32 a23, 0
    v_mfma_f32_16x16x32_bf16 v[100:103], v[236:239], a[156:159], v[100:103]
    buffer_load_dwordx4 a[200:203], v1, s[4:7], s51 offen offset:2048 sc1
    v_mfma_f32_16x16x32_bf16 v[104:107], v[224:227], a[160:163], v[104:107]
    ds_read_b64_tr_b16 v[220:221], v246 offset:12288
    v_accvgpr_write_b32 a24, 0
    v_mfma_f32_16x16x32_bf16 v[104:107], v[228:231], a[164:167], v[104:107]
    ds_read_b64_tr_b16 v[222:223], v246 offset:12800
    v_accvgpr_write_b32 a25, 0
    v_mfma_f32_16x16x32_bf16 v[104:107], v[232:235], a[168:171], v[104:107]
    v_accvgpr_write_b32 a26, 0
    v_accvgpr_write_b32 a27, 0
    v_mfma_f32_16x16x32_bf16 v[104:107], v[236:239], a[172:175], v[104:107]
    buffer_load_dwordx4 a[204:207], v1, s[4:7], s51 offen offset:3072 sc1
    v_mfma_f32_16x16x32_bf16 v[108:111], v[224:227], a[176:179], v[108:111]
    s_add_u32 m0, s68, 114688
    v_accvgpr_write_b32 a28, 0
    v_accvgpr_write_b32 a29, 0
    v_mfma_f32_16x16x32_bf16 v[108:111], v[228:231], a[180:183], v[108:111]
    s_add_u32 s51, s48, 3145728
    v_accvgpr_write_b32 a30, 0
    v_accvgpr_write_b32 a31, 0
    v_mfma_f32_16x16x32_bf16 v[108:111], v[232:235], a[184:187], v[108:111]
    buffer_load_dwordx4 v248, s[12:15], s51 offen offset:0 lds
    v_mfma_f32_16x16x32_bf16 v[108:111], v[236:239], a[188:191], v[108:111]
    s_waitcnt lgkmcnt(0)
    v_accvgpr_write_b32 a32, 0
    v_accvgpr_write_b32 a33, 0
    v_mfma_f32_16x16x32_bf16 v[112:115], v[208:211], a[128:131], v[112:115]
    ds_read_b64_tr_b16 v[224:225], v247 offset:0
    v_accvgpr_write_b32 a34, 0
    v_mfma_f32_16x16x32_bf16 v[112:115], v[212:215], a[132:135], v[112:115]
    ds_read_b64_tr_b16 v[226:227], v247 offset:512
    v_accvgpr_write_b32 a35, 0
    v_mfma_f32_16x16x32_bf16 v[112:115], v[216:219], a[136:139], v[112:115]
    ds_read_b64_tr_b16 v[228:229], v247 offset:4096
    v_accvgpr_write_b32 a36, 0
    v_mfma_f32_16x16x32_bf16 v[112:115], v[220:223], a[140:143], v[112:115]
    buffer_load_dwordx4 v249, s[12:15], s51 offen offset:1024 lds
    v_mfma_f32_16x16x32_bf16 v[116:119], v[208:211], a[144:147], v[116:119]
    ds_read_b64_tr_b16 v[230:231], v247 offset:4608
    v_accvgpr_write_b32 a37, 0
    v_mfma_f32_16x16x32_bf16 v[116:119], v[212:215], a[148:151], v[116:119]
    ds_read_b64_tr_b16 v[232:233], v247 offset:8192
    v_accvgpr_write_b32 a38, 0
    v_mfma_f32_16x16x32_bf16 v[116:119], v[216:219], a[152:155], v[116:119]
    ds_read_b64_tr_b16 v[234:235], v247 offset:8704
    v_accvgpr_write_b32 a39, 0
    v_mfma_f32_16x16x32_bf16 v[116:119], v[220:223], a[156:159], v[116:119]
    buffer_load_dwordx4 v250, s[12:15], s51 offen offset:2048 lds
    v_mfma_f32_16x16x32_bf16 v[120:123], v[208:211], a[160:163], v[120:123]
    ds_read_b64_tr_b16 v[236:237], v247 offset:12288
    v_accvgpr_write_b32 a40, 0
    v_mfma_f32_16x16x32_bf16 v[120:123], v[212:215], a[164:167], v[120:123]
    ds_read_b64_tr_b16 v[238:239], v247 offset:12800
    v_accvgpr_write_b32 a41, 0
    v_mfma_f32_16x16x32_bf16 v[120:123], v[216:219], a[168:171], v[120:123]
    v_accvgpr_write_b32 a42, 0
    v_accvgpr_write_b32 a43, 0
    v_mfma_f32_16x16x32_bf16 v[120:123], v[220:223], a[172:175], v[120:123]
    buffer_load_dwordx4 v251, s[12:15], s51 offen offset:3072 lds
    v_mfma_f32_16x16x32_bf16 v[124:127], v[208:211], a[176:179], v[124:127]
    v_accvgpr_write_b32 a44, 0
    v_accvgpr_write_b32 a45, 0
    v_mfma_f32_16x16x32_bf16 v[124:127], v[212:215], a[180:183], v[124:127]
    s_add_u32 s51, s65, 39858176
    v_accvgpr_write_b32 a46, 0
    v_accvgpr_write_b32 a47, 0
    v_mfma_f32_16x16x32_bf16 v[124:127], v[216:219], a[184:187], v[124:127]
    buffer_load_dwordx4 a[208:211], v1, s[4:7], s51 offen offset:0 sc1
    v_mfma_f32_16x16x32_bf16 v[124:127], v[220:223], a[188:191], v[124:127]
    s_waitcnt vmcnt(10) lgkmcnt(0)
    s_barrier
    v_mfma_f32_16x16x32_bf16 v[128:131], v[224:227], a[128:131], v[128:131]
    ds_read_b64_tr_b16 v[208:209], v244 offset:16384
    v_accvgpr_write_b32 a48, 0
    v_mfma_f32_16x16x32_bf16 v[128:131], v[228:231], a[132:135], v[128:131]
    ds_read_b64_tr_b16 v[210:211], v244 offset:16896
    v_accvgpr_write_b32 a49, 0
    v_mfma_f32_16x16x32_bf16 v[128:131], v[232:235], a[136:139], v[128:131]
    ds_read_b64_tr_b16 v[212:213], v244 offset:20480
    v_accvgpr_write_b32 a50, 0
    v_mfma_f32_16x16x32_bf16 v[128:131], v[236:239], a[140:143], v[128:131]
    buffer_load_dwordx4 a[212:215], v1, s[4:7], s51 offen offset:1024 sc1
    v_mfma_f32_16x16x32_bf16 v[132:135], v[224:227], a[144:147], v[132:135]
    ds_read_b64_tr_b16 v[214:215], v244 offset:20992
    v_accvgpr_write_b32 a51, 0
    v_mfma_f32_16x16x32_bf16 v[132:135], v[228:231], a[148:151], v[132:135]
    ds_read_b64_tr_b16 v[216:217], v244 offset:24576
    v_accvgpr_write_b32 a52, 0
    v_mfma_f32_16x16x32_bf16 v[132:135], v[232:235], a[152:155], v[132:135]
    ds_read_b64_tr_b16 v[218:219], v244 offset:25088
    v_accvgpr_write_b32 a53, 0
    v_mfma_f32_16x16x32_bf16 v[132:135], v[236:239], a[156:159], v[132:135]
    buffer_load_dwordx4 a[216:219], v1, s[4:7], s51 offen offset:2048 sc1
    v_mfma_f32_16x16x32_bf16 v[136:139], v[224:227], a[160:163], v[136:139]
    ds_read_b64_tr_b16 v[220:221], v244 offset:28672
    v_accvgpr_write_b32 a54, 0
    v_mfma_f32_16x16x32_bf16 v[136:139], v[228:231], a[164:167], v[136:139]
    ds_read_b64_tr_b16 v[222:223], v244 offset:29184
    v_accvgpr_write_b32 a55, 0
    v_mfma_f32_16x16x32_bf16 v[136:139], v[232:235], a[168:171], v[136:139]
    v_accvgpr_write_b32 a56, 0
    v_accvgpr_write_b32 a57, 0
    v_mfma_f32_16x16x32_bf16 v[136:139], v[236:239], a[172:175], v[136:139]
    buffer_load_dwordx4 a[220:223], v1, s[4:7], s51 offen offset:3072 sc1
    v_mfma_f32_16x16x32_bf16 v[140:143], v[224:227], a[176:179], v[140:143]
    v_accvgpr_write_b32 a58, 0
    v_accvgpr_write_b32 a59, 0
    v_mfma_f32_16x16x32_bf16 v[140:143], v[228:231], a[180:183], v[140:143]
    s_add_u32 s51, s66, 39858176
    v_accvgpr_write_b32 a60, 0
    v_accvgpr_write_b32 a61, 0
    v_mfma_f32_16x16x32_bf16 v[140:143], v[232:235], a[184:187], v[140:143]
    buffer_load_dwordx4 a[224:227], v1, s[4:7], s51 offen offset:0 sc1
    v_mfma_f32_16x16x32_bf16 v[140:143], v[236:239], a[188:191], v[140:143]
    s_waitcnt lgkmcnt(0)
    v_accvgpr_write_b32 a62, 0
    v_accvgpr_write_b32 a63, 0
    v_mfma_f32_16x16x32_bf16 v[144:147], v[208:211], a[128:131], v[144:147]
    ds_read_b64_tr_b16 v[224:225], v245 offset:16384
    v_accvgpr_write_b32 a64, 0
    v_mfma_f32_16x16x32_bf16 v[144:147], v[212:215], a[132:135], v[144:147]
    ds_read_b64_tr_b16 v[226:227], v245 offset:16896
    v_accvgpr_write_b32 a65, 0
    v_mfma_f32_16x16x32_bf16 v[144:147], v[216:219], a[136:139], v[144:147]
    ds_read_b64_tr_b16 v[228:229], v245 offset:20480
    v_accvgpr_write_b32 a66, 0
    v_mfma_f32_16x16x32_bf16 v[144:147], v[220:223], a[140:143], v[144:147]
    buffer_load_dwordx4 a[228:231], v1, s[4:7], s51 offen offset:1024 sc1
    v_mfma_f32_16x16x32_bf16 v[148:151], v[208:211], a[144:147], v[148:151]
    ds_read_b64_tr_b16 v[230:231], v245 offset:20992
    v_accvgpr_write_b32 a67, 0
    v_mfma_f32_16x16x32_bf16 v[148:151], v[212:215], a[148:151], v[148:151]
    ds_read_b64_tr_b16 v[232:233], v245 offset:24576
    v_accvgpr_write_b32 a68, 0
    v_mfma_f32_16x16x32_bf16 v[148:151], v[216:219], a[152:155], v[148:151]
    ds_read_b64_tr_b16 v[234:235], v245 offset:25088
    v_accvgpr_write_b32 a69, 0
    v_mfma_f32_16x16x32_bf16 v[148:151], v[220:223], a[156:159], v[148:151]
    buffer_load_dwordx4 a[232:235], v1, s[4:7], s51 offen offset:2048 sc1
    v_mfma_f32_16x16x32_bf16 v[152:155], v[208:211], a[160:163], v[152:155]
    ds_read_b64_tr_b16 v[236:237], v245 offset:28672
    v_accvgpr_write_b32 a70, 0
    v_mfma_f32_16x16x32_bf16 v[152:155], v[212:215], a[164:167], v[152:155]
    ds_read_b64_tr_b16 v[238:239], v245 offset:29184
    v_accvgpr_write_b32 a71, 0
    v_mfma_f32_16x16x32_bf16 v[152:155], v[216:219], a[168:171], v[152:155]
    v_accvgpr_write_b32 a72, 0
    v_accvgpr_write_b32 a73, 0
    v_mfma_f32_16x16x32_bf16 v[152:155], v[220:223], a[172:175], v[152:155]
    buffer_load_dwordx4 a[236:239], v1, s[4:7], s51 offen offset:3072 sc1
    v_mfma_f32_16x16x32_bf16 v[156:159], v[208:211], a[176:179], v[156:159]
    v_accvgpr_write_b32 a74, 0
    v_accvgpr_write_b32 a75, 0
    v_mfma_f32_16x16x32_bf16 v[156:159], v[212:215], a[180:183], v[156:159]
    s_add_u32 s51, s67, 39858176
    v_accvgpr_write_b32 a76, 0
    v_accvgpr_write_b32 a77, 0
    v_mfma_f32_16x16x32_bf16 v[156:159], v[216:219], a[184:187], v[156:159]
    buffer_load_dwordx4 a[240:243], v1, s[4:7], s51 offen offset:0 sc1
    v_mfma_f32_16x16x32_bf16 v[156:159], v[220:223], a[188:191], v[156:159]
    s_waitcnt lgkmcnt(0)
    v_accvgpr_write_b32 a78, 0
    v_accvgpr_write_b32 a79, 0
    v_mfma_f32_16x16x32_bf16 v[160:163], v[224:227], a[128:131], v[160:163]
    ds_read_b64_tr_b16 v[208:209], v246 offset:16384
    v_accvgpr_write_b32 a80, 0
    v_mfma_f32_16x16x32_bf16 v[160:163], v[228:231], a[132:135], v[160:163]
    ds_read_b64_tr_b16 v[210:211], v246 offset:16896
    v_accvgpr_write_b32 a81, 0
    v_mfma_f32_16x16x32_bf16 v[160:163], v[232:235], a[136:139], v[160:163]
    ds_read_b64_tr_b16 v[212:213], v246 offset:20480
    v_accvgpr_write_b32 a82, 0
    v_mfma_f32_16x16x32_bf16 v[160:163], v[236:239], a[140:143], v[160:163]
    buffer_load_dwordx4 a[244:247], v1, s[4:7], s51 offen offset:1024 sc1
    v_mfma_f32_16x16x32_bf16 v[164:167], v[224:227], a[144:147], v[164:167]
    ds_read_b64_tr_b16 v[214:215], v246 offset:20992
    v_accvgpr_write_b32 a83, 0
    v_mfma_f32_16x16x32_bf16 v[164:167], v[228:231], a[148:151], v[164:167]
    ds_read_b64_tr_b16 v[216:217], v246 offset:24576
    v_accvgpr_write_b32 a84, 0
    v_mfma_f32_16x16x32_bf16 v[164:167], v[232:235], a[152:155], v[164:167]
    ds_read_b64_tr_b16 v[218:219], v246 offset:25088
    v_accvgpr_write_b32 a85, 0
    v_mfma_f32_16x16x32_bf16 v[164:167], v[236:239], a[156:159], v[164:167]
    buffer_load_dwordx4 a[248:251], v1, s[4:7], s51 offen offset:2048 sc1
    v_mfma_f32_16x16x32_bf16 v[168:171], v[224:227], a[160:163], v[168:171]
    ds_read_b64_tr_b16 v[220:221], v246 offset:28672
    v_accvgpr_write_b32 a86, 0
    v_mfma_f32_16x16x32_bf16 v[168:171], v[228:231], a[164:167], v[168:171]
    ds_read_b64_tr_b16 v[222:223], v246 offset:29184
    v_accvgpr_write_b32 a87, 0
    v_mfma_f32_16x16x32_bf16 v[168:171], v[232:235], a[168:171], v[168:171]
    v_accvgpr_write_b32 a88, 0
    v_accvgpr_write_b32 a89, 0
    v_mfma_f32_16x16x32_bf16 v[168:171], v[236:239], a[172:175], v[168:171]
    buffer_load_dwordx4 a[252:255], v1, s[4:7], s51 offen offset:3072 sc1
    v_mfma_f32_16x16x32_bf16 v[172:175], v[224:227], a[176:179], v[172:175]
    s_add_u32 m0, s68, 98304
    v_accvgpr_write_b32 a90, 0
    v_accvgpr_write_b32 a91, 0
    v_mfma_f32_16x16x32_bf16 v[172:175], v[228:231], a[180:183], v[172:175]
    s_add_u32 s51, s48, 3145856
    v_accvgpr_write_b32 a92, 0
    v_accvgpr_write_b32 a93, 0
    v_mfma_f32_16x16x32_bf16 v[172:175], v[232:235], a[184:187], v[172:175]
    buffer_load_dwordx4 v248, s[12:15], s51 offen offset:0 lds
    v_mfma_f32_16x16x32_bf16 v[172:175], v[236:239], a[188:191], v[172:175]
    s_waitcnt lgkmcnt(0)
    v_accvgpr_write_b32 a94, 0
    v_accvgpr_write_b32 a95, 0
    v_mfma_f32_16x16x32_bf16 v[176:179], v[208:211], a[128:131], v[176:179]
    ds_read_b64_tr_b16 v[224:225], v247 offset:16384
    v_accvgpr_write_b32 a96, 0
    v_mfma_f32_16x16x32_bf16 v[176:179], v[212:215], a[132:135], v[176:179]
    ds_read_b64_tr_b16 v[226:227], v247 offset:16896
    v_accvgpr_write_b32 a97, 0
    v_mfma_f32_16x16x32_bf16 v[176:179], v[216:219], a[136:139], v[176:179]
    ds_read_b64_tr_b16 v[228:229], v247 offset:20480
    v_accvgpr_write_b32 a98, 0
    v_mfma_f32_16x16x32_bf16 v[176:179], v[220:223], a[140:143], v[176:179]
    buffer_load_dwordx4 v249, s[12:15], s51 offen offset:1024 lds
    v_mfma_f32_16x16x32_bf16 v[180:183], v[208:211], a[144:147], v[180:183]
    ds_read_b64_tr_b16 v[230:231], v247 offset:20992
    v_accvgpr_write_b32 a99, 0
    v_mfma_f32_16x16x32_bf16 v[180:183], v[212:215], a[148:151], v[180:183]
    ds_read_b64_tr_b16 v[232:233], v247 offset:24576
    v_accvgpr_write_b32 a100, 0
    v_mfma_f32_16x16x32_bf16 v[180:183], v[216:219], a[152:155], v[180:183]
    ds_read_b64_tr_b16 v[234:235], v247 offset:25088
    v_accvgpr_write_b32 a101, 0
    v_mfma_f32_16x16x32_bf16 v[180:183], v[220:223], a[156:159], v[180:183]
    buffer_load_dwordx4 v250, s[12:15], s51 offen offset:2048 lds
    v_mfma_f32_16x16x32_bf16 v[184:187], v[208:211], a[160:163], v[184:187]
    ds_read_b64_tr_b16 v[236:237], v247 offset:28672
    v_accvgpr_write_b32 a102, 0
    v_mfma_f32_16x16x32_bf16 v[184:187], v[212:215], a[164:167], v[184:187]
    ds_read_b64_tr_b16 v[238:239], v247 offset:29184
    v_accvgpr_write_b32 a103, 0
    v_mfma_f32_16x16x32_bf16 v[184:187], v[216:219], a[168:171], v[184:187]
    v_accvgpr_write_b32 a104, 0
    v_accvgpr_write_b32 a105, 0
    v_mfma_f32_16x16x32_bf16 v[184:187], v[220:223], a[172:175], v[184:187]
    buffer_load_dwordx4 v251, s[12:15], s51 offen offset:3072 lds
    v_mfma_f32_16x16x32_bf16 v[188:191], v[208:211], a[176:179], v[188:191]
    s_mov_b32 s64, s100
    s_mov_b32 s65, s101
    v_accvgpr_write_b32 a106, 0
    v_mfma_f32_16x16x32_bf16 v[188:191], v[212:215], a[180:183], v[188:191]
    s_mov_b32 s66, 1409024
    s_mov_b32 s67, 0x20000
    v_accvgpr_write_b32 a107, 0
    v_mfma_f32_16x16x32_bf16 v[188:191], v[216:219], a[184:187], v[188:191]
    s_add_u32 m0, s59, 135168
    v_accvgpr_write_b32 a108, 0
    v_accvgpr_write_b32 a109, 0
    v_mfma_f32_16x16x32_bf16 v[188:191], v[220:223], a[188:191], v[188:191]
    s_waitcnt vmcnt(16) lgkmcnt(0)
    s_barrier
    v_mfma_f32_16x16x32_bf16 v[192:195], v[224:227], a[128:131], v[192:195]
    ds_read_b64_tr_b16 v[208:209], v240 offset:49152
    v_accvgpr_write_b32 a110, 0
    v_mfma_f32_16x16x32_bf16 v[192:195], v[228:231], a[132:135], v[192:195]
    ds_read_b64_tr_b16 v[210:211], v240 offset:49664
    v_accvgpr_write_b32 a111, 0
    v_mfma_f32_16x16x32_bf16 v[192:195], v[232:235], a[136:139], v[192:195]
    ds_read_b64_tr_b16 v[212:213], v240 offset:53248
    v_accvgpr_write_b32 a112, 0
    v_mfma_f32_16x16x32_bf16 v[192:195], v[236:239], a[140:143], v[192:195]
    buffer_load_dwordx4 v24, s[64:67], s53 offen offset:0 lds
    v_mfma_f32_16x16x32_bf16 v[196:199], v[224:227], a[144:147], v[196:199]
    ds_read_b64_tr_b16 v[214:215], v240 offset:53760
    v_accvgpr_write_b32 a113, 0
    v_mfma_f32_16x16x32_bf16 v[196:199], v[228:231], a[148:151], v[196:199]
    ds_read_b64_tr_b16 v[216:217], v240 offset:57344
    v_accvgpr_write_b32 a114, 0
    v_mfma_f32_16x16x32_bf16 v[196:199], v[232:235], a[152:155], v[196:199]
    ds_read_b64_tr_b16 v[218:219], v240 offset:57856
    v_accvgpr_write_b32 a115, 0
    v_mfma_f32_16x16x32_bf16 v[196:199], v[236:239], a[156:159], v[196:199]
    buffer_load_dwordx4 v25, s[64:67], s53 offen offset:1024 lds
    v_mfma_f32_16x16x32_bf16 v[200:203], v[224:227], a[160:163], v[200:203]
    ds_read_b64_tr_b16 v[220:221], v240 offset:61440
    v_accvgpr_write_b32 a116, 0
    v_mfma_f32_16x16x32_bf16 v[200:203], v[228:231], a[164:167], v[200:203]
    ds_read_b64_tr_b16 v[222:223], v240 offset:61952
    v_accvgpr_write_b32 a117, 0
    v_mfma_f32_16x16x32_bf16 v[200:203], v[232:235], a[168:171], v[200:203]
    v_accvgpr_write_b32 a118, 0
    v_accvgpr_write_b32 a119, 0
    v_mfma_f32_16x16x32_bf16 v[200:203], v[236:239], a[172:175], v[200:203]
    buffer_load_dwordx4 v26, s[64:67], s53 offen offset:2048 lds
    v_mfma_f32_16x16x32_bf16 v[204:207], v[224:227], a[176:179], v[204:207]
    v_accvgpr_write_b32 a120, 0
    v_accvgpr_write_b32 a121, 0
    v_mfma_f32_16x16x32_bf16 v[204:207], v[228:231], a[180:183], v[204:207]
    v_accvgpr_write_b32 a122, 0
    v_accvgpr_write_b32 a123, 0
    v_mfma_f32_16x16x32_bf16 v[204:207], v[232:235], a[184:187], v[204:207]
    v_accvgpr_write_b32 a124, 0
    v_accvgpr_write_b32 a125, 0
    v_mfma_f32_16x16x32_bf16 v[204:207], v[236:239], a[188:191], v[204:207]
    v_accvgpr_write_b32 a126, 0
    v_accvgpr_write_b32 a127, 0
    v_cmp_ne_u32 vcc, 1, v254
    s_cbranch_vccnz L_spin_kv
L_ok_kv:
    s_waitcnt lgkmcnt(2)
    v_mfma_f32_16x16x32_bf16 v[80:83], v[208:211], a[192:195], v[80:83]
    ds_read_b64_tr_b16 v[224:225], v241 offset:49152
    v_mfma_f32_16x16x32_bf16 v[80:83], v[212:215], a[196:199], v[80:83]
    ds_read_b64_tr_b16 v[226:227], v241 offset:49664
    v_mfma_f32_16x16x32_bf16 v[80:83], v[216:219], a[200:203], v[80:83]
    ds_read_b64_tr_b16 v[228:229], v241 offset:53248
    s_waitcnt vmcnt(15)
    s_waitcnt lgkmcnt(3)
    v_mfma_f32_16x16x32_bf16 v[80:83], v[220:223], a[204:207], v[80:83]
    v_mfma_f32_16x16x32_bf16 v[84:87], v[208:211], a[208:211], v[84:87]
    ds_read_b64_tr_b16 v[230:231], v241 offset:53760
    v_mfma_f32_16x16x32_bf16 v[84:87], v[212:215], a[212:215], v[84:87]
    ds_read_b64_tr_b16 v[232:233], v241 offset:57344
    v_mfma_f32_16x16x32_bf16 v[84:87], v[216:219], a[216:219], v[84:87]
    ds_read_b64_tr_b16 v[234:235], v241 offset:57856
    s_waitcnt vmcnt(11)
    v_mfma_f32_16x16x32_bf16 v[84:87], v[220:223], a[220:223], v[84:87]
    v_mfma_f32_16x16x32_bf16 v[88:91], v[208:211], a[224:227], v[88:91]
    ds_read_b64_tr_b16 v[236:237], v241 offset:61440
    v_mfma_f32_16x16x32_bf16 v[88:91], v[212:215], a[228:231], v[88:91]
    ds_read_b64_tr_b16 v[238:239], v241 offset:61952
    v_mfma_f32_16x16x32_bf16 v[88:91], v[216:219], a[232:235], v[88:91]
    s_waitcnt vmcnt(7)
    v_mfma_f32_16x16x32_bf16 v[88:91], v[220:223], a[236:239], v[88:91]
    v_mfma_f32_16x16x32_bf16 v[92:95], v[208:211], a[240:243], v[92:95]
    s_add_u32 m0, s68, 0
    v_mfma_f32_16x16x32_bf16 v[92:95], v[212:215], a[244:247], v[92:95]
    s_add_u32 s51, s68, 0
    v_mfma_f32_16x16x32_bf16 v[92:95], v[216:219], a[248:251], v[92:95]
    buffer_load_dwordx4 v1, s[8:11], s51 offen offset:0 sc1 lds
    v_mfma_f32_16x16x32_bf16 v[92:95], v[220:223], a[252:255], v[92:95]
    s_waitcnt lgkmcnt(0)
    v_mfma_f32_16x16x32_bf16 v[96:99], v[224:227], a[192:195], v[96:99]
    ds_read_b64_tr_b16 v[208:209], v242 offset:49152
    v_mfma_f32_16x16x32_bf16 v[96:99], v[228:231], a[196:199], v[96:99]
    ds_read_b64_tr_b16 v[210:211], v242 offset:49664
    v_mfma_f32_16x16x32_bf16 v[96:99], v[232:235], a[200:203], v[96:99]
    ds_read_b64_tr_b16 v[212:213], v242 offset:53248
    v_mfma_f32_16x16x32_bf16 v[96:99], v[236:239], a[204:207], v[96:99]
    buffer_load_dwordx4 v1, s[8:11], s51 offen offset:1024 sc1 lds
    v_mfma_f32_16x16x32_bf16 v[100:103], v[224:227], a[208:211], v[100:103]
    ds_read_b64_tr_b16 v[214:215], v242 offset:53760
    v_mfma_f32_16x16x32_bf16 v[100:103], v[228:231], a[212:215], v[100:103]
    ds_read_b64_tr_b16 v[216:217], v242 offset:57344
    v_mfma_f32_16x16x32_bf16 v[100:103], v[232:235], a[216:219], v[100:103]
    ds_read_b64_tr_b16 v[218:219], v242 offset:57856
    v_mfma_f32_16x16x32_bf16 v[100:103], v[236:239], a[220:223], v[100:103]
    buffer_load_dwordx4 v1, s[8:11], s51 offen offset:2048 sc1 lds
    v_mfma_f32_16x16x32_bf16 v[104:107], v[224:227], a[224:227], v[104:107]
    ds_read_b64_tr_b16 v[220:221], v242 offset:61440
    v_mfma_f32_16x16x32_bf16 v[104:107], v[228:231], a[228:231], v[104:107]
    ds_read_b64_tr_b16 v[222:223], v242 offset:61952
    v_mfma_f32_16x16x32_bf16 v[104:107], v[232:235], a[232:235], v[104:107]
    v_mfma_f32_16x16x32_bf16 v[104:107], v[236:239], a[236:239], v[104:107]
    buffer_load_dwordx4 v1, s[8:11], s51 offen offset:3072 sc1 lds
    v_mfma_f32_16x16x32_bf16 v[108:111], v[224:227], a[240:243], v[108:111]
    v_mfma_f32_16x16x32_bf16 v[108:111], v[228:231], a[244:247], v[108:111]
    v_mfma_f32_16x16x32_bf16 v[108:111], v[232:235], a[248:251], v[108:111]
    v_mfma_f32_16x16x32_bf16 v[108:111], v[236:239], a[252:255], v[108:111]
    s_waitcnt lgkmcnt(0)
    v_mfma_f32_16x16x32_bf16 v[112:115], v[208:211], a[192:195], v[112:115]
    ds_read_b64_tr_b16 v[224:225], v243 offset:49152
    v_mfma_f32_16x16x32_bf16 v[112:115], v[212:215], a[196:199], v[112:115]
    ds_read_b64_tr_b16 v[226:227], v243 offset:49664
    v_mfma_f32_16x16x32_bf16 v[112:115], v[216:219], a[200:203], v[112:115]
    ds_read_b64_tr_b16 v[228:229], v243 offset:53248
    v_mfma_f32_16x16x32_bf16 v[112:115], v[220:223], a[204:207], v[112:115]
    v_mfma_f32_16x16x32_bf16 v[116:119], v[208:211], a[208:211], v[116:119]
    ds_read_b64_tr_b16 v[230:231], v243 offset:53760
    v_mfma_f32_16x16x32_bf16 v[116:119], v[212:215], a[212:215], v[116:119]
    ds_read_b64_tr_b16 v[232:233], v243 offset:57344
    v_mfma_f32_16x16x32_bf16 v[116:119], v[216:219], a[216:219], v[116:119]
    ds_read_b64_tr_b16 v[234:235], v243 offset:57856
    v_mfma_f32_16x16x32_bf16 v[116:119], v[220:223], a[220:223], v[116:119]
    v_mfma_f32_16x16x32_bf16 v[120:123], v[208:211], a[224:227], v[120:123]
    ds_read_b64_tr_b16 v[236:237], v243 offset:61440
    v_mfma_f32_16x16x32_bf16 v[120:123], v[212:215], a[228:231], v[120:123]
    ds_read_b64_tr_b16 v[238:239], v243 offset:61952
    v_mfma_f32_16x16x32_bf16 v[120:123], v[216:219], a[232:235], v[120:123]
    v_mfma_f32_16x16x32_bf16 v[120:123], v[220:223], a[236:239], v[120:123]
    v_mfma_f32_16x16x32_bf16 v[124:127], v[208:211], a[240:243], v[124:127]
    s_add_u32 m0, s68, 16384
    v_mfma_f32_16x16x32_bf16 v[124:127], v[212:215], a[244:247], v[124:127]
    s_add_u32 s51, s68, 37888
    v_mfma_f32_16x16x32_bf16 v[124:127], v[216:219], a[248:251], v[124:127]
    buffer_load_dwordx4 v1, s[8:11], s51 offen offset:0 sc1 lds
    v_mfma_f32_16x16x32_bf16 v[124:127], v[220:223], a[252:255], v[124:127]
    s_waitcnt vmcnt(8) lgkmcnt(0)
    s_barrier
    v_mfma_f32_16x16x32_bf16 v[128:131], v[224:227], a[192:195], v[128:131]
    ds_read_b64_tr_b16 v[208:209], v240 offset:32768
    v_mfma_f32_16x16x32_bf16 v[128:131], v[228:231], a[196:199], v[128:131]
    ds_read_b64_tr_b16 v[210:211], v240 offset:33280
    v_mfma_f32_16x16x32_bf16 v[128:131], v[232:235], a[200:203], v[128:131]
    ds_read_b64_tr_b16 v[212:213], v240 offset:36864
    v_mfma_f32_16x16x32_bf16 v[128:131], v[236:239], a[204:207], v[128:131]
    buffer_load_dwordx4 v1, s[8:11], s51 offen offset:1024 sc1 lds
    v_mfma_f32_16x16x32_bf16 v[132:135], v[224:227], a[208:211], v[132:135]
    ds_read_b64_tr_b16 v[214:215], v240 offset:37376
    v_mfma_f32_16x16x32_bf16 v[132:135], v[228:231], a[212:215], v[132:135]
    ds_read_b64_tr_b16 v[216:217], v240 offset:40960
    v_mfma_f32_16x16x32_bf16 v[132:135], v[232:235], a[216:219], v[132:135]
    ds_read_b64_tr_b16 v[218:219], v240 offset:41472
    v_mfma_f32_16x16x32_bf16 v[132:135], v[236:239], a[220:223], v[132:135]
    buffer_load_dwordx4 v1, s[8:11], s51 offen offset:2048 sc1 lds
    v_mfma_f32_16x16x32_bf16 v[136:139], v[224:227], a[224:227], v[136:139]
    ds_read_b64_tr_b16 v[220:221], v240 offset:45056
    v_mfma_f32_16x16x32_bf16 v[136:139], v[228:231], a[228:231], v[136:139]
    ds_read_b64_tr_b16 v[222:223], v240 offset:45568
    v_mfma_f32_16x16x32_bf16 v[136:139], v[232:235], a[232:235], v[136:139]
    v_mfma_f32_16x16x32_bf16 v[136:139], v[236:239], a[236:239], v[136:139]
    buffer_load_dwordx4 v1, s[8:11], s51 offen offset:3072 sc1 lds
    v_mfma_f32_16x16x32_bf16 v[140:143], v[224:227], a[240:243], v[140:143]
    v_mfma_f32_16x16x32_bf16 v[140:143], v[228:231], a[244:247], v[140:143]
    v_mfma_f32_16x16x32_bf16 v[140:143], v[232:235], a[248:251], v[140:143]
    v_mfma_f32_16x16x32_bf16 v[140:143], v[236:239], a[252:255], v[140:143]
    s_waitcnt lgkmcnt(0)
    v_mfma_f32_16x16x32_bf16 v[144:147], v[208:211], a[192:195], v[144:147]
    ds_read_b64_tr_b16 v[224:225], v241 offset:32768
    v_mfma_f32_16x16x32_bf16 v[144:147], v[212:215], a[196:199], v[144:147]
    ds_read_b64_tr_b16 v[226:227], v241 offset:33280
    v_mfma_f32_16x16x32_bf16 v[144:147], v[216:219], a[200:203], v[144:147]
    ds_read_b64_tr_b16 v[228:229], v241 offset:36864
    v_mfma_f32_16x16x32_bf16 v[144:147], v[220:223], a[204:207], v[144:147]
    v_mfma_f32_16x16x32_bf16 v[148:151], v[208:211], a[208:211], v[148:151]
    ds_read_b64_tr_b16 v[230:231], v241 offset:37376
    v_mfma_f32_16x16x32_bf16 v[148:151], v[212:215], a[212:215], v[148:151]
    ds_read_b64_tr_b16 v[232:233], v241 offset:40960
    v_mfma_f32_16x16x32_bf16 v[148:151], v[216:219], a[216:219], v[148:151]
    ds_read_b64_tr_b16 v[234:235], v241 offset:41472
    v_mfma_f32_16x16x32_bf16 v[148:151], v[220:223], a[220:223], v[148:151]
    v_mfma_f32_16x16x32_bf16 v[152:155], v[208:211], a[224:227], v[152:155]
    ds_read_b64_tr_b16 v[236:237], v241 offset:45056
    v_cvt_pk_bf16_f32 v16, v80, v81
    v_mfma_f32_16x16x32_bf16 v[152:155], v[212:215], a[228:231], v[152:155]
    ds_read_b64_tr_b16 v[238:239], v241 offset:45568
    v_cvt_pk_bf16_f32 v17, v82, v83
    v_mfma_f32_16x16x32_bf16 v[152:155], v[216:219], a[232:235], v[152:155]
    v_cvt_pk_bf16_f32 v18, v96, v97
    v_cvt_pk_bf16_f32 v19, v98, v99
    v_mfma_f32_16x16x32_bf16 v[152:155], v[220:223], a[236:239], v[152:155]
    v_cvt_pk_bf16_f32 v20, v112, v113
    v_cvt_pk_bf16_f32 v21, v114, v115
    v_mfma_f32_16x16x32_bf16 v[156:159], v[208:211], a[240:243], v[156:159]
    s_add_u32 m0, s68, 65536
    v_cvt_pk_bf16_f32 v22, v128, v129
    v_cvt_pk_bf16_f32 v23, v130, v131
    v_mfma_f32_16x16x32_bf16 v[156:159], v[212:215], a[244:247], v[156:159]
    s_add_u32 s51, s68, 16384
    v_cvt_pk_bf16_f32 v32, v84, v85
    v_cvt_pk_bf16_f32 v33, v86, v87
    v_mfma_f32_16x16x32_bf16 v[156:159], v[216:219], a[248:251], v[156:159]
    buffer_load_dwordx4 v1, s[8:11], s51 offen offset:0 sc1 lds
    v_mfma_f32_16x16x32_bf16 v[156:159], v[220:223], a[252:255], v[156:159]
    s_waitcnt lgkmcnt(0)
    v_cvt_pk_bf16_f32 v34, v100, v101
    v_cvt_pk_bf16_f32 v35, v102, v103
    v_mfma_f32_16x16x32_bf16 v[160:163], v[224:227], a[192:195], v[160:163]
    ds_read_b64_tr_b16 v[208:209], v242 offset:32768
    v_cvt_pk_bf16_f32 v36, v116, v117
    v_mfma_f32_16x16x32_bf16 v[160:163], v[228:231], a[196:199], v[160:163]
    ds_read_b64_tr_b16 v[210:211], v242 offset:33280
    v_cvt_pk_bf16_f32 v37, v118, v119
    v_mfma_f32_16x16x32_bf16 v[160:163], v[232:235], a[200:203], v[160:163]
    ds_read_b64_tr_b16 v[212:213], v242 offset:36864
    v_cvt_pk_bf16_f32 v38, v132, v133
    v_mfma_f32_16x16x32_bf16 v[160:163], v[236:239], a[204:207], v[160:163]
    buffer_load_dwordx4 v1, s[8:11], s51 offen offset:1024 sc1 lds
    v_mfma_f32_16x16x32_bf16 v[164:167], v[224:227], a[208:211], v[164:167]
    ds_read_b64_tr_b16 v[214:215], v242 offset:37376
    v_cvt_pk_bf16_f32 v39, v134, v135
    v_mfma_f32_16x16x32_bf16 v[164:167], v[228:231], a[212:215], v[164:167]
    ds_read_b64_tr_b16 v[216:217], v242 offset:40960
    v_cvt_pk_bf16_f32 v48, v88, v89
    v_mfma_f32_16x16x32_bf16 v[164:167], v[232:235], a[216:219], v[164:167]
    ds_read_b64_tr_b16 v[218:219], v242 offset:41472
    v_cvt_pk_bf16_f32 v49, v90, v91
    v_mfma_f32_16x16x32_bf16 v[164:167], v[236:239], a[220:223], v[164:167]
    buffer_load_dwordx4 v1, s[8:11], s51 offen offset:2048 sc1 lds
    v_mfma_f32_16x16x32_bf16 v[168:171], v[224:227], a[224:227], v[168:171]
    ds_read_b64_tr_b16 v[220:221], v242 offset:45056
    v_cvt_pk_bf16_f32 v50, v104, v105
    v_mfma_f32_16x16x32_bf16 v[168:171], v[228:231], a[228:231], v[168:171]
    ds_read_b64_tr_b16 v[222:223], v242 offset:45568
    v_cvt_pk_bf16_f32 v51, v106, v107
    v_mfma_f32_16x16x32_bf16 v[168:171], v[232:235], a[232:235], v[168:171]
    v_cvt_pk_bf16_f32 v52, v120, v121
    v_cvt_pk_bf16_f32 v53, v122, v123
    v_mfma_f32_16x16x32_bf16 v[168:171], v[236:239], a[236:239], v[168:171]
    buffer_load_dwordx4 v1, s[8:11], s51 offen offset:3072 sc1 lds
    v_mfma_f32_16x16x32_bf16 v[172:175], v[224:227], a[240:243], v[172:175]
    v_cvt_pk_bf16_f32 v54, v136, v137
    v_cvt_pk_bf16_f32 v55, v138, v139
    v_mfma_f32_16x16x32_bf16 v[172:175], v[228:231], a[244:247], v[172:175]
    v_cvt_pk_bf16_f32 v64, v92, v93
    v_cvt_pk_bf16_f32 v65, v94, v95
    v_mfma_f32_16x16x32_bf16 v[172:175], v[232:235], a[248:251], v[172:175]
    v_cvt_pk_bf16_f32 v66, v108, v109
    v_cvt_pk_bf16_f32 v67, v110, v111
    v_mfma_f32_16x16x32_bf16 v[172:175], v[236:239], a[252:255], v[172:175]
    s_waitcnt lgkmcnt(0)
    v_cvt_pk_bf16_f32 v68, v124, v125
    v_cvt_pk_bf16_f32 v69, v126, v127
    v_mfma_f32_16x16x32_bf16 v[176:179], v[208:211], a[192:195], v[176:179]
    ds_read_b64_tr_b16 v[224:225], v243 offset:32768
    v_cvt_pk_bf16_f32 v70, v140, v141
    v_mfma_f32_16x16x32_bf16 v[176:179], v[212:215], a[196:199], v[176:179]
    ds_read_b64_tr_b16 v[226:227], v243 offset:33280
    v_cvt_pk_bf16_f32 v71, v142, v143
    v_mfma_f32_16x16x32_bf16 v[176:179], v[216:219], a[200:203], v[176:179]
    ds_read_b64_tr_b16 v[228:229], v243 offset:36864
    v_mfma_f32_16x16x32_bf16 v[176:179], v[220:223], a[204:207], v[176:179]
    v_mfma_f32_16x16x32_bf16 v[180:183], v[208:211], a[208:211], v[180:183]
    ds_read_b64_tr_b16 v[230:231], v243 offset:37376
    v_mfma_f32_16x16x32_bf16 v[180:183], v[212:215], a[212:215], v[180:183]
    ds_read_b64_tr_b16 v[232:233], v243 offset:40960
    v_mfma_f32_16x16x32_bf16 v[180:183], v[216:219], a[216:219], v[180:183]
    ds_read_b64_tr_b16 v[234:235], v243 offset:41472
    v_mfma_f32_16x16x32_bf16 v[180:183], v[220:223], a[220:223], v[180:183]
    v_mfma_f32_16x16x32_bf16 v[184:187], v[208:211], a[224:227], v[184:187]
    ds_read_b64_tr_b16 v[236:237], v243 offset:45056
    v_mfma_f32_16x16x32_bf16 v[184:187], v[212:215], a[228:231], v[184:187]
    ds_read_b64_tr_b16 v[238:239], v243 offset:45568
    v_mfma_f32_16x16x32_bf16 v[184:187], v[216:219], a[232:235], v[184:187]
    v_mfma_f32_16x16x32_bf16 v[184:187], v[220:223], a[236:239], v[184:187]
    v_mfma_f32_16x16x32_bf16 v[188:191], v[208:211], a[240:243], v[188:191]
    s_add_u32 m0, s68, 32768
    v_mfma_f32_16x16x32_bf16 v[188:191], v[212:215], a[244:247], v[188:191]
    s_add_u32 s51, s68, 75776
    v_mfma_f32_16x16x32_bf16 v[188:191], v[216:219], a[248:251], v[188:191]
    buffer_load_dwordx4 v1, s[8:11], s51 offen offset:0 sc1 lds
    v_mfma_f32_16x16x32_bf16 v[188:191], v[220:223], a[252:255], v[188:191]
    s_waitcnt lgkmcnt(2)
    v_mfma_f32_16x16x32_bf16 v[192:195], v[224:227], a[192:195], v[192:195]
    v_mfma_f32_16x16x32_bf16 v[192:195], v[228:231], a[196:199], v[192:195]
    v_mfma_f32_16x16x32_bf16 v[192:195], v[232:235], a[200:203], v[192:195]
    s_waitcnt lgkmcnt(0)
    v_mfma_f32_16x16x32_bf16 v[192:195], v[236:239], a[204:207], v[192:195]
    buffer_load_dwordx4 v1, s[8:11], s51 offen offset:1024 sc1 lds
    v_mfma_f32_16x16x32_bf16 v[196:199], v[224:227], a[208:211], v[196:199]
    v_mfma_f32_16x16x32_bf16 v[196:199], v[228:231], a[212:215], v[196:199]
    v_mfma_f32_16x16x32_bf16 v[196:199], v[232:235], a[216:219], v[196:199]
    v_mfma_f32_16x16x32_bf16 v[196:199], v[236:239], a[220:223], v[196:199]
    buffer_load_dwordx4 v1, s[8:11], s51 offen offset:2048 sc1 lds
    v_mfma_f32_16x16x32_bf16 v[200:203], v[224:227], a[224:227], v[200:203]
    v_mfma_f32_16x16x32_bf16 v[200:203], v[228:231], a[228:231], v[200:203]
    v_mfma_f32_16x16x32_bf16 v[200:203], v[232:235], a[232:235], v[200:203]
    v_mfma_f32_16x16x32_bf16 v[200:203], v[236:239], a[236:239], v[200:203]
    buffer_load_dwordx4 v1, s[8:11], s51 offen offset:3072 sc1 lds
    v_mfma_f32_16x16x32_bf16 v[204:207], v[224:227], a[240:243], v[204:207]
    v_mfma_f32_16x16x32_bf16 v[204:207], v[228:231], a[244:247], v[204:207]
    v_mfma_f32_16x16x32_bf16 v[204:207], v[232:235], a[248:251], v[204:207]
    v_mfma_f32_16x16x32_bf16 v[204:207], v[236:239], a[252:255], v[204:207]
    s_load_dwordx2 s[12:13], s[0:1], 40
    s_load_dwordx2 s[14:15], s[0:1], 72
    s_mov_b32 s59, 0
    s_lshl_b32 s57, s49, 12
    s_add_u32 s57, s57, 42991616
    s_add_u32 s56, s68, 65536
    s_add_u32 s52, s68, 130048
    s_mov_b32 s53, 16384
    s_mov_b32 s54, 32768
    s_waitcnt vmcnt(8) lgkmcnt(0)
    s_barrier
    ds_read_b128 a[128:131], v1 offset:0
    ds_read_b128 a[132:135], v1 offset:1024
    ds_read_b128 a[136:139], v1 offset:2048
    ds_read_b128 a[140:143], v1 offset:3072
    ds_read_b128 a[144:147], v1 offset:4096
    ds_read_b128 a[148:151], v1 offset:5120
    ds_read_b128 a[152:155], v1 offset:6144
    ds_read_b128 a[156:159], v1 offset:7168
    ds_read_b128 a[160:163], v1 offset:8192
    ds_read_b128 a[164:167], v1 offset:9216
    ds_read_b128 a[168:171], v1 offset:10240
    ds_read_b128 a[172:175], v1 offset:11264
    ds_read_b128 a[176:179], v1 offset:12288
    ds_read_b128 a[180:183], v1 offset:13312
    ds_read_b128 a[184:187], v1 offset:14336
    ds_read_b128 a[188:191], v1 offset:15360
    v_cvt_pk_bf16_f32 v24, v144, v145
    v_cvt_pk_bf16_f32 v25, v146, v147
    v_cvt_pk_bf16_f32 v26, v160, v161
    v_cvt_pk_bf16_f32 v27, v162, v163
    v_cvt_pk_bf16_f32 v28, v176, v177
    v_cvt_pk_bf16_f32 v29, v178, v179
    v_cvt_pk_bf16_f32 v30, v192, v193
    v_cvt_pk_bf16_f32 v31, v194, v195
    v_cvt_pk_bf16_f32 v40, v148, v149
    v_cvt_pk_bf16_f32 v41, v150, v151
    v_cvt_pk_bf16_f32 v42, v164, v165
    v_cvt_pk_bf16_f32 v43, v166, v167
    v_cvt_pk_bf16_f32 v44, v180, v181
    v_cvt_pk_bf16_f32 v45, v182, v183
    v_cvt_pk_bf16_f32 v46, v196, v197
    v_cvt_pk_bf16_f32 v47, v198, v199
    v_cvt_pk_bf16_f32 v56, v152, v153
    v_cvt_pk_bf16_f32 v57, v154, v155
    v_cvt_pk_bf16_f32 v58, v168, v169
    v_cvt_pk_bf16_f32 v59, v170, v171
    v_cvt_pk_bf16_f32 v60, v184, v185
    v_cvt_pk_bf16_f32 v61, v186, v187
    v_cvt_pk_bf16_f32 v62, v200, v201
    v_cvt_pk_bf16_f32 v63, v202, v203
    v_cvt_pk_bf16_f32 v72, v156, v157
    v_cvt_pk_bf16_f32 v73, v158, v159
    v_cvt_pk_bf16_f32 v74, v172, v173
    v_cvt_pk_bf16_f32 v75, v174, v175
    v_cvt_pk_bf16_f32 v76, v188, v189
    v_cvt_pk_bf16_f32 v77, v190, v191
    v_cvt_pk_bf16_f32 v78, v204, v205
    v_cvt_pk_bf16_f32 v79, v206, v207
    s_cmp_eq_u32 s50, 0
    s_cbranch_scc1 L_att_P1
L_att_P0:
    s_waitcnt lgkmcnt(15)
    v_mfma_f32_16x16x32_bf16 v[80:83], a[128:131], v[16:19], 0
    s_add_u32 m0, s68, 81920
    s_add_u32 s51, s68, 54272
    v_add_u32 v2, 16384, v1
    v_mov_b32 v192, 0
    s_waitcnt lgkmcnt(14)
    v_mfma_f32_16x16x32_bf16 v[80:83], a[132:135], v[20:23], v[80:83]
    buffer_load_dwordx4 v1, s[8:11], s51 offen offset:0 sc1 lds
    v_mov_b32 v193, 0
    v_mov_b32 v194, 0
    s_waitcnt lgkmcnt(13)
    v_mfma_f32_16x16x32_bf16 v[80:83], a[136:139], v[24:27], v[80:83]
    s_waitcnt lgkmcnt(12)
    v_mov_b32 v195, 0
    v_mov_b32 v196, 0
    v_mfma_f32_16x16x32_bf16 v[80:83], a[140:143], v[28:31], v[80:83]
    v_mov_b32 v197, 0
    v_mov_b32 v198, 0
    v_mfma_f32_16x16x32_bf16 v[84:87], a[128:131], v[32:35], 0
    v_mov_b32 v199, 0
    v_mov_b32 v200, 0
    v_mfma_f32_16x16x32_bf16 v[84:87], a[132:135], v[36:39], v[84:87]
    buffer_load_dwordx4 v1, s[8:11], s51 offen offset:1024 sc1 lds
    v_mov_b32 v201, 0
    v_mov_b32 v202, 0
    v_mfma_f32_16x16x32_bf16 v[84:87], a[136:139], v[40:43], v[84:87]
    v_mov_b32 v203, 0
    v_mov_b32 v204, 0
    v_mfma_f32_16x16x32_bf16 v[84:87], a[140:143], v[44:47], v[84:87]
    v_mov_b32 v205, 0
    v_mov_b32 v206, 0
    v_mfma_f32_16x16x32_bf16 v[88:91], a[128:131], v[48:51], 0
    v_mov_b32 v207, 0
    v_max3_f32 v208, v80, v81, v82
    v_mfma_f32_16x16x32_bf16 v[88:91], a[132:135], v[52:55], v[88:91]
    buffer_load_dwordx4 v1, s[8:11], s51 offen offset:2048 sc1 lds
    v_max_f32 v208, v208, v83
    v_mov_b32 v212, v208
    v_mfma_f32_16x16x32_bf16 v[88:91], a[136:139], v[56:59], v[88:91]
    s_nop 0
    v_permlane32_swap_b32 v208, v212
    v_max_f32 v208, v208, v212
    v_mfma_f32_16x16x32_bf16 v[88:91], a[140:143], v[60:63], v[88:91]
    v_mov_b32 v212, v208
    v_mov_b32 v3, v12
    v_mfma_f32_16x16x32_bf16 v[92:95], a[128:131], v[64:67], 0
    ds_read_b128 a[128:131], v2 offset:0
    v_permlane16_swap_b32 v208, v212
    v_mfma_f32_16x16x32_bf16 v[92:95], a[132:135], v[68:71], v[92:95]
    buffer_load_dwordx4 v1, s[8:11], s51 offen offset:3072 sc1 lds
    v_max_f32 v208, v208, v212
    v_xor_b32 v176, 0x80000000, v208
    v_mfma_f32_16x16x32_bf16 v[92:95], a[136:139], v[72:75], v[92:95]
    ds_read_b128 a[132:135], v2 offset:1024
    v_xor_b32 v177, 0x80000000, v208
    v_mfma_f32_16x16x32_bf16 v[92:95], a[140:143], v[76:79], v[92:95]
    ds_read_b128 a[136:139], v2 offset:2048
    v_xor_b32 v178, 0x80000000, v208
    s_waitcnt lgkmcnt(3)
    v_mfma_f32_16x16x32_bf16 v[96:99], a[144:147], v[16:19], 0
    s_add_u32 m0, s68, 49152
    s_add_u32 s51, s68, 113664
    v_xor_b32 v179, 0x80000000, v208
    v_max3_f32 v209, v84, v85, v86
    v_mfma_f32_16x16x32_bf16 v[96:99], a[148:151], v[20:23], v[96:99]
    buffer_load_dwordx4 v1, s[8:11], s51 offen offset:0 sc1 lds
    v_max_f32 v209, v209, v87
    v_mov_b32 v213, v209
    v_mfma_f32_16x16x32_bf16 v[96:99], a[152:155], v[24:27], v[96:99]
    ds_read_b128 a[140:143], v2 offset:3072
    v_permlane32_swap_b32 v209, v213
    v_mfma_f32_16x16x32_bf16 v[96:99], a[156:159], v[28:31], v[96:99]
    v_max_f32 v209, v209, v213
    v_mov_b32 v213, v209
    v_mfma_f32_16x16x32_bf16 v[100:103], a[144:147], v[32:35], 0
    s_nop 0
    v_permlane16_swap_b32 v209, v213
    v_max_f32 v209, v209, v213
    v_mfma_f32_16x16x32_bf16 v[100:103], a[148:151], v[36:39], v[100:103]
    buffer_load_dwordx4 v1, s[8:11], s51 offen offset:1024 sc1 lds
    v_xor_b32 v180, 0x80000000, v209
    v_xor_b32 v181, 0x80000000, v209
    v_mfma_f32_16x16x32_bf16 v[100:103], a[152:155], v[40:43], v[100:103]
    v_xor_b32 v182, 0x80000000, v209
    v_xor_b32 v183, 0x80000000, v209
    v_mfma_f32_16x16x32_bf16 v[100:103], a[156:159], v[44:47], v[100:103]
    v_max3_f32 v210, v88, v89, v90
    v_max_f32 v210, v210, v91
    v_mfma_f32_16x16x32_bf16 v[104:107], a[144:147], v[48:51], 0
    v_mov_b32 v214, v210
    v_max3_f32 v211, v92, v93, v94
    v_mfma_f32_16x16x32_bf16 v[104:107], a[148:151], v[52:55], v[104:107]
    buffer_load_dwordx4 v1, s[8:11], s51 offen offset:2048 sc1 lds
    v_permlane32_swap_b32 v210, v214
    v_max_f32 v210, v210, v214
    v_mfma_f32_16x16x32_bf16 v[104:107], a[152:155], v[56:59], v[104:107]
    v_mov_b32 v214, v210
    v_max_f32 v211, v211, v95
    v_mfma_f32_16x16x32_bf16 v[104:107], a[156:159], v[60:63], v[104:107]
    v_permlane16_swap_b32 v210, v214
    v_max_f32 v210, v210, v214
    v_mfma_f32_16x16x32_bf16 v[108:111], a[144:147], v[64:67], 0
    ds_read_b128 a[144:147], v2 offset:4096
    v_xor_b32 v184, 0x80000000, v210
    v_mfma_f32_16x16x32_bf16 v[108:111], a[148:151], v[68:71], v[108:111]
    buffer_load_dwordx4 v1, s[8:11], s51 offen offset:3072 sc1 lds
    v_xor_b32 v185, 0x80000000, v210
    v_xor_b32 v186, 0x80000000, v210
    v_mfma_f32_16x16x32_bf16 v[108:111], a[152:155], v[72:75], v[108:111]
    ds_read_b128 a[148:151], v2 offset:5120
    v_xor_b32 v187, 0x80000000, v210
    v_mfma_f32_16x16x32_bf16 v[108:111], a[156:159], v[76:79], v[108:111]
    ds_read_b128 a[152:155], v2 offset:6144
    v_mov_b32 v215, v211
    v_mfma_f32_16x16x32_bf16 v[112:115], a[160:163], v[16:19], v[176:179]
    s_add_u32 m0, s68, 98304
    s_add_u32 s51, s68, 92160
    v_permlane32_swap_b32 v211, v215
    v_max_f32 v211, v211, v215
    v_mfma_f32_16x16x32_bf16 v[112:115], a[164:167], v[20:23], v[112:115]
    buffer_load_dwordx4 v1, s[8:11], s51 offen offset:0 sc1 lds
    v_mov_b32 v215, v211
    v_add_f32 v80, v80, v176
    v_mfma_f32_16x16x32_bf16 v[112:115], a[168:171], v[24:27], v[112:115]
    ds_read_b128 a[156:159], v2 offset:7168
    v_permlane16_swap_b32 v211, v215
    v_mfma_f32_16x16x32_bf16 v[112:115], a[172:175], v[28:31], v[112:115]
    v_max_f32 v211, v211, v215
    v_xor_b32 v188, 0x80000000, v211
    v_mfma_f32_16x16x32_bf16 v[116:119], a[160:163], v[32:35], v[180:183]
    v_xor_b32 v189, 0x80000000, v211
    v_xor_b32 v190, 0x80000000, v211
    v_mfma_f32_16x16x32_bf16 v[116:119], a[164:167], v[36:39], v[116:119]
    buffer_load_dwordx4 v1, s[8:11], s51 offen offset:1024 sc1 lds
    v_xor_b32 v191, 0x80000000, v211
    v_add_f32 v81, v81, v176
    v_mfma_f32_16x16x32_bf16 v[116:119], a[168:171], v[40:43], v[116:119]
    v_add_f32 v82, v82, v176
    v_add_f32 v83, v83, v176
    v_mfma_f32_16x16x32_bf16 v[116:119], a[172:175], v[44:47], v[116:119]
    v_exp_f32 v80, v80
    v_mfma_f32_16x16x32_bf16 v[120:123], a[160:163], v[48:51], v[184:187]
    v_exp_f32 v81, v81
    v_mfma_f32_16x16x32_bf16 v[120:123], a[164:167], v[52:55], v[120:123]
    buffer_load_dwordx4 v1, s[8:11], s51 offen offset:2048 sc1 lds
    v_exp_f32 v82, v82
    v_mfma_f32_16x16x32_bf16 v[120:123], a[168:171], v[56:59], v[120:123]
    v_exp_f32 v83, v83
    v_mfma_f32_16x16x32_bf16 v[120:123], a[172:175], v[60:63], v[120:123]
    v_cvt_pk_bf16_f32 v144, v80, v81
    v_add_f32 v84, v84, v180
    v_mfma_f32_16x16x32_bf16 v[124:127], a[160:163], v[64:67], v[188:191]
    ds_read_b128 a[160:163], v2 offset:8192
    v_cvt_pk_bf16_f32 v145, v82, v83
    v_mfma_f32_16x16x32_bf16 v[124:127], a[164:167], v[68:71], v[124:127]
    buffer_load_dwordx4 v1, s[8:11], s51 offen offset:3072 sc1 lds
    v_add_f32 v85, v85, v180
    v_add_f32 v86, v86, v180
    v_mfma_f32_16x16x32_bf16 v[124:127], a[168:171], v[72:75], v[124:127]
    ds_read_b128 a[164:167], v2 offset:9216
    v_add_f32 v87, v87, v180
    v_mfma_f32_16x16x32_bf16 v[124:127], a[172:175], v[76:79], v[124:127]
    s_waitcnt lgkmcnt(4)
    s_barrier
    v_exp_f32 v84, v84
    v_mfma_f32_16x16x32_bf16 v[128:131], a[176:179], v[16:19], v[176:179]
    s_add_u32 m0, s68, 0
    s_add_u32 s51, s68, 151552
    v_exp_f32 v85, v85
    v_mfma_f32_16x16x32_bf16 v[128:131], a[180:183], v[20:23], v[128:131]
    buffer_load_dwordx4 v1, s[8:11], s51 offen offset:0 sc1 lds
    v_exp_f32 v86, v86
    v_mfma_f32_16x16x32_bf16 v[128:131], a[184:187], v[24:27], v[128:131]
    ds_read_b128 a[168:171], v2 offset:10240
    v_cvt_pk_bf16_f32 v152, v84, v85
    v_mfma_f32_16x16x32_bf16 v[128:131], a[188:191], v[28:31], v[128:131]
    ds_read_b128 a[172:175], v2 offset:11264
    v_add_f32 v88, v88, v184
    v_mfma_f32_16x16x32_bf16 v[132:135], a[176:179], v[32:35], v[180:183]
    v_exp_f32 v87, v87
    v_mfma_f32_16x16x32_bf16 v[132:135], a[180:183], v[36:39], v[132:135]
    buffer_load_dwordx4 v1, s[8:11], s51 offen offset:1024 sc1 lds
    v_cvt_pk_bf16_f32 v153, v86, v87
    v_add_f32 v89, v89, v184
    v_mfma_f32_16x16x32_bf16 v[132:135], a[184:187], v[40:43], v[132:135]
    v_add_f32 v90, v90, v184
    v_add_f32 v91, v91, v184
    v_mfma_f32_16x16x32_bf16 v[132:135], a[188:191], v[44:47], v[132:135]
    v_exp_f32 v88, v88
    v_mfma_f32_16x16x32_bf16 v[136:139], a[176:179], v[48:51], v[184:187]
    v_exp_f32 v89, v89
    v_mfma_f32_16x16x32_bf16 v[136:139], a[180:183], v[52:55], v[136:139]
    buffer_load_dwordx4 v1, s[8:11], s51 offen offset:2048 sc1 lds
    v_exp_f32 v90, v90
    v_mfma_f32_16x16x32_bf16 v[136:139], a[184:187], v[56:59], v[136:139]
    v_exp_f32 v91, v91
    v_mfma_f32_16x16x32_bf16 v[136:139], a[188:191], v[60:63], v[136:139]
    v_add_f32 v92, v92, v188
    v_add_f32 v93, v93, v188
    v_mfma_f32_16x16x32_bf16 v[140:143], a[176:179], v[64:67], v[188:191]
    ds_read_b128 a[176:179], v2 offset:12288
    v_add_f32 v94, v94, v188
    v_mfma_f32_16x16x32_bf16 v[140:143], a[180:183], v[68:71], v[140:143]
    buffer_load_dwordx4 v1, s[8:11], s51 offen offset:3072 sc1 lds
    v_add_f32 v95, v95, v188
    v_add_f32 v96, v96, v176
    v_mfma_f32_16x16x32_bf16 v[140:143], a[184:187], v[72:75], v[140:143]
    ds_read_b128 a[180:183], v2 offset:13312
    v_add_f32 v97, v97, v176
    v_mfma_f32_16x16x32_bf16 v[140:143], a[188:191], v[76:79], v[140:143]
    ds_read_b128 a[184:187], v2 offset:14336
    v_add_f32 v98, v98, v176
    ds_read_b128 a[188:191], v2 offset:15360
    v_exp_f32 v92, v92
    v_exp_f32 v93, v93
    v_exp_f32 v94, v94
    v_exp_f32 v95, v95
    v_add_f32 v99, v99, v176
    v_exp_f32 v96, v96
    v_exp_f32 v97, v97
    v_exp_f32 v98, v98
    v_exp_f32 v99, v99
    v_add_f32 v100, v100, v180
    v_add_f32 v101, v101, v180
    v_add_f32 v102, v102, v180
    v_add_f32 v103, v103, v180
    v_exp_f32 v100, v100
    v_exp_f32 v101, v101
    v_exp_f32 v102, v102
    v_exp_f32 v103, v103
    v_add_f32 v104, v104, v184
    v_add_f32 v105, v105, v184
    v_add_f32 v106, v106, v184
    v_add_f32 v107, v107, v184
    v_exp_f32 v104, v104
    v_exp_f32 v105, v105
    v_exp_f32 v106, v106
    v_exp_f32 v107, v107
    v_add_f32 v108, v108, v188
    v_add_f32 v109, v109, v188
    v_add_f32 v110, v110, v188
    v_add_f32 v111, v111, v188
    v_exp_f32 v108, v108
    v_exp_f32 v109, v109
    v_exp_f32 v110, v110
    v_exp_f32 v111, v111
    v_exp_f32 v112, v112
    v_exp_f32 v113, v113
    v_exp_f32 v114, v114
    v_exp_f32 v115, v115
    v_exp_f32 v116, v116
    v_exp_f32 v117, v117
    v_exp_f32 v118, v118
    v_exp_f32 v119, v119
    s_waitcnt vmcnt(16) lgkmcnt(0)
    s_barrier
    s_lshl_b32 s58, s50, 1
    s_sub_u32 s58, s58, 1
.p2align 6
    s_nop 0
L_att_D:
    v_mfma_f32_16x16x32_bf16 v[80:83], a[128:131], v[16:19], v[176:179]
    ds_read_b128 a[192:195], v3 offset:0
    v_cvt_pk_bf16_f32 v161, v90, v91
    v_mfma_f32_16x16x32_bf16 v[80:83], a[132:135], v[20:23], v[80:83]
    v_cvt_pk_bf16_f32 v160, v88, v89
    v_cvt_pk_bf16_f32 v147, v98, v99
    v_mfma_f32_16x16x32_bf16 v[80:83], a[136:139], v[24:27], v[80:83]
L_att_D_0:
    v_exp_f32 v133, v133
    v_mfma_f32_16x16x32_bf16 v[80:83], a[140:143], v[28:31], v[80:83]
    v_exp_f32 v135, v135
    v_mfma_f32_16x16x32_bf16 v[84:87], a[128:131], v[32:35], v[180:183]
    v_cvt_pk_bf16_f32 v146, v96, v97
    v_cvt_pk_bf16_f32 v170, v108, v109
    v_mfma_f32_16x16x32_bf16 v[84:87], a[132:135], v[36:39], v[84:87]
    v_cvt_pk_bf16_f32 v163, v106, v107
    v_cvt_pk_bf16_f32 v149, v114, v115
    v_mfma_f32_16x16x32_bf16 v[84:87], a[136:139], v[40:43], v[84:87]
L_att_D_1:
    v_cvt_pk_bf16_f32 v162, v104, v105
    v_cvt_pk_bf16_f32 v157, v118, v119
    v_mfma_f32_16x16x32_bf16 v[84:87], a[140:143], v[44:47], v[84:87]
    ds_read_b128 a[196:199], v3 offset:1024
    v_cvt_pk_bf16_f32 v169, v94, v95
    v_mfma_f32_16x16x32_bf16 v[88:91], a[128:131], v[48:51], v[184:187]
    v_exp_f32 v122, v122
    v_mfma_f32_16x16x32_bf16 v[88:91], a[132:135], v[52:55], v[88:91]
    v_cvt_pk_bf16_f32 v168, v92, v93
    v_cvt_pk_bf16_f32 v155, v102, v103
    v_mfma_f32_16x16x32_bf16 v[88:91], a[136:139], v[56:59], v[88:91]
L_att_D_2:
    v_exp_f32 v131, v131
    v_mfma_f32_16x16x32_bf16 v[88:91], a[140:143], v[60:63], v[88:91]
    v_exp_f32 v126, v126
    v_mfma_f32_16x16x32_bf16 v[92:95], a[128:131], v[64:67], v[188:191]
    v_exp_f32 v87, v87
    v_mfma_f32_16x16x32_bf16 v[92:95], a[132:135], v[68:71], v[92:95]
    v_exp_f32 v140, v140
    v_mfma_f32_16x16x32_bf16 v[92:95], a[136:139], v[72:75], v[92:95]
L_att_D_3:
    v_exp_f32 v130, v130
    v_mfma_f32_16x16x32_bf16 v[92:95], a[140:143], v[76:79], v[92:95]
    ds_read_b128 a[200:203], v3 offset:2048
    v_cvt_pk_bf16_f32 v154, v100, v101
    v_mfma_f32_16x16x32_bf16 v[96:99], a[144:147], v[16:19], v[176:179]
    s_add_u32 m0, s53, s68
    v_exp_f32 v125, v125
    v_mfma_f32_16x16x32_bf16 v[96:99], a[148:151], v[20:23], v[96:99]
    v_exp_f32 v132, v132
    v_mfma_f32_16x16x32_bf16 v[96:99], a[152:155], v[24:27], v[96:99]
    v_exp_f32 v134, v134
    v_mfma_f32_16x16x32_bf16 v[96:99], a[156:159], v[28:31], v[96:99]
    v_exp_f32 v127, v127
    v_mfma_f32_16x16x32_bf16 v[100:103], a[144:147], v[32:35], v[180:183]
    v_cvt_pk_bf16_f32 v171, v110, v111
    v_cvt_pk_bf16_f32 v151, v130, v131
    v_mfma_f32_16x16x32_bf16 v[100:103], a[148:151], v[36:39], v[100:103]
    v_exp_f32 v124, v124
    v_mfma_f32_16x16x32_bf16 v[100:103], a[152:155], v[40:43], v[100:103]
    s_xor_b32 s55, s53, 0x8000
    v_exp_f32 v121, v121
    v_mfma_f32_16x16x32_bf16 v[100:103], a[156:159], v[44:47], v[100:103]
    v_exp_f32 v123, v123
    v_mfma_f32_16x16x32_bf16 v[104:107], a[144:147], v[48:51], v[184:187]
    ds_read_b128 a[204:207], v3 offset:3072
    v_cvt_pk_bf16_f32 v148, v112, v113
    v_mfma_f32_16x16x32_bf16 v[104:107], a[148:151], v[52:55], v[104:107]
    v_exp_f32 v99, v99
    v_mfma_f32_16x16x32_bf16 v[104:107], a[152:155], v[56:59], v[104:107]
    v_exp_f32 v138, v138
    v_mfma_f32_16x16x32_bf16 v[104:107], a[156:159], v[60:63], v[104:107]
    ds_read_b128 a[208:211], v3 offset:4096
    v_mfma_f32_16x16x32_bf16 v[108:111], a[144:147], v[64:67], v[188:191]
    v_exp_f32 v136, v136
    v_mfma_f32_16x16x32_bf16 v[108:111], a[148:151], v[68:71], v[108:111]
    ds_read_b128 a[212:215], v3 offset:5120
    v_cvt_pk_bf16_f32 v173, v126, v127
    v_mfma_f32_16x16x32_bf16 v[108:111], a[152:155], v[72:75], v[108:111]
    buffer_load_dwordx4 v11, s[8:11], s52 offen offset:0 sc1 lds
    v_mfma_f32_16x16x32_bf16 v[108:111], a[156:159], v[76:79], v[108:111]
    v_cvt_pk_bf16_f32 v156, v116, v117
    v_cvt_pk_bf16_f32 v165, v122, v123
    v_mfma_f32_16x16x32_bf16 v[112:115], a[160:163], v[16:19], v[176:179]
    ds_read_b128 a[216:219], v3 offset:6144
    v_cvt_pk_bf16_f32 v172, v124, v125
    v_mfma_f32_16x16x32_bf16 v[112:115], a[164:167], v[20:23], v[112:115]
    v_exp_f32 v120, v120
    v_mfma_f32_16x16x32_bf16 v[112:115], a[168:171], v[24:27], v[112:115]
    ds_read_b128 a[220:223], v3 offset:7168
    v_cvt_pk_bf16_f32 v164, v120, v121
    v_mfma_f32_16x16x32_bf16 v[112:115], a[172:175], v[28:31], v[112:115]
    v_exp_f32 v101, v101
    v_mfma_f32_16x16x32_bf16 v[116:119], a[160:163], v[32:35], v[180:183]
    v_exp_f32 v129, v129
    v_mfma_f32_16x16x32_bf16 v[116:119], a[164:167], v[36:39], v[116:119]
    v_exp_f32 v128, v128
    v_mfma_f32_16x16x32_bf16 v[116:119], a[168:171], v[40:43], v[116:119]
    v_exp_f32 v108, v108
    v_mfma_f32_16x16x32_bf16 v[116:119], a[172:175], v[44:47], v[116:119]
    ds_read_b128 a[224:227], v3 offset:8192
    v_add_u32 v2, s54, v1
    v_mfma_f32_16x16x32_bf16 v[120:123], a[160:163], v[48:51], v[184:187]
    v_mfma_f32_16x16x32_bf16 v[120:123], a[164:167], v[52:55], v[120:123]
    v_exp_f32 v142, v142
    v_mfma_f32_16x16x32_bf16 v[120:123], a[168:171], v[56:59], v[120:123]
    v_exp_f32 v143, v143
    v_mfma_f32_16x16x32_bf16 v[120:123], a[172:175], v[60:63], v[120:123]
    ds_read_b128 a[228:231], v3 offset:9216
    v_mfma_f32_16x16x32_bf16 v[124:127], a[160:163], v[64:67], v[188:191]
    v_cvt_pk_bf16_f32 v158, v132, v133
    v_mfma_f32_16x16x32_bf16 v[124:127], a[164:167], v[68:71], v[124:127]
    ds_read_b128 a[232:235], v3 offset:10240
    v_cvt_pk_bf16_f32 v159, v134, v135
    v_mfma_f32_16x16x32_bf16 v[124:127], a[168:171], v[72:75], v[124:127]
    v_cvt_pk_bf16_f32 v150, v128, v129
    v_mfma_f32_16x16x32_bf16 v[124:127], a[172:175], v[76:79], v[124:127]
    v_exp_f32 v139, v139
    v_mfma_f32_16x16x32_bf16 v[128:131], a[176:179], v[16:19], v[176:179]
    v_exp_f32 v141, v141
    v_mfma_f32_16x16x32_bf16 v[128:131], a[180:183], v[20:23], v[128:131]
    v_cvt_pk_bf16_f32 v167, v138, v139
    v_cvt_pk_bf16_f32 v175, v142, v143
    v_mfma_f32_16x16x32_bf16 v[128:131], a[184:187], v[24:27], v[128:131]
    v_exp_f32 v137, v137
    v_mfma_f32_16x16x32_bf16 v[128:131], a[188:191], v[28:31], v[128:131]
    ds_read_b128 a[236:239], v3 offset:11264
    v_mfma_f32_16x16x32_bf16 v[132:135], a[176:179], v[32:35], v[180:183]
    v_cvt_pk_bf16_f32 v166, v136, v137
    v_mfma_f32_16x16x32_bf16 v[132:135], a[180:183], v[36:39], v[132:135]
    buffer_load_dwordx4 v11, s[8:11], s52 offen offset:1024 sc1 lds
    v_mfma_f32_16x16x32_bf16 v[132:135], a[184:187], v[40:43], v[132:135]
    v_mfma_f32_16x16x32_bf16 v[132:135], a[188:191], v[44:47], v[132:135]
    ds_read_b128 a[240:243], v3 offset:12288
    v_cvt_pk_bf16_f32 v174, v140, v141
    v_mfma_f32_16x16x32_bf16 v[136:139], a[176:179], v[48:51], v[184:187]
    v_exp_f32 v110, v110
    v_mfma_f32_16x16x32_bf16 v[136:139], a[180:183], v[52:55], v[136:139]
    ds_read_b128 a[244:247], v3 offset:13312
    v_mfma_f32_16x16x32_bf16 v[136:139], a[184:187], v[56:59], v[136:139]
    buffer_load_dwordx4 v11, s[8:11], s52 offen offset:2048 sc1 lds
    v_mfma_f32_16x16x32_bf16 v[136:139], a[188:191], v[60:63], v[136:139]
    ds_read_b128 a[248:251], v3 offset:14336
    v_mfma_f32_16x16x32_bf16 v[140:143], a[176:179], v[64:67], v[188:191]
    v_exp_f32 v96, v96
    v_mfma_f32_16x16x32_bf16 v[140:143], a[180:183], v[68:71], v[140:143]
    ds_read_b128 a[252:255], v3 offset:15360
    v_mfma_f32_16x16x32_bf16 v[140:143], a[184:187], v[72:75], v[140:143]
    v_mfma_f32_16x16x32_bf16 v[140:143], a[188:191], v[76:79], v[140:143]
    v_exp_f32 v111, v111
    v_mfma_f32_16x16x32_bf16 v[192:195], v[4:7], v[144:147], v[192:195]
    buffer_load_dwordx4 v11, s[8:11], s52 offen offset:3072 sc1 lds
    v_mfma_f32_16x16x32_bf16 v[192:195], v[4:7], v[148:151], v[192:195]
    v_exp_f32 v85, v85
    v_mfma_f32_16x16x32_bf16 v[196:199], v[4:7], v[152:155], v[196:199]
    v_exp_f32 v114, v114
    v_mfma_f32_16x16x32_bf16 v[196:199], v[4:7], v[156:159], v[196:199]
    ds_read_b128 a[128:131], v2 offset:0
    v_add_u32 v3, s53, v12
    v_mfma_f32_16x16x32_bf16 v[200:203], v[4:7], v[160:163], v[200:203]
    v_mfma_f32_16x16x32_bf16 v[200:203], v[4:7], v[164:167], v[200:203]
    v_exp_f32 v98, v98
    v_mfma_f32_16x16x32_bf16 v[204:207], v[4:7], v[168:171], v[204:207]
    ds_read_b128 a[132:135], v2 offset:1024
    v_mfma_f32_16x16x32_bf16 v[204:207], v[4:7], v[172:175], v[204:207]
    s_waitcnt lgkmcnt(2)
    v_mfma_f32_16x16x32_bf16 a[0:3], a[192:195], v[144:147], a[0:3]
    ds_read_b128 a[136:139], v2 offset:2048
    v_mfma_f32_16x16x32_bf16 a[0:3], a[196:199], v[148:151], a[0:3]
    v_mfma_f32_16x16x32_bf16 a[32:35], a[192:195], v[152:155], a[32:35]
    v_mfma_f32_16x16x32_bf16 a[32:35], a[196:199], v[156:159], a[32:35]
    v_exp_f32 v80, v80
    v_mfma_f32_16x16x32_bf16 a[64:67], a[192:195], v[160:163], a[64:67]
    v_exp_f32 v105, v105
    v_mfma_f32_16x16x32_bf16 a[64:67], a[196:199], v[164:167], a[64:67]
    v_exp_f32 v119, v119
    v_mfma_f32_16x16x32_bf16 a[96:99], a[192:195], v[168:171], a[96:99]
    ds_read_b128 a[140:143], v2 offset:3072
    s_mov_b32 s53, s54
    v_mfma_f32_16x16x32_bf16 a[96:99], a[196:199], v[172:175], a[96:99]
    v_mfma_f32_16x16x32_bf16 a[4:7], a[200:203], v[144:147], a[4:7]
    v_mfma_f32_16x16x32_bf16 a[4:7], a[204:207], v[148:151], a[4:7]
    v_mfma_f32_16x16x32_bf16 a[36:39], a[200:203], v[152:155], a[36:39]
    v_exp_f32 v83, v83
    v_mfma_f32_16x16x32_bf16 a[36:39], a[204:207], v[156:159], a[36:39]
    ds_read_b128 a[144:147], v2 offset:4096
    v_mfma_f32_16x16x32_bf16 a[68:71], a[200:203], v[160:163], a[68:71]
    s_add_u32 m0, s55, s56
    v_exp_f32 v94, v94
    v_mfma_f32_16x16x32_bf16 a[68:71], a[204:207], v[164:167], a[68:71]
    v_exp_f32 v91, v91
    v_mfma_f32_16x16x32_bf16 a[100:103], a[200:203], v[168:171], a[100:103]
    ds_read_b128 a[148:151], v2 offset:5120
    v_mfma_f32_16x16x32_bf16 a[100:103], a[204:207], v[172:175], a[100:103]
    v_exp_f32 v106, v106
    v_mfma_f32_16x16x32_bf16 a[8:11], a[208:211], v[144:147], a[8:11]
    v_exp_f32 v109, v109
    v_mfma_f32_16x16x32_bf16 a[8:11], a[212:215], v[148:151], a[8:11]
    v_exp_f32 v86, v86
    v_mfma_f32_16x16x32_bf16 a[40:43], a[208:211], v[152:155], a[40:43]
    ds_read_b128 a[152:155], v2 offset:6144
    v_mfma_f32_16x16x32_bf16 a[40:43], a[212:215], v[156:159], a[40:43]
    buffer_load_dwordx4 v1, s[8:11], s52 offen offset:0 sc1 lds
    v_mfma_f32_16x16x32_bf16 a[72:75], a[208:211], v[160:163], a[72:75]
    ds_read_b128 a[156:159], v2 offset:7168
    v_mfma_f32_16x16x32_bf16 a[72:75], a[212:215], v[164:167], a[72:75]
    v_exp_f32 v113, v113
    v_mfma_f32_16x16x32_bf16 a[104:107], a[208:211], v[168:171], a[104:107]
    v_mfma_f32_16x16x32_bf16 a[104:107], a[212:215], v[172:175], a[104:107]
    v_exp_f32 v97, v97
    v_mfma_f32_16x16x32_bf16 a[12:15], a[216:219], v[144:147], a[12:15]
    v_exp_f32 v82, v82
    v_mfma_f32_16x16x32_bf16 a[12:15], a[220:223], v[148:151], a[12:15]
    buffer_load_dwordx4 v1, s[8:11], s52 offen offset:1024 sc1 lds
    v_mfma_f32_16x16x32_bf16 a[44:47], a[216:219], v[152:155], a[44:47]
    ds_read_b128 a[160:163], v2 offset:8192
    v_mfma_f32_16x16x32_bf16 a[44:47], a[220:223], v[156:159], a[44:47]
    v_mfma_f32_16x16x32_bf16 a[76:79], a[216:219], v[160:163], a[76:79]
    v_mfma_f32_16x16x32_bf16 a[76:79], a[220:223], v[164:167], a[76:79]
    ds_read_b128 a[164:167], v2 offset:9216
    v_mfma_f32_16x16x32_bf16 a[108:111], a[216:219], v[168:171], a[108:111]
    v_exp_f32 v81, v81
    v_mfma_f32_16x16x32_bf16 a[108:111], a[220:223], v[172:175], a[108:111]
    v_exp_f32 v89, v89
    v_mfma_f32_16x16x32_bf16 a[16:19], a[224:227], v[144:147], a[16:19]
    v_exp_f32 v112, v112
    v_mfma_f32_16x16x32_bf16 a[16:19], a[228:231], v[148:151], a[16:19]
    v_exp_f32 v95, v95
    v_mfma_f32_16x16x32_bf16 a[48:51], a[224:227], v[152:155], a[48:51]
    v_exp_f32 v117, v117
    v_mfma_f32_16x16x32_bf16 a[48:51], a[228:231], v[156:159], a[48:51]
    v_exp_f32 v102, v102
    v_mfma_f32_16x16x32_bf16 a[80:83], a[224:227], v[160:163], a[80:83]
    v_exp_f32 v116, v116
    v_mfma_f32_16x16x32_bf16 a[80:83], a[228:231], v[164:167], a[80:83]
    ds_read_b128 a[168:171], v2 offset:10240
    v_mfma_f32_16x16x32_bf16 a[112:115], a[224:227], v[168:171], a[112:115]
    s_mov_b32 s54, s55
    v_exp_f32 v100, v100
    v_mfma_f32_16x16x32_bf16 a[112:115], a[228:231], v[172:175], a[112:115]
    v_exp_f32 v93, v93
    v_mfma_f32_16x16x32_bf16 a[20:23], a[232:235], v[144:147], a[20:23]
    v_mfma_f32_16x16x32_bf16 a[20:23], a[236:239], v[148:151], a[20:23]
    ds_read_b128 a[172:175], v2 offset:11264
    v_mfma_f32_16x16x32_bf16 a[52:55], a[232:235], v[152:155], a[52:55]
    v_exp_f32 v90, v90
    v_mfma_f32_16x16x32_bf16 a[52:55], a[236:239], v[156:159], a[52:55]
    v_exp_f32 v107, v107
    v_mfma_f32_16x16x32_bf16 a[84:87], a[232:235], v[160:163], a[84:87]
    buffer_load_dwordx4 v1, s[8:11], s52 offen offset:2048 sc1 lds
    v_mfma_f32_16x16x32_bf16 a[84:87], a[236:239], v[164:167], a[84:87]
    ds_read_b128 a[176:179], v2 offset:12288
    v_mfma_f32_16x16x32_bf16 a[116:119], a[232:235], v[168:171], a[116:119]
    v_exp_f32 v104, v104
    v_mfma_f32_16x16x32_bf16 a[116:119], a[236:239], v[172:175], a[116:119]
    v_exp_f32 v88, v88
    v_mfma_f32_16x16x32_bf16 a[24:27], a[240:243], v[144:147], a[24:27]
    v_exp_f32 v84, v84
    v_mfma_f32_16x16x32_bf16 a[24:27], a[244:247], v[148:151], a[24:27]
    v_exp_f32 v115, v115
    v_mfma_f32_16x16x32_bf16 a[56:59], a[240:243], v[152:155], a[56:59]
    v_exp_f32 v103, v103
    v_mfma_f32_16x16x32_bf16 a[56:59], a[244:247], v[156:159], a[56:59]
    ds_read_b128 a[180:183], v2 offset:13312
    v_mfma_f32_16x16x32_bf16 a[88:91], a[240:243], v[160:163], a[88:91]
    buffer_load_dwordx4 v1, s[8:11], s52 offen offset:3072 sc1 lds
    v_mfma_f32_16x16x32_bf16 a[88:91], a[244:247], v[164:167], a[88:91]
    v_mfma_f32_16x16x32_bf16 a[120:123], a[240:243], v[168:171], a[120:123]
    v_mfma_f32_16x16x32_bf16 a[120:123], a[244:247], v[172:175], a[120:123]
    s_add_u32 s52, s52, 37888
    v_exp_f32 v92, v92
    v_mfma_f32_16x16x32_bf16 a[28:31], a[248:251], v[144:147], a[28:31]
    v_exp_f32 v118, v118
    v_mfma_f32_16x16x32_bf16 a[28:31], a[252:255], v[148:151], a[28:31]
    ds_read_b128 a[184:187], v2 offset:14336
    v_mfma_f32_16x16x32_bf16 a[60:63], a[248:251], v[152:155], a[60:63]
    s_sub_u32 s58, s58, 1
    v_mfma_f32_16x16x32_bf16 a[60:63], a[252:255], v[156:159], a[60:63]
    ds_read_b128 a[188:191], v2 offset:15360
    v_mfma_f32_16x16x32_bf16 a[92:95], a[248:251], v[160:163], a[92:95]
    v_cvt_pk_bf16_f32 v145, v82, v83
    v_mfma_f32_16x16x32_bf16 a[92:95], a[252:255], v[164:167], a[92:95]
    v_cvt_pk_bf16_f32 v144, v80, v81
    v_cvt_pk_bf16_f32 v152, v84, v85
    v_mfma_f32_16x16x32_bf16 a[124:127], a[248:251], v[168:171], a[124:127]
    s_cmp_eq_u32 s58, 0
    v_cvt_pk_bf16_f32 v153, v86, v87
    v_mfma_f32_16x16x32_bf16 a[124:127], a[252:255], v[172:175], a[124:127]
    s_waitcnt vmcnt(16) lgkmcnt(0)
    s_barrier
    s_cbranch_scc1 L_att_D_out
    v_mfma_f32_16x16x32_bf16 v[80:83], a[128:131], v[16:19], v[176:179]
    ds_read_b128 a[192:195], v3 offset:0
    v_cvt_pk_bf16_f32 v161, v90, v91
    v_mfma_f32_16x16x32_bf16 v[80:83], a[132:135], v[20:23], v[80:83]
    s_cmp_eq_u32 s3, 0
    v_cvt_pk_bf16_f32 v160, v88, v89
    v_cvt_pk_bf16_f32 v147, v98, v99
    v_mfma_f32_16x16x32_bf16 v[80:83], a[136:139], v[24:27], v[80:83]
    s_cbranch_scc1 L_att_D_0
    v_exp_f32 v133, v133
    v_mfma_f32_16x16x32_bf16 v[80:83], a[140:143], v[28:31], v[80:83]
    v_exp_f32 v135, v135
    v_mfma_f32_16x16x32_bf16 v[84:87], a[128:131], v[32:35], v[180:183]
    v_cvt_pk_bf16_f32 v146, v96, v97
    v_cvt_pk_bf16_f32 v170, v108, v109
    v_mfma_f32_16x16x32_bf16 v[84:87], a[132:135], v[36:39], v[84:87]
    s_cmp_eq_u32 s3, 1
    v_cvt_pk_bf16_f32 v163, v106, v107
    v_cvt_pk_bf16_f32 v149, v114, v115
    v_mfma_f32_16x16x32_bf16 v[84:87], a[136:139], v[40:43], v[84:87]
    s_cbranch_scc1 L_att_D_1
    v_cvt_pk_bf16_f32 v162, v104, v105
    v_cvt_pk_bf16_f32 v157, v118, v119
    v_mfma_f32_16x16x32_bf16 v[84:87], a[140:143], v[44:47], v[84:87]
    ds_read_b128 a[196:199], v3 offset:1024
    v_cvt_pk_bf16_f32 v169, v94, v95
    v_mfma_f32_16x16x32_bf16 v[88:91], a[128:131], v[48:51], v[184:187]
    v_exp_f32 v122, v122
    v_mfma_f32_16x16x32_bf16 v[88:91], a[132:135], v[52:55], v[88:91]
    s_cmp_eq_u32 s3, 2
    v_cvt_pk_bf16_f32 v168, v92, v93
    v_cvt_pk_bf16_f32 v155, v102, v103
    v_mfma_f32_16x16x32_bf16 v[88:91], a[136:139], v[56:59], v[88:91]
    s_cbranch_scc1 L_att_D_2
    v_exp_f32 v131, v131
    v_mfma_f32_16x16x32_bf16 v[88:91], a[140:143], v[60:63], v[88:91]
    v_exp_f32 v126, v126
    v_mfma_f32_16x16x32_bf16 v[92:95], a[128:131], v[64:67], v[188:191]
    v_exp_f32 v87, v87
    v_mfma_f32_16x16x32_bf16 v[92:95], a[132:135], v[68:71], v[92:95]
    v_exp_f32 v140, v140
    v_mfma_f32_16x16x32_bf16 v[92:95], a[136:139], v[72:75], v[92:95]
    s_branch L_att_D_3
L_att_D_out:
L_att_D1:
    v_mfma_f32_16x16x32_bf16 v[80:83], a[128:131], v[16:19], v[176:179]
    ds_read_b128 a[192:195], v3 offset:0
    v_cvt_pk_bf16_f32 v169, v94, v95
    v_mfma_f32_16x16x32_bf16 v[80:83], a[132:135], v[20:23], v[80:83]
    v_cvt_pk_bf16_f32 v154, v100, v101
    v_cvt_pk_bf16_f32 v155, v102, v103
    v_mfma_f32_16x16x32_bf16 v[80:83], a[136:139], v[24:27], v[80:83]
    v_exp_f32 v129, v129
    v_mfma_f32_16x16x32_bf16 v[80:83], a[140:143], v[28:31], v[80:83]
    ds_read_b128 a[196:199], v3 offset:1024
    v_cvt_pk_bf16_f32 v160, v88, v89
    v_mfma_f32_16x16x32_bf16 v[84:87], a[128:131], v[32:35], v[180:183]
    v_cvt_pk_bf16_f32 v161, v90, v91
    v_cvt_pk_bf16_f32 v168, v92, v93
    v_mfma_f32_16x16x32_bf16 v[84:87], a[132:135], v[36:39], v[84:87]
    v_exp_f32 v140, v140
    v_mfma_f32_16x16x32_bf16 v[84:87], a[136:139], v[40:43], v[84:87]
    v_cvt_pk_bf16_f32 v149, v114, v115
    v_cvt_pk_bf16_f32 v156, v116, v117
    v_mfma_f32_16x16x32_bf16 v[84:87], a[140:143], v[44:47], v[84:87]
    s_add_u32 m0, s53, s68
    v_exp_f32 v138, v138
    v_mfma_f32_16x16x32_bf16 v[88:91], a[128:131], v[48:51], v[184:187]
    v_cvt_pk_bf16_f32 v147, v98, v99
    v_mfma_f32_16x16x32_bf16 v[88:91], a[132:135], v[52:55], v[88:91]
    v_cvt_pk_bf16_f32 v146, v96, v97
    v_cvt_pk_bf16_f32 v163, v106, v107
    v_mfma_f32_16x16x32_bf16 v[88:91], a[136:139], v[56:59], v[88:91]
    v_exp_f32 v121, v121
    v_mfma_f32_16x16x32_bf16 v[88:91], a[140:143], v[60:63], v[88:91]
    v_exp_f32 v124, v124
    v_mfma_f32_16x16x32_bf16 v[92:95], a[128:131], v[64:67], v[188:191]
    ds_read_b128 a[200:203], v3 offset:2048
    v_cvt_pk_bf16_f32 v162, v104, v105
    v_mfma_f32_16x16x32_bf16 v[92:95], a[132:135], v[68:71], v[92:95]
    v_exp_f32 v122, v122
    v_mfma_f32_16x16x32_bf16 v[92:95], a[136:139], v[72:75], v[92:95]
    v_exp_f32 v126, v126
    v_mfma_f32_16x16x32_bf16 v[92:95], a[140:143], v[76:79], v[92:95]
    v_exp_f32 v135, v135
    v_mfma_f32_16x16x32_bf16 v[96:99], a[144:147], v[16:19], v[176:179]
    v_exp_f32 v125, v125
    v_mfma_f32_16x16x32_bf16 v[96:99], a[148:151], v[20:23], v[96:99]
    v_cvt_pk_bf16_f32 v171, v110, v111
    v_cvt_pk_bf16_f32 v172, v124, v125
    v_mfma_f32_16x16x32_bf16 v[96:99], a[152:155], v[24:27], v[96:99]
    v_exp_f32 v141, v141
    v_mfma_f32_16x16x32_bf16 v[96:99], a[156:159], v[28:31], v[96:99]
    v_cvt_pk_bf16_f32 v157, v118, v119
    v_add_u32 v2, s54, v1
    v_mfma_f32_16x16x32_bf16 v[100:103], a[144:147], v[32:35], v[180:183]
    v_cvt_pk_bf16_f32 v170, v108, v109
    v_cvt_pk_bf16_f32 v174, v140, v141
    v_mfma_f32_16x16x32_bf16 v[100:103], a[148:151], v[36:39], v[100:103]
    v_exp_f32 v123, v123
    v_mfma_f32_16x16x32_bf16 v[100:103], a[152:155], v[40:43], v[100:103]
    ds_read_b128 a[204:207], v3 offset:3072
    v_mfma_f32_16x16x32_bf16 v[100:103], a[156:159], v[44:47], v[100:103]
    v_exp_f32 v131, v131
    v_mfma_f32_16x16x32_bf16 v[104:107], a[144:147], v[48:51], v[184:187]
    v_cvt_pk_bf16_f32 v148, v112, v113
    v_cvt_pk_bf16_f32 v165, v122, v123
    v_mfma_f32_16x16x32_bf16 v[104:107], a[148:151], v[52:55], v[104:107]
    v_exp_f32 v134, v134
    v_mfma_f32_16x16x32_bf16 v[104:107], a[152:155], v[56:59], v[104:107]
    v_exp_f32 v120, v120
    v_mfma_f32_16x16x32_bf16 v[104:107], a[156:159], v[60:63], v[104:107]
    buffer_load_dwordx4 v11, s[8:11], s52 offen offset:0 sc1 lds
    v_mfma_f32_16x16x32_bf16 v[108:111], a[144:147], v[64:67], v[188:191]
    v_exp_f32 v127, v127
    v_mfma_f32_16x16x32_bf16 v[108:111], a[148:151], v[68:71], v[108:111]
    v_exp_f32 v132, v132
    v_mfma_f32_16x16x32_bf16 v[108:111], a[152:155], v[72:75], v[108:111]
    v_exp_f32 v137, v137
    v_mfma_f32_16x16x32_bf16 v[108:111], a[156:159], v[76:79], v[108:111]
    v_exp_f32 v133, v133
    v_mfma_f32_16x16x32_bf16 v[112:115], a[160:163], v[16:19], v[176:179]
    v_exp_f32 v136, v136
    v_mfma_f32_16x16x32_bf16 v[112:115], a[164:167], v[20:23], v[112:115]
    ds_read_b128 a[208:211], v3 offset:4096
    v_cndmask_b32 v88, v88, v8, s[16:17]
    v_mfma_f32_16x16x32_bf16 v[112:115], a[168:171], v[24:27], v[112:115]
    v_exp_f32 v139, v139
    v_mfma_f32_16x16x32_bf16 v[112:115], a[172:175], v[28:31], v[112:115]
    ds_read_b128 a[212:215], v3 offset:5120
    v_cvt_pk_bf16_f32 v158, v132, v133
    v_mfma_f32_16x16x32_bf16 v[116:119], a[160:163], v[32:35], v[180:183]
    v_cndmask_b32 v105, v105, v8, s[26:27]
    v_mfma_f32_16x16x32_bf16 v[116:119], a[164:167], v[36:39], v[116:119]
    v_exp_f32 v130, v130
    v_mfma_f32_16x16x32_bf16 v[116:119], a[168:171], v[40:43], v[116:119]
    v_cvt_pk_bf16_f32 v164, v120, v121
    v_cvt_pk_bf16_f32 v173, v126, v127
    v_mfma_f32_16x16x32_bf16 v[116:119], a[172:175], v[44:47], v[116:119]
    ds_read_b128 a[216:219], v3 offset:6144
    v_cndmask_b32 v91, v91, v8, s[22:23]
    v_mfma_f32_16x16x32_bf16 v[120:123], a[160:163], v[48:51], v[184:187]
    v_exp_f32 v143, v143
    v_mfma_f32_16x16x32_bf16 v[120:123], a[164:167], v[52:55], v[120:123]
    s_xor_b32 s55, s53, 0x8000
    v_exp_f32 v128, v128
    v_mfma_f32_16x16x32_bf16 v[120:123], a[168:171], v[56:59], v[120:123]
    v_exp_f32 v114, v114
    v_mfma_f32_16x16x32_bf16 v[120:123], a[172:175], v[60:63], v[120:123]
    ds_read_b128 a[220:223], v3 offset:7168
    v_cvt_pk_bf16_f32 v159, v134, v135
    v_mfma_f32_16x16x32_bf16 v[124:127], a[160:163], v[64:67], v[188:191]
    buffer_load_dwordx4 v11, s[8:11], s52 offen offset:1024 sc1 lds
    v_mfma_f32_16x16x32_bf16 v[124:127], a[164:167], v[68:71], v[124:127]
    ds_read_b128 a[224:227], v3 offset:8192
    v_cvt_pk_bf16_f32 v150, v128, v129
    v_mfma_f32_16x16x32_bf16 v[124:127], a[168:171], v[72:75], v[124:127]
    v_exp_f32 v82, v82
    v_mfma_f32_16x16x32_bf16 v[124:127], a[172:175], v[76:79], v[124:127]
    ds_read_b128 a[228:231], v3 offset:9216
    v_cvt_pk_bf16_f32 v151, v130, v131
    v_mfma_f32_16x16x32_bf16 v[128:131], a[176:179], v[16:19], v[176:179]
    v_mfma_f32_16x16x32_bf16 v[128:131], a[180:183], v[20:23], v[128:131]
    v_cvt_pk_bf16_f32 v167, v138, v139
    v_mfma_f32_16x16x32_bf16 v[128:131], a[184:187], v[24:27], v[128:131]
    v_exp_f32 v101, v101
    v_mfma_f32_16x16x32_bf16 v[128:131], a[188:191], v[28:31], v[128:131]
    v_exp_f32 v102, v102
    v_mfma_f32_16x16x32_bf16 v[132:135], a[176:179], v[32:35], v[180:183]
    ds_read_b128 a[232:235], v3 offset:10240
    v_mfma_f32_16x16x32_bf16 v[132:135], a[180:183], v[36:39], v[132:135]
    v_cvt_pk_bf16_f32 v166, v136, v137
    v_mfma_f32_16x16x32_bf16 v[132:135], a[184:187], v[40:43], v[132:135]
    ds_read_b128 a[236:239], v3 offset:11264
    v_mfma_f32_16x16x32_bf16 v[132:135], a[188:191], v[44:47], v[132:135]
    v_exp_f32 v142, v142
    v_mfma_f32_16x16x32_bf16 v[136:139], a[176:179], v[48:51], v[184:187]
    buffer_load_dwordx4 v11, s[8:11], s52 offen offset:2048 sc1 lds
    v_mfma_f32_16x16x32_bf16 v[136:139], a[180:183], v[52:55], v[136:139]
    ds_read_b128 a[240:243], v3 offset:12288
    v_mfma_f32_16x16x32_bf16 v[136:139], a[184:187], v[56:59], v[136:139]
    v_mfma_f32_16x16x32_bf16 v[136:139], a[188:191], v[60:63], v[136:139]
    ds_read_b128 a[244:247], v3 offset:13312
    v_cvt_pk_bf16_f32 v175, v142, v143
    v_mfma_f32_16x16x32_bf16 v[140:143], a[176:179], v[64:67], v[188:191]
    v_exp_f32 v113, v113
    v_mfma_f32_16x16x32_bf16 v[140:143], a[180:183], v[68:71], v[140:143]
    v_mfma_f32_16x16x32_bf16 v[140:143], a[184:187], v[72:75], v[140:143]
    v_mfma_f32_16x16x32_bf16 v[140:143], a[188:191], v[76:79], v[140:143]
    v_cndmask_b32 v107, v107, v8, s[30:31]
    v_mfma_f32_16x16x32_bf16 v[192:195], v[4:7], v[144:147], v[192:195]
    ds_read_b128 a[248:251], v3 offset:14336
    v_mfma_f32_16x16x32_bf16 v[192:195], v[4:7], v[148:151], v[192:195]
    v_exp_f32 v91, v91
    v_mfma_f32_16x16x32_bf16 v[196:199], v[4:7], v[152:155], v[196:199]
    ds_read_b128 a[252:255], v3 offset:15360
    v_mfma_f32_16x16x32_bf16 v[196:199], v[4:7], v[156:159], v[196:199]
    v_exp_f32 v100, v100
    v_mfma_f32_16x16x32_bf16 v[200:203], v[4:7], v[160:163], v[200:203]
    buffer_load_dwordx4 v11, s[8:11], s52 offen offset:3072 sc1 lds
    v_mfma_f32_16x16x32_bf16 v[200:203], v[4:7], v[164:167], v[200:203]
    v_exp_f32 v98, v98
    v_mfma_f32_16x16x32_bf16 v[204:207], v[4:7], v[168:171], v[204:207]
    s_add_u32 m0, s55, s56
    v_mfma_f32_16x16x32_bf16 v[204:207], v[4:7], v[172:175], v[204:207]
    s_waitcnt lgkmcnt(2)
    v_exp_f32 v85, v85
    v_mfma_f32_16x16x32_bf16 a[0:3], a[192:195], v[144:147], a[0:3]
    v_cndmask_b32 v104, v104, v8, s[24:25]
    v_mfma_f32_16x16x32_bf16 a[0:3], a[196:199], v[148:151], a[0:3]
    ds_read_b128 a[128:131], v2 offset:0
    v_mfma_f32_16x16x32_bf16 a[32:35], a[192:195], v[152:155], a[32:35]
    v_cndmask_b32 v89, v89, v8, s[18:19]
    v_mfma_f32_16x16x32_bf16 a[32:35], a[196:199], v[156:159], a[32:35]
    v_cndmask_b32 v90, v90, v8, s[20:21]
    v_mfma_f32_16x16x32_bf16 a[64:67], a[192:195], v[160:163], a[64:67]
    v_exp_f32 v115, v115
    v_mfma_f32_16x16x32_bf16 a[64:67], a[196:199], v[164:167], a[64:67]
    v_mfma_f32_16x16x32_bf16 a[96:99], a[192:195], v[168:171], a[96:99]
    v_exp_f32 v95, v95
    v_mfma_f32_16x16x32_bf16 a[96:99], a[196:199], v[172:175], a[96:99]
    ds_read_b128 a[132:135], v2 offset:1024
    v_mfma_f32_16x16x32_bf16 a[4:7], a[200:203], v[144:147], a[4:7]
    v_exp_f32 v83, v83
    v_mfma_f32_16x16x32_bf16 a[4:7], a[204:207], v[148:151], a[4:7]
    v_exp_f32 v94, v94
    v_mfma_f32_16x16x32_bf16 a[36:39], a[200:203], v[152:155], a[36:39]
    buffer_load_dwordx4 v1, s[8:11], s52 offen offset:0 sc1 lds
    v_mfma_f32_16x16x32_bf16 a[36:39], a[204:207], v[156:159], a[36:39]
    v_mfma_f32_16x16x32_bf16 a[68:71], a[200:203], v[160:163], a[68:71]
    ds_read_b128 a[136:139], v2 offset:2048
    v_add_u32 v3, s53, v12
    v_mfma_f32_16x16x32_bf16 a[68:71], a[204:207], v[164:167], a[68:71]
    v_exp_f32 v116, v116
    v_mfma_f32_16x16x32_bf16 a[100:103], a[200:203], v[168:171], a[100:103]
    v_mfma_f32_16x16x32_bf16 a[100:103], a[204:207], v[172:175], a[100:103]
    ds_read_b128 a[140:143], v2 offset:3072
    v_cndmask_b32 v106, v106, v8, s[28:29]
    v_mfma_f32_16x16x32_bf16 a[8:11], a[208:211], v[144:147], a[8:11]
    v_exp_f32 v97, v97
    v_mfma_f32_16x16x32_bf16 a[8:11], a[212:215], v[148:151], a[8:11]
    v_exp_f32 v105, v105
    v_mfma_f32_16x16x32_bf16 a[40:43], a[208:211], v[152:155], a[40:43]
    v_exp_f32 v88, v88
    v_mfma_f32_16x16x32_bf16 a[40:43], a[212:215], v[156:159], a[40:43]
    buffer_load_dwordx4 v1, s[8:11], s52 offen offset:1024 sc1 lds
    v_mfma_f32_16x16x32_bf16 a[72:75], a[208:211], v[160:163], a[72:75]
    v_mfma_f32_16x16x32_bf16 a[72:75], a[212:215], v[164:167], a[72:75]
    ds_read_b128 a[144:147], v2 offset:4096
    v_mfma_f32_16x16x32_bf16 a[104:107], a[208:211], v[168:171], a[104:107]
    v_exp_f32 v110, v110
    v_mfma_f32_16x16x32_bf16 a[104:107], a[212:215], v[172:175], a[104:107]
    ds_read_b128 a[148:151], v2 offset:5120
    v_mfma_f32_16x16x32_bf16 a[12:15], a[216:219], v[144:147], a[12:15]
    v_exp_f32 v80, v80
    v_mfma_f32_16x16x32_bf16 a[12:15], a[220:223], v[148:151], a[12:15]
    s_mov_b32 s53, s54
    v_mfma_f32_16x16x32_bf16 a[44:47], a[216:219], v[152:155], a[44:47]
    v_exp_f32 v117, v117
    v_mfma_f32_16x16x32_bf16 a[44:47], a[220:223], v[156:159], a[44:47]
    buffer_load_dwordx4 v1, s[8:11], s52 offen offset:2048 sc1 lds
    v_mfma_f32_16x16x32_bf16 a[76:79], a[216:219], v[160:163], a[76:79]
    v_exp_f32 v109, v109
    v_mfma_f32_16x16x32_bf16 a[76:79], a[220:223], v[164:167], a[76:79]
    v_exp_f32 v118, v118
    v_mfma_f32_16x16x32_bf16 a[108:111], a[216:219], v[168:171], a[108:111]
    v_exp_f32 v92, v92
    v_mfma_f32_16x16x32_bf16 a[108:111], a[220:223], v[172:175], a[108:111]
    ds_read_b128 a[152:155], v2 offset:6144
    v_mfma_f32_16x16x32_bf16 a[16:19], a[224:227], v[144:147], a[16:19]
    v_exp_f32 v111, v111
    v_mfma_f32_16x16x32_bf16 a[16:19], a[228:231], v[148:151], a[16:19]
    v_exp_f32 v103, v103
    v_mfma_f32_16x16x32_bf16 a[48:51], a[224:227], v[152:155], a[48:51]
    v_mfma_f32_16x16x32_bf16 a[48:51], a[228:231], v[156:159], a[48:51]
    ds_read_b128 a[156:159], v2 offset:7168
    v_mfma_f32_16x16x32_bf16 a[80:83], a[224:227], v[160:163], a[80:83]
    v_exp_f32 v96, v96
    v_mfma_f32_16x16x32_bf16 a[80:83], a[228:231], v[164:167], a[80:83]
    buffer_load_dwordx4 v1, s[8:11], s52 offen offset:3072 sc1 lds
    v_mfma_f32_16x16x32_bf16 a[112:115], a[224:227], v[168:171], a[112:115]
    ds_read_b128 a[160:163], v2 offset:8192
    v_mfma_f32_16x16x32_bf16 a[112:115], a[228:231], v[172:175], a[112:115]
    v_exp_f32 v84, v84
    v_mfma_f32_16x16x32_bf16 a[20:23], a[232:235], v[144:147], a[20:23]
    ds_read_b128 a[164:167], v2 offset:9216
    v_mfma_f32_16x16x32_bf16 a[20:23], a[236:239], v[148:151], a[20:23]
    s_add_u32 s52, s52, 37888
    v_exp_f32 v89, v89
    v_mfma_f32_16x16x32_bf16 a[52:55], a[232:235], v[152:155], a[52:55]
    v_exp_f32 v119, v119
    v_mfma_f32_16x16x32_bf16 a[52:55], a[236:239], v[156:159], a[52:55]
    v_exp_f32 v87, v87
    v_mfma_f32_16x16x32_bf16 a[84:87], a[232:235], v[160:163], a[84:87]
    ds_read_b128 a[168:171], v2 offset:10240
    v_mfma_f32_16x16x32_bf16 a[84:87], a[236:239], v[164:167], a[84:87]
    v_exp_f32 v99, v99
    v_mfma_f32_16x16x32_bf16 a[116:119], a[232:235], v[168:171], a[116:119]
    v_exp_f32 v86, v86
    v_mfma_f32_16x16x32_bf16 a[116:119], a[236:239], v[172:175], a[116:119]
    v_mfma_f32_16x16x32_bf16 a[24:27], a[240:243], v[144:147], a[24:27]
    v_exp_f32 v81, v81
    v_mfma_f32_16x16x32_bf16 a[24:27], a[244:247], v[148:151], a[24:27]
    ds_read_b128 a[172:175], v2 offset:11264
    v_mfma_f32_16x16x32_bf16 a[56:59], a[240:243], v[152:155], a[56:59]
    v_exp_f32 v90, v90
    v_mfma_f32_16x16x32_bf16 a[56:59], a[244:247], v[156:159], a[56:59]
    ds_read_b128 a[176:179], v2 offset:12288
    v_mfma_f32_16x16x32_bf16 a[88:91], a[240:243], v[160:163], a[88:91]
    v_exp_f32 v112, v112
    v_mfma_f32_16x16x32_bf16 a[88:91], a[244:247], v[164:167], a[88:91]
    v_mfma_f32_16x16x32_bf16 a[120:123], a[240:243], v[168:171], a[120:123]
    ds_read_b128 a[180:183], v2 offset:13312
    v_mfma_f32_16x16x32_bf16 a[120:123], a[244:247], v[172:175], a[120:123]
    s_waitcnt lgkmcnt(3)
    v_exp_f32 v107, v107
    v_mfma_f32_16x16x32_bf16 a[28:31], a[248:251], v[144:147], a[28:31]
    ds_read_b128 a[184:187], v2 offset:14336
    v_mfma_f32_16x16x32_bf16 a[28:31], a[252:255], v[148:151], a[28:31]
    v_exp_f32 v108, v108
    v_mfma_f32_16x16x32_bf16 a[60:63], a[248:251], v[152:155], a[60:63]
    ds_read_b128 a[188:191], v2 offset:15360
    v_cvt_pk_bf16_f32 v145, v82, v83
    v_mfma_f32_16x16x32_bf16 a[60:63], a[252:255], v[156:159], a[60:63]
    v_exp_f32 v104, v104
    v_mfma_f32_16x16x32_bf16 a[92:95], a[248:251], v[160:163], a[92:95]
    s_mov_b32 s54, s55
    v_cvt_pk_bf16_f32 v152, v84, v85
    v_cvt_pk_bf16_f32 v153, v86, v87
    v_mfma_f32_16x16x32_bf16 a[92:95], a[252:255], v[164:167], a[92:95]
    v_exp_f32 v106, v106
    v_mfma_f32_16x16x32_bf16 a[124:127], a[248:251], v[168:171], a[124:127]
    v_exp_f32 v93, v93
    v_mfma_f32_16x16x32_bf16 a[124:127], a[252:255], v[172:175], a[124:127]
    v_cvt_pk_bf16_f32 v144, v80, v81
    s_waitcnt vmcnt(16) lgkmcnt(0)
    s_barrier
L_att_D2:
    v_mfma_f32_16x16x32_bf16 v[80:83], a[128:131], v[16:19], v[176:179]
    v_cvt_pk_bf16_f32 v155, v102, v103
    v_cvt_pk_bf16_f32 v163, v106, v107
    v_mfma_f32_16x16x32_bf16 v[80:83], a[132:135], v[20:23], v[80:83]
    ds_read_b128 a[192:195], v3 offset:0
    v_exp_f32 v141, v141
    v_mfma_f32_16x16x32_bf16 v[80:83], a[136:139], v[24:27], v[80:83]
    s_add_u32 m0, s53, s68
    v_cvt_pk_bf16_f32 v168, v92, v93
    v_exp_f32 v130, v130
    v_mfma_f32_16x16x32_bf16 v[80:83], a[140:143], v[28:31], v[80:83]
    ds_read_b128 a[196:199], v3 offset:1024
    v_cvt_pk_bf16_f32 v148, v112, v113
    v_mfma_f32_16x16x32_bf16 v[84:87], a[128:131], v[32:35], v[180:183]
    v_exp_f32 v127, v127
    v_mfma_f32_16x16x32_bf16 v[84:87], a[132:135], v[36:39], v[84:87]
    ds_read_b128 a[200:203], v3 offset:2048
    v_exp_f32 v124, v124
    v_mfma_f32_16x16x32_bf16 v[84:87], a[136:139], v[40:43], v[84:87]
    s_mul_i32 s48, s2, 12288
    v_cvt_pk_bf16_f32 v171, v110, v111
    v_cndmask_b32 v123, v123, v8, s[38:39]
    v_mfma_f32_16x16x32_bf16 v[84:87], a[140:143], v[44:47], v[84:87]
    ds_read_b128 a[204:207], v3 offset:3072
    v_cvt_pk_bf16_f32 v169, v94, v95
    v_mfma_f32_16x16x32_bf16 v[92:95], a[128:131], v[64:67], v[188:191]
    v_cvt_pk_bf16_f32 v161, v90, v91
    v_cvt_pk_bf16_f32 v157, v118, v119
    v_mfma_f32_16x16x32_bf16 v[92:95], a[132:135], v[68:71], v[92:95]
    s_mul_i32 s51, s3, 3072
    v_cndmask_b32 v120, v120, v8, s[32:33]
    v_exp_f32 v125, v125
    v_mfma_f32_16x16x32_bf16 v[92:95], a[136:139], v[72:75], v[92:95]
    ds_read_b128 a[208:211], v3 offset:4096
    v_cvt_pk_bf16_f32 v146, v96, v97
    v_mfma_f32_16x16x32_bf16 v[92:95], a[140:143], v[76:79], v[92:95]
    v_cvt_pk_bf16_f32 v147, v98, v99
    v_cvt_pk_bf16_f32 v156, v116, v117
    v_mfma_f32_16x16x32_bf16 v[96:99], a[144:147], v[16:19], v[176:179]
    s_add_u32 s48, s48, s51
    v_exp_f32 v133, v133
    v_mfma_f32_16x16x32_bf16 v[96:99], a[148:151], v[20:23], v[96:99]
    s_add_u32 s48, s48, 77594624
    v_cvt_pk_bf16_f32 v154, v100, v101
    v_cvt_pk_bf16_f32 v149, v114, v115
    v_mfma_f32_16x16x32_bf16 v[96:99], a[152:155], v[24:27], v[96:99]
    v_exp_f32 v135, v135
    v_mfma_f32_16x16x32_bf16 v[96:99], a[156:159], v[28:31], v[96:99]
    ds_read_b128 a[212:215], v3 offset:5120
    v_cvt_pk_bf16_f32 v170, v108, v109
    v_mfma_f32_16x16x32_bf16 v[100:103], a[144:147], v[32:35], v[180:183]
    v_exp_f32 v126, v126
    v_mfma_f32_16x16x32_bf16 v[100:103], a[148:151], v[36:39], v[100:103]
    ds_read_b128 a[216:219], v3 offset:6144
    v_cvt_pk_bf16_f32 v160, v88, v89
    v_mfma_f32_16x16x32_bf16 v[100:103], a[152:155], v[40:43], v[100:103]
    s_xor_b32 s55, s53, 0x8000
    v_exp_f32 v128, v128
    v_mfma_f32_16x16x32_bf16 v[100:103], a[156:159], v[44:47], v[100:103]
    s_lshr_b32 s51, s3, 1
    v_exp_f32 v129, v129
    v_mfma_f32_16x16x32_bf16 v[108:111], a[144:147], v[64:67], v[188:191]
    ds_read_b128 a[220:223], v3 offset:7168
    v_cvt_pk_bf16_f32 v150, v128, v129
    v_mfma_f32_16x16x32_bf16 v[108:111], a[148:151], v[68:71], v[108:111]
    s_mul_i32 s51, s51, 6144
    v_exp_f32 v143, v143
    v_mfma_f32_16x16x32_bf16 v[108:111], a[152:155], v[72:75], v[108:111]
    v_exp_f32 v123, v123
    v_mfma_f32_16x16x32_bf16 v[108:111], a[156:159], v[76:79], v[108:111]
    v_exp_f32 v134, v134
    v_mfma_f32_16x16x32_bf16 v[112:115], a[160:163], v[16:19], v[176:179]
    v_cvt_pk_bf16_f32 v172, v124, v125
    v_cvt_pk_bf16_f32 v173, v126, v127
    v_cndmask_b32 v136, v136, v8, s[40:41]
    v_mfma_f32_16x16x32_bf16 v[112:115], a[164:167], v[20:23], v[112:115]
    s_add_u32 s51, s51, 135168
    v_exp_f32 v120, v120
    v_mfma_f32_16x16x32_bf16 v[112:115], a[168:171], v[24:27], v[112:115]
    buffer_load_dwordx4 v11, s[8:11], s52 offen offset:0 sc1 lds
    v_mfma_f32_16x16x32_bf16 v[112:115], a[172:175], v[28:31], v[112:115]
    v_cvt_pk_bf16_f32 v162, v104, v105
    v_exp_f32 v132, v132
    v_mfma_f32_16x16x32_bf16 v[116:119], a[160:163], v[32:35], v[180:183]
    ds_read_b128 a[224:227], v3 offset:8192
    v_exp_f32 v131, v131
    v_mfma_f32_16x16x32_bf16 v[116:119], a[164:167], v[36:39], v[116:119]
    v_exp_f32 v140, v140
    v_mfma_f32_16x16x32_bf16 v[116:119], a[168:171], v[40:43], v[116:119]
    ds_read_b128 a[228:231], v3 offset:9216
    v_cndmask_b32 v139, v139, v8, s[46:47]
    v_mfma_f32_16x16x32_bf16 v[116:119], a[172:175], v[44:47], v[116:119]
    buffer_load_dwordx4 v11, s[8:11], s52 offen offset:1024 sc1 lds
    v_mfma_f32_16x16x32_bf16 v[124:127], a[160:163], v[64:67], v[188:191]
    v_exp_f32 v142, v142
    v_mfma_f32_16x16x32_bf16 v[124:127], a[164:167], v[68:71], v[124:127]
    s_and_b32 s58, s3, 1
    v_cndmask_b32 v121, v121, v8, s[34:35]
    v_cvt_pk_bf16_f32 v174, v140, v141
    v_mfma_f32_16x16x32_bf16 v[124:127], a[168:171], v[72:75], v[124:127]
    ds_read_b128 a[232:235], v3 offset:10240
    v_cvt_pk_bf16_f32 v151, v130, v131
    v_mfma_f32_16x16x32_bf16 v[124:127], a[172:175], v[76:79], v[124:127]
    v_cndmask_b32 v122, v122, v8, s[36:37]
    v_cvt_pk_bf16_f32 v159, v134, v135
    v_mfma_f32_16x16x32_bf16 v[128:131], a[176:179], v[16:19], v[176:179]
    v_exp_f32 v121, v121
    v_cvt_pk_bf16_f32 v175, v142, v143
    v_mfma_f32_16x16x32_bf16 v[128:131], a[180:183], v[20:23], v[128:131]
    ds_read_b128 a[236:239], v3 offset:11264
    v_cvt_pk_bf16_f32 v158, v132, v133
    v_mfma_f32_16x16x32_bf16 v[128:131], a[184:187], v[24:27], v[128:131]
    buffer_load_dwordx4 v11, s[8:11], s52 offen offset:2048 sc1 lds
    v_mfma_f32_16x16x32_bf16 v[128:131], a[188:191], v[28:31], v[128:131]
    v_cndmask_b32 v137, v137, v8, s[42:43]
    v_cndmask_b32 v138, v138, v8, s[44:45]
    v_mfma_f32_16x16x32_bf16 v[132:135], a[176:179], v[32:35], v[180:183]
    s_mul_i32 s58, s58, 3
    v_exp_f32 v122, v122
    v_mfma_f32_16x16x32_bf16 v[132:135], a[180:183], v[36:39], v[132:135]
    ds_read_b128 a[240:243], v3 offset:12288
    v_add_u32 v2, s54, v1
    v_mfma_f32_16x16x32_bf16 v[132:135], a[184:187], v[40:43], v[132:135]
    v_exp_f32 v136, v136
    v_mfma_f32_16x16x32_bf16 v[132:135], a[188:191], v[44:47], v[132:135]
    ds_read_b128 a[244:247], v3 offset:13312
    v_cvt_pk_bf16_f32 v165, v122, v123
    v_mfma_f32_16x16x32_bf16 v[140:143], a[176:179], v[64:67], v[188:191]
    ds_read_b128 a[248:251], v3 offset:14336
    v_cvt_pk_bf16_f32 v164, v120, v121
    v_mfma_f32_16x16x32_bf16 v[140:143], a[180:183], v[68:71], v[140:143]
    v_exp_f32 v139, v139
    v_mfma_f32_16x16x32_bf16 v[140:143], a[184:187], v[72:75], v[140:143]
    buffer_load_dwordx4 v11, s[8:11], s52 offen offset:3072 sc1 lds
    v_mfma_f32_16x16x32_bf16 v[140:143], a[188:191], v[76:79], v[140:143]
    ds_read_b128 a[252:255], v3 offset:15360
    v_mfma_f32_16x16x32_bf16 v[192:195], v[4:7], v[144:147], v[192:195]
    v_exp_f32 v137, v137
    v_mfma_f32_16x16x32_bf16 v[192:195], v[4:7], v[148:151], v[192:195]
    v_exp_f32 v138, v138
    v_mfma_f32_16x16x32_bf16 v[196:199], v[4:7], v[152:155], v[196:199]
    s_add_u32 m0, s55, s56
    v_cvt_pk_bf16_f32 v166, v136, v137
    v_cndmask_b32 v109, v109, v8, s[26:27]
    v_mfma_f32_16x16x32_bf16 v[196:199], v[4:7], v[156:159], v[196:199]
    ds_read_b128 a[128:131], v2 offset:0
    v_cvt_pk_bf16_f32 v167, v138, v139
    v_mfma_f32_16x16x32_bf16 v[200:203], v[4:7], v[160:163], v[200:203]
    s_waitcnt lgkmcnt(2)
    v_mfma_f32_16x16x32_bf16 v[200:203], v[4:7], v[164:167], v[200:203]
    ds_read_b128 a[132:135], v2 offset:1024
    v_lshrrev_b32 v247, 4, v0
    v_mfma_f32_16x16x32_bf16 v[204:207], v[4:7], v[168:171], v[204:207]
    buffer_load_dwordx4 v1, s[8:11], s52 offen offset:0 sc1 lds
    v_mfma_f32_16x16x32_bf16 v[204:207], v[4:7], v[172:175], v[204:207]
    ds_read_b128 a[136:139], v2 offset:2048
    v_mfma_f32_16x16x32_bf16 a[0:3], a[192:195], v[144:147], a[0:3]
    v_mfma_f32_16x16x32_bf16 a[0:3], a[196:199], v[148:151], a[0:3]
    ds_read_b128 a[140:143], v2 offset:3072
    v_bfe_u32 v251, v0, 2, 2
    v_mfma_f32_16x16x32_bf16 a[32:35], a[192:195], v[152:155], a[32:35]
    v_exp_f32 v101, v101
    v_mfma_f32_16x16x32_bf16 a[32:35], a[196:199], v[156:159], a[32:35]
    ds_read_b128 a[144:147], v2 offset:4096
    v_add_u32 v3, s53, v12
    v_mfma_f32_16x16x32_bf16 a[64:67], a[192:195], v[160:163], a[64:67]
    global_load_dword v254, v13, s[12:13]
    v_mfma_f32_16x16x32_bf16 a[64:67], a[196:199], v[164:167], a[64:67]
    v_exp_f32 v100, v100
    v_mfma_f32_16x16x32_bf16 a[96:99], a[192:195], v[168:171], a[96:99]
    s_mov_b32 s53, s54
    v_lshl_add_u32 v251, v247, 2, v251
    v_mfma_f32_16x16x32_bf16 a[96:99], a[196:199], v[172:175], a[96:99]
    v_exp_f32 v115, v115
    v_mfma_f32_16x16x32_bf16 a[4:7], a[200:203], v[144:147], a[4:7]
    ds_read_b128 a[148:151], v2 offset:5120
    v_cndmask_b32 v108, v108, v8, s[24:25]
    v_mfma_f32_16x16x32_bf16 a[4:7], a[204:207], v[148:151], a[4:7]
    v_exp_f32 v82, v82
    v_mfma_f32_16x16x32_bf16 a[36:39], a[200:203], v[152:155], a[36:39]
    v_exp_f32 v85, v85
    v_mfma_f32_16x16x32_bf16 a[36:39], a[204:207], v[156:159], a[36:39]
    ds_read_b128 a[152:155], v2 offset:6144
    v_cndmask_b32 v94, v94, v8, s[20:21]
    v_mfma_f32_16x16x32_bf16 a[68:71], a[200:203], v[160:163], a[68:71]
    v_exp_f32 v87, v87
    v_mfma_f32_16x16x32_bf16 a[68:71], a[204:207], v[164:167], a[68:71]
    v_exp_f32 v80, v80
    v_mfma_f32_16x16x32_bf16 a[100:103], a[200:203], v[168:171], a[100:103]
    v_cndmask_b32 v110, v110, v8, s[28:29]
    v_mfma_f32_16x16x32_bf16 a[100:103], a[204:207], v[172:175], a[100:103]
    ds_read_b128 a[156:159], v2 offset:7168
    v_cndmask_b32 v95, v95, v8, s[22:23]
    v_mfma_f32_16x16x32_bf16 a[8:11], a[208:211], v[144:147], a[8:11]
    v_cndmask_b32 v93, v93, v8, s[18:19]
    v_mfma_f32_16x16x32_bf16 a[8:11], a[212:215], v[148:151], a[8:11]
    v_mul_u32_u24 v251, 192, v251
    v_mfma_f32_16x16x32_bf16 a[40:43], a[208:211], v[152:155], a[40:43]
    v_and_b32 v243, 3, v0
    v_lshl_add_u32 v251, v243, 3, v251
    v_mfma_f32_16x16x32_bf16 a[40:43], a[212:215], v[156:159], a[40:43]
    v_exp_f32 v108, v108
    v_mfma_f32_16x16x32_bf16 a[72:75], a[208:211], v[160:163], a[72:75]
    v_add_u32 v251, s51, v251
    v_mfma_f32_16x16x32_bf16 a[72:75], a[212:215], v[164:167], a[72:75]
    v_and_b32 v247, 1, v247
    v_mfma_f32_16x16x32_bf16 a[104:107], a[208:211], v[168:171], a[104:107]
    ds_read_b128 a[160:163], v2 offset:8192
    v_mfma_f32_16x16x32_bf16 a[104:107], a[212:215], v[172:175], a[104:107]
    v_mfma_f32_16x16x32_bf16 a[12:15], a[216:219], v[144:147], a[12:15]
    v_cndmask_b32 v111, v111, v8, s[30:31]
    v_mfma_f32_16x16x32_bf16 a[12:15], a[220:223], v[148:151], a[12:15]
    buffer_load_dwordx4 v1, s[8:11], s52 offen offset:1024 sc1 lds
    v_mfma_f32_16x16x32_bf16 a[44:47], a[216:219], v[152:155], a[44:47]
    s_mov_b32 s54, s55
    v_exp_f32 v97, v97
    v_mfma_f32_16x16x32_bf16 a[44:47], a[220:223], v[156:159], a[44:47]
    v_exp_f32 v114, v114
    v_mfma_f32_16x16x32_bf16 a[76:79], a[216:219], v[160:163], a[76:79]
    v_exp_f32 v111, v111
    v_mfma_f32_16x16x32_bf16 a[76:79], a[220:223], v[164:167], a[76:79]
    v_exp_f32 v83, v83
    v_mfma_f32_16x16x32_bf16 a[108:111], a[216:219], v[168:171], a[108:111]
    ds_read_b128 a[164:167], v2 offset:9216
    v_cndmask_b32 v92, v92, v8, s[16:17]
    v_mfma_f32_16x16x32_bf16 a[108:111], a[220:223], v[172:175], a[108:111]
    v_exp_f32 v103, v103
    v_mfma_f32_16x16x32_bf16 a[16:19], a[224:227], v[144:147], a[16:19]
    v_exp_f32 v84, v84
    v_mfma_f32_16x16x32_bf16 a[16:19], a[228:231], v[148:151], a[16:19]
    v_exp_f32 v95, v95
    v_mfma_f32_16x16x32_bf16 a[48:51], a[224:227], v[152:155], a[48:51]
    buffer_load_dwordx4 v1, s[8:11], s52 offen offset:2048 sc1 lds
    v_mfma_f32_16x16x32_bf16 a[48:51], a[228:231], v[156:159], a[48:51]
    v_exp_f32 v110, v110
    v_mfma_f32_16x16x32_bf16 a[80:83], a[224:227], v[160:163], a[80:83]
    v_exp_f32 v92, v92
    v_mfma_f32_16x16x32_bf16 a[80:83], a[228:231], v[164:167], a[80:83]
    v_exp_f32 v112, v112
    v_mfma_f32_16x16x32_bf16 a[112:115], a[224:227], v[168:171], a[112:115]
    v_exp_f32 v94, v94
    v_mfma_f32_16x16x32_bf16 a[112:115], a[228:231], v[172:175], a[112:115]
    v_exp_f32 v102, v102
    v_mfma_f32_16x16x32_bf16 a[20:23], a[232:235], v[144:147], a[20:23]
    v_xor_b32 v243, s58, v247
    v_lshl_add_u32 v243, v243, 5, v251
    v_mfma_f32_16x16x32_bf16 a[20:23], a[236:239], v[148:151], a[20:23]
    buffer_load_dwordx4 v1, s[8:11], s52 offen offset:3072 sc1 lds
    v_mfma_f32_16x16x32_bf16 a[52:55], a[232:235], v[152:155], a[52:55]
    s_add_u32 s58, s58, 2
    v_exp_f32 v99, v99
    v_mfma_f32_16x16x32_bf16 a[52:55], a[236:239], v[156:159], a[52:55]
    v_exp_f32 v93, v93
    v_mfma_f32_16x16x32_bf16 a[84:87], a[232:235], v[160:163], a[84:87]
    ds_read_b128 a[168:171], v2 offset:10240
    v_xor_b32 v250, s58, v247
    v_mfma_f32_16x16x32_bf16 a[84:87], a[236:239], v[164:167], a[84:87]
    s_sub_u32 s58, s58, 1
    v_exp_f32 v86, v86
    v_mfma_f32_16x16x32_bf16 a[116:119], a[232:235], v[168:171], a[116:119]
    ds_read_b128 a[172:175], v2 offset:11264
    v_mfma_f32_16x16x32_bf16 a[116:119], a[236:239], v[172:175], a[116:119]
    v_exp_f32 v98, v98
    v_mfma_f32_16x16x32_bf16 a[24:27], a[240:243], v[144:147], a[24:27]
    s_add_u32 s52, s52, 37888
    v_mfma_f32_16x16x32_bf16 a[24:27], a[244:247], v[148:151], a[24:27]
    ds_read_b128 a[176:179], v2 offset:12288
    v_mfma_f32_16x16x32_bf16 a[56:59], a[240:243], v[152:155], a[56:59]
    v_exp_f32 v96, v96
    v_mfma_f32_16x16x32_bf16 a[56:59], a[244:247], v[156:159], a[56:59]
    ds_read_b128 a[180:183], v2 offset:13312
    v_mfma_f32_16x16x32_bf16 a[88:91], a[240:243], v[160:163], a[88:91]
    v_xor_b32 v247, s58, v247
    v_mfma_f32_16x16x32_bf16 a[88:91], a[244:247], v[164:167], a[88:91]
    v_exp_f32 v109, v109
    v_mfma_f32_16x16x32_bf16 a[120:123], a[240:243], v[168:171], a[120:123]
    v_exp_f32 v113, v113
    v_mfma_f32_16x16x32_bf16 a[120:123], a[244:247], v[172:175], a[120:123]
    v_mfma_f32_16x16x32_bf16 a[28:31], a[248:251], v[144:147], a[28:31]
    s_waitcnt lgkmcnt(2)
    v_exp_f32 v81, v81
    v_mfma_f32_16x16x32_bf16 a[28:31], a[252:255], v[148:151], a[28:31]
    ds_read_b128 a[184:187], v2 offset:14336
    v_lshl_add_u32 v247, v247, 5, v251
    v_mfma_f32_16x16x32_bf16 a[60:63], a[248:251], v[152:155], a[60:63]
    v_mfma_f32_16x16x32_bf16 a[60:63], a[252:255], v[156:159], a[60:63]
    ds_read_b128 a[188:191], v2 offset:15360
    v_cvt_pk_bf16_f32 v153, v86, v87
    v_mfma_f32_16x16x32_bf16 a[92:95], a[248:251], v[160:163], a[92:95]
    v_lshl_add_u32 v251, v250, 5, v251
    v_mfma_f32_16x16x32_bf16 a[92:95], a[252:255], v[164:167], a[92:95]
    v_cvt_pk_bf16_f32 v145, v82, v83
    v_cvt_pk_bf16_f32 v152, v84, v85
    v_mfma_f32_16x16x32_bf16 a[124:127], a[248:251], v[168:171], a[124:127]
    v_cvt_pk_bf16_f32 v144, v80, v81
    v_mfma_f32_16x16x32_bf16 a[124:127], a[252:255], v[172:175], a[124:127]
    s_waitcnt vmcnt(17) lgkmcnt(0)
    s_barrier
    s_cmp_eq_u32 s50, 7
    s_cbranch_scc1 L_att_T1
L_att_T0:
    v_mfma_f32_16x16x32_bf16 v[80:83], a[128:131], v[16:19], v[176:179]
    v_exp_f32 v118, v118
    v_cndmask_b32 v127, v127, v8, s[38:39]
    v_mfma_f32_16x16x32_bf16 v[80:83], a[132:135], v[20:23], v[80:83]
    ds_read_b128 a[192:195], v3 offset:0
    v_cvt_pk_bf16_f32 v171, v110, v111
    v_mfma_f32_16x16x32_bf16 v[80:83], a[136:139], v[24:27], v[80:83]
    s_add_u32 m0, s53, s68
    v_cvt_pk_bf16_f32 v154, v100, v101
    v_exp_f32 v130, v130
    v_mfma_f32_16x16x32_bf16 v[80:83], a[140:143], v[28:31], v[80:83]
    ds_read_b128 a[196:199], v3 offset:1024
    v_cvt_pk_bf16_f32 v147, v98, v99
    v_accvgpr_read_b32 v218, a74
    v_mfma_f32_16x16x32_bf16 v[84:87], a[128:131], v[32:35], v[180:183]
    v_cvt_pk_bf16_f32 v149, v114, v115
    v_exp_f32 v117, v117
    v_exp_f32 v133, v133
    v_mfma_f32_16x16x32_bf16 v[84:87], a[132:135], v[36:39], v[84:87]
    ds_read_b128 a[200:203], v3 offset:2048
    v_cvt_pk_bf16_f32 v169, v94, v95
    v_exp_f32 v119, v119
    v_cndmask_b32 v124, v124, v8, s[32:33]
    v_exp_f32 v128, v128
    v_accvgpr_read_b32 v216, a72
    v_mfma_f32_16x16x32_bf16 v[84:87], a[136:139], v[40:43], v[84:87]
    v_cvt_pk_bf16_f32 v146, v96, v97
    v_accvgpr_read_b32 v214, a70
    v_mfma_f32_16x16x32_bf16 v[84:87], a[140:143], v[44:47], v[84:87]
    ds_read_b128 a[204:207], v3 offset:3072
    v_cvt_pk_bf16_f32 v148, v112, v113
    v_exp_f32 v134, v134
    v_rcp_f32 v9, v200
    v_mfma_f32_16x16x32_bf16 v[96:99], a[144:147], v[16:19], v[176:179]
    v_exp_f32 v116, v116
    v_exp_f32 v135, v135
    v_add_u32 v2, s54, v1
    v_mfma_f32_16x16x32_bf16 v[96:99], a[148:151], v[20:23], v[96:99]
    ds_read_b128 a[208:211], v3 offset:4096
    v_cvt_pk_bf16_f32 v155, v102, v103
    v_cndmask_b32 v126, v126, v8, s[36:37]
    v_accvgpr_read_b32 v213, a69
    v_mfma_f32_16x16x32_bf16 v[96:99], a[152:155], v[24:27], v[96:99]
    buffer_load_dwordx4 v11, s[8:11], s52 offen offset:0 sc1 lds
    v_cvt_pk_bf16_f32 v157, v118, v119
    v_accvgpr_read_b32 v211, a67
    v_accvgpr_read_b32 v217, a73
    v_mfma_f32_16x16x32_bf16 v[96:99], a[156:159], v[28:31], v[96:99]
    ds_read_b128 a[212:215], v3 offset:5120
    v_cndmask_b32 v141, v141, v8, s[42:43]
    v_exp_f32 v83, v83
    v_exp_f32 v86, v86
    v_mul_f32 v216, v216, v9
    v_mfma_f32_16x16x32_bf16 v[100:103], a[144:147], v[32:35], v[180:183]
    ds_read_b128 a[216:219], v3 offset:6144
    v_cndmask_b32 v125, v125, v8, s[34:35]
    v_mul_f32 v218, v218, v9
    v_mfma_f32_16x16x32_bf16 v[100:103], a[148:151], v[36:39], v[100:103]
    v_cvt_pk_bf16_f32 v170, v108, v109
    v_cvt_pk_bf16_f32 v156, v116, v117
    v_cndmask_b32 v140, v140, v8, s[40:41]
    v_accvgpr_read_b32 v212, a68
    v_mfma_f32_16x16x32_bf16 v[100:103], a[152:155], v[40:43], v[100:103]
    ds_read_b128 a[220:223], v3 offset:7168
    v_cndmask_b32 v142, v142, v8, s[44:45]
    v_mfma_f32_16x16x32_bf16 v[100:103], a[156:159], v[44:47], v[100:103]
    v_exp_f32 v131, v131
    v_exp_f32 v132, v132
    v_accvgpr_read_b32 v220, a76
    v_mfma_f32_16x16x32_bf16 v[112:115], a[160:163], v[16:19], v[176:179]
    ds_read_b128 a[224:227], v3 offset:8192
    v_accvgpr_read_b32 v222, a78
    v_mfma_f32_16x16x32_bf16 v[112:115], a[164:167], v[20:23], v[112:115]
    buffer_load_dwordx4 v11, s[8:11], s52 offen offset:1024 sc1 lds
    v_exp_f32 v141, v141
    v_mul_f32 v212, v212, v9
    v_mfma_f32_16x16x32_bf16 v[112:115], a[168:171], v[24:27], v[112:115]
    ds_read_b128 a[228:231], v3 offset:9216
    v_exp_f32 v126, v126
    v_mul_f32 v211, v211, v9
    v_mfma_f32_16x16x32_bf16 v[112:115], a[172:175], v[28:31], v[112:115]
    s_xor_b32 s55, s53, 0x8000
    v_exp_f32 v129, v129
    v_mul_f32 v214, v214, v9
    v_mfma_f32_16x16x32_bf16 v[116:119], a[160:163], v[32:35], v[180:183]
    v_cvt_pk_bf16_f32 v151, v130, v131
    v_accvgpr_read_b32 v215, a71
    v_accvgpr_read_b32 v219, a75
    v_mfma_f32_16x16x32_bf16 v[116:119], a[164:167], v[36:39], v[116:119]
    ds_read_b128 a[232:235], v3 offset:10240
    v_cvt_pk_bf16_f32 v150, v128, v129
    v_cvt_pk_bf16_f32 v158, v132, v133
    v_cvt_pk_bf16_f32 v159, v134, v135
    v_cndmask_b32 v143, v143, v8, s[46:47]
    v_mul_f32 v213, v213, v9
    v_mul_f32 v219, v219, v9
    v_mfma_f32_16x16x32_bf16 v[116:119], a[168:171], v[40:43], v[116:119]
    buffer_load_dwordx4 v11, s[8:11], s52 offen offset:2048 sc1 lds
    v_exp_f32 v140, v140
    v_mul_f32 v215, v215, v9
    v_cvt_pk_bf16_f32 v227, v214, v215
    v_mfma_f32_16x16x32_bf16 v[116:119], a[172:175], v[44:47], v[116:119]
    ds_read_b128 a[236:239], v3 offset:11264
    v_exp_f32 v142, v142
    v_mfma_f32_16x16x32_bf16 v[128:131], a[176:179], v[16:19], v[176:179]
    v_exp_f32 v127, v127
    v_mfma_f32_16x16x32_bf16 v[128:131], a[180:183], v[20:23], v[128:131]
    ds_read_b128 a[240:243], v3 offset:12288
    v_exp_f32 v125, v125
    v_mfma_f32_16x16x32_bf16 v[128:131], a[184:187], v[24:27], v[128:131]
    v_exp_f32 v124, v124
    v_mfma_f32_16x16x32_bf16 v[128:131], a[188:191], v[28:31], v[128:131]
    ds_read_b128 a[244:247], v3 offset:13312
    v_cvt_pk_bf16_f32 v168, v92, v93
    v_cvt_pk_bf16_f32 v174, v140, v141
    v_accvgpr_read_b32 v210, a66
    v_mfma_f32_16x16x32_bf16 v[132:135], a[176:179], v[32:35], v[180:183]
    v_exp_f32 v143, v143
    v_mul_f32 v210, v210, v9
    v_mfma_f32_16x16x32_bf16 v[132:135], a[180:183], v[36:39], v[132:135]
    ds_read_b128 a[248:251], v3 offset:14336
    v_cvt_pk_bf16_f32 v229, v218, v219
    v_accvgpr_read_b32 v221, a77
    v_mul_f32 v221, v221, v9
    v_mfma_f32_16x16x32_bf16 v[132:135], a[184:187], v[40:43], v[132:135]
    buffer_load_dwordx4 v11, s[8:11], s52 offen offset:3072 sc1 lds
    v_mfma_f32_16x16x32_bf16 v[132:135], a[188:191], v[44:47], v[132:135]
    ds_read_b128 a[252:255], v3 offset:15360
    v_mul_f32 v222, v222, v9
    v_mfma_f32_16x16x32_bf16 v[192:195], v[4:7], v[144:147], v[192:195]
    v_cvt_pk_bf16_f32 v173, v126, v127
    v_mul_f32 v217, v217, v9
    v_mfma_f32_16x16x32_bf16 v[192:195], v[4:7], v[148:151], v[192:195]
    ds_read_b64_tr_b16 v[240:241], v243 offset:0
    v_cvt_pk_bf16_f32 v175, v142, v143
    v_mfma_f32_16x16x32_bf16 v[196:199], v[4:7], v[152:155], v[196:199]
    s_add_u32 m0, s55, s56
    v_exp_f32 v103, v103
    v_mul_f32 v220, v220, v9
    v_mfma_f32_16x16x32_bf16 v[196:199], v[4:7], v[156:159], v[196:199]
    ds_read_b64_tr_b16 v[242:243], v243 offset:3072
    v_cvt_pk_bf16_f32 v172, v124, v125
    v_add_u32 v3, s53, v12
    v_mfma_f32_16x16x32_bf16 v[204:207], v[4:7], v[168:171], v[204:207]
    buffer_load_dwordx4 v1, s[8:11], s52 offen offset:0 sc1 lds
    v_cvt_pk_bf16_f32 v225, v210, v211
    v_mfma_f32_16x16x32_bf16 v[204:207], v[4:7], v[172:175], v[204:207]
    ds_read_b64_tr_b16 v[244:245], v247 offset:0
    v_accvgpr_read_b32 v209, a65
    v_cvt_pk_bf16_f32 v230, v220, v221
    s_waitcnt lgkmcnt(4)
    v_mfma_f32_16x16x32_bf16 a[0:3], a[192:195], v[144:147], a[0:3]
    v_accvgpr_read_b32 v208, a64
    v_cvt_pk_bf16_f32 v228, v216, v217
    v_mfma_f32_16x16x32_bf16 a[0:3], a[196:199], v[148:151], a[0:3]
    ds_read_b128 a[128:131], v2 offset:0
    v_accvgpr_read_b32 v223, a79
    v_mfma_f32_16x16x32_bf16 a[32:35], a[192:195], v[152:155], a[32:35]
    v_exp_f32 v97, v97
    v_mfma_f32_16x16x32_bf16 a[32:35], a[196:199], v[156:159], a[32:35]
    ds_read_b64_tr_b16 v[246:247], v247 offset:3072
    v_exp_f32 v81, v81
    v_mfma_f32_16x16x32_bf16 a[96:99], a[192:195], v[168:171], a[96:99]
    v_exp_f32 v80, v80
    v_mul_f32 v209, v209, v9
    v_mfma_f32_16x16x32_bf16 a[96:99], a[196:199], v[172:175], a[96:99]
    ds_read_b64_tr_b16 v[248:249], v251 offset:0
    v_exp_f32 v82, v82
    v_mfma_f32_16x16x32_bf16 a[4:7], a[200:203], v[144:147], a[4:7]
    buffer_load_dwordx4 v1, s[8:11], s52 offen offset:1024 sc1 lds
    v_mfma_f32_16x16x32_bf16 a[4:7], a[204:207], v[148:151], a[4:7]
    v_exp_f32 v100, v100
    v_mul_f32 v223, v223, v9
    v_mfma_f32_16x16x32_bf16 a[36:39], a[200:203], v[152:155], a[36:39]
    ds_read_b64_tr_b16 v[250:251], v251 offset:3072
    v_cvt_pk_bf16_f32 v231, v222, v223
    v_mfma_f32_16x16x32_bf16 a[36:39], a[204:207], v[156:159], a[36:39]
    s_mov_b32 s53, s54
    v_accvgpr_read_b32 v217, a89
    v_accvgpr_read_b32 v223, a95
    v_mfma_f32_16x16x32_bf16 a[100:103], a[200:203], v[168:171], a[100:103]
    ds_read_b128 a[132:135], v2 offset:1024
    v_cvt_pk_bf16_f32 v226, v212, v213
    v_mfma_f32_16x16x32_bf16 a[100:103], a[204:207], v[172:175], a[100:103]
    buffer_load_dwordx4 v1, s[8:11], s52 offen offset:2048 sc1 lds
    v_mfma_f32_16x16x32_bf16 a[8:11], a[208:211], v[144:147], a[8:11]
    ds_read_b128 a[136:139], v2 offset:2048
    v_accvgpr_read_b32 v218, a90
    v_mfma_f32_16x16x32_bf16 a[8:11], a[212:215], v[148:151], a[8:11]
    ds_read_b128 a[140:143], v2 offset:3072
    v_exp_f32 v85, v85
    v_mfma_f32_16x16x32_bf16 a[40:43], a[208:211], v[152:155], a[40:43]
    v_exp_f32 v87, v87
    v_mul_f32 v208, v208, v9
    v_cvt_pk_bf16_f32 v224, v208, v209
    v_mfma_f32_16x16x32_bf16 a[40:43], a[212:215], v[156:159], a[40:43]
    ds_read_b128 a[144:147], v2 offset:4096
    v_exp_f32 v102, v102
    v_accvgpr_read_b32 v216, a88
    v_mfma_f32_16x16x32_bf16 a[104:107], a[208:211], v[168:171], a[104:107]
    s_waitcnt lgkmcnt(4)
    buffer_store_dwordx4 v[240:243], v1, s[4:7], s48 offen offset:0 sc1
    v_mfma_f32_16x16x32_bf16 a[104:107], a[212:215], v[172:175], a[104:107]
    ds_read_b128 a[148:151], v2 offset:5120
    v_accvgpr_read_b32 v222, a94
    v_mfma_f32_16x16x32_bf16 a[12:15], a[216:219], v[144:147], a[12:15]
    buffer_store_dwordx4 v[244:247], v1, s[4:7], s48 offen offset:1024 sc1
    v_mfma_f32_16x16x32_bf16 a[12:15], a[220:223], v[148:151], a[12:15]
    ds_read_b128 a[152:155], v2 offset:6144
    v_mul_f32 v216, v216, v9
    v_accvgpr_read_b32 v219, a91
    v_mfma_f32_16x16x32_bf16 a[44:47], a[216:219], v[152:155], a[44:47]
    v_exp_f32 v84, v84
    v_mfma_f32_16x16x32_bf16 a[44:47], a[220:223], v[156:159], a[44:47]
    ds_read_b128 a[156:159], v2 offset:7168
    v_exp_f32 v99, v99
    v_mfma_f32_16x16x32_bf16 a[108:111], a[216:219], v[168:171], a[108:111]
    global_load_dword v255, v14, s[14:15]
    v_exp_f32 v113, v113
    v_mfma_f32_16x16x32_bf16 a[108:111], a[220:223], v[172:175], a[108:111]
    v_mul_f32 v217, v217, v9
    v_mul_f32 v218, v218, v9
    v_mfma_f32_16x16x32_bf16 a[16:19], a[224:227], v[144:147], a[16:19]
    ds_read_b128 a[160:163], v2 offset:8192
    v_accvgpr_read_b32 v220, a92
    v_mfma_f32_16x16x32_bf16 a[16:19], a[228:231], v[148:151], a[16:19]
    v_accvgpr_read_b32 v208, a80
    v_mul_f32 v219, v219, v9
    v_mfma_f32_16x16x32_bf16 a[48:51], a[224:227], v[152:155], a[48:51]
    ds_read_b128 a[164:167], v2 offset:9216
    v_accvgpr_read_b32 v221, a93
    v_mfma_f32_16x16x32_bf16 a[48:51], a[228:231], v[156:159], a[48:51]
    buffer_store_dwordx4 v[248:251], v1, s[4:7], s48 offen offset:2048 sc1
    v_mfma_f32_16x16x32_bf16 a[112:115], a[224:227], v[168:171], a[112:115]
    ds_read_b128 a[168:171], v2 offset:10240
    v_accvgpr_read_b32 v215, a87
    v_mfma_f32_16x16x32_bf16 a[112:115], a[228:231], v[172:175], a[112:115]
    v_accvgpr_read_b32 v212, a84
    v_accvgpr_read_b32 v213, a85
    v_mul_f32 v213, v213, v9
    v_mfma_f32_16x16x32_bf16 a[20:23], a[232:235], v[144:147], a[20:23]
    ds_read_b128 a[172:175], v2 offset:11264
    v_exp_f32 v114, v114
    v_mfma_f32_16x16x32_bf16 a[20:23], a[236:239], v[148:151], a[20:23]
    v_accvgpr_read_b32 v209, a81
    v_mul_f32 v209, v209, v9
    v_mul_f32 v222, v222, v9
    v_mfma_f32_16x16x32_bf16 a[52:55], a[232:235], v[152:155], a[52:55]
    v_mul_f32 v208, v208, v9
    v_mul_f32 v223, v223, v9
    v_mfma_f32_16x16x32_bf16 a[52:55], a[236:239], v[156:159], a[52:55]
    v_accvgpr_read_b32 v214, a86
    v_mul_f32 v221, v221, v9
    v_mfma_f32_16x16x32_bf16 a[116:119], a[232:235], v[168:171], a[116:119]
    ds_read_b128 a[176:179], v2 offset:12288
    v_accvgpr_read_b32 v210, a82
    v_mfma_f32_16x16x32_bf16 a[116:119], a[236:239], v[172:175], a[116:119]
    s_mov_b32 s54, s55
    v_mul_f32 v215, v215, v9
    v_cvt_pk_bf16_f32 v239, v222, v223
    v_mfma_f32_16x16x32_bf16 a[24:27], a[240:243], v[144:147], a[24:27]
    v_mul_f32 v212, v212, v9
    v_mul_f32 v220, v220, v9
    v_mfma_f32_16x16x32_bf16 a[24:27], a[244:247], v[148:151], a[24:27]
    v_cvt_pk_bf16_f32 v232, v208, v209
    v_mul_f32 v210, v210, v9
    v_mfma_f32_16x16x32_bf16 a[56:59], a[240:243], v[152:155], a[56:59]
    ds_read_b128 a[180:183], v2 offset:13312
    v_exp_f32 v112, v112
    v_mfma_f32_16x16x32_bf16 a[56:59], a[244:247], v[156:159], a[56:59]
    v_accvgpr_read_b32 v211, a83
    v_cvt_pk_bf16_f32 v238, v220, v221
    v_mfma_f32_16x16x32_bf16 a[120:123], a[240:243], v[168:171], a[120:123]
    v_exp_f32 v115, v115
    v_mfma_f32_16x16x32_bf16 a[120:123], a[244:247], v[172:175], a[120:123]
    ds_read_b128 a[184:187], v2 offset:14336
    v_mul_f32 v211, v211, v9
    v_cvt_pk_bf16_f32 v236, v216, v217
    v_mfma_f32_16x16x32_bf16 a[28:31], a[248:251], v[144:147], a[28:31]
    buffer_load_dwordx4 v1, s[8:11], s52 offen offset:3072 sc1 lds
    v_mul_f32 v214, v214, v9
    v_mfma_f32_16x16x32_bf16 a[28:31], a[252:255], v[148:151], a[28:31]
    ds_read_b128 a[188:191], v2 offset:15360
    v_cvt_pk_bf16_f32 v145, v82, v83
    v_mfma_f32_16x16x32_bf16 a[60:63], a[248:251], v[152:155], a[60:63]
    s_add_u32 s52, s52, 37888
    v_exp_f32 v96, v96
    v_exp_f32 v101, v101
    v_cvt_pk_bf16_f32 v233, v210, v211
    v_cvt_pk_bf16_f32 v235, v214, v215
    v_mfma_f32_16x16x32_bf16 a[60:63], a[252:255], v[156:159], a[60:63]
    v_exp_f32 v98, v98
    v_mfma_f32_16x16x32_bf16 a[124:127], a[248:251], v[168:171], a[124:127]
    v_cvt_pk_bf16_f32 v144, v80, v81
    v_cvt_pk_bf16_f32 v237, v218, v219
    v_mfma_f32_16x16x32_bf16 a[124:127], a[252:255], v[172:175], a[124:127]
    v_cvt_pk_bf16_f32 v234, v212, v213
    s_waitcnt vmcnt(21) lgkmcnt(0)
    s_barrier
    s_mul_i32 s51, s62, 136192
    s_add_u32 s51, s51, s57
    buffer_store_dwordx4 v[224:227], v1, s[4:7], s51 offen offset:0 sc1
    v_mfma_f32_16x16x32_bf16 v[240:243], v[224:227], v[4:7], 0
    buffer_store_dwordx4 v[228:231], v1, s[4:7], s51 offen offset:1024 sc1
    v_mfma_f32_16x16x32_bf16 v[240:243], v[228:231], v[4:7], v[240:243]
    buffer_store_dwordx4 v[232:235], v1, s[4:7], s51 offen offset:2048 sc1
    v_mfma_f32_16x16x32_bf16 v[240:243], v[232:235], v[4:7], v[240:243]
    buffer_store_dwordx4 v[236:239], v1, s[4:7], s51 offen offset:3072 sc1
    v_mfma_f32_16x16x32_bf16 v[240:243], v[236:239], v[4:7], v[240:243]
    v_cmp_ngt_f32 vcc, 0x71800000, v200
    s_or_b32 s59, s59, vcc_lo
    s_or_b32 s59, s59, vcc_hi
    v_rcp_f32 v10, v204
    v_cmp_ngt_f32 vcc, 0x71800000, v204
    s_or_b32 s59, s59, vcc_lo
    s_or_b32 s59, s59, vcc_hi
    s_mul_i32 s51, s63, 136192
    s_add_u32 s51, s51, s57
    v_accvgpr_read_b32 v208, a96
    v_accvgpr_read_b32 v209, a97
    v_accvgpr_read_b32 v210, a98
    v_accvgpr_read_b32 v211, a99
    v_accvgpr_read_b32 v212, a100
    v_accvgpr_read_b32 v213, a101
    v_accvgpr_read_b32 v214, a102
    v_accvgpr_read_b32 v215, a103
    v_pk_mul_f32 v[208:209], v[208:209], v[10:11] op_sel:[0,0] op_sel_hi:[1,0]
    v_pk_mul_f32 v[210:211], v[210:211], v[10:11] op_sel:[0,0] op_sel_hi:[1,0]
    v_pk_mul_f32 v[212:213], v[212:213], v[10:11] op_sel:[0,0] op_sel_hi:[1,0]
    v_pk_mul_f32 v[214:215], v[214:215], v[10:11] op_sel:[0,0] op_sel_hi:[1,0]
    v_cvt_pk_bf16_f32 v224, v208, v209
    v_cvt_pk_bf16_f32 v225, v210, v211
    v_cvt_pk_bf16_f32 v226, v212, v213
    v_cvt_pk_bf16_f32 v227, v214, v215
    buffer_store_dwordx4 v[224:227], v1, s[4:7], s51 offen offset:0 sc1
    s_nop 0
    v_mfma_f32_16x16x32_bf16 v[240:243], v[224:227], v[4:7], v[240:243]
    v_accvgpr_read_b32 v216, a104
    v_accvgpr_read_b32 v217, a105
    v_accvgpr_read_b32 v218, a106
    v_accvgpr_read_b32 v219, a107
    v_accvgpr_read_b32 v220, a108
    v_accvgpr_read_b32 v221, a109
    v_accvgpr_read_b32 v222, a110
    v_accvgpr_read_b32 v223, a111
    v_pk_mul_f32 v[216:217], v[216:217], v[10:11] op_sel:[0,0] op_sel_hi:[1,0]
    v_pk_mul_f32 v[218:219], v[218:219], v[10:11] op_sel:[0,0] op_sel_hi:[1,0]
    v_pk_mul_f32 v[220:221], v[220:221], v[10:11] op_sel:[0,0] op_sel_hi:[1,0]
    v_pk_mul_f32 v[222:223], v[222:223], v[10:11] op_sel:[0,0] op_sel_hi:[1,0]
    v_cvt_pk_bf16_f32 v228, v216, v217
    v_cvt_pk_bf16_f32 v229, v218, v219
    v_cvt_pk_bf16_f32 v230, v220, v221
    v_cvt_pk_bf16_f32 v231, v222, v223
    buffer_store_dwordx4 v[228:231], v1, s[4:7], s51 offen offset:1024 sc1
    s_nop 0
    v_mfma_f32_16x16x32_bf16 v[240:243], v[228:231], v[4:7], v[240:243]
    v_accvgpr_read_b32 v208, a112
    v_accvgpr_read_b32 v209, a113
    v_accvgpr_read_b32 v210, a114
    v_accvgpr_read_b32 v211, a115
    v_accvgpr_read_b32 v212, a116
    v_accvgpr_read_b32 v213, a117
    v_accvgpr_read_b32 v214, a118
    v_accvgpr_read_b32 v215, a119
    v_pk_mul_f32 v[208:209], v[208:209], v[10:11] op_sel:[0,0] op_sel_hi:[1,0]
    v_pk_mul_f32 v[210:211], v[210:211], v[10:11] op_sel:[0,0] op_sel_hi:[1,0]
    v_pk_mul_f32 v[212:213], v[212:213], v[10:11] op_sel:[0,0] op_sel_hi:[1,0]
    v_pk_mul_f32 v[214:215], v[214:215], v[10:11] op_sel:[0,0] op_sel_hi:[1,0]
    v_cvt_pk_bf16_f32 v232, v208, v209
    v_cvt_pk_bf16_f32 v233, v210, v211
    v_cvt_pk_bf16_f32 v234, v212, v213
    v_cvt_pk_bf16_f32 v235, v214, v215
    buffer_store_dwordx4 v[232:235], v1, s[4:7], s51 offen offset:2048 sc1
    s_nop 0
    v_mfma_f32_16x16x32_bf16 v[240:243], v[232:235], v[4:7], v[240:243]
    v_accvgpr_read_b32 v216, a120
    v_accvgpr_read_b32 v217, a121
    v_accvgpr_read_b32 v218, a122
    v_accvgpr_read_b32 v219, a123
    v_accvgpr_read_b32 v220, a124
    v_accvgpr_read_b32 v221, a125
    v_accvgpr_read_b32 v222, a126
    v_accvgpr_read_b32 v223, a127
    v_pk_mul_f32 v[216:217], v[216:217], v[10:11] op_sel:[0,0] op_sel_hi:[1,0]
    v_pk_mul_f32 v[218:219], v[218:219], v[10:11] op_sel:[0,0] op_sel_hi:[1,0]
    v_pk_mul_f32 v[220:221], v[220:221], v[10:11] op_sel:[0,0] op_sel_hi:[1,0]
    v_pk_mul_f32 v[222:223], v[222:223], v[10:11] op_sel:[0,0] op_sel_hi:[1,0]
    v_cvt_pk_bf16_f32 v236, v216, v217
    v_cvt_pk_bf16_f32 v237, v218, v219
    v_cvt_pk_bf16_f32 v238, v220, v221
    v_cvt_pk_bf16_f32 v239, v222, v223
    buffer_store_dwordx4 v[236:239], v1, s[4:7], s51 offen offset:3072 sc1
    s_nop 0
    v_mfma_f32_16x16x32_bf16 v[240:243], v[236:239], v[4:7], v[240:243]
    s_movk_i32 s51, 0x207
    s_nop 6
    v_cmp_class_f32 vcc, v240, s51
    s_or_b32 s59, s59, vcc_lo
    s_or_b32 s59, s59, vcc_hi
    v_cmp_class_f32 vcc, v241, s51
    s_or_b32 s59, s59, vcc_lo
    s_or_b32 s59, s59, vcc_hi
    v_cmp_class_f32 vcc, v242, s51
    s_or_b32 s59, s59, vcc_lo
    s_or_b32 s59, s59, vcc_hi
    v_cmp_class_f32 vcc, v243, s51
    s_or_b32 s59, s59, vcc_lo
    s_or_b32 s59, s59, vcc_hi
    s_lshl_b32 s58, s50, 2
    s_sub_u32 s58, 27, s58
.p2align 6
    s_nop 0
L_att_S:
    v_mfma_f32_16x16x32_bf16 v[80:83], a[128:131], v[16:19], v[176:179]
    ds_read_b128 a[192:195], v3 offset:0
    v_cvt_pk_bf16_f32 v153, v86, v87
    v_cvt_pk_bf16_f32 v147, v98, v99
    v_mfma_f32_16x16x32_bf16 v[80:83], a[132:135], v[20:23], v[80:83]
    v_cvt_pk_bf16_f32 v152, v84, v85
    v_cvt_pk_bf16_f32 v154, v100, v101
    v_mfma_f32_16x16x32_bf16 v[80:83], a[136:139], v[24:27], v[80:83]
L_att_S_0:
    v_exp_f32 v128, v128
    v_mfma_f32_16x16x32_bf16 v[80:83], a[140:143], v[28:31], v[80:83]
    ds_read_b128 a[196:199], v3 offset:1024
    v_exp_f32 v129, v129
    v_mfma_f32_16x16x32_bf16 v[84:87], a[128:131], v[32:35], v[180:183]
    v_exp_f32 v119, v119
    v_mfma_f32_16x16x32_bf16 v[84:87], a[132:135], v[36:39], v[84:87]
    v_exp_f32 v135, v135
    v_mfma_f32_16x16x32_bf16 v[84:87], a[136:139], v[40:43], v[84:87]
L_att_S_1:
    v_exp_f32 v130, v130
    v_mfma_f32_16x16x32_bf16 v[84:87], a[140:143], v[44:47], v[84:87]
    ds_read_b128 a[200:203], v3 offset:2048
    v_cvt_pk_bf16_f32 v146, v96, v97
    v_cvt_pk_bf16_f32 v155, v102, v103
    v_mfma_f32_16x16x32_bf16 v[96:99], a[144:147], v[16:19], v[176:179]
    ds_read_b128 a[204:207], v3 offset:3072
    v_cvt_pk_bf16_f32 v148, v112, v113
    v_mfma_f32_16x16x32_bf16 v[96:99], a[148:151], v[20:23], v[96:99]
    v_exp_f32 v117, v117
    v_mfma_f32_16x16x32_bf16 v[96:99], a[152:155], v[24:27], v[96:99]
L_att_S_2:
    v_exp_f32 v118, v118
    v_mfma_f32_16x16x32_bf16 v[96:99], a[156:159], v[28:31], v[96:99]
    ds_read_b128 a[208:211], v3 offset:4096
    v_cvt_pk_bf16_f32 v149, v114, v115
    v_mfma_f32_16x16x32_bf16 v[100:103], a[144:147], v[32:35], v[180:183]
    s_add_u32 m0, s53, s68
    v_exp_f32 v132, v132
    v_mfma_f32_16x16x32_bf16 v[100:103], a[148:151], v[36:39], v[100:103]
    v_exp_f32 v116, v116
    v_mfma_f32_16x16x32_bf16 v[100:103], a[152:155], v[40:43], v[100:103]
L_att_S_3:
    v_exp_f32 v131, v131
    v_mfma_f32_16x16x32_bf16 v[100:103], a[156:159], v[44:47], v[100:103]
    ds_read_b128 a[212:215], v3 offset:5120
    v_cvt_pk_bf16_f32 v156, v116, v117
    v_mfma_f32_16x16x32_bf16 v[112:115], a[160:163], v[16:19], v[176:179]
    buffer_load_dwordx4 v11, s[8:11], s52 offen offset:0 sc1 lds
    v_mfma_f32_16x16x32_bf16 v[112:115], a[164:167], v[20:23], v[112:115]
    ds_read_b128 a[216:219], v3 offset:6144
    v_exp_f32 v134, v134
    v_mfma_f32_16x16x32_bf16 v[112:115], a[168:171], v[24:27], v[112:115]
    v_exp_f32 v133, v133
    v_mfma_f32_16x16x32_bf16 v[112:115], a[172:175], v[28:31], v[112:115]
    ds_read_b128 a[220:223], v3 offset:7168
    v_cvt_pk_bf16_f32 v157, v118, v119
    v_mfma_f32_16x16x32_bf16 v[116:119], a[160:163], v[32:35], v[180:183]
    ds_read_b128 a[224:227], v3 offset:8192
    v_cvt_pk_bf16_f32 v158, v132, v133
    v_mfma_f32_16x16x32_bf16 v[116:119], a[164:167], v[36:39], v[116:119]
    v_exp_f32 v83, v83
    v_mfma_f32_16x16x32_bf16 v[116:119], a[168:171], v[40:43], v[116:119]
    ds_read_b128 a[228:231], v3 offset:9216
    v_cvt_pk_bf16_f32 v150, v128, v129
    v_mfma_f32_16x16x32_bf16 v[116:119], a[172:175], v[44:47], v[116:119]
    ds_read_b128 a[232:235], v3 offset:10240
    v_cvt_pk_bf16_f32 v151, v130, v131
    v_mfma_f32_16x16x32_bf16 v[128:131], a[176:179], v[16:19], v[176:179]
    buffer_load_dwordx4 v11, s[8:11], s52 offen offset:1024 sc1 lds
    v_mfma_f32_16x16x32_bf16 v[128:131], a[180:183], v[20:23], v[128:131]
    ds_read_b128 a[236:239], v3 offset:11264
    v_cvt_pk_bf16_f32 v159, v134, v135
    v_mfma_f32_16x16x32_bf16 v[128:131], a[184:187], v[24:27], v[128:131]
    v_exp_f32 v100, v100
    v_mfma_f32_16x16x32_bf16 v[128:131], a[188:191], v[28:31], v[128:131]
    ds_read_b128 a[240:243], v3 offset:12288
    v_exp_f32 v102, v102
    v_mfma_f32_16x16x32_bf16 v[132:135], a[176:179], v[32:35], v[180:183]
    ds_read_b128 a[244:247], v3 offset:13312
    v_mfma_f32_16x16x32_bf16 v[132:135], a[180:183], v[36:39], v[132:135]
    ds_read_b128 a[248:251], v3 offset:14336
    s_xor_b32 s55, s53, 0x8000
    v_mfma_f32_16x16x32_bf16 v[132:135], a[184:187], v[40:43], v[132:135]
    buffer_load_dwordx4 v11, s[8:11], s52 offen offset:2048 sc1 lds
    v_mfma_f32_16x16x32_bf16 v[132:135], a[188:191], v[44:47], v[132:135]
    ds_read_b128 a[252:255], v3 offset:15360
    v_add_u32 v2, s54, v1
    v_mfma_f32_16x16x32_bf16 v[192:195], v[4:7], v[144:147], v[192:195]
    v_exp_f32 v96, v96
    v_mfma_f32_16x16x32_bf16 v[192:195], v[4:7], v[148:151], v[192:195]
    ds_read_b128 a[128:131], v2 offset:0
    v_mfma_f32_16x16x32_bf16 v[196:199], v[4:7], v[152:155], v[196:199]
    s_waitcnt lgkmcnt(5)
    v_exp_f32 v98, v98
    v_mfma_f32_16x16x32_bf16 v[196:199], v[4:7], v[156:159], v[196:199]
    ds_read_b128 a[132:135], v2 offset:1024
    v_mfma_f32_16x16x32_bf16 a[0:3], a[192:195], v[144:147], a[0:3]
    buffer_load_dwordx4 v11, s[8:11], s52 offen offset:3072 sc1 lds
    v_mfma_f32_16x16x32_bf16 a[0:3], a[196:199], v[148:151], a[0:3]
    ds_read_b128 a[136:139], v2 offset:2048
    v_mfma_f32_16x16x32_bf16 a[32:35], a[192:195], v[152:155], a[32:35]
    s_add_u32 m0, s55, s56
    v_exp_f32 v115, v115
    v_mfma_f32_16x16x32_bf16 a[32:35], a[196:199], v[156:159], a[32:35]
    ds_read_b128 a[140:143], v2 offset:3072
    v_mfma_f32_16x16x32_bf16 a[4:7], a[200:203], v[144:147], a[4:7]
    v_exp_f32 v97, v97
    v_mfma_f32_16x16x32_bf16 a[4:7], a[204:207], v[148:151], a[4:7]
    ds_read_b128 a[144:147], v2 offset:4096
    v_exp_f32 v81, v81
    v_mfma_f32_16x16x32_bf16 a[36:39], a[200:203], v[152:155], a[36:39]
    buffer_load_dwordx4 v1, s[8:11], s52 offen offset:0 sc1 lds
    v_mfma_f32_16x16x32_bf16 a[36:39], a[204:207], v[156:159], a[36:39]
    ds_read_b128 a[148:151], v2 offset:5120
    v_add_u32 v3, s53, v12
    v_mfma_f32_16x16x32_bf16 a[8:11], a[208:211], v[144:147], a[8:11]
    s_mov_b32 s53, s54
    v_exp_f32 v99, v99
    v_mfma_f32_16x16x32_bf16 a[8:11], a[212:215], v[148:151], a[8:11]
    ds_read_b128 a[152:155], v2 offset:6144
    v_mfma_f32_16x16x32_bf16 a[40:43], a[208:211], v[152:155], a[40:43]
    ds_read_b128 a[156:159], v2 offset:7168
    v_exp_f32 v114, v114
    v_mfma_f32_16x16x32_bf16 a[40:43], a[212:215], v[156:159], a[40:43]
    buffer_load_dwordx4 v1, s[8:11], s52 offen offset:1024 sc1 lds
    v_mfma_f32_16x16x32_bf16 a[12:15], a[216:219], v[144:147], a[12:15]
    ds_read_b128 a[160:163], v2 offset:8192
    v_mfma_f32_16x16x32_bf16 a[12:15], a[220:223], v[148:151], a[12:15]
    s_mov_b32 s54, s55
    v_exp_f32 v112, v112
    v_mfma_f32_16x16x32_bf16 a[44:47], a[216:219], v[152:155], a[44:47]
    ds_read_b128 a[164:167], v2 offset:9216
    v_mfma_f32_16x16x32_bf16 a[44:47], a[220:223], v[156:159], a[44:47]
    v_exp_f32 v80, v80
    v_mfma_f32_16x16x32_bf16 a[16:19], a[224:227], v[144:147], a[16:19]
    ds_read_b128 a[168:171], v2 offset:10240
    v_mfma_f32_16x16x32_bf16 a[16:19], a[228:231], v[148:151], a[16:19]
    v_exp_f32 v87, v87
    v_mfma_f32_16x16x32_bf16 a[48:51], a[224:227], v[152:155], a[48:51]
    ds_read_b128 a[172:175], v2 offset:11264
    v_mfma_f32_16x16x32_bf16 a[48:51], a[228:231], v[156:159], a[48:51]
    buffer_load_dwordx4 v1, s[8:11], s52 offen offset:2048 sc1 lds
    v_mfma_f32_16x16x32_bf16 a[20:23], a[232:235], v[144:147], a[20:23]
    ds_read_b128 a[176:179], v2 offset:12288
    v_exp_f32 v103, v103
    v_mfma_f32_16x16x32_bf16 a[20:23], a[236:239], v[148:151], a[20:23]
    v_exp_f32 v113, v113
    v_mfma_f32_16x16x32_bf16 a[52:55], a[232:235], v[152:155], a[52:55]
    ds_read_b128 a[180:183], v2 offset:13312
    v_mfma_f32_16x16x32_bf16 a[52:55], a[236:239], v[156:159], a[52:55]
    s_waitcnt lgkmcnt(4)
    v_exp_f32 v84, v84
    v_mfma_f32_16x16x32_bf16 a[24:27], a[240:243], v[144:147], a[24:27]
    ds_read_b128 a[184:187], v2 offset:14336
    v_exp_f32 v82, v82
    v_mfma_f32_16x16x32_bf16 a[24:27], a[244:247], v[148:151], a[24:27]
    buffer_load_dwordx4 v1, s[8:11], s52 offen offset:3072 sc1 lds
    v_mfma_f32_16x16x32_bf16 a[56:59], a[240:243], v[152:155], a[56:59]
    v_exp_f32 v85, v85
    v_mfma_f32_16x16x32_bf16 a[56:59], a[244:247], v[156:159], a[56:59]
    ds_read_b128 a[188:191], v2 offset:15360
    s_add_u32 s52, s52, 37888
    v_mfma_f32_16x16x32_bf16 a[28:31], a[248:251], v[144:147], a[28:31]
    s_sub_u32 s58, s58, 1
    v_exp_f32 v101, v101
    v_mfma_f32_16x16x32_bf16 a[28:31], a[252:255], v[148:151], a[28:31]
    v_exp_f32 v86, v86
    v_mfma_f32_16x16x32_bf16 a[60:63], a[248:251], v[152:155], a[60:63]
    s_cmp_eq_u32 s58, 0
    v_cvt_pk_bf16_f32 v144, v80, v81
    v_cvt_pk_bf16_f32 v145, v82, v83
    v_mfma_f32_16x16x32_bf16 a[60:63], a[252:255], v[156:159], a[60:63]
    s_waitcnt vmcnt(16) lgkmcnt(0)
    s_barrier
    s_cbranch_scc1 L_att_S_out
    v_mfma_f32_16x16x32_bf16 v[80:83], a[128:131], v[16:19], v[176:179]
    ds_read_b128 a[192:195], v3 offset:0
    v_cvt_pk_bf16_f32 v153, v86, v87
    v_cvt_pk_bf16_f32 v147, v98, v99
    v_mfma_f32_16x16x32_bf16 v[80:83], a[132:135], v[20:23], v[80:83]
    s_cmp_eq_u32 s3, 0
    v_cvt_pk_bf16_f32 v152, v84, v85
    v_cvt_pk_bf16_f32 v154, v100, v101
    v_mfma_f32_16x16x32_bf16 v[80:83], a[136:139], v[24:27], v[80:83]
    s_cbranch_scc1 L_att_S_0
    v_exp_f32 v128, v128
    v_mfma_f32_16x16x32_bf16 v[80:83], a[140:143], v[28:31], v[80:83]
    ds_read_b128 a[196:199], v3 offset:1024
    v_exp_f32 v129, v129
    v_mfma_f32_16x16x32_bf16 v[84:87], a[128:131], v[32:35], v[180:183]
    v_exp_f32 v119, v119
    v_mfma_f32_16x16x32_bf16 v[84:87], a[132:135], v[36:39], v[84:87]
    s_cmp_eq_u32 s3, 1
    v_exp_f32 v135, v135
    v_mfma_f32_16x16x32_bf16 v[84:87], a[136:139], v[40:43], v[84:87]
    s_cbranch_scc1 L_att_S_1
    v_exp_f32 v130, v130
    v_mfma_f32_16x16x32_bf16 v[84:87], a[140:143], v[44:47], v[84:87]
    ds_read_b128 a[200:203], v3 offset:2048
    v_cvt_pk_bf16_f32 v146, v96, v97
    v_cvt_pk_bf16_f32 v155, v102, v103
    v_mfma_f32_16x16x32_bf16 v[96:99], a[144:147], v[16:19], v[176:179]
    ds_read_b128 a[204:207], v3 offset:3072
    v_cvt_pk_bf16_f32 v148, v112, v113
    v_mfma_f32_16x16x32_bf16 v[96:99], a[148:151], v[20:23], v[96:99]
    s_cmp_eq_u32 s3, 2
    v_exp_f32 v117, v117
    v_mfma_f32_16x16x32_bf16 v[96:99], a[152:155], v[24:27], v[96:99]
    s_cbranch_scc1 L_att_S_2
    v_exp_f32 v118, v118
    v_mfma_f32_16x16x32_bf16 v[96:99], a[156:159], v[28:31], v[96:99]
    ds_read_b128 a[208:211], v3 offset:4096
    v_cvt_pk_bf16_f32 v149, v114, v115
    v_mfma_f32_16x16x32_bf16 v[100:103], a[144:147], v[32:35], v[180:183]
    s_add_u32 m0, s53, s68
    v_exp_f32 v132, v132
    v_mfma_f32_16x16x32_bf16 v[100:103], a[148:151], v[36:39], v[100:103]
    v_exp_f32 v116, v116
    v_mfma_f32_16x16x32_bf16 v[100:103], a[152:155], v[40:43], v[100:103]
    s_branch L_att_S_3
L_att_S_out:
L_att_S1:
    v_mfma_f32_16x16x32_bf16 v[80:83], a[128:131], v[16:19], v[176:179]
    ds_read_b128 a[192:195], v3 offset:0
    v_cvt_pk_bf16_f32 v152, v84, v85
    v_mfma_f32_16x16x32_bf16 v[80:83], a[132:135], v[20:23], v[80:83]
    v_exp_f32 v133, v133
    v_mfma_f32_16x16x32_bf16 v[80:83], a[136:139], v[24:27], v[80:83]
    ds_read_b128 a[196:199], v3 offset:1024
    v_cvt_pk_bf16_f32 v146, v96, v97
    v_mfma_f32_16x16x32_bf16 v[80:83], a[140:143], v[28:31], v[80:83]
    v_cvt_pk_bf16_f32 v153, v86, v87
    v_cvt_pk_bf16_f32 v149, v114, v115
    v_mfma_f32_16x16x32_bf16 v[84:87], a[128:131], v[32:35], v[180:183]
    ds_read_b128 a[200:203], v3 offset:2048
    v_cvt_pk_bf16_f32 v154, v100, v101
    v_mfma_f32_16x16x32_bf16 v[84:87], a[132:135], v[36:39], v[84:87]
    v_exp_f32 v117, v117
    v_mfma_f32_16x16x32_bf16 v[84:87], a[136:139], v[40:43], v[84:87]
    ds_read_b128 a[204:207], v3 offset:3072
    v_cvt_pk_bf16_f32 v147, v98, v99
    v_mfma_f32_16x16x32_bf16 v[84:87], a[140:143], v[44:47], v[84:87]
    v_exp_f32 v119, v119
    v_mfma_f32_16x16x32_bf16 v[96:99], a[144:147], v[16:19], v[176:179]
    ds_read_b128 a[208:211], v3 offset:4096
    v_cvt_pk_bf16_f32 v155, v102, v103
    v_mfma_f32_16x16x32_bf16 v[96:99], a[148:151], v[20:23], v[96:99]
    v_exp_f32 v129, v129
    v_mfma_f32_16x16x32_bf16 v[96:99], a[152:155], v[24:27], v[96:99]
    v_exp_f32 v116, v116
    v_mfma_f32_16x16x32_bf16 v[96:99], a[156:159], v[28:31], v[96:99]
    ds_read_b128 a[212:215], v3 offset:5120
    v_add_u32 v2, s54, v1
    v_mfma_f32_16x16x32_bf16 v[100:103], a[144:147], v[32:35], v[180:183]
    v_exp_f32 v118, v118
    v_mfma_f32_16x16x32_bf16 v[100:103], a[148:151], v[36:39], v[100:103]
    ds_read_b128 a[216:219], v3 offset:6144
    v_cvt_pk_bf16_f32 v148, v112, v113
    v_mfma_f32_16x16x32_bf16 v[100:103], a[152:155], v[40:43], v[100:103]
    s_xor_b32 s55, s53, 0x8000
    v_exp_f32 v130, v130
    v_mfma_f32_16x16x32_bf16 v[100:103], a[156:159], v[44:47], v[100:103]
    ds_read_b128 a[220:223], v3 offset:7168
    v_cvt_pk_bf16_f32 v156, v116, v117
    v_mfma_f32_16x16x32_bf16 v[112:115], a[160:163], v[16:19], v[176:179]
    v_exp_f32 v132, v132
    v_mfma_f32_16x16x32_bf16 v[112:115], a[164:167], v[20:23], v[112:115]
    ds_read_b128 a[224:227], v3 offset:8192
    v_cvt_pk_bf16_f32 v157, v118, v119
    v_mfma_f32_16x16x32_bf16 v[112:115], a[168:171], v[24:27], v[112:115]
    v_exp_f32 v131, v131
    v_mfma_f32_16x16x32_bf16 v[112:115], a[172:175], v[28:31], v[112:115]
    ds_read_b128 a[228:231], v3 offset:9216
    v_exp_f32 v128, v128
    v_mfma_f32_16x16x32_bf16 v[116:119], a[160:163], v[32:35], v[180:183]
    global_load_dword v246, v15, s[12:13]
    v_mfma_f32_16x16x32_bf16 v[116:119], a[164:167], v[36:39], v[116:119]
    ds_read_b128 a[232:235], v3 offset:10240
    v_cvt_pk_bf16_f32 v150, v128, v129
    v_mfma_f32_16x16x32_bf16 v[116:119], a[168:171], v[40:43], v[116:119]
    ds_read_b128 a[236:239], v3 offset:11264
    v_cvt_pk_bf16_f32 v151, v130, v131
    v_mfma_f32_16x16x32_bf16 v[116:119], a[172:175], v[44:47], v[116:119]
    v_exp_f32 v134, v134
    v_mfma_f32_16x16x32_bf16 v[128:131], a[176:179], v[16:19], v[176:179]
    v_exp_f32 v135, v135
    v_mfma_f32_16x16x32_bf16 v[128:131], a[180:183], v[20:23], v[128:131]
    ds_read_b128 a[240:243], v3 offset:12288
    v_cvt_pk_bf16_f32 v158, v132, v133
    v_mfma_f32_16x16x32_bf16 v[128:131], a[184:187], v[24:27], v[128:131]
    v_exp_f32 v102, v102
    v_mfma_f32_16x16x32_bf16 v[128:131], a[188:191], v[28:31], v[128:131]
    ds_read_b128 a[244:247], v3 offset:13312
    v_cvt_pk_bf16_f32 v159, v134, v135
    v_mfma_f32_16x16x32_bf16 v[132:135], a[176:179], v[32:35], v[180:183]
    v_exp_f32 v86, v86
    v_mfma_f32_16x16x32_bf16 v[132:135], a[180:183], v[36:39], v[132:135]
    ds_read_b128 a[248:251], v3 offset:14336
    v_cndmask_b32 v99, v99, v8, s[30:31]
    v_mfma_f32_16x16x32_bf16 v[132:135], a[184:187], v[40:43], v[132:135]
    v_exp_f32 v103, v103
    v_mfma_f32_16x16x32_bf16 v[132:135], a[188:191], v[44:47], v[132:135]
    ds_read_b128 a[252:255], v3 offset:15360
    v_cndmask_b32 v114, v114, v8, s[36:37]
    v_mfma_f32_16x16x32_bf16 v[192:195], v[4:7], v[144:147], v[192:195]
    v_cndmask_b32 v80, v80, v8, s[16:17]
    v_cndmask_b32 v112, v112, v8, s[32:33]
    v_mfma_f32_16x16x32_bf16 v[192:195], v[4:7], v[148:151], v[192:195]
    ds_read_b128 a[128:131], v2 offset:0
    v_mfma_f32_16x16x32_bf16 v[196:199], v[4:7], v[152:155], v[196:199]
    s_waitcnt lgkmcnt(4)
    v_exp_f32 v99, v99
    v_mfma_f32_16x16x32_bf16 v[196:199], v[4:7], v[156:159], v[196:199]
    ds_read_b128 a[132:135], v2 offset:1024
    v_cndmask_b32 v113, v113, v8, s[34:35]
    v_mfma_f32_16x16x32_bf16 a[0:3], a[192:195], v[144:147], a[0:3]
    v_cndmask_b32 v96, v96, v8, s[24:25]
    v_mfma_f32_16x16x32_bf16 a[0:3], a[196:199], v[148:151], a[0:3]
    ds_read_b128 a[136:139], v2 offset:2048
    v_cndmask_b32 v81, v81, v8, s[18:19]
    v_mfma_f32_16x16x32_bf16 a[32:35], a[192:195], v[152:155], a[32:35]
    v_exp_f32 v84, v84
    v_mfma_f32_16x16x32_bf16 a[32:35], a[196:199], v[156:159], a[32:35]
    ds_read_b128 a[140:143], v2 offset:3072
    v_cndmask_b32 v97, v97, v8, s[26:27]
    v_mfma_f32_16x16x32_bf16 a[4:7], a[200:203], v[144:147], a[4:7]
    v_exp_f32 v81, v81
    v_mfma_f32_16x16x32_bf16 a[4:7], a[204:207], v[148:151], a[4:7]
    ds_read_b128 a[144:147], v2 offset:4096
    v_exp_f32 v96, v96
    v_mfma_f32_16x16x32_bf16 a[36:39], a[200:203], v[152:155], a[36:39]
    v_exp_f32 v87, v87
    v_mfma_f32_16x16x32_bf16 a[36:39], a[204:207], v[156:159], a[36:39]
    ds_read_b128 a[148:151], v2 offset:5120
    v_cndmask_b32 v82, v82, v8, s[20:21]
    v_mfma_f32_16x16x32_bf16 a[8:11], a[208:211], v[144:147], a[8:11]
    v_exp_f32 v113, v113
    v_mfma_f32_16x16x32_bf16 a[8:11], a[212:215], v[148:151], a[8:11]
    ds_read_b128 a[152:155], v2 offset:6144
    v_cndmask_b32 v98, v98, v8, s[28:29]
    v_mfma_f32_16x16x32_bf16 a[40:43], a[208:211], v[152:155], a[40:43]
    v_exp_f32 v100, v100
    v_mfma_f32_16x16x32_bf16 a[40:43], a[212:215], v[156:159], a[40:43]
    ds_read_b128 a[156:159], v2 offset:7168
    v_cndmask_b32 v83, v83, v8, s[22:23]
    v_mfma_f32_16x16x32_bf16 a[12:15], a[216:219], v[144:147], a[12:15]
    v_exp_f32 v83, v83
    v_mfma_f32_16x16x32_bf16 a[12:15], a[220:223], v[148:151], a[12:15]
    ds_read_b128 a[160:163], v2 offset:8192
    v_mfma_f32_16x16x32_bf16 a[44:47], a[216:219], v[152:155], a[44:47]
    v_exp_f32 v80, v80
    v_mfma_f32_16x16x32_bf16 a[44:47], a[220:223], v[156:159], a[44:47]
    ds_read_b128 a[164:167], v2 offset:9216
    v_mfma_f32_16x16x32_bf16 a[16:19], a[224:227], v[144:147], a[16:19]
    v_exp_f32 v97, v97
    v_mfma_f32_16x16x32_bf16 a[16:19], a[228:231], v[148:151], a[16:19]
    ds_read_b128 a[168:171], v2 offset:10240
    v_mfma_f32_16x16x32_bf16 a[48:51], a[224:227], v[152:155], a[48:51]
    v_exp_f32 v112, v112
    v_mfma_f32_16x16x32_bf16 a[48:51], a[228:231], v[156:159], a[48:51]
    ds_read_b128 a[172:175], v2 offset:11264
    v_cndmask_b32 v115, v115, v8, s[38:39]
    v_mfma_f32_16x16x32_bf16 a[20:23], a[232:235], v[144:147], a[20:23]
    v_exp_f32 v101, v101
    v_mfma_f32_16x16x32_bf16 a[20:23], a[236:239], v[148:151], a[20:23]
    ds_read_b128 a[176:179], v2 offset:12288
    v_add_u32 v3, s53, v12
    v_mfma_f32_16x16x32_bf16 a[52:55], a[232:235], v[152:155], a[52:55]
    v_exp_f32 v82, v82
    v_mfma_f32_16x16x32_bf16 a[52:55], a[236:239], v[156:159], a[52:55]
    ds_read_b128 a[180:183], v2 offset:13312
    v_mfma_f32_16x16x32_bf16 a[24:27], a[240:243], v[144:147], a[24:27]
    s_waitcnt lgkmcnt(4)
    v_exp_f32 v114, v114
    v_mfma_f32_16x16x32_bf16 a[24:27], a[244:247], v[148:151], a[24:27]
    ds_read_b128 a[184:187], v2 offset:14336
    v_mfma_f32_16x16x32_bf16 a[56:59], a[240:243], v[152:155], a[56:59]
    v_exp_f32 v85, v85
    v_mfma_f32_16x16x32_bf16 a[56:59], a[244:247], v[156:159], a[56:59]
    ds_read_b128 a[188:191], v2 offset:15360
    v_mfma_f32_16x16x32_bf16 a[28:31], a[248:251], v[144:147], a[28:31]
    s_mov_b32 s53, s54
    v_cvt_pk_bf16_f32 v144, v80, v81
    v_cvt_pk_bf16_f32 v145, v82, v83
    v_mfma_f32_16x16x32_bf16 a[28:31], a[252:255], v[148:151], a[28:31]
    v_exp_f32 v115, v115
    v_mfma_f32_16x16x32_bf16 a[60:63], a[248:251], v[152:155], a[60:63]
    v_exp_f32 v98, v98
    v_mfma_f32_16x16x32_bf16 a[60:63], a[252:255], v[156:159], a[60:63]
    s_mov_b32 s54, s55
    s_waitcnt vmcnt(1) lgkmcnt(0)
    s_barrier
L_att_S2:
    v_cvt_pk_bf16_f32 v152, v84, v85
    v_cvt_pk_bf16_f32 v153, v86, v87
    v_mfma_f32_16x16x32_bf16 v[84:87], a[128:131], v[32:35], v[180:183]
    s_lshr_b32 s54, s2, 3
    s_lshl_b32 s54, s54, 2
    s_add_u32 s54, s54, s3
    s_lshl_b32 s54, s54, 9
    ds_read_b128 a[192:195], v3 offset:0
    v_cvt_pk_bf16_f32 v154, v100, v101
    v_exp_f32 v118, v118
    v_exp_f32 v135, v135
    v_mfma_f32_16x16x32_bf16 v[84:87], a[132:135], v[36:39], v[84:87]
    ds_read_b128 a[196:199], v3 offset:1024
    v_cvt_pk_bf16_f32 v155, v102, v103
    v_exp_f32 v117, v117
    v_exp_f32 v119, v119
    v_mfma_f32_16x16x32_bf16 v[84:87], a[136:139], v[40:43], v[84:87]
    v_lshrrev_b32 v247, 4, v0
    v_lshl_add_u32 v247, v247, 7, s54
    v_min_u32 v247, L_text_last-L_att_done, v247
    ds_read_b128 a[200:203], v3 offset:2048
    v_mfma_f32_16x16x32_bf16 v[84:87], a[140:143], v[44:47], v[84:87]
    ds_read_b128 a[204:207], v3 offset:3072
    v_cvt_pk_bf16_f32 v147, v98, v99
    v_cndmask_b32 v128, v128, v8, s[40:41]
    v_cndmask_b32 v129, v129, v8, s[42:43]
    v_cndmask_b32 v130, v130, v8, s[44:45]
    v_mfma_f32_16x16x32_bf16 v[100:103], a[144:147], v[32:35], v[180:183]
    s_getpc_b64 s[54:55]
L_cs_b:
    s_add_u32 s54, s54, L_att_done-L_cs_b
    s_addc_u32 s55, s55, 0
    global_load_dword v247, v247, s[54:55]
    v_exp_f32 v128, v128
    v_exp_f32 v134, v134
    v_mfma_f32_16x16x32_bf16 v[100:103], a[148:151], v[36:39], v[100:103]
    ds_read_b128 a[208:211], v3 offset:4096
    v_exp_f32 v116, v116
    v_cvt_pk_bf16_f32 v157, v118, v119
    v_cvt_pk_bf16_f32 v159, v134, v135
    v_mfma_f32_16x16x32_bf16 v[100:103], a[152:155], v[40:43], v[100:103]
    s_mov_b32 s8, s12
    s_mov_b32 s9, s13
    s_mov_b32 s10, 4194304
    s_mov_b32 s11, 0x20000
    s_mul_i32 s55, s3, 1048576
    s_bfe_u32 s58, s2, 0x30003
    s_lshl_b32 s58, s58, 7
    s_add_u32 s55, s55, s58
    s_lshl_b32 s56, s3, 14
    ds_read_b128 a[212:215], v3 offset:5120
    v_exp_f32 v133, v133
    v_mfma_f32_16x16x32_bf16 v[100:103], a[156:159], v[44:47], v[100:103]
    ds_read_b128 a[216:219], v3 offset:6144
    v_cvt_pk_bf16_f32 v156, v116, v117
    v_exp_f32 v130, v130
    v_cndmask_b32 v131, v131, v8, s[46:47]
    v_mfma_f32_16x16x32_bf16 v[116:119], a[160:163], v[32:35], v[180:183]
    v_lshrrev_b32 v208, 3, v0
    v_and_b32 v209, 7, v0
    v_and_b32 v210, 6, v208
    v_xor_b32 v209, v209, v210
    v_lshlrev_b32 v208, 10, v208
    v_lshl_add_u32 v176, v209, 4, v208
    v_add_u32 v177, 7168, v176
    v_add_u32 v178, 14336, v176
    v_add_u32 v179, 21504, v176
    ds_read_b128 a[220:223], v3 offset:7168
    v_mfma_f32_16x16x32_bf16 v[116:119], a[164:167], v[36:39], v[116:119]
    ds_read_b128 a[224:227], v3 offset:8192
    v_exp_f32 v132, v132
    v_mfma_f32_16x16x32_bf16 v[116:119], a[168:171], v[40:43], v[116:119]
    ds_read_b128 a[228:231], v3 offset:9216
    v_exp_f32 v129, v129
    v_mfma_f32_16x16x32_bf16 v[116:119], a[172:175], v[44:47], v[116:119]
    ds_read_b128 a[232:235], v3 offset:10240
    v_cvt_pk_bf16_f32 v158, v132, v133
    v_mfma_f32_16x16x32_bf16 v[132:135], a[176:179], v[32:35], v[180:183]
    s_add_u32 m0, s56, 0
    s_add_u32 s58, s55, 0
    buffer_load_dwordx4 v176, s[8:11], s58 offen offset:0 lds
    ds_read_b128 a[236:239], v3 offset:11264
    v_cvt_pk_bf16_f32 v149, v114, v115
    v_exp_f32 v131, v131
    v_mfma_f32_16x16x32_bf16 v[132:135], a[180:183], v[36:39], v[132:135]
    ds_read_b128 a[240:243], v3 offset:12288
    v_cvt_pk_bf16_f32 v146, v96, v97
    v_cvt_pk_bf16_f32 v148, v112, v113
    v_cvt_pk_bf16_f32 v151, v130, v131
    v_mfma_f32_16x16x32_bf16 v[132:135], a[184:187], v[40:43], v[132:135]
    buffer_load_dwordx4 v177, s[8:11], s58 offen offset:1024 lds
    v_mfma_f32_16x16x32_bf16 v[132:135], a[188:191], v[44:47], v[132:135]
    ds_read_b128 a[244:247], v3 offset:13312
    v_cvt_pk_bf16_f32 v150, v128, v129
    v_mfma_f32_16x16x32_bf16 v[192:195], v[4:7], v[144:147], v[192:195]
    buffer_load_dwordx4 v178, s[8:11], s58 offen offset:2048 lds
    v_mfma_f32_16x16x32_bf16 v[192:195], v[4:7], v[148:151], v[192:195]
    ds_read_b128 a[248:251], v3 offset:14336
    v_add_u32 v2, s53, v12
    v_mfma_f32_16x16x32_bf16 v[196:199], v[4:7], v[152:155], v[196:199]
    buffer_load_dwordx4 v179, s[8:11], s58 offen offset:3072 lds
    ds_read_b128 a[252:255], v3 offset:15360
    v_mfma_f32_16x16x32_bf16 v[196:199], v[4:7], v[156:159], v[196:199]
    ds_read_b128 a[128:131], v2 offset:0
    v_cndmask_b32 v102, v102, v8, s[28:29]
    s_waitcnt lgkmcnt(6)
    v_mfma_f32_16x16x32_bf16 a[0:3], a[192:195], v[144:147], a[0:3]
    ds_read_b128 a[132:135], v2 offset:1024
    v_mfma_f32_16x16x32_bf16 a[0:3], a[196:199], v[148:151], a[0:3]
    v_exp_f32 v102, v102
    v_mfma_f32_16x16x32_bf16 a[32:35], a[192:195], v[152:155], a[32:35]
    s_add_u32 m0, s56, 4096
    s_add_u32 s58, s55, 32768
    buffer_load_dwordx4 v176, s[8:11], s58 offen offset:0 lds
    v_mfma_f32_16x16x32_bf16 a[32:35], a[196:199], v[156:159], a[32:35]
    ds_read_b128 a[136:139], v2 offset:2048
    v_cndmask_b32 v87, v87, v8, s[22:23]
    v_mfma_f32_16x16x32_bf16 a[4:7], a[200:203], v[144:147], a[4:7]
    buffer_load_dwordx4 v177, s[8:11], s58 offen offset:1024 lds
    v_mfma_f32_16x16x32_bf16 a[4:7], a[204:207], v[148:151], a[4:7]
    ds_read_b128 a[140:143], v2 offset:3072
    v_cndmask_b32 v84, v84, v8, s[16:17]
    v_mfma_f32_16x16x32_bf16 a[36:39], a[200:203], v[152:155], a[36:39]
    buffer_load_dwordx4 v178, s[8:11], s58 offen offset:2048 lds
    v_mfma_f32_16x16x32_bf16 a[36:39], a[204:207], v[156:159], a[36:39]
    ds_read_b128 a[144:147], v2 offset:4096
    v_cndmask_b32 v86, v86, v8, s[20:21]
    v_mfma_f32_16x16x32_bf16 a[8:11], a[208:211], v[144:147], a[8:11]
    buffer_load_dwordx4 v179, s[8:11], s58 offen offset:3072 lds
    v_mfma_f32_16x16x32_bf16 a[8:11], a[212:215], v[148:151], a[8:11]
    ds_read_b128 a[148:151], v2 offset:5120
    v_mfma_f32_16x16x32_bf16 a[40:43], a[208:211], v[152:155], a[40:43]
    ds_read_b128 a[152:155], v2 offset:6144
    v_cndmask_b32 v100, v100, v8, s[24:25]
    v_mfma_f32_16x16x32_bf16 a[40:43], a[212:215], v[156:159], a[40:43]
    v_exp_f32 v86, v86
    v_mfma_f32_16x16x32_bf16 a[12:15], a[216:219], v[144:147], a[12:15]
    s_add_u32 m0, s56, 8192
    s_add_u32 s58, s55, 65536
    buffer_load_dwordx4 v176, s[8:11], s58 offen offset:0 lds
    v_mfma_f32_16x16x32_bf16 a[12:15], a[220:223], v[148:151], a[12:15]
    ds_read_b128 a[156:159], v2 offset:7168
    v_exp_f32 v100, v100
    v_mfma_f32_16x16x32_bf16 a[44:47], a[216:219], v[152:155], a[44:47]
    buffer_load_dwordx4 v177, s[8:11], s58 offen offset:1024 lds
    v_mfma_f32_16x16x32_bf16 a[44:47], a[220:223], v[156:159], a[44:47]
    ds_read_b128 a[160:163], v2 offset:8192
    v_cndmask_b32 v85, v85, v8, s[18:19]
    v_mfma_f32_16x16x32_bf16 a[16:19], a[224:227], v[144:147], a[16:19]
    buffer_load_dwordx4 v178, s[8:11], s58 offen offset:2048 lds
    v_mfma_f32_16x16x32_bf16 a[16:19], a[228:231], v[148:151], a[16:19]
    ds_read_b128 a[164:167], v2 offset:9216
    v_cndmask_b32 v101, v101, v8, s[26:27]
    v_mfma_f32_16x16x32_bf16 a[48:51], a[224:227], v[152:155], a[48:51]
    buffer_load_dwordx4 v179, s[8:11], s58 offen offset:3072 lds
    v_mfma_f32_16x16x32_bf16 a[48:51], a[228:231], v[156:159], a[48:51]
    ds_read_b128 a[168:171], v2 offset:10240
    v_exp_f32 v87, v87
    v_mfma_f32_16x16x32_bf16 a[20:23], a[232:235], v[144:147], a[20:23]
    s_waitcnt lgkmcnt(4)
    v_exp_f32 v84, v84
    v_mfma_f32_16x16x32_bf16 a[20:23], a[236:239], v[148:151], a[20:23]
    ds_read_b128 a[172:175], v2 offset:11264
    v_mfma_f32_16x16x32_bf16 a[52:55], a[232:235], v[152:155], a[52:55]
    s_add_u32 m0, s56, 12288
    s_add_u32 s58, s55, 98304
    buffer_load_dwordx4 v176, s[8:11], s58 offen offset:0 lds
    v_mfma_f32_16x16x32_bf16 a[52:55], a[236:239], v[156:159], a[52:55]
    ds_read_b128 a[176:179], v2 offset:12288
    v_cndmask_b32 v103, v103, v8, s[30:31]
    v_mfma_f32_16x16x32_bf16 a[24:27], a[240:243], v[144:147], a[24:27]
    buffer_load_dwordx4 v177, s[8:11], s58 offen offset:1024 lds
    v_mfma_f32_16x16x32_bf16 a[24:27], a[244:247], v[148:151], a[24:27]
    ds_read_b128 a[180:183], v2 offset:13312
    v_exp_f32 v103, v103
    v_mfma_f32_16x16x32_bf16 a[56:59], a[240:243], v[152:155], a[56:59]
    buffer_load_dwordx4 v178, s[8:11], s58 offen offset:2048 lds
    v_mfma_f32_16x16x32_bf16 a[56:59], a[244:247], v[156:159], a[56:59]
    ds_read_b128 a[184:187], v2 offset:14336
    v_mfma_f32_16x16x32_bf16 a[28:31], a[248:251], v[144:147], a[28:31]
    buffer_load_dwordx4 v179, s[8:11], s58 offen offset:3072 lds
    v_mfma_f32_16x16x32_bf16 a[28:31], a[252:255], v[148:151], a[28:31]
    ds_read_b128 a[188:191], v2 offset:15360
    v_mfma_f32_16x16x32_bf16 a[60:63], a[248:251], v[152:155], a[60:63]
    v_exp_f32 v85, v85
    v_mfma_f32_16x16x32_bf16 a[60:63], a[252:255], v[156:159], a[60:63]
    v_exp_f32 v101, v101
L_att_F:
    v_cvt_pk_bf16_f32 v152, v84, v85
    v_cvt_pk_bf16_f32 v153, v86, v87
    v_cvt_pk_bf16_f32 v154, v100, v101
    v_cvt_pk_bf16_f32 v155, v102, v103
    v_cndmask_b32 v116, v116, v8, s[32:33]
    v_exp_f32 v116, v116
    v_cndmask_b32 v117, v117, v8, s[34:35]
    v_exp_f32 v117, v117
    v_cndmask_b32 v118, v118, v8, s[36:37]
    v_exp_f32 v118, v118
    v_cndmask_b32 v119, v119, v8, s[38:39]
    v_exp_f32 v119, v119
    v_cvt_pk_bf16_f32 v156, v116, v117
    v_cvt_pk_bf16_f32 v157, v118, v119
    v_cndmask_b32 v132, v132, v8, s[40:41]
    v_exp_f32 v132, v132
    v_cndmask_b32 v133, v133, v8, s[42:43]
    v_exp_f32 v133, v133
    v_cndmask_b32 v134, v134, v8, s[44:45]
    v_exp_f32 v134, v134
    v_cndmask_b32 v135, v135, v8, s[46:47]
    v_exp_f32 v135, v135
    v_cvt_pk_bf16_f32 v158, v132, v133
    v_cvt_pk_bf16_f32 v159, v134, v135
    v_mfma_f32_16x16x32_bf16 v[196:199], v[4:7], v[152:155], v[196:199]
    s_nop 0
    v_mfma_f32_16x16x32_bf16 v[196:199], v[4:7], v[156:159], v[196:199]
    v_mfma_f32_16x16x32_bf16 a[32:35], a[128:131], v[152:155], a[32:35]
    v_rcp_f32 v9, v192
    v_accvgpr_read_b32 v220, a12
    v_accvgpr_read_b32 v221, a13
    v_accvgpr_read_b32 v222, a14
    v_accvgpr_read_b32 v223, a15
    v_mfma_f32_16x16x32_bf16 a[32:35], a[132:135], v[156:159], a[32:35]
    v_accvgpr_read_b32 v208, a0
    v_mul_f32 v208, v208, v9
    v_mul_f32 v220, v220, v9
    v_mul_f32 v221, v221, v9
    v_cvt_pk_bf16_f32 v230, v220, v221
    v_mul_f32 v222, v222, v9
    v_mul_f32 v223, v223, v9
    v_cvt_pk_bf16_f32 v231, v222, v223
    v_mfma_f32_16x16x32_bf16 a[36:39], a[136:139], v[152:155], a[36:39]
    v_accvgpr_read_b32 v209, a1
    v_mul_f32 v209, v209, v9
    v_mfma_f32_16x16x32_bf16 a[36:39], a[140:143], v[156:159], a[36:39]
    v_cvt_pk_bf16_f32 v224, v208, v209
    v_accvgpr_read_b32 v210, a2
    v_mfma_f32_16x16x32_bf16 a[40:43], a[144:147], v[152:155], a[40:43]
    v_mul_f32 v210, v210, v9
    v_accvgpr_read_b32 v211, a3
    v_mfma_f32_16x16x32_bf16 a[40:43], a[148:151], v[156:159], a[40:43]
    v_mul_f32 v211, v211, v9
    v_cvt_pk_bf16_f32 v225, v210, v211
    v_mfma_f32_16x16x32_bf16 a[44:47], a[152:155], v[152:155], a[44:47]
    s_waitcnt lgkmcnt(0)
    v_accvgpr_read_b32 v212, a4
    v_mul_f32 v212, v212, v9
    v_mfma_f32_16x16x32_bf16 a[44:47], a[156:159], v[156:159], a[44:47]
    v_accvgpr_read_b32 v213, a5
    v_mul_f32 v213, v213, v9
    v_mfma_f32_16x16x32_bf16 a[48:51], a[160:163], v[152:155], a[48:51]
    v_cvt_pk_bf16_f32 v226, v212, v213
    v_accvgpr_read_b32 v214, a6
    v_mfma_f32_16x16x32_bf16 a[48:51], a[164:167], v[156:159], a[48:51]
    v_mul_f32 v214, v214, v9
    v_accvgpr_read_b32 v215, a7
    v_mfma_f32_16x16x32_bf16 a[52:55], a[168:171], v[152:155], a[52:55]
    v_mul_f32 v215, v215, v9
    v_cvt_pk_bf16_f32 v227, v214, v215
    v_accvgpr_read_b32 v208, a16
    v_mul_f32 v208, v208, v9
    v_accvgpr_read_b32 v209, a17
    v_mul_f32 v209, v209, v9
    v_cvt_pk_bf16_f32 v232, v208, v209
    v_accvgpr_read_b32 v210, a18
    v_mul_f32 v210, v210, v9
    v_accvgpr_read_b32 v211, a19
    v_mul_f32 v211, v211, v9
    v_cvt_pk_bf16_f32 v233, v210, v211
    v_accvgpr_read_b32 v212, a20
    v_mul_f32 v212, v212, v9
    v_accvgpr_read_b32 v213, a21
    v_mul_f32 v213, v213, v9
    v_cvt_pk_bf16_f32 v234, v212, v213
    v_accvgpr_read_b32 v214, a22
    v_mul_f32 v214, v214, v9
    v_accvgpr_read_b32 v215, a23
    v_mul_f32 v215, v215, v9
    v_cvt_pk_bf16_f32 v235, v214, v215
    v_mfma_f32_16x16x32_bf16 a[52:55], a[172:175], v[156:159], a[52:55]
    v_accvgpr_read_b32 v216, a8
    v_mul_f32 v216, v216, v9
    v_mfma_f32_16x16x32_bf16 a[56:59], a[176:179], v[152:155], a[56:59]
    v_accvgpr_read_b32 v217, a9
    v_mul_f32 v217, v217, v9
    v_mfma_f32_16x16x32_bf16 a[56:59], a[180:183], v[156:159], a[56:59]
    v_cvt_pk_bf16_f32 v228, v216, v217
    v_accvgpr_read_b32 v218, a10
    v_mfma_f32_16x16x32_bf16 a[60:63], a[184:187], v[152:155], a[60:63]
    v_mul_f32 v218, v218, v9
    v_accvgpr_read_b32 v219, a11
    v_mfma_f32_16x16x32_bf16 a[60:63], a[188:191], v[156:159], a[60:63]
    v_mul_f32 v219, v219, v9
    v_cvt_pk_bf16_f32 v229, v218, v219
    v_accvgpr_read_b32 v216, a24
    v_mul_f32 v216, v216, v9
    v_accvgpr_read_b32 v217, a25
    v_mul_f32 v217, v217, v9
    v_cvt_pk_bf16_f32 v236, v216, v217
    v_accvgpr_read_b32 v218, a26
    v_mul_f32 v218, v218, v9
    v_accvgpr_read_b32 v219, a27
    v_mul_f32 v219, v219, v9
    v_cvt_pk_bf16_f32 v237, v218, v219
    v_accvgpr_read_b32 v220, a28
    v_mul_f32 v220, v220, v9
    v_accvgpr_read_b32 v221, a29
    v_mul_f32 v221, v221, v9
    v_cvt_pk_bf16_f32 v238, v220, v221
    v_accvgpr_read_b32 v222, a30
    v_mul_f32 v222, v222, v9
    v_accvgpr_read_b32 v223, a31
    v_mul_f32 v223, v223, v9
    v_cvt_pk_bf16_f32 v239, v222, v223
    s_mul_i32 s51, s60, 136192
    s_add_u32 s51, s51, s57
    buffer_store_dwordx4 v[224:227], v1, s[4:7], s51 offen offset:0 sc1
    v_mfma_f32_16x16x32_bf16 v[240:243], v[224:227], v[4:7], 0
    buffer_store_dwordx4 v[228:231], v1, s[4:7], s51 offen offset:1024 sc1
    v_mfma_f32_16x16x32_bf16 v[240:243], v[228:231], v[4:7], v[240:243]
    buffer_store_dwordx4 v[232:235], v1, s[4:7], s51 offen offset:2048 sc1
    v_mfma_f32_16x16x32_bf16 v[240:243], v[232:235], v[4:7], v[240:243]
    buffer_store_dwordx4 v[236:239], v1, s[4:7], s51 offen offset:3072 sc1
    v_mfma_f32_16x16x32_bf16 v[240:243], v[236:239], v[4:7], v[240:243]
    v_cmp_ngt_f32 vcc, 0x71800000, v192
    s_or_b32 s59, s59, vcc_lo
    s_or_b32 s59, s59, vcc_hi
    v_rcp_f32 v10, v196
    v_cmp_ngt_f32 vcc, 0x71800000, v196
    s_or_b32 s59, s59, vcc_lo
    s_or_b32 s59, s59, vcc_hi
    s_mul_i32 s51, s61, 136192
    s_add_u32 s51, s51, s57
    v_accvgpr_read_b32 v208, a32
    v_accvgpr_read_b32 v209, a33
    v_accvgpr_read_b32 v210, a34
    v_accvgpr_read_b32 v211, a35
    v_accvgpr_read_b32 v212, a36
    v_accvgpr_read_b32 v213, a37
    v_accvgpr_read_b32 v214, a38
    v_accvgpr_read_b32 v215, a39
    v_pk_mul_f32 v[208:209], v[208:209], v[10:11] op_sel:[0,0] op_sel_hi:[1,0]
    v_pk_mul_f32 v[210:211], v[210:211], v[10:11] op_sel:[0,0] op_sel_hi:[1,0]
    v_pk_mul_f32 v[212:213], v[212:213], v[10:11] op_sel:[0,0] op_sel_hi:[1,0]
    v_pk_mul_f32 v[214:215], v[214:215], v[10:11] op_sel:[0,0] op_sel_hi:[1,0]
    v_cvt_pk_bf16_f32 v224, v208, v209
    v_cvt_pk_bf16_f32 v225, v210, v211
    v_cvt_pk_bf16_f32 v226, v212, v213
    v_cvt_pk_bf16_f32 v227, v214, v215
    buffer_store_dwordx4 v[224:227], v1, s[4:7], s51 offen offset:0 sc1
    s_nop 0
    v_mfma_f32_16x16x32_bf16 v[240:243], v[224:227], v[4:7], v[240:243]
    v_accvgpr_read_b32 v216, a40
    v_accvgpr_read_b32 v217, a41
    v_accvgpr_read_b32 v218, a42
    v_accvgpr_read_b32 v219, a43
    v_accvgpr_read_b32 v220, a44
    v_accvgpr_read_b32 v221, a45
    v_accvgpr_read_b32 v222, a46
    v_accvgpr_read_b32 v223, a47
    v_pk_mul_f32 v[216:217], v[216:217], v[10:11] op_sel:[0,0] op_sel_hi:[1,0]
    v_pk_mul_f32 v[218:219], v[218:219], v[10:11] op_sel:[0,0] op_sel_hi:[1,0]
    v_pk_mul_f32 v[220:221], v[220:221], v[10:11] op_sel:[0,0] op_sel_hi:[1,0]
    v_pk_mul_f32 v[222:223], v[222:223], v[10:11] op_sel:[0,0] op_sel_hi:[1,0]
    v_cvt_pk_bf16_f32 v228, v216, v217
    v_cvt_pk_bf16_f32 v229, v218, v219
    v_cvt_pk_bf16_f32 v230, v220, v221
    v_cvt_pk_bf16_f32 v231, v222, v223
    buffer_store_dwordx4 v[228:231], v1, s[4:7], s51 offen offset:1024 sc1
    s_nop 0
    v_mfma_f32_16x16x32_bf16 v[240:243], v[228:231], v[4:7], v[240:243]
    v_accvgpr_read_b32 v208, a48
    v_accvgpr_read_b32 v209, a49
    v_accvgpr_read_b32 v210, a50
    v_accvgpr_read_b32 v211, a51
    v_accvgpr_read_b32 v212, a52
    v_accvgpr_read_b32 v213, a53
    v_accvgpr_read_b32 v214, a54
    v_accvgpr_read_b32 v215, a55
    v_pk_mul_f32 v[208:209], v[208:209], v[10:11] op_sel:[0,0] op_sel_hi:[1,0]
    v_pk_mul_f32 v[210:211], v[210:211], v[10:11] op_sel:[0,0] op_sel_hi:[1,0]
    v_pk_mul_f32 v[212:213], v[212:213], v[10:11] op_sel:[0,0] op_sel_hi:[1,0]
    v_pk_mul_f32 v[214:215], v[214:215], v[10:11] op_sel:[0,0] op_sel_hi:[1,0]
    v_cvt_pk_bf16_f32 v232, v208, v209
    v_cvt_pk_bf16_f32 v233, v210, v211
    v_cvt_pk_bf16_f32 v234, v212, v213
    v_cvt_pk_bf16_f32 v235, v214, v215
    buffer_store_dwordx4 v[232:235], v1, s[4:7], s51 offen offset:2048 sc1
    s_nop 0
    v_mfma_f32_16x16x32_bf16 v[240:243], v[232:235], v[4:7], v[240:243]
    v_accvgpr_read_b32 v216, a56
    v_accvgpr_read_b32 v217, a57
    v_accvgpr_read_b32 v218, a58
    v_accvgpr_read_b32 v219, a59
    v_accvgpr_read_b32 v220, a60
    v_accvgpr_read_b32 v221, a61
    v_accvgpr_read_b32 v222, a62
    v_accvgpr_read_b32 v223, a63
    v_pk_mul_f32 v[216:217], v[216:217], v[10:11] op_sel:[0,0] op_sel_hi:[1,0]
    v_pk_mul_f32 v[218:219], v[218:219], v[10:11] op_sel:[0,0] op_sel_hi:[1,0]
    v_pk_mul_f32 v[220:221], v[220:221], v[10:11] op_sel:[0,0] op_sel_hi:[1,0]
    v_pk_mul_f32 v[222:223], v[222:223], v[10:11] op_sel:[0,0] op_sel_hi:[1,0]
    v_cvt_pk_bf16_f32 v236, v216, v217
    v_cvt_pk_bf16_f32 v237, v218, v219
    v_cvt_pk_bf16_f32 v238, v220, v221
    v_cvt_pk_bf16_f32 v239, v222, v223
    buffer_store_dwordx4 v[236:239], v1, s[4:7], s51 offen offset:3072 sc1
    s_nop 0
    v_mfma_f32_16x16x32_bf16 v[240:243], v[236:239], v[4:7], v[240:243]
    s_movk_i32 s51, 0x207
    s_nop 6
    v_cmp_class_f32 vcc, v240, s51
    s_or_b32 s59, s59, vcc_lo
    s_or_b32 s59, s59, vcc_hi
    v_cmp_class_f32 vcc, v241, s51
    s_or_b32 s59, s59, vcc_lo
    s_or_b32 s59, s59, vcc_hi
    v_cmp_class_f32 vcc, v242, s51
    s_or_b32 s59, s59, vcc_lo
    s_or_b32 s59, s59, vcc_hi
    v_cmp_class_f32 vcc, v243, s51
    s_or_b32 s59, s59, vcc_lo
    s_or_b32 s59, s59, vcc_hi
L_att_done:
    v_mov_b32 v9, s59
    s_lshl_b32 s51, s3, 2
    s_add_u32 s51, s51, 131072
    v_mov_b32 v10, s51
    ds_write_b32 v10, v9
    v_mov_b32 v10, 131072
    s_load_dwordx2 s[20:21], s[0:1], 0
    s_load_dwordx2 s[24:25], s[0:1], 80
    s_load_dwordx4 s[64:67], s[0:1], 56
    s_and_b32 s58, s2, 7
    s_lshr_b32 s37, s2, 3
    s_and_b32 s33, s37, 15
    s_lshl_b32 s46, s58, 4
    s_add_u32 s46, s46, s33
    s_add_u32 s32, s58, 8
    s_cmp_lt_u32 s58, 4
    s_cselect_b32 s32, s58, s32
    s_add_u32 s58, s58, 4
    s_cmp_ge_u32 s37, 16
    s_cselect_b32 s32, s58, s32
    s_cselect_b32 s46, s46, 128
    s_lshr_b32 s34, s33, 3
    s_lshl_b32 s58, s32, 1
    s_add_u32 s34, s34, s58
    s_and_b32 s35, s33, 7
    s_mul_i32 s37, s3, 32768
    s_add_u32 s37, s37, 42991616
    s_add_u32 s58, s3, 0
    s_and_b32 s58, s58, 3
    s_lshl_b32 s38, s34, 2
    s_add_u32 s38, s38, s58
    s_mul_i32 s38, s38, 136192
    s_add_u32 s38, s38, s37
    s_add_u32 s58, s3, 1
    s_and_b32 s58, s58, 3
    s_lshl_b32 s39, s34, 2
    s_add_u32 s39, s39, s58
    s_mul_i32 s39, s39, 136192
    s_add_u32 s39, s39, s37
    s_add_u32 s58, s3, 2
    s_and_b32 s58, s58, 3
    s_lshl_b32 s40, s34, 2
    s_add_u32 s40, s40, s58
    s_mul_i32 s40, s40, 136192
    s_add_u32 s40, s40, s37
    s_add_u32 s58, s3, 3
    s_and_b32 s58, s58, 3
    s_lshl_b32 s41, s34, 2
    s_add_u32 s41, s41, s58
    s_mul_i32 s41, s41, 136192
    s_add_u32 s41, s41, s37
    v_lshrrev_b32 v188, 4, v0
    v_bfe_u32 v189, v0, 2, 2
    v_lshl_add_u32 v189, v188, 2, v189
    v_bfe_u32 v188, v189, 1, 2
    v_lshlrev_b32 v189, 7, v189
    v_and_b32 v190, 3, v0
    v_lshl_add_u32 v189, v190, 3, v189
    v_add_u32 v189, s56, v189
    v_xor_b32 v190, 0, v188
    v_lshl_add_u32 v180, v190, 5, v189
    v_add_u32 v248, 0x10000, v180
    v_xor_b32 v190, 1, v188
    v_lshl_add_u32 v181, v190, 5, v189
    v_add_u32 v249, 0x10000, v181
    v_xor_b32 v190, 2, v188
    v_lshl_add_u32 v182, v190, 5, v189
    v_add_u32 v250, 0x10000, v182
    v_xor_b32 v190, 3, v188
    v_lshl_add_u32 v183, v190, 5, v189
    v_add_u32 v251, 0x10000, v183
    s_add_u32 s58, s3, 0
    s_and_b32 s58, s58, 3
    s_lshl_b32 s58, s58, 12
    s_add_u32 s58, s58, s56
    v_add_u32 v184, s58, v1
    s_add_u32 s58, s3, 1
    s_and_b32 s58, s58, 3
    s_lshl_b32 s58, s58, 12
    s_add_u32 s58, s58, s56
    v_add_u32 v185, s58, v1
    s_add_u32 s58, s3, 2
    s_and_b32 s58, s58, 3
    s_lshl_b32 s58, s58, 12
    s_add_u32 s58, s58, s56
    v_add_u32 v186, s58, v1
    s_add_u32 s58, s3, 3
    s_and_b32 s58, s58, 3
    s_lshl_b32 s58, s58, 12
    s_add_u32 s58, s58, s56
    v_add_u32 v187, s58, v1
    s_lshl_b32 s58, s32, 7
    s_add_u32 s58, s58, 74455040
    s_lshl_b32 s37, s3, 5
    s_add_u32 s58, s58, s37
    v_and_b32 v188, 3, v0
    v_lshl_add_u32 v188, v188, 2, s58
    s_waitcnt vmcnt(0) lgkmcnt(0)
    s_barrier
    ds_read_b128 v[208:211], v10
    s_lshl_b32 s51, s49, 2
    s_lshl_b32 s58, s50, 7
    s_add_u32 s53, s58, s51
    s_sub_u32 s54, s51, s58
    s_add_u32 s53, s53, 74455040
    s_add_u32 s54, s54, 74456960
    s_waitcnt lgkmcnt(0)
    v_or_b32 v208, v208, v209
    v_or3_b32 v208, v208, v210, v211
    v_cmp_ne_u32 vcc, 0, v208
    s_cbranch_vccnz L_att_slow
    s_add_u32 s51, s54, s69
    buffer_store_dword v253, v252, s[4:7], s51 offen sc1
    s_add_u32 s51, s53, s69
    buffer_store_dword v253, v252, s[4:7], s51 offen sc1
    s_lshl_b32 s53, s2, 2
    s_add_u32 s53, s53, 74462208
    s_add_u32 s51, s53, s69
    buffer_store_dword v253, v252, s[4:7], s51 offen sc1
    s_mov_b32 s22, 2097152
    s_mov_b32 s23, 0x20000
    s_mov_b32 s26, 2097152
    s_mov_b32 s27, 0x20000
    v_mov_b32 v255, v188
    s_add_u32 m0, s56, 65536
    s_add_u32 s58, s55, 131072
    buffer_load_dwordx4 v176, s[8:11], s58 offen offset:0 lds
    buffer_load_dwordx4 v177, s[8:11], s58 offen offset:1024 lds
    buffer_load_dwordx4 v178, s[8:11], s58 offen offset:2048 lds
    buffer_load_dwordx4 v179, s[8:11], s58 offen offset:3072 lds
    s_add_u32 m0, s56, 69632
    s_add_u32 s58, s55, 163840
    buffer_load_dwordx4 v176, s[8:11], s58 offen offset:0 lds
    buffer_load_dwordx4 v177, s[8:11], s58 offen offset:1024 lds
    buffer_load_dwordx4 v178, s[8:11], s58 offen offset:2048 lds
    buffer_load_dwordx4 v179, s[8:11], s58 offen offset:3072 lds
    s_add_u32 m0, s56, 73728
    s_add_u32 s58, s55, 196608
    buffer_load_dwordx4 v176, s[8:11], s58 offen offset:0 lds
    buffer_load_dwordx4 v177, s[8:11], s58 offen offset:1024 lds
    buffer_load_dwordx4 v178, s[8:11], s58 offen offset:2048 lds
    buffer_load_dwordx4 v179, s[8:11], s58 offen offset:3072 lds
    s_add_u32 m0, s56, 77824
    s_add_u32 s58, s55, 229376
    buffer_load_dwordx4 v176, s[8:11], s58 offen offset:0 lds
    buffer_load_dwordx4 v177, s[8:11], s58 offen offset:1024 lds
    buffer_load_dwordx4 v178, s[8:11], s58 offen offset:2048 lds
    buffer_load_dwordx4 v179, s[8:11], s58 offen offset:3072 lds
    s_cmp_ge_u32 s46, 86
    s_cbranch_scc1 L_nocs
    s_cmp_ge_u32 s46, 43
    s_cselect_b32 s28, s66, s64
    s_cselect_b32 s29, s67, s65
    s_cselect_b32 s58, 43, 0
    s_sub_u32 s58, s46, s58
    s_mov_b32 s30, 1409024
    s_mov_b32 s31, 0x20000
    s_lshl_b32 s58, s58, 6
    s_mul_i32 s37, s3, 352256
    s_add_u32 s58, s58, s37
    v_lshrrev_b32 v189, 2, v0
    v_mul_u32_u24 v189, 2752, v189
    v_and_b32 v190, 3, v0
    v_lshl_add_u32 v189, v190, 4, v189
    buffer_load_dwordx4 v[16:19], v189, s[28:31], s58 offen
    s_add_u32 s58, s58, 44032
    buffer_load_dwordx4 v[20:23], v189, s[28:31], s58 offen
    s_add_u32 s58, s58, 44032
    buffer_load_dwordx4 v[24:27], v189, s[28:31], s58 offen
    s_add_u32 s58, s58, 44032
    buffer_load_dwordx4 v[28:31], v189, s[28:31], s58 offen
    s_add_u32 s58, s58, 44032
    buffer_load_dwordx4 v[32:35], v189, s[28:31], s58 offen
    s_add_u32 s58, s58, 44032
    buffer_load_dwordx4 v[36:39], v189, s[28:31], s58 offen
    s_add_u32 s58, s58, 44032
    buffer_load_dwordx4 v[40:43], v189, s[28:31], s58 offen
    s_add_u32 s58, s58, 44032
    buffer_load_dwordx4 v[44:47], v189, s[28:31], s58 offen
    s_waitcnt vmcnt(7)
    v_lshlrev_b32 v48, 16, v16
    v_and_b32 v49, 0xffff0000, v16
    v_lshlrev_b32 v50, 16, v17
    v_and_b32 v51, 0xffff0000, v17
    v_lshlrev_b32 v52, 16, v18
    v_and_b32 v53, 0xffff0000, v18
    v_lshlrev_b32 v54, 16, v19
    v_and_b32 v55, 0xffff0000, v19
    s_waitcnt vmcnt(6)
    v_lshlrev_b32 v56, 16, v20
    v_and_b32 v57, 0xffff0000, v20
    v_add_f32 v48, v48, v56
    v_add_f32 v49, v49, v57
    v_lshlrev_b32 v56, 16, v21
    v_and_b32 v57, 0xffff0000, v21
    v_add_f32 v50, v50, v56
    v_add_f32 v51, v51, v57
    v_lshlrev_b32 v56, 16, v22
    v_and_b32 v57, 0xffff0000, v22
    v_add_f32 v52, v52, v56
    v_add_f32 v53, v53, v57
    v_lshlrev_b32 v56, 16, v23
    v_and_b32 v57, 0xffff0000, v23
    v_add_f32 v54, v54, v56
    v_add_f32 v55, v55, v57
    s_waitcnt vmcnt(5)
    v_lshlrev_b32 v56, 16, v24
    v_and_b32 v57, 0xffff0000, v24
    v_add_f32 v48, v48, v56
    v_add_f32 v49, v49, v57
    v_lshlrev_b32 v56, 16, v25
    v_and_b32 v57, 0xffff0000, v25
    v_add_f32 v50, v50, v56
    v_add_f32 v51, v51, v57
    v_lshlrev_b32 v56, 16, v26
    v_and_b32 v57, 0xffff0000, v26
    v_add_f32 v52, v52, v56
    v_add_f32 v53, v53, v57
    v_lshlrev_b32 v56, 16, v27
    v_and_b32 v57, 0xffff0000, v27
    v_add_f32 v54, v54, v56
    v_add_f32 v55, v55, v57
    s_waitcnt vmcnt(4)
    v_lshlrev_b32 v56, 16, v28
    v_and_b32 v57, 0xffff0000, v28
    v_add_f32 v48, v48, v56
    v_add_f32 v49, v49, v57
    v_lshlrev_b32 v56, 16, v29
    v_and_b32 v57, 0xffff0000, v29
    v_add_f32 v50, v50, v56
    v_add_f32 v51, v51, v57
    v_lshlrev_b32 v56, 16, v30
    v_and_b32 v57, 0xffff0000, v30
    v_add_f32 v52, v52, v56
    v_add_f32 v53, v53, v57
    v_lshlrev_b32 v56, 16, v31
    v_and_b32 v57, 0xffff0000, v31
    v_add_f32 v54, v54, v56
    v_add_f32 v55, v55, v57
    s_waitcnt vmcnt(3)
    v_lshlrev_b32 v56, 16, v32
    v_and_b32 v57, 0xffff0000, v32
    v_add_f32 v48, v48, v56
    v_add_f32 v49, v49, v57
    v_lshlrev_b32 v56, 16, v33
    v_and_b32 v57, 0xffff0000, v33
    v_add_f32 v50, v50, v56
    v_add_f32 v51, v51, v57
    v_lshlrev_b32 v56, 16, v34
    v_and_b32 v57, 0xffff0000, v34
    v_add_f32 v52, v52, v56
    v_add_f32 v53, v53, v57
    v_lshlrev_b32 v56, 16, v35
    v_and_b32 v57, 0xffff0000, v35
    v_add_f32 v54, v54, v56
    v_add_f32 v55, v55, v57
    s_waitcnt vmcnt(2)
    v_lshlrev_b32 v56, 16, v36
    v_and_b32 v57, 0xffff0000, v36
    v_add_f32 v48, v48, v56
    v_add_f32 v49, v49, v57
    v_lshlrev_b32 v56, 16, v37
    v_and_b32 v57, 0xffff0000, v37
    v_add_f32 v50, v50, v56
    v_add_f32 v51, v51, v57
    v_lshlrev_b32 v56, 16, v38
    v_and_b32 v57, 0xffff0000, v38
    v_add_f32 v52, v52, v56
    v_add_f32 v53, v53, v57
    v_lshlrev_b32 v56, 16, v39
    v_and_b32 v57, 0xffff0000, v39
    v_add_f32 v54, v54, v56
    v_add_f32 v55, v55, v57
    s_waitcnt vmcnt(1)
    v_lshlrev_b32 v56, 16, v40
    v_and_b32 v57, 0xffff0000, v40
    v_add_f32 v48, v48, v56
    v_add_f32 v49, v49, v57
    v_lshlrev_b32 v56, 16, v41
    v_and_b32 v57, 0xffff0000, v41
    v_add_f32 v50, v50, v56
    v_add_f32 v51, v51, v57
    v_lshlrev_b32 v56, 16, v42
    v_and_b32 v57, 0xffff0000, v42
    v_add_f32 v52, v52, v56
    v_add_f32 v53, v53, v57
    v_lshlrev_b32 v56, 16, v43
    v_and_b32 v57, 0xffff0000, v43
    v_add_f32 v54, v54, v56
    v_add_f32 v55, v55, v57
    s_waitcnt vmcnt(0)
    v_lshlrev_b32 v56, 16, v44
    v_and_b32 v57, 0xffff0000, v44
    v_add_f32 v48, v48, v56
    v_add_f32 v49, v49, v57
    v_lshlrev_b32 v56, 16, v45
    v_and_b32 v57, 0xffff0000, v45
    v_add_f32 v50, v50, v56
    v_add_f32 v51, v51, v57
    v_lshlrev_b32 v56, 16, v46
    v_and_b32 v57, 0xffff0000, v46
    v_add_f32 v52, v52, v56
    v_add_f32 v53, v53, v57
    v_lshlrev_b32 v56, 16, v47
    v_and_b32 v57, 0xffff0000, v47
    v_add_f32 v54, v54, v56
    v_add_f32 v55, v55, v57
    v_add_f32_dpp v48, v48, v48 row_ror:4 row_mask:0xf bank_mask:0xf
    v_add_f32_dpp v49, v49, v49 row_ror:4 row_mask:0xf bank_mask:0xf
    v_add_f32_dpp v50, v50, v50 row_ror:4 row_mask:0xf bank_mask:0xf
    v_add_f32_dpp v51, v51, v51 row_ror:4 row_mask:0xf bank_mask:0xf
    v_add_f32_dpp v52, v52, v52 row_ror:4 row_mask:0xf bank_mask:0xf
    v_add_f32_dpp v53, v53, v53 row_ror:4 row_mask:0xf bank_mask:0xf
    v_add_f32_dpp v54, v54, v54 row_ror:4 row_mask:0xf bank_mask:0xf
    v_add_f32_dpp v55, v55, v55 row_ror:4 row_mask:0xf bank_mask:0xf
    v_add_f32_dpp v48, v48, v48 row_ror:8 row_mask:0xf bank_mask:0xf
    v_add_f32_dpp v49, v49, v49 row_ror:8 row_mask:0xf bank_mask:0xf
    v_add_f32_dpp v50, v50, v50 row_ror:8 row_mask:0xf bank_mask:0xf
    v_add_f32_dpp v51, v51, v51 row_ror:8 row_mask:0xf bank_mask:0xf
    v_add_f32_dpp v52, v52, v52 row_ror:8 row_mask:0xf bank_mask:0xf
    v_add_f32_dpp v53, v53, v53 row_ror:8 row_mask:0xf bank_mask:0xf
    v_add_f32_dpp v54, v54, v54 row_ror:8 row_mask:0xf bank_mask:0xf
    v_add_f32_dpp v55, v55, v55 row_ror:8 row_mask:0xf bank_mask:0xf
    v_permlane32_swap_b32 v48, v49
    v_permlane32_swap_b32 v50, v51
    v_permlane32_swap_b32 v52, v53
    v_permlane32_swap_b32 v54, v55
    v_add_f32 v48, v48, v49
    v_add_f32 v50, v50, v51
    v_add_f32 v52, v52, v53
    v_add_f32 v54, v54, v55
    v_permlane16_swap_b32 v48, v50
    s_nop 0
    v_permlane16_swap_b32 v52, v54
    v_add_f32 v48, v48, v50
    v_add_f32 v49, v52, v54
    s_lshl_b32 s58, s3, 9
    s_add_u32 s58, s58, 132096
    v_lshl_add_u32 v189, v0, 3, s58
    ds_write_b64 v189, v[48:49]
    v_lshlrev_b32 v189, 3, v0
    v_add_u32 v189, 132096, v189
    s_waitcnt lgkmcnt(0)
    s_barrier
    ds_read_b64 v[16:17], v189 offset:0
    ds_read_b64 v[18:19], v189 offset:512
    ds_read_b64 v[20:21], v189 offset:1024
    ds_read_b64 v[22:23], v189 offset:1536
    v_bfe_u32 v189, v0, 4, 1
    v_lshrrev_b32 v190, 5, v0
    v_lshl_add_u32 v189, v189, 1, v190
    v_and_b32 v190, 3, v0
    v_lshl_add_u32 v189, v190, 3, v189
    v_lshlrev_b32 v189, 2, v189
    s_lshl_b32 s58, s46, 7
    s_add_u32 s58, s58, 65011712
    s_add_u32 s58, s58, s69
    s_waitcnt lgkmcnt(2)
    v_add_f32 v48, v16, v18
    v_add_f32 v49, v17, v19
    s_waitcnt lgkmcnt(1)
    v_add_f32 v48, v48, v20
    v_add_f32 v49, v49, v21
    s_waitcnt lgkmcnt(0)
    v_add_f32 v48, v48, v22
    v_add_f32 v49, v49, v23
    buffer_store_dword v48, v189, s[4:7], s58 offen sc1
    buffer_store_dword v49, v189, s[4:7], s58 offen offset:16 sc1
L_nocs:
    s_lshl_b32 s45, s34, 6
    s_add_u32 s45, s45, s3
    s_lshl_b32 s45, s45, 10
    s_lshl_b32 s37, s35, 7
    s_add_u32 s45, s45, s37
    v_and_b32 v188, 15, v0
    v_lshrrev_b32 v189, 4, v0
    v_lshlrev_b32 v189, 3, v189
    v_lshl_add_u32 v188, v188, 12, v189
    buffer_load_dword v254, v255, s[4:7], 0 offen sc1
    s_mov_b32 s47, 131072
    s_waitcnt vmcnt(0)
    v_cmp_ne_u32 vcc, 1, v254
    s_cbranch_vccz L_ok_ctx
L_spin_ctx:
    buffer_load_dword v254, v255, s[4:7], 0 offen sc1
    s_sub_u32 s47, s47, 1
    s_cbranch_scc1 L_ok_ctx
    s_waitcnt vmcnt(0)
    v_cmp_ne_u32 vcc, 1, v254
    s_cbranch_vccnz L_spin_ctx
L_ok_ctx:
    buffer_load_dwordx4 v[16:19], v1, s[4:7], s38 offen offset:0 sc1
    buffer_load_dwordx4 v[20:23], v1, s[4:7], s39 offen offset:0 sc1
    buffer_load_dwordx4 v[24:27], v1, s[4:7], s40 offen offset:0 sc1
    buffer_load_dwordx4 v[28:31], v1, s[4:7], s41 offen offset:0 sc1
    ds_read_b64_tr_b16 v[192:193], v180 offset:0
    ds_read_b64_tr_b16 v[194:195], v180 offset:2048
    ds_read_b64_tr_b16 v[196:197], v181 offset:0
    ds_read_b64_tr_b16 v[198:199], v181 offset:2048
    ds_read_b64_tr_b16 v[200:201], v182 offset:0
    ds_read_b64_tr_b16 v[202:203], v182 offset:2048
    ds_read_b64_tr_b16 v[204:205], v183 offset:0
    ds_read_b64_tr_b16 v[206:207], v183 offset:2048
    buffer_load_dwordx4 v[32:35], v1, s[4:7], s38 offen offset:1024 sc1
    buffer_load_dwordx4 v[36:39], v1, s[4:7], s39 offen offset:1024 sc1
    buffer_load_dwordx4 v[40:43], v1, s[4:7], s40 offen offset:1024 sc1
    buffer_load_dwordx4 v[44:47], v1, s[4:7], s41 offen offset:1024 sc1
    buffer_load_dwordx4 v[48:51], v1, s[4:7], s38 offen offset:2048 sc1
    buffer_load_dwordx4 v[52:55], v1, s[4:7], s39 offen offset:2048 sc1
    buffer_load_dwordx4 v[56:59], v1, s[4:7], s40 offen offset:2048 sc1
    buffer_load_dwordx4 v[60:63], v1, s[4:7], s41 offen offset:2048 sc1
    buffer_load_dwordx4 v[64:67], v1, s[4:7], s38 offen offset:3072 sc1
    buffer_load_dwordx4 v[68:71], v1, s[4:7], s39 offen offset:3072 sc1
    buffer_load_dwordx4 v[72:75], v1, s[4:7], s40 offen offset:3072 sc1
    buffer_load_dwordx4 v[76:79], v1, s[4:7], s41 offen offset:3072 sc1
    s_waitcnt vmcnt(12) lgkmcnt(0)
    v_mfma_f32_16x16x32_bf16 v[80:83], v[192:195], v[16:19], 0
    ds_read_b64_tr_b16 v[208:209], v180 offset:4096
    v_mfma_f32_16x16x32_bf16 v[84:87], v[196:199], v[16:19], 0
    ds_read_b64_tr_b16 v[210:211], v180 offset:6144
    v_mfma_f32_16x16x32_bf16 v[88:91], v[200:203], v[16:19], 0
    ds_read_b64_tr_b16 v[212:213], v181 offset:4096
    v_mfma_f32_16x16x32_bf16 v[92:95], v[204:207], v[16:19], 0
    ds_read_b64_tr_b16 v[214:215], v181 offset:6144
    v_mfma_f32_16x16x32_bf16 v[96:99], v[192:195], v[20:23], 0
    ds_read_b64_tr_b16 v[216:217], v182 offset:4096
    v_mfma_f32_16x16x32_bf16 v[100:103], v[196:199], v[20:23], 0
    ds_read_b64_tr_b16 v[218:219], v182 offset:6144
    v_mfma_f32_16x16x32_bf16 v[104:107], v[200:203], v[20:23], 0
    ds_read_b64_tr_b16 v[220:221], v183 offset:4096
    v_mfma_f32_16x16x32_bf16 v[108:111], v[204:207], v[20:23], 0
    ds_read_b64_tr_b16 v[222:223], v183 offset:6144
    v_mfma_f32_16x16x32_bf16 v[112:115], v[192:195], v[24:27], 0
    s_add_u32 m0, s56, 0
    s_add_u32 s58, s55, 262144
    buffer_load_dwordx4 v176, s[8:11], s58 offen offset:0 lds
    v_mfma_f32_16x16x32_bf16 v[116:119], v[196:199], v[24:27], 0
    s_add_u32 s38, s38, 4096
    buffer_load_dwordx4 v[16:19], v1, s[4:7], s38 offen offset:0 sc1
    v_mfma_f32_16x16x32_bf16 v[120:123], v[200:203], v[24:27], 0
    buffer_load_dwordx4 v177, s[8:11], s58 offen offset:1024 lds
    v_mfma_f32_16x16x32_bf16 v[124:127], v[204:207], v[24:27], 0
    s_add_u32 s39, s39, 4096
    buffer_load_dwordx4 v[20:23], v1, s[4:7], s39 offen offset:0 sc1
    v_mfma_f32_16x16x32_bf16 v[128:131], v[192:195], v[28:31], 0
    buffer_load_dwordx4 v178, s[8:11], s58 offen offset:2048 lds
    v_mfma_f32_16x16x32_bf16 v[132:135], v[196:199], v[28:31], 0
    s_add_u32 s40, s40, 4096
    buffer_load_dwordx4 v[24:27], v1, s[4:7], s40 offen offset:0 sc1
    v_mfma_f32_16x16x32_bf16 v[136:139], v[200:203], v[28:31], 0
    buffer_load_dwordx4 v179, s[8:11], s58 offen offset:3072 lds
    v_mfma_f32_16x16x32_bf16 v[140:143], v[204:207], v[28:31], 0
    s_add_u32 s41, s41, 4096
    buffer_load_dwordx4 v[28:31], v1, s[4:7], s41 offen offset:0 sc1
    s_waitcnt vmcnt(16) lgkmcnt(0)
    v_mfma_f32_16x16x32_bf16 v[80:83], v[208:211], v[32:35], v[80:83]
    ds_read_b64_tr_b16 v[192:193], v180 offset:8192
    v_mfma_f32_16x16x32_bf16 v[84:87], v[212:215], v[32:35], v[84:87]
    ds_read_b64_tr_b16 v[194:195], v180 offset:10240
    v_mfma_f32_16x16x32_bf16 v[88:91], v[216:219], v[32:35], v[88:91]
    ds_read_b64_tr_b16 v[196:197], v181 offset:8192
    v_mfma_f32_16x16x32_bf16 v[92:95], v[220:223], v[32:35], v[92:95]
    ds_read_b64_tr_b16 v[198:199], v181 offset:10240
    v_mfma_f32_16x16x32_bf16 v[96:99], v[208:211], v[36:39], v[96:99]
    ds_read_b64_tr_b16 v[200:201], v182 offset:8192
    v_mfma_f32_16x16x32_bf16 v[100:103], v[212:215], v[36:39], v[100:103]
    ds_read_b64_tr_b16 v[202:203], v182 offset:10240
    v_mfma_f32_16x16x32_bf16 v[104:107], v[216:219], v[36:39], v[104:107]
    ds_read_b64_tr_b16 v[204:205], v183 offset:8192
    v_mfma_f32_16x16x32_bf16 v[108:111], v[220:223], v[36:39], v[108:111]
    ds_read_b64_tr_b16 v[206:207], v183 offset:10240
    v_mfma_f32_16x16x32_bf16 v[112:115], v[208:211], v[40:43], v[112:115]
    s_add_u32 m0, s56, 4096
    s_add_u32 s58, s55, 294912
    buffer_load_dwordx4 v176, s[8:11], s58 offen offset:0 lds
    v_mfma_f32_16x16x32_bf16 v[116:119], v[212:215], v[40:43], v[116:119]
    buffer_load_dwordx4 v[32:35], v1, s[4:7], s38 offen offset:1024 sc1
    v_mfma_f32_16x16x32_bf16 v[120:123], v[216:219], v[40:43], v[120:123]
    buffer_load_dwordx4 v177, s[8:11], s58 offen offset:1024 lds
    v_mfma_f32_16x16x32_bf16 v[124:127], v[220:223], v[40:43], v[124:127]
    buffer_load_dwordx4 v[36:39], v1, s[4:7], s39 offen offset:1024 sc1
    v_mfma_f32_16x16x32_bf16 v[128:131], v[208:211], v[44:47], v[128:131]
    buffer_load_dwordx4 v178, s[8:11], s58 offen offset:2048 lds
    v_mfma_f32_16x16x32_bf16 v[132:135], v[212:215], v[44:47], v[132:135]
    buffer_load_dwordx4 v[40:43], v1, s[4:7], s40 offen offset:1024 sc1
    v_mfma_f32_16x16x32_bf16 v[136:139], v[216:219], v[44:47], v[136:139]
    buffer_load_dwordx4 v179, s[8:11], s58 offen offset:3072 lds
    v_mfma_f32_16x16x32_bf16 v[140:143], v[220:223], v[44:47], v[140:143]
    buffer_load_dwordx4 v[44:47], v1, s[4:7], s41 offen offset:1024 sc1
    s_lshl_b32 s37, s46, 2
    s_add_u32 s37, s37, 74461184
    s_cmp_lt_u32 s46, 86
    s_cselect_b32 s37, s37, 0x20000000
    s_add_u32 s58, s37, s69
    buffer_store_dword v253, v252, s[4:7], s58 offen sc1
    s_waitcnt vmcnt(21) lgkmcnt(0)
    v_mfma_f32_16x16x32_bf16 v[80:83], v[192:195], v[48:51], v[80:83]
    ds_read_b64_tr_b16 v[208:209], v180 offset:12288
    v_mfma_f32_16x16x32_bf16 v[84:87], v[196:199], v[48:51], v[84:87]
    ds_read_b64_tr_b16 v[210:211], v180 offset:14336
    v_mfma_f32_16x16x32_bf16 v[88:91], v[200:203], v[48:51], v[88:91]
    ds_read_b64_tr_b16 v[212:213], v181 offset:12288
    v_mfma_f32_16x16x32_bf16 v[92:95], v[204:207], v[48:51], v[92:95]
    ds_read_b64_tr_b16 v[214:215], v181 offset:14336
    v_mfma_f32_16x16x32_bf16 v[96:99], v[192:195], v[52:55], v[96:99]
    ds_read_b64_tr_b16 v[216:217], v182 offset:12288
    v_mfma_f32_16x16x32_bf16 v[100:103], v[196:199], v[52:55], v[100:103]
    ds_read_b64_tr_b16 v[218:219], v182 offset:14336
    v_mfma_f32_16x16x32_bf16 v[104:107], v[200:203], v[52:55], v[104:107]
    ds_read_b64_tr_b16 v[220:221], v183 offset:12288
    v_mfma_f32_16x16x32_bf16 v[108:111], v[204:207], v[52:55], v[108:111]
    ds_read_b64_tr_b16 v[222:223], v183 offset:14336
    v_mfma_f32_16x16x32_bf16 v[112:115], v[192:195], v[56:59], v[112:115]
    s_add_u32 m0, s56, 8192
    s_add_u32 s58, s55, 327680
    buffer_load_dwordx4 v176, s[8:11], s58 offen offset:0 lds
    v_mfma_f32_16x16x32_bf16 v[116:119], v[196:199], v[56:59], v[116:119]
    buffer_load_dwordx4 v[48:51], v1, s[4:7], s38 offen offset:2048 sc1
    v_mfma_f32_16x16x32_bf16 v[120:123], v[200:203], v[56:59], v[120:123]
    buffer_load_dwordx4 v177, s[8:11], s58 offen offset:1024 lds
    v_mfma_f32_16x16x32_bf16 v[124:127], v[204:207], v[56:59], v[124:127]
    buffer_load_dwordx4 v[52:55], v1, s[4:7], s39 offen offset:2048 sc1
    v_mfma_f32_16x16x32_bf16 v[128:131], v[192:195], v[60:63], v[128:131]
    buffer_load_dwordx4 v178, s[8:11], s58 offen offset:2048 lds
    v_mfma_f32_16x16x32_bf16 v[132:135], v[196:199], v[60:63], v[132:135]
    buffer_load_dwordx4 v[56:59], v1, s[4:7], s40 offen offset:2048 sc1
    v_mfma_f32_16x16x32_bf16 v[136:139], v[200:203], v[60:63], v[136:139]
    buffer_load_dwordx4 v179, s[8:11], s58 offen offset:3072 lds
    v_mfma_f32_16x16x32_bf16 v[140:143], v[204:207], v[60:63], v[140:143]
    buffer_load_dwordx4 v[60:63], v1, s[4:7], s41 offen offset:2048 sc1
    s_waitcnt vmcnt(25) lgkmcnt(0)
    v_mfma_f32_16x16x32_bf16 v[80:83], v[208:211], v[64:67], v[80:83]
    ds_read_b64_tr_b16 v[192:193], v248 offset:0
    v_mfma_f32_16x16x32_bf16 v[84:87], v[212:215], v[64:67], v[84:87]
    ds_read_b64_tr_b16 v[194:195], v248 offset:2048
    v_mfma_f32_16x16x32_bf16 v[88:91], v[216:219], v[64:67], v[88:91]
    ds_read_b64_tr_b16 v[196:197], v249 offset:0
    v_mfma_f32_16x16x32_bf16 v[92:95], v[220:223], v[64:67], v[92:95]
    ds_read_b64_tr_b16 v[198:199], v249 offset:2048
    v_mfma_f32_16x16x32_bf16 v[96:99], v[208:211], v[68:71], v[96:99]
    ds_read_b64_tr_b16 v[200:201], v250 offset:0
    v_mfma_f32_16x16x32_bf16 v[100:103], v[212:215], v[68:71], v[100:103]
    ds_read_b64_tr_b16 v[202:203], v250 offset:2048
    v_mfma_f32_16x16x32_bf16 v[104:107], v[216:219], v[68:71], v[104:107]
    ds_read_b64_tr_b16 v[204:205], v251 offset:0
    v_mfma_f32_16x16x32_bf16 v[108:111], v[220:223], v[68:71], v[108:111]
    ds_read_b64_tr_b16 v[206:207], v251 offset:2048
    v_mfma_f32_16x16x32_bf16 v[112:115], v[208:211], v[72:75], v[112:115]
    s_add_u32 m0, s56, 12288
    s_add_u32 s58, s55, 360448
    buffer_load_dwordx4 v176, s[8:11], s58 offen offset:0 lds
    v_mfma_f32_16x16x32_bf16 v[116:119], v[212:215], v[72:75], v[116:119]
    buffer_load_dwordx4 v[64:67], v1, s[4:7], s38 offen offset:3072 sc1
    v_mfma_f32_16x16x32_bf16 v[120:123], v[216:219], v[72:75], v[120:123]
    buffer_load_dwordx4 v177, s[8:11], s58 offen offset:1024 lds
    v_mfma_f32_16x16x32_bf16 v[124:127], v[220:223], v[72:75], v[124:127]
    buffer_load_dwordx4 v[68:71], v1, s[4:7], s39 offen offset:3072 sc1
    v_mfma_f32_16x16x32_bf16 v[128:131], v[208:211], v[76:79], v[128:131]
    buffer_load_dwordx4 v178, s[8:11], s58 offen offset:2048 lds
    v_mfma_f32_16x16x32_bf16 v[132:135], v[212:215], v[76:79], v[132:135]
    buffer_load_dwordx4 v[72:75], v1, s[4:7], s40 offen offset:3072 sc1
    v_mfma_f32_16x16x32_bf16 v[136:139], v[216:219], v[76:79], v[136:139]
    buffer_load_dwordx4 v179, s[8:11], s58 offen offset:3072 lds
    v_mfma_f32_16x16x32_bf16 v[140:143], v[220:223], v[76:79], v[140:143]
    buffer_load_dwordx4 v[76:79], v1, s[4:7], s41 offen offset:3072 sc1
    v_and_b32 v14, 0xfffbffff, v15
    s_mov_b32 s58, 524288
    buffer_load_dword v236, v14, s[8:11], s58 offen
    s_waitcnt vmcnt(26) lgkmcnt(0)
    v_mfma_f32_16x16x32_bf16 v[80:83], v[192:195], v[16:19], v[80:83]
    ds_read_b64_tr_b16 v[208:209], v248 offset:4096
    v_mfma_f32_16x16x32_bf16 v[84:87], v[196:199], v[16:19], v[84:87]
    ds_read_b64_tr_b16 v[210:211], v248 offset:6144
    v_mfma_f32_16x16x32_bf16 v[88:91], v[200:203], v[16:19], v[88:91]
    ds_read_b64_tr_b16 v[212:213], v249 offset:4096
    v_mfma_f32_16x16x32_bf16 v[92:95], v[204:207], v[16:19], v[92:95]
    ds_read_b64_tr_b16 v[214:215], v249 offset:6144
    v_mfma_f32_16x16x32_bf16 v[96:99], v[192:195], v[20:23], v[96:99]
    ds_read_b64_tr_b16 v[216:217], v250 offset:4096
    v_mfma_f32_16x16x32_bf16 v[100:103], v[196:199], v[20:23], v[100:103]
    ds_read_b64_tr_b16 v[218:219], v250 offset:6144
    v_mfma_f32_16x16x32_bf16 v[104:107], v[200:203], v[20:23], v[104:107]
    ds_read_b64_tr_b16 v[220:221], v251 offset:4096
    v_mfma_f32_16x16x32_bf16 v[108:111], v[204:207], v[20:23], v[108:111]
    ds_read_b64_tr_b16 v[222:223], v251 offset:6144
    v_mfma_f32_16x16x32_bf16 v[112:115], v[192:195], v[24:27], v[112:115]
    s_add_u32 m0, s56, 65536
    s_add_u32 s58, s55, 393216
    buffer_load_dwordx4 v176, s[8:11], s58 offen offset:0 lds
    v_mfma_f32_16x16x32_bf16 v[116:119], v[196:199], v[24:27], v[116:119]
    s_add_u32 s38, s38, 4096
    buffer_load_dwordx4 v[16:19], v1, s[4:7], s38 offen offset:0 sc1
    v_mfma_f32_16x16x32_bf16 v[120:123], v[200:203], v[24:27], v[120:123]
    buffer_load_dwordx4 v177, s[8:11], s58 offen offset:1024 lds
    v_mfma_f32_16x16x32_bf16 v[124:127], v[204:207], v[24:27], v[124:127]
    s_add_u32 s39, s39, 4096
    buffer_load_dwordx4 v[20:23], v1, s[4:7], s39 offen offset:0 sc1
    v_mfma_f32_16x16x32_bf16 v[128:131], v[192:195], v[28:31], v[128:131]
    buffer_load_dwordx4 v178, s[8:11], s58 offen offset:2048 lds
    v_mfma_f32_16x16x32_bf16 v[132:135], v[196:199], v[28:31], v[132:135]
    s_add_u32 s40, s40, 4096
    buffer_load_dwordx4 v[24:27], v1, s[4:7], s40 offen offset:0 sc1
    v_mfma_f32_16x16x32_bf16 v[136:139], v[200:203], v[28:31], v[136:139]
    buffer_load_dwordx4 v179, s[8:11], s58 offen offset:3072 lds
    v_mfma_f32_16x16x32_bf16 v[140:143], v[204:207], v[28:31], v[140:143]
    s_add_u32 s41, s41, 4096
    buffer_load_dwordx4 v[28:31], v1, s[4:7], s41 offen offset:0 sc1
    s_waitcnt vmcnt(26) lgkmcnt(0)
    v_mfma_f32_16x16x32_bf16 v[80:83], v[208:211], v[32:35], v[80:83]
    ds_read_b64_tr_b16 v[192:193], v248 offset:8192
    v_mfma_f32_16x16x32_bf16 v[84:87], v[212:215], v[32:35], v[84:87]
    ds_read_b64_tr_b16 v[194:195], v248 offset:10240
    v_mfma_f32_16x16x32_bf16 v[88:91], v[216:219], v[32:35], v[88:91]
    ds_read_b64_tr_b16 v[196:197], v249 offset:8192
    v_mfma_f32_16x16x32_bf16 v[92:95], v[220:223], v[32:35], v[92:95]
    ds_read_b64_tr_b16 v[198:199], v249 offset:10240
    v_mfma_f32_16x16x32_bf16 v[96:99], v[208:211], v[36:39], v[96:99]
    ds_read_b64_tr_b16 v[200:201], v250 offset:8192
    v_mfma_f32_16x16x32_bf16 v[100:103], v[212:215], v[36:39], v[100:103]
    ds_read_b64_tr_b16 v[202:203], v250 offset:10240
    v_mfma_f32_16x16x32_bf16 v[104:107], v[216:219], v[36:39], v[104:107]
    ds_read_b64_tr_b16 v[204:205], v251 offset:8192
    v_mfma_f32_16x16x32_bf16 v[108:111], v[220:223], v[36:39], v[108:111]
    ds_read_b64_tr_b16 v[206:207], v251 offset:10240
    v_mfma_f32_16x16x32_bf16 v[112:115], v[208:211], v[40:43], v[112:115]
    s_add_u32 m0, s56, 69632
    s_add_u32 s58, s55, 425984
    buffer_load_dwordx4 v176, s[8:11], s58 offen offset:0 lds
    v_mfma_f32_16x16x32_bf16 v[116:119], v[212:215], v[40:43], v[116:119]
    buffer_load_dwordx4 v[32:35], v1, s[4:7], s38 offen offset:1024 sc1
    v_mfma_f32_16x16x32_bf16 v[120:123], v[216:219], v[40:43], v[120:123]
    buffer_load_dwordx4 v177, s[8:11], s58 offen offset:1024 lds
    v_mfma_f32_16x16x32_bf16 v[124:127], v[220:223], v[40:43], v[124:127]
    buffer_load_dwordx4 v[36:39], v1, s[4:7], s39 offen offset:1024 sc1
    v_mfma_f32_16x16x32_bf16 v[128:131], v[208:211], v[44:47], v[128:131]
    buffer_load_dwordx4 v178, s[8:11], s58 offen offset:2048 lds
    v_mfma_f32_16x16x32_bf16 v[132:135], v[212:215], v[44:47], v[132:135]
    buffer_load_dwordx4 v[40:43], v1, s[4:7], s40 offen offset:1024 sc1
    v_mfma_f32_16x16x32_bf16 v[136:139], v[216:219], v[44:47], v[136:139]
    buffer_load_dwordx4 v179, s[8:11], s58 offen offset:3072 lds
    v_mfma_f32_16x16x32_bf16 v[140:143], v[220:223], v[44:47], v[140:143]
    buffer_load_dwordx4 v[44:47], v1, s[4:7], s41 offen offset:1024 sc1
    s_waitcnt vmcnt(25) lgkmcnt(0)
    v_mfma_f32_16x16x32_bf16 v[80:83], v[192:195], v[48:51], v[80:83]
    ds_read_b64_tr_b16 v[208:209], v248 offset:12288
    v_mfma_f32_16x16x32_bf16 v[84:87], v[196:199], v[48:51], v[84:87]
    ds_read_b64_tr_b16 v[210:211], v248 offset:14336
    v_mfma_f32_16x16x32_bf16 v[88:91], v[200:203], v[48:51], v[88:91]
    ds_read_b64_tr_b16 v[212:213], v249 offset:12288
    v_mfma_f32_16x16x32_bf16 v[92:95], v[204:207], v[48:51], v[92:95]
    ds_read_b64_tr_b16 v[214:215], v249 offset:14336
    v_mfma_f32_16x16x32_bf16 v[96:99], v[192:195], v[52:55], v[96:99]
    ds_read_b64_tr_b16 v[216:217], v250 offset:12288
    v_mfma_f32_16x16x32_bf16 v[100:103], v[196:199], v[52:55], v[100:103]
    ds_read_b64_tr_b16 v[218:219], v250 offset:14336
    v_mfma_f32_16x16x32_bf16 v[104:107], v[200:203], v[52:55], v[104:107]
    ds_read_b64_tr_b16 v[220:221], v251 offset:12288
    v_mfma_f32_16x16x32_bf16 v[108:111], v[204:207], v[52:55], v[108:111]
    ds_read_b64_tr_b16 v[222:223], v251 offset:14336
    v_mfma_f32_16x16x32_bf16 v[112:115], v[192:195], v[56:59], v[112:115]
    s_add_u32 m0, s56, 73728
    s_add_u32 s58, s55, 458752
    buffer_load_dwordx4 v176, s[8:11], s58 offen offset:0 lds
    v_mfma_f32_16x16x32_bf16 v[116:119], v[196:199], v[56:59], v[116:119]
    buffer_load_dwordx4 v[48:51], v1, s[4:7], s38 offen offset:2048 sc1
    v_mfma_f32_16x16x32_bf16 v[120:123], v[200:203], v[56:59], v[120:123]
    buffer_load_dwordx4 v177, s[8:11], s58 offen offset:1024 lds
    v_mfma_f32_16x16x32_bf16 v[124:127], v[204:207], v[56:59], v[124:127]
    buffer_load_dwordx4 v[52:55], v1, s[4:7], s39 offen offset:2048 sc1
    v_mfma_f32_16x16x32_bf16 v[128:131], v[192:195], v[60:63], v[128:131]
    buffer_load_dwordx4 v178, s[8:11], s58 offen offset:2048 lds
    v_mfma_f32_16x16x32_bf16 v[132:135], v[196:199], v[60:63], v[132:135]
    buffer_load_dwordx4 v[56:59], v1, s[4:7], s40 offen offset:2048 sc1
    v_mfma_f32_16x16x32_bf16 v[136:139], v[200:203], v[60:63], v[136:139]
    buffer_load_dwordx4 v179, s[8:11], s58 offen offset:3072 lds
    v_mfma_f32_16x16x32_bf16 v[140:143], v[204:207], v[60:63], v[140:143]
    buffer_load_dwordx4 v[60:63], v1, s[4:7], s41 offen offset:2048 sc1
    s_waitcnt vmcnt(25) lgkmcnt(0)
    v_mfma_f32_16x16x32_bf16 v[80:83], v[208:211], v[64:67], v[80:83]
    ds_read_b64_tr_b16 v[192:193], v180 offset:0
    v_mfma_f32_16x16x32_bf16 v[84:87], v[212:215], v[64:67], v[84:87]
    ds_read_b64_tr_b16 v[194:195], v180 offset:2048
    v_mfma_f32_16x16x32_bf16 v[88:91], v[216:219], v[64:67], v[88:91]
    ds_read_b64_tr_b16 v[196:197], v181 offset:0
    v_mfma_f32_16x16x32_bf16 v[92:95], v[220:223], v[64:67], v[92:95]
    ds_read_b64_tr_b16 v[198:199], v181 offset:2048
    v_mfma_f32_16x16x32_bf16 v[96:99], v[208:211], v[68:71], v[96:99]
    ds_read_b64_tr_b16 v[200:201], v182 offset:0
    v_mfma_f32_16x16x32_bf16 v[100:103], v[212:215], v[68:71], v[100:103]
    ds_read_b64_tr_b16 v[202:203], v182 offset:2048
    v_mfma_f32_16x16x32_bf16 v[104:107], v[216:219], v[68:71], v[104:107]
    ds_read_b64_tr_b16 v[204:205], v183 offset:0
    v_mfma_f32_16x16x32_bf16 v[108:111], v[220:223], v[68:71], v[108:111]
    ds_read_b64_tr_b16 v[206:207], v183 offset:2048
    v_mfma_f32_16x16x32_bf16 v[112:115], v[208:211], v[72:75], v[112:115]
    s_add_u32 m0, s56, 77824
    s_add_u32 s58, s55, 491520
    buffer_load_dwordx4 v176, s[8:11], s58 offen offset:0 lds
    v_mfma_f32_16x16x32_bf16 v[116:119], v[212:215], v[72:75], v[116:119]
    buffer_load_dwordx4 v[64:67], v1, s[4:7], s38 offen offset:3072 sc1
    v_mfma_f32_16x16x32_bf16 v[120:123], v[216:219], v[72:75], v[120:123]
    buffer_load_dwordx4 v177, s[8:11], s58 offen offset:1024 lds
    v_mfma_f32_16x16x32_bf16 v[124:127], v[220:223], v[72:75], v[124:127]
    buffer_load_dwordx4 v[68:71], v1, s[4:7], s39 offen offset:3072 sc1
    v_mfma_f32_16x16x32_bf16 v[128:131], v[208:211], v[76:79], v[128:131]
    buffer_load_dwordx4 v178, s[8:11], s58 offen offset:2048 lds
    v_mfma_f32_16x16x32_bf16 v[132:135], v[212:215], v[76:79], v[132:135]
    buffer_load_dwordx4 v[72:75], v1, s[4:7], s40 offen offset:3072 sc1
    v_mfma_f32_16x16x32_bf16 v[136:139], v[216:219], v[76:79], v[136:139]
    buffer_load_dwordx4 v179, s[8:11], s58 offen offset:3072 lds
    v_mfma_f32_16x16x32_bf16 v[140:143], v[220:223], v[76:79], v[140:143]
    buffer_load_dwordx4 v[76:79], v1, s[4:7], s41 offen offset:3072 sc1
    v_add_u32 v255, 16, v255
    buffer_load_dword v254, v255, s[4:7], 0 offen sc1
    s_waitcnt vmcnt(25) lgkmcnt(0)
    v_mfma_f32_16x16x32_bf16 v[80:83], v[192:195], v[16:19], v[80:83]
    ds_read_b64_tr_b16 v[208:209], v180 offset:4096
    v_mfma_f32_16x16x32_bf16 v[84:87], v[196:199], v[16:19], v[84:87]
    ds_read_b64_tr_b16 v[210:211], v180 offset:6144
    v_mfma_f32_16x16x32_bf16 v[88:91], v[200:203], v[16:19], v[88:91]
    ds_read_b64_tr_b16 v[212:213], v181 offset:4096
    v_mfma_f32_16x16x32_bf16 v[92:95], v[204:207], v[16:19], v[92:95]
    ds_read_b64_tr_b16 v[214:215], v181 offset:6144
    v_mfma_f32_16x16x32_bf16 v[96:99], v[192:195], v[20:23], v[96:99]
    ds_read_b64_tr_b16 v[216:217], v182 offset:4096
    v_mfma_f32_16x16x32_bf16 v[100:103], v[196:199], v[20:23], v[100:103]
    ds_read_b64_tr_b16 v[218:219], v182 offset:6144
    v_mfma_f32_16x16x32_bf16 v[104:107], v[200:203], v[20:23], v[104:107]
    ds_read_b64_tr_b16 v[220:221], v183 offset:4096
    v_mfma_f32_16x16x32_bf16 v[108:111], v[204:207], v[20:23], v[108:111]
    ds_read_b64_tr_b16 v[222:223], v183 offset:6144
    v_mfma_f32_16x16x32_bf16 v[112:115], v[192:195], v[24:27], v[112:115]
    s_add_u32 m0, s56, 0
    s_add_u32 s58, s55, 524288
    buffer_load_dwordx4 v176, s[8:11], s58 offen offset:0 lds
    v_mfma_f32_16x16x32_bf16 v[116:119], v[196:199], v[24:27], v[116:119]
    s_add_u32 s38, s38, 4096
    buffer_load_dwordx4 v[16:19], v1, s[4:7], s38 offen offset:0 sc1
    v_mfma_f32_16x16x32_bf16 v[120:123], v[200:203], v[24:27], v[120:123]
    buffer_load_dwordx4 v177, s[8:11], s58 offen offset:1024 lds
    v_mfma_f32_16x16x32_bf16 v[124:127], v[204:207], v[24:27], v[124:127]
    s_add_u32 s39, s39, 4096
    buffer_load_dwordx4 v[20:23], v1, s[4:7], s39 offen offset:0 sc1
    v_mfma_f32_16x16x32_bf16 v[128:131], v[192:195], v[28:31], v[128:131]
    buffer_load_dwordx4 v178, s[8:11], s58 offen offset:2048 lds
    v_mfma_f32_16x16x32_bf16 v[132:135], v[196:199], v[28:31], v[132:135]
    s_add_u32 s40, s40, 4096
    buffer_load_dwordx4 v[24:27], v1, s[4:7], s40 offen offset:0 sc1
    v_mfma_f32_16x16x32_bf16 v[136:139], v[200:203], v[28:31], v[136:139]
    buffer_load_dwordx4 v179, s[8:11], s58 offen offset:3072 lds
    v_mfma_f32_16x16x32_bf16 v[140:143], v[204:207], v[28:31], v[140:143]
    s_add_u32 s41, s41, 4096
    buffer_load_dwordx4 v[28:31], v1, s[4:7], s41 offen offset:0 sc1
    s_waitcnt vmcnt(25) lgkmcnt(0)
    v_mfma_f32_16x16x32_bf16 v[80:83], v[208:211], v[32:35], v[80:83]
    ds_read_b64_tr_b16 v[192:193], v180 offset:8192
    v_mfma_f32_16x16x32_bf16 v[84:87], v[212:215], v[32:35], v[84:87]
    ds_read_b64_tr_b16 v[194:195], v180 offset:10240
    v_mfma_f32_16x16x32_bf16 v[88:91], v[216:219], v[32:35], v[88:91]
    ds_read_b64_tr_b16 v[196:197], v181 offset:8192
    v_mfma_f32_16x16x32_bf16 v[92:95], v[220:223], v[32:35], v[92:95]
    ds_read_b64_tr_b16 v[198:199], v181 offset:10240
    v_mfma_f32_16x16x32_bf16 v[96:99], v[208:211], v[36:39], v[96:99]
    ds_read_b64_tr_b16 v[200:201], v182 offset:8192
    v_mfma_f32_16x16x32_bf16 v[100:103], v[212:215], v[36:39], v[100:103]
    ds_read_b64_tr_b16 v[202:203], v182 offset:10240
    v_mfma_f32_16x16x32_bf16 v[104:107], v[216:219], v[36:39], v[104:107]
    ds_read_b64_tr_b16 v[204:205], v183 offset:8192
    v_mfma_f32_16x16x32_bf16 v[108:111], v[220:223], v[36:39], v[108:111]
    ds_read_b64_tr_b16 v[206:207], v183 offset:10240
    v_mfma_f32_16x16x32_bf16 v[112:115], v[208:211], v[40:43], v[112:115]
    s_add_u32 m0, s56, 4096
    s_add_u32 s58, s55, 557056
    buffer_load_dwordx4 v176, s[8:11], s58 offen offset:0 lds
    v_mfma_f32_16x16x32_bf16 v[116:119], v[212:215], v[40:43], v[116:119]
    buffer_load_dwordx4 v[32:35], v1, s[4:7], s38 offen offset:1024 sc1
    v_mfma_f32_16x16x32_bf16 v[120:123], v[216:219], v[40:43], v[120:123]
    buffer_load_dwordx4 v177, s[8:11], s58 offen offset:1024 lds
    v_mfma_f32_16x16x32_bf16 v[124:127], v[220:223], v[40:43], v[124:127]
    buffer_load_dwordx4 v[36:39], v1, s[4:7], s39 offen offset:1024 sc1
    v_mfma_f32_16x16x32_bf16 v[128:131], v[208:211], v[44:47], v[128:131]
    buffer_load_dwordx4 v178, s[8:11], s58 offen offset:2048 lds
    v_mfma_f32_16x16x32_bf16 v[132:135], v[212:215], v[44:47], v[132:135]
    buffer_load_dwordx4 v[40:43], v1, s[4:7], s40 offen offset:1024 sc1
    v_mfma_f32_16x16x32_bf16 v[136:139], v[216:219], v[44:47], v[136:139]
    buffer_load_dwordx4 v179, s[8:11], s58 offen offset:3072 lds
    v_mfma_f32_16x16x32_bf16 v[140:143], v[220:223], v[44:47], v[140:143]
    buffer_load_dwordx4 v[44:47], v1, s[4:7], s41 offen offset:1024 sc1
    s_waitcnt vmcnt(25) lgkmcnt(0)
    v_mfma_f32_16x16x32_bf16 v[80:83], v[192:195], v[48:51], v[80:83]
    ds_read_b64_tr_b16 v[208:209], v180 offset:12288
    v_mfma_f32_16x16x32_bf16 v[84:87], v[196:199], v[48:51], v[84:87]
    ds_read_b64_tr_b16 v[210:211], v180 offset:14336
    v_mfma_f32_16x16x32_bf16 v[88:91], v[200:203], v[48:51], v[88:91]
    ds_read_b64_tr_b16 v[212:213], v181 offset:12288
    v_mfma_f32_16x16x32_bf16 v[92:95], v[204:207], v[48:51], v[92:95]
    ds_read_b64_tr_b16 v[214:215], v181 offset:14336
    v_mfma_f32_16x16x32_bf16 v[96:99], v[192:195], v[52:55], v[96:99]
    ds_read_b64_tr_b16 v[216:217], v182 offset:12288
    v_mfma_f32_16x16x32_bf16 v[100:103], v[196:199], v[52:55], v[100:103]
    ds_read_b64_tr_b16 v[218:219], v182 offset:14336
    v_mfma_f32_16x16x32_bf16 v[104:107], v[200:203], v[52:55], v[104:107]
    ds_read_b64_tr_b16 v[220:221], v183 offset:12288
    v_mfma_f32_16x16x32_bf16 v[108:111], v[204:207], v[52:55], v[108:111]
    ds_read_b64_tr_b16 v[222:223], v183 offset:14336
    v_mfma_f32_16x16x32_bf16 v[112:115], v[192:195], v[56:59], v[112:115]
    s_add_u32 m0, s56, 8192
    s_add_u32 s58, s55, 589824
    buffer_load_dwordx4 v176, s[8:11], s58 offen offset:0 lds
    v_mfma_f32_16x16x32_bf16 v[116:119], v[196:199], v[56:59], v[116:119]
    buffer_load_dwordx4 v[48:51], v1, s[4:7], s38 offen offset:2048 sc1
    v_mfma_f32_16x16x32_bf16 v[120:123], v[200:203], v[56:59], v[120:123]
    buffer_load_dwordx4 v177, s[8:11], s58 offen offset:1024 lds
    v_mfma_f32_16x16x32_bf16 v[124:127], v[204:207], v[56:59], v[124:127]
    buffer_load_dwordx4 v[52:55], v1, s[4:7], s39 offen offset:2048 sc1
    v_mfma_f32_16x16x32_bf16 v[128:131], v[192:195], v[60:63], v[128:131]
    buffer_load_dwordx4 v178, s[8:11], s58 offen offset:2048 lds
    v_mfma_f32_16x16x32_bf16 v[132:135], v[196:199], v[60:63], v[132:135]
    buffer_load_dwordx4 v[56:59], v1, s[4:7], s40 offen offset:2048 sc1
    v_mfma_f32_16x16x32_bf16 v[136:139], v[200:203], v[60:63], v[136:139]
    buffer_load_dwordx4 v179, s[8:11], s58 offen offset:3072 lds
    v_mfma_f32_16x16x32_bf16 v[140:143], v[204:207], v[60:63], v[140:143]
    buffer_load_dwordx4 v[60:63], v1, s[4:7], s41 offen offset:2048 sc1
    s_waitcnt vmcnt(25) lgkmcnt(0)
    v_mfma_f32_16x16x32_bf16 v[80:83], v[208:211], v[64:67], v[80:83]
    ds_read_b64_tr_b16 v[192:193], v248 offset:0
    v_mfma_f32_16x16x32_bf16 v[84:87], v[212:215], v[64:67], v[84:87]
    ds_read_b64_tr_b16 v[194:195], v248 offset:2048
    v_mfma_f32_16x16x32_bf16 v[88:91], v[216:219], v[64:67], v[88:91]
    ds_read_b64_tr_b16 v[196:197], v249 offset:0
    v_mfma_f32_16x16x32_bf16 v[92:95], v[220:223], v[64:67], v[92:95]
    ds_read_b64_tr_b16 v[198:199], v249 offset:2048
    v_mfma_f32_16x16x32_bf16 v[96:99], v[208:211], v[68:71], v[96:99]
    ds_read_b64_tr_b16 v[200:201], v250 offset:0
    v_mfma_f32_16x16x32_bf16 v[100:103], v[212:215], v[68:71], v[100:103]
    ds_read_b64_tr_b16 v[202:203], v250 offset:2048
    v_mfma_f32_16x16x32_bf16 v[104:107], v[216:219], v[68:71], v[104:107]
    ds_read_b64_tr_b16 v[204:205], v251 offset:0
    v_mfma_f32_16x16x32_bf16 v[108:111], v[220:223], v[68:71], v[108:111]
    ds_read_b64_tr_b16 v[206:207], v251 offset:2048
    v_mfma_f32_16x16x32_bf16 v[112:115], v[208:211], v[72:75], v[112:115]
    s_add_u32 m0, s56, 12288
    s_add_u32 s58, s55, 622592
    buffer_load_dwordx4 v176, s[8:11], s58 offen offset:0 lds
    v_mfma_f32_16x16x32_bf16 v[116:119], v[212:215], v[72:75], v[116:119]
    buffer_load_dwordx4 v[64:67], v1, s[4:7], s38 offen offset:3072 sc1
    v_mfma_f32_16x16x32_bf16 v[120:123], v[216:219], v[72:75], v[120:123]
    buffer_load_dwordx4 v177, s[8:11], s58 offen offset:1024 lds
    v_mfma_f32_16x16x32_bf16 v[124:127], v[220:223], v[72:75], v[124:127]
    buffer_load_dwordx4 v[68:71], v1, s[4:7], s39 offen offset:3072 sc1
    v_mfma_f32_16x16x32_bf16 v[128:131], v[208:211], v[76:79], v[128:131]
    buffer_load_dwordx4 v178, s[8:11], s58 offen offset:2048 lds
    v_mfma_f32_16x16x32_bf16 v[132:135], v[212:215], v[76:79], v[132:135]
    buffer_load_dwordx4 v[72:75], v1, s[4:7], s40 offen offset:3072 sc1
    v_mfma_f32_16x16x32_bf16 v[136:139], v[216:219], v[76:79], v[136:139]
    buffer_load_dwordx4 v179, s[8:11], s58 offen offset:3072 lds
    v_mfma_f32_16x16x32_bf16 v[140:143], v[220:223], v[76:79], v[140:143]
    buffer_load_dwordx4 v[76:79], v1, s[4:7], s41 offen offset:3072 sc1
    s_waitcnt vmcnt(32)
    v_cmp_ne_u32 vcc, 1, v254
    s_cbranch_vccnz L_spin_ctx2
L_ok_ctx2:
    s_waitcnt vmcnt(24) lgkmcnt(0)
    v_mfma_f32_16x16x32_bf16 v[80:83], v[192:195], v[16:19], v[80:83]
    ds_read_b64_tr_b16 v[208:209], v248 offset:4096
    v_mfma_f32_16x16x32_bf16 v[84:87], v[196:199], v[16:19], v[84:87]
    ds_read_b64_tr_b16 v[210:211], v248 offset:6144
    v_mfma_f32_16x16x32_bf16 v[88:91], v[200:203], v[16:19], v[88:91]
    ds_read_b64_tr_b16 v[212:213], v249 offset:4096
    v_mfma_f32_16x16x32_bf16 v[92:95], v[204:207], v[16:19], v[92:95]
    ds_read_b64_tr_b16 v[214:215], v249 offset:6144
    v_mfma_f32_16x16x32_bf16 v[96:99], v[192:195], v[20:23], v[96:99]
    ds_read_b64_tr_b16 v[216:217], v250 offset:4096
    v_mfma_f32_16x16x32_bf16 v[100:103], v[196:199], v[20:23], v[100:103]
    ds_read_b64_tr_b16 v[218:219], v250 offset:6144
    v_mfma_f32_16x16x32_bf16 v[104:107], v[200:203], v[20:23], v[104:107]
    ds_read_b64_tr_b16 v[220:221], v251 offset:4096
    v_mfma_f32_16x16x32_bf16 v[108:111], v[204:207], v[20:23], v[108:111]
    ds_read_b64_tr_b16 v[222:223], v251 offset:6144
    v_mfma_f32_16x16x32_bf16 v[112:115], v[192:195], v[24:27], v[112:115]
    s_add_u32 m0, s56, 65536
    s_add_u32 s58, s55, 655360
    buffer_load_dwordx4 v176, s[8:11], s58 offen offset:0 lds
    v_mfma_f32_16x16x32_bf16 v[116:119], v[196:199], v[24:27], v[116:119]
    s_add_u32 s38, s38, 4096
    buffer_load_dwordx4 v[16:19], v1, s[4:7], s38 offen offset:0 sc1
    v_mfma_f32_16x16x32_bf16 v[120:123], v[200:203], v[24:27], v[120:123]
    buffer_load_dwordx4 v177, s[8:11], s58 offen offset:1024 lds
    v_mfma_f32_16x16x32_bf16 v[124:127], v[204:207], v[24:27], v[124:127]
    s_add_u32 s39, s39, 4096
    buffer_load_dwordx4 v[20:23], v1, s[4:7], s39 offen offset:0 sc1
    v_mfma_f32_16x16x32_bf16 v[128:131], v[192:195], v[28:31], v[128:131]
    buffer_load_dwordx4 v178, s[8:11], s58 offen offset:2048 lds
    v_mfma_f32_16x16x32_bf16 v[132:135], v[196:199], v[28:31], v[132:135]
    s_add_u32 s40, s40, 4096
    buffer_load_dwordx4 v[24:27], v1, s[4:7], s40 offen offset:0 sc1
    v_mfma_f32_16x16x32_bf16 v[136:139], v[200:203], v[28:31], v[136:139]
    buffer_load_dwordx4 v179, s[8:11], s58 offen offset:3072 lds
    v_mfma_f32_16x16x32_bf16 v[140:143], v[204:207], v[28:31], v[140:143]
    s_add_u32 s41, s41, 4096
    buffer_load_dwordx4 v[28:31], v1, s[4:7], s41 offen offset:0 sc1
    s_mov_b32 s58, 786432
    buffer_load_dword v237, v14, s[8:11], s58 offen
    s_waitcnt vmcnt(25) lgkmcnt(0)
    v_mfma_f32_16x16x32_bf16 v[80:83], v[208:211], v[32:35], v[80:83]
    ds_read_b64_tr_b16 v[192:193], v248 offset:8192
    v_mfma_f32_16x16x32_bf16 v[84:87], v[212:215], v[32:35], v[84:87]
    ds_read_b64_tr_b16 v[194:195], v248 offset:10240
    v_mfma_f32_16x16x32_bf16 v[88:91], v[216:219], v[32:35], v[88:91]
    ds_read_b64_tr_b16 v[196:197], v249 offset:8192
    v_mfma_f32_16x16x32_bf16 v[92:95], v[220:223], v[32:35], v[92:95]
    ds_read_b64_tr_b16 v[198:199], v249 offset:10240
    v_mfma_f32_16x16x32_bf16 v[96:99], v[208:211], v[36:39], v[96:99]
    ds_read_b64_tr_b16 v[200:201], v250 offset:8192
    v_mfma_f32_16x16x32_bf16 v[100:103], v[212:215], v[36:39], v[100:103]
    ds_read_b64_tr_b16 v[202:203], v250 offset:10240
    v_mfma_f32_16x16x32_bf16 v[104:107], v[216:219], v[36:39], v[104:107]
    ds_read_b64_tr_b16 v[204:205], v251 offset:8192
    v_mfma_f32_16x16x32_bf16 v[108:111], v[220:223], v[36:39], v[108:111]
    ds_read_b64_tr_b16 v[206:207], v251 offset:10240
    v_mfma_f32_16x16x32_bf16 v[112:115], v[208:211], v[40:43], v[112:115]
    s_add_u32 m0, s56, 69632
    s_add_u32 s58, s55, 688128
    buffer_load_dwordx4 v176, s[8:11], s58 offen offset:0 lds
    v_mfma_f32_16x16x32_bf16 v[116:119], v[212:215], v[40:43], v[116:119]
    buffer_load_dwordx4 v[32:35], v1, s[4:7], s38 offen offset:1024 sc1
    v_mfma_f32_16x16x32_bf16 v[120:123], v[216:219], v[40:43], v[120:123]
    buffer_load_dwordx4 v177, s[8:11], s58 offen offset:1024 lds
    v_mfma_f32_16x16x32_bf16 v[124:127], v[220:223], v[40:43], v[124:127]
    buffer_load_dwordx4 v[36:39], v1, s[4:7], s39 offen offset:1024 sc1
    v_mfma_f32_16x16x32_bf16 v[128:131], v[208:211], v[44:47], v[128:131]
    buffer_load_dwordx4 v178, s[8:11], s58 offen offset:2048 lds
    v_mfma_f32_16x16x32_bf16 v[132:135], v[212:215], v[44:47], v[132:135]
    buffer_load_dwordx4 v[40:43], v1, s[4:7], s40 offen offset:1024 sc1
    v_mfma_f32_16x16x32_bf16 v[136:139], v[216:219], v[44:47], v[136:139]
    buffer_load_dwordx4 v179, s[8:11], s58 offen offset:3072 lds
    v_mfma_f32_16x16x32_bf16 v[140:143], v[220:223], v[44:47], v[140:143]
    buffer_load_dwordx4 v[44:47], v1, s[4:7], s41 offen offset:1024 sc1
    s_waitcnt vmcnt(25) lgkmcnt(0)
    v_mfma_f32_16x16x32_bf16 v[80:83], v[192:195], v[48:51], v[80:83]
    ds_read_b64_tr_b16 v[208:209], v248 offset:12288
    v_mfma_f32_16x16x32_bf16 v[84:87], v[196:199], v[48:51], v[84:87]
    ds_read_b64_tr_b16 v[210:211], v248 offset:14336
    v_mfma_f32_16x16x32_bf16 v[88:91], v[200:203], v[48:51], v[88:91]
    ds_read_b64_tr_b16 v[212:213], v249 offset:12288
    v_mfma_f32_16x16x32_bf16 v[92:95], v[204:207], v[48:51], v[92:95]
    ds_read_b64_tr_b16 v[214:215], v249 offset:14336
    v_mfma_f32_16x16x32_bf16 v[96:99], v[192:195], v[52:55], v[96:99]
    ds_read_b64_tr_b16 v[216:217], v250 offset:12288
    v_mfma_f32_16x16x32_bf16 v[100:103], v[196:199], v[52:55], v[100:103]
    ds_read_b64_tr_b16 v[218:219], v250 offset:14336
    v_mfma_f32_16x16x32_bf16 v[104:107], v[200:203], v[52:55], v[104:107]
    ds_read_b64_tr_b16 v[220:221], v251 offset:12288
    v_mfma_f32_16x16x32_bf16 v[108:111], v[204:207], v[52:55], v[108:111]
    ds_read_b64_tr_b16 v[222:223], v251 offset:14336
    v_mfma_f32_16x16x32_bf16 v[112:115], v[192:195], v[56:59], v[112:115]
    s_add_u32 m0, s56, 73728
    s_add_u32 s58, s55, 720896
    buffer_load_dwordx4 v176, s[8:11], s58 offen offset:0 lds
    v_mfma_f32_16x16x32_bf16 v[116:119], v[196:199], v[56:59], v[116:119]
    buffer_load_dwordx4 v[48:51], v1, s[4:7], s38 offen offset:2048 sc1
    v_mfma_f32_16x16x32_bf16 v[120:123], v[200:203], v[56:59], v[120:123]
    buffer_load_dwordx4 v177, s[8:11], s58 offen offset:1024 lds
    v_mfma_f32_16x16x32_bf16 v[124:127], v[204:207], v[56:59], v[124:127]
    buffer_load_dwordx4 v[52:55], v1, s[4:7], s39 offen offset:2048 sc1
    v_mfma_f32_16x16x32_bf16 v[128:131], v[192:195], v[60:63], v[128:131]
    buffer_load_dwordx4 v178, s[8:11], s58 offen offset:2048 lds
    v_mfma_f32_16x16x32_bf16 v[132:135], v[196:199], v[60:63], v[132:135]
    buffer_load_dwordx4 v[56:59], v1, s[4:7], s40 offen offset:2048 sc1
    v_mfma_f32_16x16x32_bf16 v[136:139], v[200:203], v[60:63], v[136:139]
    buffer_load_dwordx4 v179, s[8:11], s58 offen offset:3072 lds
    v_mfma_f32_16x16x32_bf16 v[140:143], v[204:207], v[60:63], v[140:143]
    buffer_load_dwordx4 v[60:63], v1, s[4:7], s41 offen offset:2048 sc1
    s_cmp_gt_u32 s33, 3
    s_cselect_b32 s58, 1, 0
    s_sub_u32 s36, s33, s58
    s_cmp_gt_u32 s33, 11
    s_cselect_b32 s58, 1, 0
    s_sub_u32 s36, s36, s58
    s_cmp_eq_u32 s33, 11
    s_cselect_b32 s36, 14, s36
    s_cmp_eq_u32 s33, 3
    s_cselect_b32 s36, 15, s36
    s_mul_i32 s18, s36, 196608
    s_mul_i32 s19, s3, 3072
    s_add_u32 s18, s18, s19
    s_add_u32 s18, s18, 77594624
    s_add_u32 s19, s19, 77824
    s_lshl_b32 s58, s36, 6
    s_add_u32 s58, s58, 74462208
    v_and_b32 v2, 15, v0
    v_lshl_add_u32 v2, v2, 2, s58
    buffer_load_dword v254, v2, s[4:7], 0 offen sc1
    s_lshl_b32 s42, s32, 3
    s_lshl_b32 s58, s3, 1
    s_add_u32 s42, s42, s58
    s_mul_i32 s16, s42, 21504
    s_add_u32 s16, s16, 60817408
    s_add_u32 s17, s16, 21504
    s_lshl_b32 s58, s32, 7
    s_add_u32 s58, s58, 74457088
    s_lshr_b32 s43, s3, 1
    s_lshl_b32 s43, s43, 5
    s_add_u32 s58, s58, s43
    v_and_b32 v7, 7, v0
    v_lshl_add_u32 v11, v7, 2, s58
    v_mov_b32 v255, v11
    s_mul_i32 s58, s36, 3
    v_and_b32 v8, 3, v0
    v_min_u32 v8, 2, v8
    v_add_u32 v8, s58, v8
    v_min_u32 v8, 42, v8
    v_bfe_u32 v9, v0, 2, 1
    v_mul_u32_u24 v9, 43, v9
    v_add_u32 v8, v8, v9
    v_lshlrev_b32 v8, 2, v8
    v_add_u32 v8, 74461184, v8
    v_cmp_lt_u32 vcc, 31, v0
    v_add_u32 v5, 77824, v1
    v_add_u32 v6, 139264, v1
    v_cndmask_b32 v255, v255, v8, vcc
    s_waitcnt vmcnt(26) lgkmcnt(0)
    v_mfma_f32_16x16x32_bf16 v[80:83], v[208:211], v[64:67], v[80:83]
    ds_read_b64_tr_b16 v[192:193], v180 offset:0
    v_mfma_f32_16x16x32_bf16 v[84:87], v[212:215], v[64:67], v[84:87]
    ds_read_b64_tr_b16 v[194:195], v180 offset:2048
    v_mfma_f32_16x16x32_bf16 v[88:91], v[216:219], v[64:67], v[88:91]
    ds_read_b64_tr_b16 v[196:197], v181 offset:0
    v_mfma_f32_16x16x32_bf16 v[92:95], v[220:223], v[64:67], v[92:95]
    ds_read_b64_tr_b16 v[198:199], v181 offset:2048
    v_mfma_f32_16x16x32_bf16 v[96:99], v[208:211], v[68:71], v[96:99]
    ds_read_b64_tr_b16 v[200:201], v182 offset:0
    v_mfma_f32_16x16x32_bf16 v[100:103], v[212:215], v[68:71], v[100:103]
    ds_read_b64_tr_b16 v[202:203], v182 offset:2048
    v_mfma_f32_16x16x32_bf16 v[104:107], v[216:219], v[68:71], v[104:107]
    ds_read_b64_tr_b16 v[204:205], v183 offset:0
    v_mfma_f32_16x16x32_bf16 v[108:111], v[220:223], v[68:71], v[108:111]
    ds_read_b64_tr_b16 v[206:207], v183 offset:2048
    v_mfma_f32_16x16x32_bf16 v[112:115], v[208:211], v[72:75], v[112:115]
    s_add_u32 m0, s56, 77824
    s_add_u32 s58, s55, 753664
    buffer_load_dwordx4 v176, s[8:11], s58 offen offset:0 lds
    v_mfma_f32_16x16x32_bf16 v[116:119], v[212:215], v[72:75], v[116:119]
    buffer_load_dwordx4 v[64:67], v1, s[4:7], s38 offen offset:3072 sc1
    v_mfma_f32_16x16x32_bf16 v[120:123], v[216:219], v[72:75], v[120:123]
    buffer_load_dwordx4 v177, s[8:11], s58 offen offset:1024 lds
    v_mfma_f32_16x16x32_bf16 v[124:127], v[220:223], v[72:75], v[124:127]
    buffer_load_dwordx4 v[68:71], v1, s[4:7], s39 offen offset:3072 sc1
    v_mfma_f32_16x16x32_bf16 v[128:131], v[208:211], v[76:79], v[128:131]
    buffer_load_dwordx4 v178, s[8:11], s58 offen offset:2048 lds
    v_mfma_f32_16x16x32_bf16 v[132:135], v[212:215], v[76:79], v[132:135]
    buffer_load_dwordx4 v[72:75], v1, s[4:7], s40 offen offset:3072 sc1
    v_mfma_f32_16x16x32_bf16 v[136:139], v[216:219], v[76:79], v[136:139]
    buffer_load_dwordx4 v179, s[8:11], s58 offen offset:3072 lds
    v_mfma_f32_16x16x32_bf16 v[140:143], v[220:223], v[76:79], v[140:143]
    buffer_load_dwordx4 v[76:79], v1, s[4:7], s41 offen offset:3072 sc1
    s_waitcnt vmcnt(26) lgkmcnt(0)
    v_mfma_f32_16x16x32_bf16 v[80:83], v[192:195], v[16:19], v[80:83]
    ds_read_b64_tr_b16 v[208:209], v180 offset:4096
    v_mfma_f32_16x16x32_bf16 v[84:87], v[196:199], v[16:19], v[84:87]
    ds_read_b64_tr_b16 v[210:211], v180 offset:6144
    v_mfma_f32_16x16x32_bf16 v[88:91], v[200:203], v[16:19], v[88:91]
    ds_read_b64_tr_b16 v[212:213], v181 offset:4096
    v_mfma_f32_16x16x32_bf16 v[92:95], v[204:207], v[16:19], v[92:95]
    ds_read_b64_tr_b16 v[214:215], v181 offset:6144
    v_mfma_f32_16x16x32_bf16 v[96:99], v[192:195], v[20:23], v[96:99]
    ds_read_b64_tr_b16 v[216:217], v182 offset:4096
    v_mfma_f32_16x16x32_bf16 v[100:103], v[196:199], v[20:23], v[100:103]
    ds_read_b64_tr_b16 v[218:219], v182 offset:6144
    v_mfma_f32_16x16x32_bf16 v[104:107], v[200:203], v[20:23], v[104:107]
    ds_read_b64_tr_b16 v[220:221], v183 offset:4096
    v_mfma_f32_16x16x32_bf16 v[108:111], v[204:207], v[20:23], v[108:111]
    ds_read_b64_tr_b16 v[222:223], v183 offset:6144
    v_mfma_f32_16x16x32_bf16 v[112:115], v[192:195], v[24:27], v[112:115]
    s_add_u32 m0, s56, 0
    s_add_u32 s58, s55, 786432
    buffer_load_dwordx4 v176, s[8:11], s58 offen offset:0 lds
    v_mfma_f32_16x16x32_bf16 v[116:119], v[196:199], v[24:27], v[116:119]
    s_add_u32 s38, s38, 4096
    buffer_load_dwordx4 v[16:19], v1, s[4:7], s38 offen offset:0 sc1
    v_mfma_f32_16x16x32_bf16 v[120:123], v[200:203], v[24:27], v[120:123]
    buffer_load_dwordx4 v177, s[8:11], s58 offen offset:1024 lds
    v_mfma_f32_16x16x32_bf16 v[124:127], v[204:207], v[24:27], v[124:127]
    s_add_u32 s39, s39, 4096
    buffer_load_dwordx4 v[20:23], v1, s[4:7], s39 offen offset:0 sc1
    v_mfma_f32_16x16x32_bf16 v[128:131], v[192:195], v[28:31], v[128:131]
    buffer_load_dwordx4 v178, s[8:11], s58 offen offset:2048 lds
    v_mfma_f32_16x16x32_bf16 v[132:135], v[196:199], v[28:31], v[132:135]
    s_add_u32 s40, s40, 4096
    buffer_load_dwordx4 v[24:27], v1, s[4:7], s40 offen offset:0 sc1
    v_mfma_f32_16x16x32_bf16 v[136:139], v[200:203], v[28:31], v[136:139]
    buffer_load_dwordx4 v179, s[8:11], s58 offen offset:3072 lds
    v_mfma_f32_16x16x32_bf16 v[140:143], v[204:207], v[28:31], v[140:143]
    s_add_u32 s41, s41, 4096
    buffer_load_dwordx4 v[28:31], v1, s[4:7], s41 offen offset:0 sc1
    s_waitcnt vmcnt(25) lgkmcnt(0)
    v_mfma_f32_16x16x32_bf16 v[80:83], v[208:211], v[32:35], v[80:83]
    ds_read_b64_tr_b16 v[192:193], v180 offset:8192
    v_mfma_f32_16x16x32_bf16 v[84:87], v[212:215], v[32:35], v[84:87]
    ds_read_b64_tr_b16 v[194:195], v180 offset:10240
    v_mfma_f32_16x16x32_bf16 v[88:91], v[216:219], v[32:35], v[88:91]
    ds_read_b64_tr_b16 v[196:197], v181 offset:8192
    v_mfma_f32_16x16x32_bf16 v[92:95], v[220:223], v[32:35], v[92:95]
    ds_read_b64_tr_b16 v[198:199], v181 offset:10240
    v_mfma_f32_16x16x32_bf16 v[96:99], v[208:211], v[36:39], v[96:99]
    ds_read_b64_tr_b16 v[200:201], v182 offset:8192
    v_mfma_f32_16x16x32_bf16 v[100:103], v[212:215], v[36:39], v[100:103]
    ds_read_b64_tr_b16 v[202:203], v182 offset:10240
    v_mfma_f32_16x16x32_bf16 v[104:107], v[216:219], v[36:39], v[104:107]
    ds_read_b64_tr_b16 v[204:205], v183 offset:8192
    v_mfma_f32_16x16x32_bf16 v[108:111], v[220:223], v[36:39], v[108:111]
    ds_read_b64_tr_b16 v[206:207], v183 offset:10240
    v_mfma_f32_16x16x32_bf16 v[112:115], v[208:211], v[40:43], v[112:115]
    s_add_u32 m0, s56, 4096
    s_add_u32 s58, s55, 819200
    buffer_load_dwordx4 v176, s[8:11], s58 offen offset:0 lds
    v_mfma_f32_16x16x32_bf16 v[116:119], v[212:215], v[40:43], v[116:119]
    buffer_load_dwordx4 v[32:35], v1, s[4:7], s38 offen offset:1024 sc1
    v_mfma_f32_16x16x32_bf16 v[120:123], v[216:219], v[40:43], v[120:123]
    buffer_load_dwordx4 v177, s[8:11], s58 offen offset:1024 lds
    v_mfma_f32_16x16x32_bf16 v[124:127], v[220:223], v[40:43], v[124:127]
    buffer_load_dwordx4 v[36:39], v1, s[4:7], s39 offen offset:1024 sc1
    v_mfma_f32_16x16x32_bf16 v[128:131], v[208:211], v[44:47], v[128:131]
    buffer_load_dwordx4 v178, s[8:11], s58 offen offset:2048 lds
    v_mfma_f32_16x16x32_bf16 v[132:135], v[212:215], v[44:47], v[132:135]
    buffer_load_dwordx4 v[40:43], v1, s[4:7], s40 offen offset:1024 sc1
    v_mfma_f32_16x16x32_bf16 v[136:139], v[216:219], v[44:47], v[136:139]
    buffer_load_dwordx4 v179, s[8:11], s58 offen offset:3072 lds
    v_mfma_f32_16x16x32_bf16 v[140:143], v[220:223], v[44:47], v[140:143]
    buffer_load_dwordx4 v[44:47], v1, s[4:7], s41 offen offset:1024 sc1
    s_waitcnt vmcnt(25) lgkmcnt(0)
    v_mfma_f32_16x16x32_bf16 v[80:83], v[192:195], v[48:51], v[80:83]
    ds_read_b64_tr_b16 v[208:209], v180 offset:12288
    v_mfma_f32_16x16x32_bf16 v[84:87], v[196:199], v[48:51], v[84:87]
    ds_read_b64_tr_b16 v[210:211], v180 offset:14336
    v_mfma_f32_16x16x32_bf16 v[88:91], v[200:203], v[48:51], v[88:91]
    ds_read_b64_tr_b16 v[212:213], v181 offset:12288
    v_mfma_f32_16x16x32_bf16 v[92:95], v[204:207], v[48:51], v[92:95]
    ds_read_b64_tr_b16 v[214:215], v181 offset:14336
    v_mfma_f32_16x16x32_bf16 v[96:99], v[192:195], v[52:55], v[96:99]
    ds_read_b64_tr_b16 v[216:217], v182 offset:12288
    v_mfma_f32_16x16x32_bf16 v[100:103], v[196:199], v[52:55], v[100:103]
    ds_read_b64_tr_b16 v[218:219], v182 offset:14336
    v_mfma_f32_16x16x32_bf16 v[104:107], v[200:203], v[52:55], v[104:107]
    ds_read_b64_tr_b16 v[220:221], v183 offset:12288
    v_mfma_f32_16x16x32_bf16 v[108:111], v[204:207], v[52:55], v[108:111]
    ds_read_b64_tr_b16 v[222:223], v183 offset:14336
    v_mfma_f32_16x16x32_bf16 v[112:115], v[192:195], v[56:59], v[112:115]
    s_add_u32 m0, s56, 8192
    s_add_u32 s58, s55, 851968
    buffer_load_dwordx4 v176, s[8:11], s58 offen offset:0 lds
    v_mfma_f32_16x16x32_bf16 v[116:119], v[196:199], v[56:59], v[116:119]
    buffer_load_dwordx4 v[48:51], v1, s[4:7], s38 offen offset:2048 sc1
    v_mfma_f32_16x16x32_bf16 v[120:123], v[200:203], v[56:59], v[120:123]
    buffer_load_dwordx4 v177, s[8:11], s58 offen offset:1024 lds
    v_mfma_f32_16x16x32_bf16 v[124:127], v[204:207], v[56:59], v[124:127]
    buffer_load_dwordx4 v[52:55], v1, s[4:7], s39 offen offset:2048 sc1
    v_mfma_f32_16x16x32_bf16 v[128:131], v[192:195], v[60:63], v[128:131]
    buffer_load_dwordx4 v178, s[8:11], s58 offen offset:2048 lds
    v_mfma_f32_16x16x32_bf16 v[132:135], v[196:199], v[60:63], v[132:135]
    buffer_load_dwordx4 v[56:59], v1, s[4:7], s40 offen offset:2048 sc1
    v_mfma_f32_16x16x32_bf16 v[136:139], v[200:203], v[60:63], v[136:139]
    buffer_load_dwordx4 v179, s[8:11], s58 offen offset:3072 lds
    v_mfma_f32_16x16x32_bf16 v[140:143], v[204:207], v[60:63], v[140:143]
    buffer_load_dwordx4 v[60:63], v1, s[4:7], s41 offen offset:2048 sc1
    s_waitcnt vmcnt(24) lgkmcnt(0)
    v_mfma_f32_16x16x32_bf16 v[80:83], v[208:211], v[64:67], v[80:83]
    ds_read_b64_tr_b16 v[192:193], v248 offset:0
    v_mfma_f32_16x16x32_bf16 v[84:87], v[212:215], v[64:67], v[84:87]
    ds_read_b64_tr_b16 v[194:195], v248 offset:2048
    v_mfma_f32_16x16x32_bf16 v[88:91], v[216:219], v[64:67], v[88:91]
    ds_read_b64_tr_b16 v[196:197], v249 offset:0
    v_mfma_f32_16x16x32_bf16 v[92:95], v[220:223], v[64:67], v[92:95]
    ds_read_b64_tr_b16 v[198:199], v249 offset:2048
    v_mfma_f32_16x16x32_bf16 v[96:99], v[208:211], v[68:71], v[96:99]
    ds_read_b64_tr_b16 v[200:201], v250 offset:0
    v_mfma_f32_16x16x32_bf16 v[100:103], v[212:215], v[68:71], v[100:103]
    ds_read_b64_tr_b16 v[202:203], v250 offset:2048
    v_mfma_f32_16x16x32_bf16 v[104:107], v[216:219], v[68:71], v[104:107]
    ds_read_b64_tr_b16 v[204:205], v251 offset:0
    v_mfma_f32_16x16x32_bf16 v[108:111], v[220:223], v[68:71], v[108:111]
    ds_read_b64_tr_b16 v[206:207], v251 offset:2048
    v_mfma_f32_16x16x32_bf16 v[112:115], v[208:211], v[72:75], v[112:115]
    s_add_u32 m0, s56, 12288
    s_add_u32 s58, s55, 884736
    buffer_load_dwordx4 v176, s[8:11], s58 offen offset:0 lds
    v_mfma_f32_16x16x32_bf16 v[116:119], v[212:215], v[72:75], v[116:119]
    buffer_load_dwordx4 v[64:67], v1, s[4:7], s38 offen offset:3072 sc1
    v_mfma_f32_16x16x32_bf16 v[120:123], v[216:219], v[72:75], v[120:123]
    buffer_load_dwordx4 v177, s[8:11], s58 offen offset:1024 lds
    v_mfma_f32_16x16x32_bf16 v[124:127], v[220:223], v[72:75], v[124:127]
    buffer_load_dwordx4 v[68:71], v1, s[4:7], s39 offen offset:3072 sc1
    v_mfma_f32_16x16x32_bf16 v[128:131], v[208:211], v[76:79], v[128:131]
    buffer_load_dwordx4 v178, s[8:11], s58 offen offset:2048 lds
    v_mfma_f32_16x16x32_bf16 v[132:135], v[212:215], v[76:79], v[132:135]
    buffer_load_dwordx4 v[72:75], v1, s[4:7], s40 offen offset:3072 sc1
    v_mfma_f32_16x16x32_bf16 v[136:139], v[216:219], v[76:79], v[136:139]
    buffer_load_dwordx4 v179, s[8:11], s58 offen offset:3072 lds
    v_mfma_f32_16x16x32_bf16 v[140:143], v[220:223], v[76:79], v[140:143]
    buffer_load_dwordx4 v[76:79], v1, s[4:7], s41 offen offset:3072 sc1
    v_cmp_ne_u32 vcc, 1, v254
    s_cbranch_vccnz L_spin_w
L_ok_w:
    s_waitcnt vmcnt(24) lgkmcnt(0)
    v_mfma_f32_16x16x32_bf16 v[80:83], v[192:195], v[16:19], v[80:83]
    ds_read_b64_tr_b16 v[208:209], v248 offset:4096
    v_mfma_f32_16x16x32_bf16 v[84:87], v[196:199], v[16:19], v[84:87]
    ds_read_b64_tr_b16 v[210:211], v248 offset:6144
    v_mfma_f32_16x16x32_bf16 v[88:91], v[200:203], v[16:19], v[88:91]
    ds_read_b64_tr_b16 v[212:213], v249 offset:4096
    v_mfma_f32_16x16x32_bf16 v[92:95], v[204:207], v[16:19], v[92:95]
    ds_read_b64_tr_b16 v[214:215], v249 offset:6144
    v_mfma_f32_16x16x32_bf16 v[96:99], v[192:195], v[20:23], v[96:99]
    ds_read_b64_tr_b16 v[216:217], v250 offset:4096
    v_mfma_f32_16x16x32_bf16 v[100:103], v[196:199], v[20:23], v[100:103]
    ds_read_b64_tr_b16 v[218:219], v250 offset:6144
    v_mfma_f32_16x16x32_bf16 v[104:107], v[200:203], v[20:23], v[104:107]
    ds_read_b64_tr_b16 v[220:221], v251 offset:4096
    v_mfma_f32_16x16x32_bf16 v[108:111], v[204:207], v[20:23], v[108:111]
    ds_read_b64_tr_b16 v[222:223], v251 offset:6144
    v_mfma_f32_16x16x32_bf16 v[112:115], v[192:195], v[24:27], v[112:115]
    s_add_u32 m0, s56, 65536
    s_add_u32 s58, s55, 917504
    buffer_load_dwordx4 v176, s[8:11], s58 offen offset:0 lds
    v_mfma_f32_16x16x32_bf16 v[116:119], v[196:199], v[24:27], v[116:119]
    s_add_u32 s38, s38, 4096
    buffer_load_dwordx4 v[16:19], v1, s[4:7], s38 offen offset:0 sc1
    v_mfma_f32_16x16x32_bf16 v[120:123], v[200:203], v[24:27], v[120:123]
    buffer_load_dwordx4 v177, s[8:11], s58 offen offset:1024 lds
    v_mfma_f32_16x16x32_bf16 v[124:127], v[204:207], v[24:27], v[124:127]
    s_add_u32 s39, s39, 4096
    buffer_load_dwordx4 v[20:23], v1, s[4:7], s39 offen offset:0 sc1
    v_mfma_f32_16x16x32_bf16 v[128:131], v[192:195], v[28:31], v[128:131]
    buffer_load_dwordx4 v178, s[8:11], s58 offen offset:2048 lds
    v_mfma_f32_16x16x32_bf16 v[132:135], v[196:199], v[28:31], v[132:135]
    s_add_u32 s40, s40, 4096
    buffer_load_dwordx4 v[24:27], v1, s[4:7], s40 offen offset:0 sc1
    v_mfma_f32_16x16x32_bf16 v[136:139], v[200:203], v[28:31], v[136:139]
    buffer_load_dwordx4 v179, s[8:11], s58 offen offset:3072 lds
    v_mfma_f32_16x16x32_bf16 v[140:143], v[204:207], v[28:31], v[140:143]
    s_add_u32 s41, s41, 4096
    buffer_load_dwordx4 v[28:31], v1, s[4:7], s41 offen offset:0 sc1
    s_waitcnt vmcnt(24) lgkmcnt(0)
    v_mfma_f32_16x16x32_bf16 v[80:83], v[208:211], v[32:35], v[80:83]
    ds_read_b64_tr_b16 v[192:193], v248 offset:8192
    v_mfma_f32_16x16x32_bf16 v[84:87], v[212:215], v[32:35], v[84:87]
    ds_read_b64_tr_b16 v[194:195], v248 offset:10240
    v_mfma_f32_16x16x32_bf16 v[88:91], v[216:219], v[32:35], v[88:91]
    ds_read_b64_tr_b16 v[196:197], v249 offset:8192
    v_mfma_f32_16x16x32_bf16 v[92:95], v[220:223], v[32:35], v[92:95]
    ds_read_b64_tr_b16 v[198:199], v249 offset:10240
    v_mfma_f32_16x16x32_bf16 v[96:99], v[208:211], v[36:39], v[96:99]
    ds_read_b64_tr_b16 v[200:201], v250 offset:8192
    v_mfma_f32_16x16x32_bf16 v[100:103], v[212:215], v[36:39], v[100:103]
    ds_read_b64_tr_b16 v[202:203], v250 offset:10240
    v_mfma_f32_16x16x32_bf16 v[104:107], v[216:219], v[36:39], v[104:107]
    ds_read_b64_tr_b16 v[204:205], v251 offset:8192
    v_mfma_f32_16x16x32_bf16 v[108:111], v[220:223], v[36:39], v[108:111]
    ds_read_b64_tr_b16 v[206:207], v251 offset:10240
    v_mfma_f32_16x16x32_bf16 v[112:115], v[208:211], v[40:43], v[112:115]
    s_add_u32 m0, s56, 69632
    s_add_u32 s58, s55, 950272
    buffer_load_dwordx4 v176, s[8:11], s58 offen offset:0 lds
    v_mfma_f32_16x16x32_bf16 v[116:119], v[212:215], v[40:43], v[116:119]
    buffer_load_dwordx4 v[32:35], v1, s[4:7], s38 offen offset:1024 sc1
    v_mfma_f32_16x16x32_bf16 v[120:123], v[216:219], v[40:43], v[120:123]
    buffer_load_dwordx4 v177, s[8:11], s58 offen offset:1024 lds
    v_mfma_f32_16x16x32_bf16 v[124:127], v[220:223], v[40:43], v[124:127]
    buffer_load_dwordx4 v[36:39], v1, s[4:7], s39 offen offset:1024 sc1
    v_mfma_f32_16x16x32_bf16 v[128:131], v[208:211], v[44:47], v[128:131]
    buffer_load_dwordx4 v178, s[8:11], s58 offen offset:2048 lds
    v_mfma_f32_16x16x32_bf16 v[132:135], v[212:215], v[44:47], v[132:135]
    buffer_load_dwordx4 v[40:43], v1, s[4:7], s40 offen offset:1024 sc1
    v_mfma_f32_16x16x32_bf16 v[136:139], v[216:219], v[44:47], v[136:139]
    buffer_load_dwordx4 v179, s[8:11], s58 offen offset:3072 lds
    v_mfma_f32_16x16x32_bf16 v[140:143], v[220:223], v[44:47], v[140:143]
    buffer_load_dwordx4 v[44:47], v1, s[4:7], s41 offen offset:1024 sc1
    s_waitcnt vmcnt(24) lgkmcnt(0)
    v_mfma_f32_16x16x32_bf16 v[80:83], v[192:195], v[48:51], v[80:83]
    ds_read_b64_tr_b16 v[208:209], v248 offset:12288
    v_mfma_f32_16x16x32_bf16 v[84:87], v[196:199], v[48:51], v[84:87]
    ds_read_b64_tr_b16 v[210:211], v248 offset:14336
    v_mfma_f32_16x16x32_bf16 v[88:91], v[200:203], v[48:51], v[88:91]
    ds_read_b64_tr_b16 v[212:213], v249 offset:12288
    v_mfma_f32_16x16x32_bf16 v[92:95], v[204:207], v[48:51], v[92:95]
    ds_read_b64_tr_b16 v[214:215], v249 offset:14336
    v_mfma_f32_16x16x32_bf16 v[96:99], v[192:195], v[52:55], v[96:99]
    ds_read_b64_tr_b16 v[216:217], v250 offset:12288
    v_mfma_f32_16x16x32_bf16 v[100:103], v[196:199], v[52:55], v[100:103]
    ds_read_b64_tr_b16 v[218:219], v250 offset:14336
    v_mfma_f32_16x16x32_bf16 v[104:107], v[200:203], v[52:55], v[104:107]
    ds_read_b64_tr_b16 v[220:221], v251 offset:12288
    v_mfma_f32_16x16x32_bf16 v[108:111], v[204:207], v[52:55], v[108:111]
    ds_read_b64_tr_b16 v[222:223], v251 offset:14336
    v_mfma_f32_16x16x32_bf16 v[112:115], v[192:195], v[56:59], v[112:115]
    s_add_u32 m0, s56, 73728
    s_add_u32 s58, s55, 983040
    buffer_load_dwordx4 v176, s[8:11], s58 offen offset:0 lds
    v_mfma_f32_16x16x32_bf16 v[116:119], v[196:199], v[56:59], v[116:119]
    buffer_load_dwordx4 v[48:51], v1, s[4:7], s38 offen offset:2048 sc1
    v_mfma_f32_16x16x32_bf16 v[120:123], v[200:203], v[56:59], v[120:123]
    buffer_load_dwordx4 v177, s[8:11], s58 offen offset:1024 lds
    v_mfma_f32_16x16x32_bf16 v[124:127], v[204:207], v[56:59], v[124:127]
    buffer_load_dwordx4 v[52:55], v1, s[4:7], s39 offen offset:2048 sc1
    v_mfma_f32_16x16x32_bf16 v[128:131], v[192:195], v[60:63], v[128:131]
    buffer_load_dwordx4 v178, s[8:11], s58 offen offset:2048 lds
    v_mfma_f32_16x16x32_bf16 v[132:135], v[196:199], v[60:63], v[132:135]
    buffer_load_dwordx4 v[56:59], v1, s[4:7], s40 offen offset:2048 sc1
    v_mfma_f32_16x16x32_bf16 v[136:139], v[200:203], v[60:63], v[136:139]
    buffer_load_dwordx4 v179, s[8:11], s58 offen offset:3072 lds
    v_mfma_f32_16x16x32_bf16 v[140:143], v[204:207], v[60:63], v[140:143]
    buffer_load_dwordx4 v[60:63], v1, s[4:7], s41 offen offset:2048 sc1
    s_waitcnt vmcnt(24) lgkmcnt(0)
    v_mfma_f32_16x16x32_bf16 v[80:83], v[208:211], v[64:67], v[80:83]
    ds_read_b64_tr_b16 v[192:193], v180 offset:0
    v_mfma_f32_16x16x32_bf16 v[84:87], v[212:215], v[64:67], v[84:87]
    ds_read_b64_tr_b16 v[194:195], v180 offset:2048
    v_mfma_f32_16x16x32_bf16 v[88:91], v[216:219], v[64:67], v[88:91]
    ds_read_b64_tr_b16 v[196:197], v181 offset:0
    v_mfma_f32_16x16x32_bf16 v[92:95], v[220:223], v[64:67], v[92:95]
    ds_read_b64_tr_b16 v[198:199], v181 offset:2048
    v_mfma_f32_16x16x32_bf16 v[96:99], v[208:211], v[68:71], v[96:99]
    ds_read_b64_tr_b16 v[200:201], v182 offset:0
    v_mfma_f32_16x16x32_bf16 v[100:103], v[212:215], v[68:71], v[100:103]
    ds_read_b64_tr_b16 v[202:203], v182 offset:2048
    v_mfma_f32_16x16x32_bf16 v[104:107], v[216:219], v[68:71], v[104:107]
    ds_read_b64_tr_b16 v[204:205], v183 offset:0
    v_mfma_f32_16x16x32_bf16 v[108:111], v[220:223], v[68:71], v[108:111]
    ds_read_b64_tr_b16 v[206:207], v183 offset:2048
    v_mfma_f32_16x16x32_bf16 v[112:115], v[208:211], v[72:75], v[112:115]
    s_add_u32 m0, s56, 77824
    s_add_u32 s58, s55, 1015808
    buffer_load_dwordx4 v176, s[8:11], s58 offen offset:0 lds
    v_mfma_f32_16x16x32_bf16 v[116:119], v[212:215], v[72:75], v[116:119]
    buffer_load_dwordx4 v[64:67], v1, s[4:7], s38 offen offset:3072 sc1
    v_mfma_f32_16x16x32_bf16 v[120:123], v[216:219], v[72:75], v[120:123]
    buffer_load_dwordx4 v177, s[8:11], s58 offen offset:1024 lds
    v_mfma_f32_16x16x32_bf16 v[124:127], v[220:223], v[72:75], v[124:127]
    buffer_load_dwordx4 v[68:71], v1, s[4:7], s39 offen offset:3072 sc1
    v_mfma_f32_16x16x32_bf16 v[128:131], v[208:211], v[76:79], v[128:131]
    buffer_load_dwordx4 v178, s[8:11], s58 offen offset:2048 lds
    v_mfma_f32_16x16x32_bf16 v[132:135], v[212:215], v[76:79], v[132:135]
    buffer_load_dwordx4 v[72:75], v1, s[4:7], s40 offen offset:3072 sc1
    v_mfma_f32_16x16x32_bf16 v[136:139], v[216:219], v[76:79], v[136:139]
    buffer_load_dwordx4 v179, s[8:11], s58 offen offset:3072 lds
    v_mfma_f32_16x16x32_bf16 v[140:143], v[220:223], v[76:79], v[140:143]
    buffer_load_dwordx4 v[76:79], v1, s[4:7], s41 offen offset:3072 sc1
    s_waitcnt vmcnt(24) lgkmcnt(0)
    v_mfma_f32_16x16x32_bf16 v[80:83], v[192:195], v[16:19], v[80:83]
    ds_read_b64_tr_b16 v[208:209], v180 offset:4096
    v_mfma_f32_16x16x32_bf16 v[84:87], v[196:199], v[16:19], v[84:87]
    ds_read_b64_tr_b16 v[210:211], v180 offset:6144
    v_mfma_f32_16x16x32_bf16 v[88:91], v[200:203], v[16:19], v[88:91]
    ds_read_b64_tr_b16 v[212:213], v181 offset:4096
    v_mfma_f32_16x16x32_bf16 v[92:95], v[204:207], v[16:19], v[92:95]
    ds_read_b64_tr_b16 v[214:215], v181 offset:6144
    v_mfma_f32_16x16x32_bf16 v[96:99], v[192:195], v[20:23], v[96:99]
    ds_read_b64_tr_b16 v[216:217], v182 offset:4096
    v_mfma_f32_16x16x32_bf16 v[100:103], v[196:199], v[20:23], v[100:103]
    ds_read_b64_tr_b16 v[218:219], v182 offset:6144
    v_mfma_f32_16x16x32_bf16 v[104:107], v[200:203], v[20:23], v[104:107]
    ds_read_b64_tr_b16 v[220:221], v183 offset:4096
    v_mfma_f32_16x16x32_bf16 v[108:111], v[204:207], v[20:23], v[108:111]
    ds_read_b64_tr_b16 v[222:223], v183 offset:6144
    v_mfma_f32_16x16x32_bf16 v[112:115], v[192:195], v[24:27], v[112:115]
    v_mfma_f32_16x16x32_bf16 v[116:119], v[196:199], v[24:27], v[116:119]
    s_add_u32 s38, s38, 4096
    buffer_load_dwordx4 v[16:19], v1, s[4:7], s38 offen offset:0 sc1
    v_mfma_f32_16x16x32_bf16 v[120:123], v[200:203], v[24:27], v[120:123]
    v_mfma_f32_16x16x32_bf16 v[124:127], v[204:207], v[24:27], v[124:127]
    s_add_u32 s39, s39, 4096
    buffer_load_dwordx4 v[20:23], v1, s[4:7], s39 offen offset:0 sc1
    v_mfma_f32_16x16x32_bf16 v[128:131], v[192:195], v[28:31], v[128:131]
    v_mfma_f32_16x16x32_bf16 v[132:135], v[196:199], v[28:31], v[132:135]
    s_add_u32 s40, s40, 4096
    buffer_load_dwordx4 v[24:27], v1, s[4:7], s40 offen offset:0 sc1
    v_mfma_f32_16x16x32_bf16 v[136:139], v[200:203], v[28:31], v[136:139]
    v_mfma_f32_16x16x32_bf16 v[140:143], v[204:207], v[28:31], v[140:143]
    s_add_u32 s41, s41, 4096
    buffer_load_dwordx4 v[28:31], v1, s[4:7], s41 offen offset:0 sc1
    s_waitcnt vmcnt(20) lgkmcnt(0)
    v_mfma_f32_16x16x32_bf16 v[80:83], v[208:211], v[32:35], v[80:83]
    ds_read_b64_tr_b16 v[192:193], v180 offset:8192
    v_mfma_f32_16x16x32_bf16 v[84:87], v[212:215], v[32:35], v[84:87]
    ds_read_b64_tr_b16 v[194:195], v180 offset:10240
    v_mfma_f32_16x16x32_bf16 v[88:91], v[216:219], v[32:35], v[88:91]
    ds_read_b64_tr_b16 v[196:197], v181 offset:8192
    v_mfma_f32_16x16x32_bf16 v[92:95], v[220:223], v[32:35], v[92:95]
    ds_read_b64_tr_b16 v[198:199], v181 offset:10240
    v_mfma_f32_16x16x32_bf16 v[96:99], v[208:211], v[36:39], v[96:99]
    ds_read_b64_tr_b16 v[200:201], v182 offset:8192
    v_mfma_f32_16x16x32_bf16 v[100:103], v[212:215], v[36:39], v[100:103]
    ds_read_b64_tr_b16 v[202:203], v182 offset:10240
    v_mfma_f32_16x16x32_bf16 v[104:107], v[216:219], v[36:39], v[104:107]
    ds_read_b64_tr_b16 v[204:205], v183 offset:8192
    v_mfma_f32_16x16x32_bf16 v[108:111], v[220:223], v[36:39], v[108:111]
    ds_read_b64_tr_b16 v[206:207], v183 offset:10240
    v_mfma_f32_16x16x32_bf16 v[112:115], v[208:211], v[40:43], v[112:115]
    v_mfma_f32_16x16x32_bf16 v[116:119], v[212:215], v[40:43], v[116:119]
    buffer_load_dwordx4 v[32:35], v1, s[4:7], s38 offen offset:1024 sc1
    v_mfma_f32_16x16x32_bf16 v[120:123], v[216:219], v[40:43], v[120:123]
    v_mfma_f32_16x16x32_bf16 v[124:127], v[220:223], v[40:43], v[124:127]
    buffer_load_dwordx4 v[36:39], v1, s[4:7], s39 offen offset:1024 sc1
    v_mfma_f32_16x16x32_bf16 v[128:131], v[208:211], v[44:47], v[128:131]
    v_mfma_f32_16x16x32_bf16 v[132:135], v[212:215], v[44:47], v[132:135]
    buffer_load_dwordx4 v[40:43], v1, s[4:7], s40 offen offset:1024 sc1
    v_mfma_f32_16x16x32_bf16 v[136:139], v[216:219], v[44:47], v[136:139]
    v_mfma_f32_16x16x32_bf16 v[140:143], v[220:223], v[44:47], v[140:143]
    buffer_load_dwordx4 v[44:47], v1, s[4:7], s41 offen offset:1024 sc1
    s_waitcnt vmcnt(16) lgkmcnt(0)
    v_mfma_f32_16x16x32_bf16 v[80:83], v[192:195], v[48:51], v[80:83]
    ds_read_b64_tr_b16 v[208:209], v180 offset:12288
    v_mfma_f32_16x16x32_bf16 v[84:87], v[196:199], v[48:51], v[84:87]
    ds_read_b64_tr_b16 v[210:211], v180 offset:14336
    v_mfma_f32_16x16x32_bf16 v[88:91], v[200:203], v[48:51], v[88:91]
    ds_read_b64_tr_b16 v[212:213], v181 offset:12288
    v_mfma_f32_16x16x32_bf16 v[92:95], v[204:207], v[48:51], v[92:95]
    ds_read_b64_tr_b16 v[214:215], v181 offset:14336
    v_mfma_f32_16x16x32_bf16 v[96:99], v[192:195], v[52:55], v[96:99]
    ds_read_b64_tr_b16 v[216:217], v182 offset:12288
    v_mfma_f32_16x16x32_bf16 v[100:103], v[196:199], v[52:55], v[100:103]
    ds_read_b64_tr_b16 v[218:219], v182 offset:14336
    v_mfma_f32_16x16x32_bf16 v[104:107], v[200:203], v[52:55], v[104:107]
    ds_read_b64_tr_b16 v[220:221], v183 offset:12288
    v_mfma_f32_16x16x32_bf16 v[108:111], v[204:207], v[52:55], v[108:111]
    ds_read_b64_tr_b16 v[222:223], v183 offset:14336
    v_mfma_f32_16x16x32_bf16 v[112:115], v[192:195], v[56:59], v[112:115]
    v_mfma_f32_16x16x32_bf16 v[116:119], v[196:199], v[56:59], v[116:119]
    buffer_load_dwordx4 v[48:51], v1, s[4:7], s38 offen offset:2048 sc1
    v_mfma_f32_16x16x32_bf16 v[120:123], v[200:203], v[56:59], v[120:123]
    v_mfma_f32_16x16x32_bf16 v[124:127], v[204:207], v[56:59], v[124:127]
    buffer_load_dwordx4 v[52:55], v1, s[4:7], s39 offen offset:2048 sc1
    v_mfma_f32_16x16x32_bf16 v[128:131], v[192:195], v[60:63], v[128:131]
    v_mfma_f32_16x16x32_bf16 v[132:135], v[196:199], v[60:63], v[132:135]
    buffer_load_dwordx4 v[56:59], v1, s[4:7], s40 offen offset:2048 sc1
    v_mfma_f32_16x16x32_bf16 v[136:139], v[200:203], v[60:63], v[136:139]
    v_mfma_f32_16x16x32_bf16 v[140:143], v[204:207], v[60:63], v[140:143]
    buffer_load_dwordx4 v[60:63], v1, s[4:7], s41 offen offset:2048 sc1
    s_waitcnt vmcnt(12) lgkmcnt(0)
    v_mfma_f32_16x16x32_bf16 v[80:83], v[208:211], v[64:67], v[80:83]
    ds_read_b64_tr_b16 v[192:193], v248 offset:0
    v_mfma_f32_16x16x32_bf16 v[84:87], v[212:215], v[64:67], v[84:87]
    ds_read_b64_tr_b16 v[194:195], v248 offset:2048
    v_mfma_f32_16x16x32_bf16 v[88:91], v[216:219], v[64:67], v[88:91]
    ds_read_b64_tr_b16 v[196:197], v249 offset:0
    v_mfma_f32_16x16x32_bf16 v[92:95], v[220:223], v[64:67], v[92:95]
    ds_read_b64_tr_b16 v[198:199], v249 offset:2048
    v_mfma_f32_16x16x32_bf16 v[96:99], v[208:211], v[68:71], v[96:99]
    ds_read_b64_tr_b16 v[200:201], v250 offset:0
    v_mfma_f32_16x16x32_bf16 v[100:103], v[212:215], v[68:71], v[100:103]
    ds_read_b64_tr_b16 v[202:203], v250 offset:2048
    v_mfma_f32_16x16x32_bf16 v[104:107], v[216:219], v[68:71], v[104:107]
    ds_read_b64_tr_b16 v[204:205], v251 offset:0
    v_mfma_f32_16x16x32_bf16 v[108:111], v[220:223], v[68:71], v[108:111]
    ds_read_b64_tr_b16 v[206:207], v251 offset:2048
    v_mfma_f32_16x16x32_bf16 v[112:115], v[208:211], v[72:75], v[112:115]
    v_mfma_f32_16x16x32_bf16 v[116:119], v[212:215], v[72:75], v[116:119]
    buffer_load_dwordx4 v[64:67], v1, s[4:7], s38 offen offset:3072 sc1
    v_mfma_f32_16x16x32_bf16 v[120:123], v[216:219], v[72:75], v[120:123]
    v_mfma_f32_16x16x32_bf16 v[124:127], v[220:223], v[72:75], v[124:127]
    buffer_load_dwordx4 v[68:71], v1, s[4:7], s39 offen offset:3072 sc1
    v_mfma_f32_16x16x32_bf16 v[128:131], v[208:211], v[76:79], v[128:131]
    v_mfma_f32_16x16x32_bf16 v[132:135], v[212:215], v[76:79], v[132:135]
    buffer_load_dwordx4 v[72:75], v1, s[4:7], s40 offen offset:3072 sc1
    v_mfma_f32_16x16x32_bf16 v[136:139], v[216:219], v[76:79], v[136:139]
    v_mfma_f32_16x16x32_bf16 v[140:143], v[220:223], v[76:79], v[140:143]
    buffer_load_dwordx4 v[76:79], v1, s[4:7], s41 offen offset:3072 sc1
    buffer_load_dwordx2 v[224:225], v188, s[20:23], s45 offen offset:0
    buffer_load_dwordx2 v[226:227], v188, s[20:23], s45 offen offset:32
    buffer_load_dwordx2 v[228:229], v188, s[20:23], s45 offen offset:64
    buffer_load_dwordx2 v[230:231], v188, s[20:23], s45 offen offset:96
    s_waitcnt vmcnt(16) lgkmcnt(0)
    v_mfma_f32_16x16x32_bf16 v[80:83], v[192:195], v[16:19], v[80:83]
    ds_read_b64_tr_b16 v[208:209], v248 offset:4096
    v_mfma_f32_16x16x32_bf16 v[84:87], v[196:199], v[16:19], v[84:87]
    ds_read_b64_tr_b16 v[210:211], v248 offset:6144
    v_mfma_f32_16x16x32_bf16 v[88:91], v[200:203], v[16:19], v[88:91]
    ds_read_b64_tr_b16 v[212:213], v249 offset:4096
    v_mfma_f32_16x16x32_bf16 v[92:95], v[204:207], v[16:19], v[92:95]
    ds_read_b64_tr_b16 v[214:215], v249 offset:6144
    v_mfma_f32_16x16x32_bf16 v[96:99], v[192:195], v[20:23], v[96:99]
    ds_read_b64_tr_b16 v[216:217], v250 offset:4096
    v_mfma_f32_16x16x32_bf16 v[100:103], v[196:199], v[20:23], v[100:103]
    ds_read_b64_tr_b16 v[218:219], v250 offset:6144
    v_mfma_f32_16x16x32_bf16 v[104:107], v[200:203], v[20:23], v[104:107]
    ds_read_b64_tr_b16 v[220:221], v251 offset:4096
    v_mfma_f32_16x16x32_bf16 v[108:111], v[204:207], v[20:23], v[108:111]
    ds_read_b64_tr_b16 v[222:223], v251 offset:6144
    v_mfma_f32_16x16x32_bf16 v[112:115], v[192:195], v[24:27], v[112:115]
    v_mfma_f32_16x16x32_bf16 v[116:119], v[196:199], v[24:27], v[116:119]
    v_mfma_f32_16x16x32_bf16 v[120:123], v[200:203], v[24:27], v[120:123]
    v_mfma_f32_16x16x32_bf16 v[124:127], v[204:207], v[24:27], v[124:127]
    v_mfma_f32_16x16x32_bf16 v[128:131], v[192:195], v[28:31], v[128:131]
    v_mfma_f32_16x16x32_bf16 v[132:135], v[196:199], v[28:31], v[132:135]
    v_mfma_f32_16x16x32_bf16 v[136:139], v[200:203], v[28:31], v[136:139]
    v_mfma_f32_16x16x32_bf16 v[140:143], v[204:207], v[28:31], v[140:143]
    s_waitcnt vmcnt(12) lgkmcnt(0)
    v_mfma_f32_16x16x32_bf16 v[80:83], v[208:211], v[32:35], v[80:83]
    ds_read_b64_tr_b16 v[192:193], v248 offset:8192
    v_mfma_f32_16x16x32_bf16 v[84:87], v[212:215], v[32:35], v[84:87]
    ds_read_b64_tr_b16 v[194:195], v248 offset:10240
    v_mfma_f32_16x16x32_bf16 v[88:91], v[216:219], v[32:35], v[88:91]
    ds_read_b64_tr_b16 v[196:197], v249 offset:8192
    v_mfma_f32_16x16x32_bf16 v[92:95], v[220:223], v[32:35], v[92:95]
    ds_read_b64_tr_b16 v[198:199], v249 offset:10240
    v_mfma_f32_16x16x32_bf16 v[96:99], v[208:211], v[36:39], v[96:99]
    ds_read_b64_tr_b16 v[200:201], v250 offset:8192
    v_mfma_f32_16x16x32_bf16 v[100:103], v[212:215], v[36:39], v[100:103]
    ds_read_b64_tr_b16 v[202:203], v250 offset:10240
    v_mfma_f32_16x16x32_bf16 v[104:107], v[216:219], v[36:39], v[104:107]
    ds_read_b64_tr_b16 v[204:205], v251 offset:8192
    v_mfma_f32_16x16x32_bf16 v[108:111], v[220:223], v[36:39], v[108:111]
    ds_read_b64_tr_b16 v[206:207], v251 offset:10240
    v_mfma_f32_16x16x32_bf16 v[112:115], v[208:211], v[40:43], v[112:115]
    v_mfma_f32_16x16x32_bf16 v[116:119], v[212:215], v[40:43], v[116:119]
    v_mfma_f32_16x16x32_bf16 v[120:123], v[216:219], v[40:43], v[120:123]
    v_mfma_f32_16x16x32_bf16 v[124:127], v[220:223], v[40:43], v[124:127]
    v_mfma_f32_16x16x32_bf16 v[128:131], v[208:211], v[44:47], v[128:131]
    v_mfma_f32_16x16x32_bf16 v[132:135], v[212:215], v[44:47], v[132:135]
    v_mfma_f32_16x16x32_bf16 v[136:139], v[216:219], v[44:47], v[136:139]
    v_mfma_f32_16x16x32_bf16 v[140:143], v[220:223], v[44:47], v[140:143]
    s_waitcnt vmcnt(8) lgkmcnt(0)
    v_mfma_f32_16x16x32_bf16 v[80:83], v[192:195], v[48:51], v[80:83]
    ds_read_b64_tr_b16 v[208:209], v248 offset:12288
    v_mfma_f32_16x16x32_bf16 v[84:87], v[196:199], v[48:51], v[84:87]
    ds_read_b64_tr_b16 v[210:211], v248 offset:14336
    v_mfma_f32_16x16x32_bf16 v[88:91], v[200:203], v[48:51], v[88:91]
    ds_read_b64_tr_b16 v[212:213], v249 offset:12288
    v_mfma_f32_16x16x32_bf16 v[92:95], v[204:207], v[48:51], v[92:95]
    ds_read_b64_tr_b16 v[214:215], v249 offset:14336
    v_mfma_f32_16x16x32_bf16 v[96:99], v[192:195], v[52:55], v[96:99]
    ds_read_b64_tr_b16 v[216:217], v250 offset:12288
    v_mfma_f32_16x16x32_bf16 v[100:103], v[196:199], v[52:55], v[100:103]
    ds_read_b64_tr_b16 v[218:219], v250 offset:14336
    v_mfma_f32_16x16x32_bf16 v[104:107], v[200:203], v[52:55], v[104:107]
    ds_read_b64_tr_b16 v[220:221], v251 offset:12288
    v_mfma_f32_16x16x32_bf16 v[108:111], v[204:207], v[52:55], v[108:111]
    ds_read_b64_tr_b16 v[222:223], v251 offset:14336
    v_mfma_f32_16x16x32_bf16 v[112:115], v[192:195], v[56:59], v[112:115]
    v_mfma_f32_16x16x32_bf16 v[116:119], v[196:199], v[56:59], v[116:119]
    v_mfma_f32_16x16x32_bf16 v[120:123], v[200:203], v[56:59], v[120:123]
    v_mfma_f32_16x16x32_bf16 v[124:127], v[204:207], v[56:59], v[124:127]
    v_mfma_f32_16x16x32_bf16 v[128:131], v[192:195], v[60:63], v[128:131]
    v_mfma_f32_16x16x32_bf16 v[132:135], v[196:199], v[60:63], v[132:135]
    v_mfma_f32_16x16x32_bf16 v[136:139], v[200:203], v[60:63], v[136:139]
    v_mfma_f32_16x16x32_bf16 v[140:143], v[204:207], v[60:63], v[140:143]
    s_waitcnt vmcnt(4) lgkmcnt(0)
    v_mfma_f32_16x16x32_bf16 v[80:83], v[208:211], v[64:67], v[80:83]
    v_mfma_f32_16x16x32_bf16 v[84:87], v[212:215], v[64:67], v[84:87]
    v_mfma_f32_16x16x32_bf16 v[88:91], v[216:219], v[64:67], v[88:91]
    v_mfma_f32_16x16x32_bf16 v[92:95], v[220:223], v[64:67], v[92:95]
    v_mfma_f32_16x16x32_bf16 v[96:99], v[208:211], v[68:71], v[96:99]
    v_mfma_f32_16x16x32_bf16 v[100:103], v[212:215], v[68:71], v[100:103]
    v_mfma_f32_16x16x32_bf16 v[104:107], v[216:219], v[68:71], v[104:107]
    v_mfma_f32_16x16x32_bf16 v[108:111], v[220:223], v[68:71], v[108:111]
    v_mfma_f32_16x16x32_bf16 v[112:115], v[208:211], v[72:75], v[112:115]
    v_mfma_f32_16x16x32_bf16 v[116:119], v[212:215], v[72:75], v[116:119]
    v_mfma_f32_16x16x32_bf16 v[120:123], v[216:219], v[72:75], v[120:123]
    v_mfma_f32_16x16x32_bf16 v[124:127], v[220:223], v[72:75], v[124:127]
    v_mfma_f32_16x16x32_bf16 v[128:131], v[208:211], v[76:79], v[128:131]
    v_mfma_f32_16x16x32_bf16 v[132:135], v[212:215], v[76:79], v[132:135]
    v_mfma_f32_16x16x32_bf16 v[136:139], v[216:219], v[76:79], v[136:139]
    v_mfma_f32_16x16x32_bf16 v[140:143], v[220:223], v[76:79], v[140:143]
    ds_write_b128 v185, v[96:99] offset:0
    ds_write_b128 v185, v[100:103] offset:1024
    ds_write_b128 v185, v[104:107] offset:2048
    ds_write_b128 v185, v[108:111] offset:3072
    ds_write_b128 v186, v[112:115] offset:0
    ds_write_b128 v186, v[116:119] offset:1024
    ds_write_b128 v186, v[120:123] offset:2048
    ds_write_b128 v186, v[124:127] offset:3072
    ds_write_b128 v187, v[128:131] offset:0
    ds_write_b128 v187, v[132:135] offset:1024
    ds_write_b128 v187, v[136:139] offset:2048
    ds_write_b128 v187, v[140:143] offset:3072
    s_waitcnt vmcnt(3)
    v_lshlrev_b32 v16, 16, v224
    v_and_b32 v17, 0xffff0000, v224
    v_add_f32 v80, v80, v16
    v_add_f32 v81, v81, v17
    v_lshlrev_b32 v16, 16, v225
    v_and_b32 v17, 0xffff0000, v225
    v_add_f32 v82, v82, v16
    v_add_f32 v83, v83, v17
    s_waitcnt vmcnt(2)
    v_lshlrev_b32 v16, 16, v226
    v_and_b32 v17, 0xffff0000, v226
    v_add_f32 v84, v84, v16
    v_add_f32 v85, v85, v17
    v_lshlrev_b32 v16, 16, v227
    v_and_b32 v17, 0xffff0000, v227
    v_add_f32 v86, v86, v16
    v_add_f32 v87, v87, v17
    s_waitcnt vmcnt(1)
    v_lshlrev_b32 v16, 16, v228
    v_and_b32 v17, 0xffff0000, v228
    v_add_f32 v88, v88, v16
    v_add_f32 v89, v89, v17
    v_lshlrev_b32 v16, 16, v229
    v_and_b32 v17, 0xffff0000, v229
    v_add_f32 v90, v90, v16
    v_add_f32 v91, v91, v17
    s_waitcnt vmcnt(0)
    v_lshlrev_b32 v16, 16, v230
    v_and_b32 v17, 0xffff0000, v230
    v_add_f32 v92, v92, v16
    v_add_f32 v93, v93, v17
    v_lshlrev_b32 v16, 16, v231
    v_and_b32 v17, 0xffff0000, v231
    v_add_f32 v94, v94, v16
    v_add_f32 v95, v95, v17
    s_add_u32 s58, s3, 1
    s_and_b32 s58, s58, 3
    s_lshl_b32 s58, s58, 14
    s_lshl_b32 s37, s3, 12
    s_add_u32 s58, s58, s37
    v_add_u32 v188, s58, v1
    s_add_u32 s58, s3, 2
    s_and_b32 s58, s58, 3
    s_lshl_b32 s58, s58, 14
    s_lshl_b32 s37, s3, 12
    s_add_u32 s58, s58, s37
    v_add_u32 v189, s58, v1
    s_add_u32 s58, s3, 3
    s_and_b32 s58, s58, 3
    s_lshl_b32 s58, s58, 14
    s_lshl_b32 s37, s3, 12
    s_add_u32 s58, s58, s37
    v_add_u32 v190, s58, v1
    s_lshl_b32 s37, s34, 2
    s_add_u32 s37, s37, s3
    s_mul_i32 s58, s37, 21504
    s_lshl_b32 s38, s35, 11
    s_add_u32 s58, s58, s38
    s_add_u32 s58, s58, 60817408
    s_lshl_b32 s38, s35, 7
    s_add_u32 s37, s37, s38
    s_lshl_b32 s37, s37, 7
    s_add_u32 s37, s37, 63963136
    s_waitcnt lgkmcnt(0)
    s_barrier
    ds_read_b128 v[16:19], v188 offset:0
    ds_read_b128 v[20:23], v188 offset:1024
    ds_read_b128 v[24:27], v188 offset:2048
    ds_read_b128 v[28:31], v188 offset:3072
    ds_read_b128 v[32:35], v189 offset:0
    ds_read_b128 v[36:39], v189 offset:1024
    ds_read_b128 v[40:43], v189 offset:2048
    ds_read_b128 v[44:47], v189 offset:3072
    ds_read_b128 v[48:51], v190 offset:0
    ds_read_b128 v[52:55], v190 offset:1024
    ds_read_b128 v[56:59], v190 offset:2048
    ds_read_b128 v[60:63], v190 offset:3072
    s_waitcnt lgkmcnt(11)
    v_add_f32 v80, v80, v16
    v_add_f32 v81, v81, v17
    v_add_f32 v82, v82, v18
    v_add_f32 v83, v83, v19
    s_waitcnt lgkmcnt(10)
    v_add_f32 v84, v84, v20
    v_add_f32 v85, v85, v21
    v_add_f32 v86, v86, v22
    v_add_f32 v87, v87, v23
    s_waitcnt lgkmcnt(9)
    v_add_f32 v88, v88, v24
    v_add_f32 v89, v89, v25
    v_add_f32 v90, v90, v26
    v_add_f32 v91, v91, v27
    s_waitcnt lgkmcnt(8)
    v_add_f32 v92, v92, v28
    v_add_f32 v93, v93, v29
    v_add_f32 v94, v94, v30
    v_add_f32 v95, v95, v31
    s_waitcnt lgkmcnt(7)
    v_add_f32 v80, v80, v32
    v_add_f32 v81, v81, v33
    v_add_f32 v82, v82, v34
    v_add_f32 v83, v83, v35
    s_waitcnt lgkmcnt(6)
    v_add_f32 v84, v84, v36
    v_add_f32 v85, v85, v37
    v_add_f32 v86, v86, v38
    v_add_f32 v87, v87, v39
    s_waitcnt lgkmcnt(5)
    v_add_f32 v88, v88, v40
    v_add_f32 v89, v89, v41
    v_add_f32 v90, v90, v42
    v_add_f32 v91, v91, v43
    s_waitcnt lgkmcnt(4)
    v_add_f32 v92, v92, v44
    v_add_f32 v93, v93, v45
    v_add_f32 v94, v94, v46
    v_add_f32 v95, v95, v47
    s_waitcnt lgkmcnt(3)
    v_add_f32 v80, v80, v48
    v_add_f32 v81, v81, v49
    v_add_f32 v82, v82, v50
    v_add_f32 v83, v83, v51
    s_waitcnt lgkmcnt(2)
    v_add_f32 v84, v84, v52
    v_add_f32 v85, v85, v53
    v_add_f32 v86, v86, v54
    v_add_f32 v87, v87, v55
    s_waitcnt lgkmcnt(1)
    v_add_f32 v88, v88, v56
    v_add_f32 v89, v89, v57
    v_add_f32 v90, v90, v58
    v_add_f32 v91, v91, v59
    s_waitcnt lgkmcnt(0)
    v_add_f32 v92, v92, v60
    v_add_f32 v93, v93, v61
    v_add_f32 v94, v94, v62
    v_add_f32 v95, v95, v63
    v_cvt_pk_bf16_f32 v240, v80, v81
    v_cvt_pk_bf16_f32 v241, v82, v83
    v_cvt_pk_bf16_f32 v242, v84, v85
    v_cvt_pk_bf16_f32 v243, v86, v87
    v_cvt_pk_bf16_f32 v244, v88, v89
    v_cvt_pk_bf16_f32 v245, v90, v91
    v_cvt_pk_bf16_f32 v246, v92, v93
    v_cvt_pk_bf16_f32 v247, v94, v95
    buffer_store_dwordx4 v[240:243], v1, s[4:7], s58 offen sc1
    buffer_store_dwordx4 v[244:247], v1, s[4:7], s58 offen offset:1024 sc1
    v_lshlrev_b32 v16, 16, v240
    v_and_b32 v17, 0xffff0000, v240
    v_lshlrev_b32 v18, 16, v241
    v_and_b32 v19, 0xffff0000, v241
    v_lshlrev_b32 v20, 16, v242
    v_and_b32 v21, 0xffff0000, v242
    v_lshlrev_b32 v22, 16, v243
    v_and_b32 v23, 0xffff0000, v243
    v_lshlrev_b32 v24, 16, v244
    v_and_b32 v25, 0xffff0000, v244
    v_lshlrev_b32 v26, 16, v245
    v_and_b32 v27, 0xffff0000, v245
    v_lshlrev_b32 v28, 16, v246
    v_and_b32 v29, 0xffff0000, v246
    v_lshlrev_b32 v30, 16, v247
    v_and_b32 v31, 0xffff0000, v247
    v_add_f32 v32, v16, v17
    v_mul_f32 v33, v16, v16
    v_add_f32 v34, v18, v19
    v_mul_f32 v35, v17, v17
    v_fmac_f32 v33, v18, v18
    v_fmac_f32 v35, v19, v19
    v_add_f32 v32, v32, v20
    v_fmac_f32 v33, v20, v20
    v_add_f32 v34, v34, v21
    v_fmac_f32 v35, v21, v21
    v_add_f32 v32, v32, v22
    v_fmac_f32 v33, v22, v22
    v_add_f32 v34, v34, v23
    v_fmac_f32 v35, v23, v23
    v_add_f32 v32, v32, v24
    v_fmac_f32 v33, v24, v24
    v_add_f32 v34, v34, v25
    v_fmac_f32 v35, v25, v25
    v_add_f32 v32, v32, v26
    v_fmac_f32 v33, v26, v26
    v_add_f32 v34, v34, v27
    v_fmac_f32 v35, v27, v27
    v_add_f32 v32, v32, v28
    v_fmac_f32 v33, v28, v28
    v_add_f32 v34, v34, v29
    v_fmac_f32 v35, v29, v29
    v_add_f32 v32, v32, v30
    v_fmac_f32 v33, v30, v30
    v_add_f32 v34, v34, v31
    v_fmac_f32 v35, v31, v31
    v_add_f32 v32, v32, v34
    v_add_f32 v33, v33, v35
    v_and_b32 v188, 15, v0
    v_lshrrev_b32 v189, 5, v0
    v_permlane32_swap_b32 v32, v33
    v_lshl_add_u32 v188, v189, 4, v188
    v_add_f32 v32, v32, v33
    v_lshlrev_b32 v188, 2, v188
    v_mov_b32 v33, v32
    s_lshl_b32 s44, s32, 5
    s_add_u32 s44, s44, s33
    v_permlane16_swap_b32 v32, v33
    s_lshl_b32 s44, s44, 2
    v_add_f32 v32, v32, v33
    buffer_store_dword v32, v188, s[4:7], s37 offen sc1
    s_add_u32 s37, s44, 74457088
    s_waitcnt vmcnt(0)
    s_barrier
    s_add_u32 s58, s37, s69
    buffer_store_dword v253, v252, s[4:7], s58 offen sc1
    s_cmp_eq_u32 s36, 15
    s_cbranch_scc1 L_p4_skip
    s_add_u32 m0, s19, 61440
    s_add_u32 s58, s18, 0
    buffer_load_dwordx4 v1, s[4:7], s58 offen offset:0 sc1 lds
    buffer_load_dwordx4 v1, s[4:7], s58 offen offset:1024 sc1 lds
    buffer_load_dwordx4 v1, s[4:7], s58 offen offset:2048 sc1 lds
    s_add_u32 m0, s19, 73728
    s_add_u32 s58, s18, 12288
    buffer_load_dwordx4 v1, s[4:7], s58 offen offset:0 sc1 lds
    buffer_load_dwordx4 v1, s[4:7], s58 offen offset:1024 sc1 lds
    buffer_load_dwordx4 v1, s[4:7], s58 offen offset:2048 sc1 lds
    s_add_u32 m0, s19, 0
    s_add_u32 s58, s18, 24576
    buffer_load_dwordx4 v1, s[4:7], s58 offen offset:0 sc1 lds
    buffer_load_dwordx4 v1, s[4:7], s58 offen offset:1024 sc1 lds
    buffer_load_dwordx4 v1, s[4:7], s58 offen offset:2048 sc1 lds
    s_add_u32 m0, s19, 12288
    s_add_u32 s58, s18, 36864
    buffer_load_dwordx4 v1, s[4:7], s58 offen offset:0 sc1 lds
    buffer_load_dwordx4 v1, s[4:7], s58 offen offset:1024 sc1 lds
    buffer_load_dwordx4 v1, s[4:7], s58 offen offset:2048 sc1 lds
    s_add_u32 m0, s19, 24576
    s_add_u32 s58, s18, 49152
    buffer_load_dwordx4 v1, s[4:7], s58 offen offset:0 sc1 lds
    buffer_load_dwordx4 v1, s[4:7], s58 offen offset:1024 sc1 lds
    buffer_load_dwordx4 v1, s[4:7], s58 offen offset:2048 sc1 lds
    s_add_u32 m0, s19, 36864
    s_add_u32 s58, s18, 61440
    buffer_load_dwordx4 v1, s[4:7], s58 offen offset:0 sc1 lds
    buffer_load_dwordx4 v1, s[4:7], s58 offen offset:1024 sc1 lds
    buffer_load_dwordx4 v1, s[4:7], s58 offen offset:2048 sc1 lds
    buffer_load_dword v254, v255, s[4:7], 0 offen sc1
    v_and_b32 v7, 15, v0
    v_lshrrev_b32 v8, 4, v0
    v_lshlrev_b32 v9, 15, v8
    v_lshl_add_u32 v9, v7, 2, v9
    v_add_u32 v10, 16384, v9
    v_lshlrev_b32 v8, 4, v8
    s_lshl_b32 s45, s42, 7
    s_add_u32 s45, s45, 63963136
    s_mul_i32 s37, s36, 384
    s_add_u32 s37, s37, 65011712
    s_add_u32 s38, s37, 5504
    s_waitcnt vmcnt(13)
    s_barrier
    ds_read_b128 a[0:3], v6 offset:0
    ds_read_b128 a[4:7], v6 offset:1024
    ds_read_b128 a[8:11], v6 offset:2048
    ds_read_b128 a[12:15], v6 offset:3072
    ds_read_b128 a[16:19], v6 offset:4096
    ds_read_b128 a[20:23], v6 offset:5120
    ds_read_b128 a[24:27], v6 offset:6144
    ds_read_b128 a[28:31], v6 offset:7168
    ds_read_b128 a[32:35], v6 offset:8192
    ds_read_b128 a[36:39], v6 offset:9216
    ds_read_b128 a[40:43], v6 offset:10240
    ds_read_b128 a[44:47], v6 offset:11264
    s_mov_b32 s47, 131072
    s_waitcnt vmcnt(0)
    v_cmp_ne_u32 vcc, 1, v254
    s_cbranch_vccz L_ok_h
L_spin_h:
    buffer_load_dword v254, v255, s[4:7], 0 offen sc1
    s_sub_u32 s47, s47, 1
    s_cbranch_scc1 L_ok_h
    s_waitcnt vmcnt(0)
    v_cmp_ne_u32 vcc, 1, v254
    s_cbranch_vccnz L_spin_h
L_ok_h:
    buffer_load_dwordx4 a[96:99], v1, s[4:7], s16 offen offset:0 sc1
    buffer_load_dwordx4 a[100:103], v1, s[4:7], s17 offen offset:0 sc1
    buffer_load_dwordx4 a[104:107], v1, s[4:7], s16 offen offset:1024 sc1
    buffer_load_dwordx4 a[108:111], v1, s[4:7], s17 offen offset:1024 sc1
    buffer_load_dwordx4 a[112:115], v1, s[4:7], s16 offen offset:2048 sc1
    buffer_load_dwordx4 a[116:119], v1, s[4:7], s17 offen offset:2048 sc1
    buffer_load_dwordx4 a[120:123], v1, s[4:7], s16 offen offset:3072 sc1
    buffer_load_dwordx4 a[124:127], v1, s[4:7], s17 offen offset:3072 sc1
    s_add_u32 s43, s16, 4096
    buffer_load_dwordx4 a[128:131], v1, s[4:7], s43 offen offset:0 sc1
    s_add_u32 s43, s17, 4096
    buffer_load_dwordx4 a[132:135], v1, s[4:7], s43 offen offset:0 sc1
    s_waitcnt vmcnt(8) lgkmcnt(0)
    v_mfma_f32_16x16x32_bf16 v[16:19], a[0:3], a[96:99], 0
    ds_read_b128 a[48:51], v6 offset:12288
    v_mfma_f32_16x16x32_bf16 v[20:23], a[0:3], a[100:103], 0
    s_add_u32 m0, s19, 49152
    s_add_u32 s58, s18, 73728
    v_mfma_f32_16x16x32_bf16 v[24:27], a[4:7], a[96:99], 0
    ds_read_b128 a[52:55], v6 offset:13312
    v_mfma_f32_16x16x32_bf16 v[28:31], a[4:7], a[100:103], 0
    buffer_load_dwordx4 v1, s[4:7], s58 offen offset:0 sc1 lds
    v_mfma_f32_16x16x32_bf16 v[32:35], a[8:11], a[96:99], 0
    ds_read_b128 a[56:59], v6 offset:14336
    v_mfma_f32_16x16x32_bf16 v[36:39], a[8:11], a[100:103], 0
    buffer_load_dwordx4 v[112:115], v8, s[4:7], s37 offen offset:0 sc1
    v_mfma_f32_16x16x32_bf16 v[40:43], a[12:15], a[96:99], 0
    ds_read_b128 a[60:63], v6 offset:15360
    v_mfma_f32_16x16x32_bf16 v[44:47], a[12:15], a[100:103], 0
    buffer_load_dwordx4 v1, s[4:7], s58 offen offset:1024 sc1 lds
    v_mfma_f32_16x16x32_bf16 v[48:51], a[16:19], a[96:99], 0
    ds_read_b128 a[64:67], v6 offset:16384
    v_mfma_f32_16x16x32_bf16 v[52:55], a[16:19], a[100:103], 0
    buffer_load_dwordx4 v[116:119], v8, s[4:7], s37 offen offset:64 sc1
    v_mfma_f32_16x16x32_bf16 v[56:59], a[20:23], a[96:99], 0
    ds_read_b128 a[68:71], v6 offset:17408
    v_mfma_f32_16x16x32_bf16 v[60:63], a[20:23], a[100:103], 0
    buffer_load_dwordx4 v1, s[4:7], s58 offen offset:2048 sc1 lds
    v_mfma_f32_16x16x32_bf16 v[64:67], a[24:27], a[96:99], 0
    ds_read_b128 a[72:75], v6 offset:18432
    v_mfma_f32_16x16x32_bf16 v[68:71], a[24:27], a[100:103], 0
    s_add_u32 s43, s16, 4096
    v_mfma_f32_16x16x32_bf16 v[72:75], a[28:31], a[96:99], 0
    ds_read_b128 a[76:79], v6 offset:19456
    v_mfma_f32_16x16x32_bf16 v[76:79], a[28:31], a[100:103], 0
    buffer_load_dwordx4 a[136:139], v1, s[4:7], s43 offen offset:1024 sc1
    v_mfma_f32_16x16x32_bf16 v[80:83], a[32:35], a[96:99], 0
    ds_read_b128 a[80:83], v6 offset:20480
    v_mfma_f32_16x16x32_bf16 v[84:87], a[32:35], a[100:103], 0
    s_add_u32 s43, s17, 4096
    v_mfma_f32_16x16x32_bf16 v[88:91], a[36:39], a[96:99], 0
    ds_read_b128 a[84:87], v6 offset:21504
    v_mfma_f32_16x16x32_bf16 v[92:95], a[36:39], a[100:103], 0
    buffer_load_dwordx4 a[140:143], v1, s[4:7], s43 offen offset:1024 sc1
    v_mfma_f32_16x16x32_bf16 v[96:99], a[40:43], a[96:99], 0
    ds_read_b128 a[88:91], v6 offset:22528
    v_mfma_f32_16x16x32_bf16 v[100:103], a[40:43], a[100:103], 0
    buffer_load_dwordx4 v[120:123], v8, s[4:7], s37 offen offset:128 sc1
    buffer_load_dwordx4 v[124:127], v8, s[4:7], s37 offen offset:192 sc1
    v_mfma_f32_16x16x32_bf16 v[104:107], a[44:47], a[96:99], 0
    ds_read_b128 a[92:95], v6 offset:23552
    v_mfma_f32_16x16x32_bf16 v[108:111], a[44:47], a[100:103], 0
    s_waitcnt vmcnt(15)
    s_barrier
    s_waitcnt lgkmcnt(4)
    v_mfma_f32_16x16x32_bf16 v[16:19], a[48:51], a[104:107], v[16:19]
    ds_read_b128 a[0:3], v5 offset:0
    v_mfma_f32_16x16x32_bf16 v[20:23], a[48:51], a[108:111], v[20:23]
    s_add_u32 m0, s19, 61440
    s_add_u32 s58, s18, 86016
    v_mfma_f32_16x16x32_bf16 v[24:27], a[52:55], a[104:107], v[24:27]
    ds_read_b128 a[4:7], v5 offset:1024
    v_mfma_f32_16x16x32_bf16 v[28:31], a[52:55], a[108:111], v[28:31]
    buffer_load_dwordx4 v1, s[4:7], s58 offen offset:0 sc1 lds
    v_mfma_f32_16x16x32_bf16 v[32:35], a[56:59], a[104:107], v[32:35]
    ds_read_b128 a[8:11], v5 offset:2048
    v_mfma_f32_16x16x32_bf16 v[36:39], a[56:59], a[108:111], v[36:39]
    buffer_load_dwordx4 v[128:131], v8, s[4:7], s37 offen offset:256 sc1
    v_mfma_f32_16x16x32_bf16 v[40:43], a[60:63], a[104:107], v[40:43]
    ds_read_b128 a[12:15], v5 offset:3072
    v_mfma_f32_16x16x32_bf16 v[44:47], a[60:63], a[108:111], v[44:47]
    buffer_load_dwordx4 v1, s[4:7], s58 offen offset:1024 sc1 lds
    v_mfma_f32_16x16x32_bf16 v[48:51], a[64:67], a[104:107], v[48:51]
    ds_read_b128 a[16:19], v5 offset:4096
    v_mfma_f32_16x16x32_bf16 v[52:55], a[64:67], a[108:111], v[52:55]
    buffer_load_dwordx4 v[132:135], v8, s[4:7], s37 offen offset:320 sc1
    v_mfma_f32_16x16x32_bf16 v[56:59], a[68:71], a[104:107], v[56:59]
    ds_read_b128 a[20:23], v5 offset:5120
    v_mfma_f32_16x16x32_bf16 v[60:63], a[68:71], a[108:111], v[60:63]
    buffer_load_dwordx4 v1, s[4:7], s58 offen offset:2048 sc1 lds
    v_mfma_f32_16x16x32_bf16 v[64:67], a[72:75], a[104:107], v[64:67]
    ds_read_b128 a[24:27], v5 offset:6144
    v_mfma_f32_16x16x32_bf16 v[68:71], a[72:75], a[108:111], v[68:71]
    s_add_u32 s43, s16, 4096
    v_mfma_f32_16x16x32_bf16 v[72:75], a[76:79], a[104:107], v[72:75]
    ds_read_b128 a[28:31], v5 offset:7168
    v_mfma_f32_16x16x32_bf16 v[76:79], a[76:79], a[108:111], v[76:79]
    buffer_load_dwordx4 a[96:99], v1, s[4:7], s43 offen offset:2048 sc1
    s_waitcnt lgkmcnt(4)
    v_mfma_f32_16x16x32_bf16 v[80:83], a[80:83], a[104:107], v[80:83]
    ds_read_b128 a[32:35], v5 offset:8192
    v_mfma_f32_16x16x32_bf16 v[84:87], a[80:83], a[108:111], v[84:87]
    s_add_u32 s43, s17, 4096
    v_mfma_f32_16x16x32_bf16 v[88:91], a[84:87], a[104:107], v[88:91]
    ds_read_b128 a[36:39], v5 offset:9216
    v_mfma_f32_16x16x32_bf16 v[92:95], a[84:87], a[108:111], v[92:95]
    buffer_load_dwordx4 a[100:103], v1, s[4:7], s43 offen offset:2048 sc1
    v_mfma_f32_16x16x32_bf16 v[96:99], a[88:91], a[104:107], v[96:99]
    ds_read_b128 a[40:43], v5 offset:10240
    v_mfma_f32_16x16x32_bf16 v[100:103], a[88:91], a[108:111], v[100:103]
    buffer_load_dwordx4 v[136:139], v8, s[4:7], s38 offen offset:0 sc1
    buffer_load_dwordx4 v[140:143], v8, s[4:7], s38 offen offset:64 sc1
    v_mfma_f32_16x16x32_bf16 v[104:107], a[92:95], a[104:107], v[104:107]
    ds_read_b128 a[44:47], v5 offset:11264
    v_mfma_f32_16x16x32_bf16 v[108:111], a[92:95], a[108:111], v[108:111]
    s_waitcnt vmcnt(22)
    s_barrier
    v_mfma_f32_16x16x32_bf16 v[16:19], a[0:3], a[112:115], v[16:19]
    ds_read_b128 a[48:51], v5 offset:12288
    v_mfma_f32_16x16x32_bf16 v[20:23], a[0:3], a[116:119], v[20:23]
    s_add_u32 m0, s19, 73728
    s_add_u32 s58, s18, 98304
    v_mfma_f32_16x16x32_bf16 v[24:27], a[4:7], a[112:115], v[24:27]
    ds_read_b128 a[52:55], v5 offset:13312
    v_mfma_f32_16x16x32_bf16 v[28:31], a[4:7], a[116:119], v[28:31]
    buffer_load_dwordx4 v1, s[4:7], s58 offen offset:0 sc1 lds
    v_mfma_f32_16x16x32_bf16 v[32:35], a[8:11], a[112:115], v[32:35]
    ds_read_b128 a[56:59], v5 offset:14336
    v_mfma_f32_16x16x32_bf16 v[36:39], a[8:11], a[116:119], v[36:39]
    buffer_load_dwordx4 v[144:147], v8, s[4:7], s38 offen offset:128 sc1
    v_mfma_f32_16x16x32_bf16 v[40:43], a[12:15], a[112:115], v[40:43]
    ds_read_b128 a[60:63], v5 offset:15360
    v_mfma_f32_16x16x32_bf16 v[44:47], a[12:15], a[116:119], v[44:47]
    buffer_load_dwordx4 v1, s[4:7], s58 offen offset:1024 sc1 lds
    s_waitcnt lgkmcnt(4)
    v_mfma_f32_16x16x32_bf16 v[48:51], a[16:19], a[112:115], v[48:51]
    ds_read_b128 a[64:67], v5 offset:16384
    v_mfma_f32_16x16x32_bf16 v[52:55], a[16:19], a[116:119], v[52:55]
    buffer_load_dwordx4 v[148:151], v8, s[4:7], s38 offen offset:192 sc1
    v_mfma_f32_16x16x32_bf16 v[56:59], a[20:23], a[112:115], v[56:59]
    ds_read_b128 a[68:71], v5 offset:17408
    v_mfma_f32_16x16x32_bf16 v[60:63], a[20:23], a[116:119], v[60:63]
    buffer_load_dwordx4 v1, s[4:7], s58 offen offset:2048 sc1 lds
    v_mfma_f32_16x16x32_bf16 v[64:67], a[24:27], a[112:115], v[64:67]
    ds_read_b128 a[72:75], v5 offset:18432
    v_mfma_f32_16x16x32_bf16 v[68:71], a[24:27], a[116:119], v[68:71]
    s_add_u32 s43, s16, 4096
    v_mfma_f32_16x16x32_bf16 v[72:75], a[28:31], a[112:115], v[72:75]
    ds_read_b128 a[76:79], v5 offset:19456
    v_mfma_f32_16x16x32_bf16 v[76:79], a[28:31], a[116:119], v[76:79]
    buffer_load_dwordx4 a[104:107], v1, s[4:7], s43 offen offset:3072 sc1
    v_mfma_f32_16x16x32_bf16 v[80:83], a[32:35], a[112:115], v[80:83]
    ds_read_b128 a[80:83], v5 offset:20480
    v_mfma_f32_16x16x32_bf16 v[84:87], a[32:35], a[116:119], v[84:87]
    s_add_u32 s43, s17, 4096
    v_mfma_f32_16x16x32_bf16 v[88:91], a[36:39], a[112:115], v[88:91]
    ds_read_b128 a[84:87], v5 offset:21504
    v_mfma_f32_16x16x32_bf16 v[92:95], a[36:39], a[116:119], v[92:95]
    buffer_load_dwordx4 a[108:111], v1, s[4:7], s43 offen offset:3072 sc1
    v_mfma_f32_16x16x32_bf16 v[96:99], a[40:43], a[112:115], v[96:99]
    ds_read_b128 a[88:91], v5 offset:22528
    v_mfma_f32_16x16x32_bf16 v[100:103], a[40:43], a[116:119], v[100:103]
    buffer_load_dwordx4 v[152:155], v8, s[4:7], s38 offen offset:256 sc1
    buffer_load_dwordx4 v[156:159], v8, s[4:7], s38 offen offset:320 sc1
    v_mfma_f32_16x16x32_bf16 v[104:107], a[44:47], a[112:115], v[104:107]
    ds_read_b128 a[92:95], v5 offset:23552
    v_mfma_f32_16x16x32_bf16 v[108:111], a[44:47], a[116:119], v[108:111]
    s_waitcnt vmcnt(29)
    s_barrier
    s_waitcnt lgkmcnt(4)
    v_mfma_f32_16x16x32_bf16 v[16:19], a[48:51], a[120:123], v[16:19]
    ds_read_b128 a[0:3], v5 offset:24576
    v_mfma_f32_16x16x32_bf16 v[20:23], a[48:51], a[124:127], v[20:23]
    s_add_u32 m0, s19, 0
    s_add_u32 s58, s18, 110592
    v_mfma_f32_16x16x32_bf16 v[24:27], a[52:55], a[120:123], v[24:27]
    ds_read_b128 a[4:7], v5 offset:25600
    v_mfma_f32_16x16x32_bf16 v[28:31], a[52:55], a[124:127], v[28:31]
    buffer_load_dwordx4 v1, s[4:7], s58 offen offset:0 sc1 lds
    v_mfma_f32_16x16x32_bf16 v[32:35], a[56:59], a[120:123], v[32:35]
    ds_read_b128 a[8:11], v5 offset:26624
    v_mfma_f32_16x16x32_bf16 v[36:39], a[56:59], a[124:127], v[36:39]
    buffer_load_dword v160, v9, s[4:7], s45 offen offset:0 sc1
    v_mfma_f32_16x16x32_bf16 v[40:43], a[60:63], a[120:123], v[40:43]
    ds_read_b128 a[12:15], v5 offset:27648
    v_mfma_f32_16x16x32_bf16 v[44:47], a[60:63], a[124:127], v[44:47]
    buffer_load_dwordx4 v1, s[4:7], s58 offen offset:1024 sc1 lds
    v_mfma_f32_16x16x32_bf16 v[48:51], a[64:67], a[120:123], v[48:51]
    ds_read_b128 a[16:19], v5 offset:28672
    v_mfma_f32_16x16x32_bf16 v[52:55], a[64:67], a[124:127], v[52:55]
    buffer_load_dword v161, v9, s[4:7], s45 offen offset:64 sc1
    v_mfma_f32_16x16x32_bf16 v[56:59], a[68:71], a[120:123], v[56:59]
    ds_read_b128 a[20:23], v5 offset:29696
    v_mfma_f32_16x16x32_bf16 v[60:63], a[68:71], a[124:127], v[60:63]
    buffer_load_dwordx4 v1, s[4:7], s58 offen offset:2048 sc1 lds
    v_mfma_f32_16x16x32_bf16 v[64:67], a[72:75], a[120:123], v[64:67]
    ds_read_b128 a[24:27], v5 offset:30720
    v_mfma_f32_16x16x32_bf16 v[68:71], a[72:75], a[124:127], v[68:71]
    s_add_u32 s43, s16, 8192
    v_mfma_f32_16x16x32_bf16 v[72:75], a[76:79], a[120:123], v[72:75]
    ds_read_b128 a[28:31], v5 offset:31744
    v_mfma_f32_16x16x32_bf16 v[76:79], a[76:79], a[124:127], v[76:79]
    buffer_load_dwordx4 a[112:115], v1, s[4:7], s43 offen offset:0 sc1
    s_waitcnt lgkmcnt(4)
    v_mfma_f32_16x16x32_bf16 v[80:83], a[80:83], a[120:123], v[80:83]
    ds_read_b128 a[32:35], v5 offset:32768
    v_mfma_f32_16x16x32_bf16 v[84:87], a[80:83], a[124:127], v[84:87]
    s_add_u32 s43, s17, 8192
    v_mfma_f32_16x16x32_bf16 v[88:91], a[84:87], a[120:123], v[88:91]
    ds_read_b128 a[36:39], v5 offset:33792
    v_mfma_f32_16x16x32_bf16 v[92:95], a[84:87], a[124:127], v[92:95]
    buffer_load_dwordx4 a[116:119], v1, s[4:7], s43 offen offset:0 sc1
    v_mfma_f32_16x16x32_bf16 v[96:99], a[88:91], a[120:123], v[96:99]
    ds_read_b128 a[40:43], v5 offset:34816
    v_mfma_f32_16x16x32_bf16 v[100:103], a[88:91], a[124:127], v[100:103]
    buffer_load_dword v162, v10, s[4:7], s45 offen offset:0 sc1
    buffer_load_dword v163, v10, s[4:7], s45 offen offset:64 sc1
    v_mfma_f32_16x16x32_bf16 v[104:107], a[92:95], a[120:123], v[104:107]
    ds_read_b128 a[44:47], v5 offset:35840
    v_mfma_f32_16x16x32_bf16 v[108:111], a[92:95], a[124:127], v[108:111]
    s_waitcnt vmcnt(36)
    s_barrier
    v_mfma_f32_16x16x32_bf16 v[16:19], a[0:3], a[128:131], v[16:19]
    ds_read_b128 a[48:51], v5 offset:36864
    v_mfma_f32_16x16x32_bf16 v[20:23], a[0:3], a[132:135], v[20:23]
    s_add_u32 m0, s19, 12288
    s_add_u32 s58, s18, 122880
    v_mfma_f32_16x16x32_bf16 v[24:27], a[4:7], a[128:131], v[24:27]
    ds_read_b128 a[52:55], v5 offset:37888
    v_mfma_f32_16x16x32_bf16 v[28:31], a[4:7], a[132:135], v[28:31]
    buffer_load_dwordx4 v1, s[4:7], s58 offen offset:0 sc1 lds
    v_mfma_f32_16x16x32_bf16 v[32:35], a[8:11], a[128:131], v[32:35]
    ds_read_b128 a[56:59], v5 offset:38912
    v_mfma_f32_16x16x32_bf16 v[36:39], a[8:11], a[132:135], v[36:39]
    buffer_load_dword v164, v9, s[4:7], s45 offen offset:128 sc1
    v_mfma_f32_16x16x32_bf16 v[40:43], a[12:15], a[128:131], v[40:43]
    ds_read_b128 a[60:63], v5 offset:39936
    v_mfma_f32_16x16x32_bf16 v[44:47], a[12:15], a[132:135], v[44:47]
    buffer_load_dwordx4 v1, s[4:7], s58 offen offset:1024 sc1 lds
    s_waitcnt lgkmcnt(4)
    v_mfma_f32_16x16x32_bf16 v[48:51], a[16:19], a[128:131], v[48:51]
    ds_read_b128 a[64:67], v5 offset:40960
    v_mfma_f32_16x16x32_bf16 v[52:55], a[16:19], a[132:135], v[52:55]
    buffer_load_dword v165, v9, s[4:7], s45 offen offset:192 sc1
    v_mfma_f32_16x16x32_bf16 v[56:59], a[20:23], a[128:131], v[56:59]
    ds_read_b128 a[68:71], v5 offset:41984
    v_mfma_f32_16x16x32_bf16 v[60:63], a[20:23], a[132:135], v[60:63]
    buffer_load_dwordx4 v1, s[4:7], s58 offen offset:2048 sc1 lds
    v_mfma_f32_16x16x32_bf16 v[64:67], a[24:27], a[128:131], v[64:67]
    ds_read_b128 a[72:75], v5 offset:43008
    v_mfma_f32_16x16x32_bf16 v[68:71], a[24:27], a[132:135], v[68:71]
    s_add_u32 s43, s16, 8192
    v_mfma_f32_16x16x32_bf16 v[72:75], a[28:31], a[128:131], v[72:75]
    ds_read_b128 a[76:79], v5 offset:44032
    v_mfma_f32_16x16x32_bf16 v[76:79], a[28:31], a[132:135], v[76:79]
    buffer_load_dwordx4 a[120:123], v1, s[4:7], s43 offen offset:1024 sc1
    v_mfma_f32_16x16x32_bf16 v[80:83], a[32:35], a[128:131], v[80:83]
    ds_read_b128 a[80:83], v5 offset:45056
    v_mfma_f32_16x16x32_bf16 v[84:87], a[32:35], a[132:135], v[84:87]
    s_add_u32 s43, s17, 8192
    v_mfma_f32_16x16x32_bf16 v[88:91], a[36:39], a[128:131], v[88:91]
    ds_read_b128 a[84:87], v5 offset:46080
    v_mfma_f32_16x16x32_bf16 v[92:95], a[36:39], a[132:135], v[92:95]
    buffer_load_dwordx4 a[124:127], v1, s[4:7], s43 offen offset:1024 sc1
    v_mfma_f32_16x16x32_bf16 v[96:99], a[40:43], a[128:131], v[96:99]
    ds_read_b128 a[88:91], v5 offset:47104
    v_mfma_f32_16x16x32_bf16 v[100:103], a[40:43], a[132:135], v[100:103]
    buffer_load_dword v166, v10, s[4:7], s45 offen offset:128 sc1
    buffer_load_dword v167, v10, s[4:7], s45 offen offset:192 sc1
    v_mfma_f32_16x16x32_bf16 v[104:107], a[44:47], a[128:131], v[104:107]
    ds_read_b128 a[92:95], v5 offset:48128
    v_mfma_f32_16x16x32_bf16 v[108:111], a[44:47], a[132:135], v[108:111]
    s_waitcnt vmcnt(38)
    s_barrier
    s_waitcnt lgkmcnt(4)
    v_mfma_f32_16x16x32_bf16 v[16:19], a[48:51], a[136:139], v[16:19]
    ds_read_b128 a[0:3], v5 offset:49152
    v_mfma_f32_16x16x32_bf16 v[20:23], a[48:51], a[140:143], v[20:23]
    s_add_u32 m0, s19, 24576
    s_add_u32 s58, s18, 135168
    v_mfma_f32_16x16x32_bf16 v[24:27], a[52:55], a[136:139], v[24:27]
    ds_read_b128 a[4:7], v5 offset:50176
    v_mfma_f32_16x16x32_bf16 v[28:31], a[52:55], a[140:143], v[28:31]
    buffer_load_dwordx4 v1, s[4:7], s58 offen offset:0 sc1 lds
    v_mfma_f32_16x16x32_bf16 v[32:35], a[56:59], a[136:139], v[32:35]
    ds_read_b128 a[8:11], v5 offset:51200
    v_mfma_f32_16x16x32_bf16 v[36:39], a[56:59], a[140:143], v[36:39]
    v_mfma_f32_16x16x32_bf16 v[40:43], a[60:63], a[136:139], v[40:43]
    ds_read_b128 a[12:15], v5 offset:52224
    v_mfma_f32_16x16x32_bf16 v[44:47], a[60:63], a[140:143], v[44:47]
    buffer_load_dwordx4 v1, s[4:7], s58 offen offset:1024 sc1 lds
    v_mfma_f32_16x16x32_bf16 v[48:51], a[64:67], a[136:139], v[48:51]
    ds_read_b128 a[16:19], v5 offset:53248
    v_mfma_f32_16x16x32_bf16 v[52:55], a[64:67], a[140:143], v[52:55]
    v_mfma_f32_16x16x32_bf16 v[56:59], a[68:71], a[136:139], v[56:59]
    ds_read_b128 a[20:23], v5 offset:54272
    v_mfma_f32_16x16x32_bf16 v[60:63], a[68:71], a[140:143], v[60:63]
    buffer_load_dwordx4 v1, s[4:7], s58 offen offset:2048 sc1 lds
    v_mfma_f32_16x16x32_bf16 v[64:67], a[72:75], a[136:139], v[64:67]
    ds_read_b128 a[24:27], v5 offset:55296
    v_mfma_f32_16x16x32_bf16 v[68:71], a[72:75], a[140:143], v[68:71]
    s_add_u32 s43, s16, 8192
    v_mfma_f32_16x16x32_bf16 v[72:75], a[76:79], a[136:139], v[72:75]
    ds_read_b128 a[28:31], v5 offset:56320
    v_mfma_f32_16x16x32_bf16 v[76:79], a[76:79], a[140:143], v[76:79]
    buffer_load_dwordx4 a[128:131], v1, s[4:7], s43 offen offset:2048 sc1
    s_waitcnt lgkmcnt(4)
    v_mfma_f32_16x16x32_bf16 v[80:83], a[80:83], a[136:139], v[80:83]
    ds_read_b128 a[32:35], v5 offset:57344
    v_mfma_f32_16x16x32_bf16 v[84:87], a[80:83], a[140:143], v[84:87]
    s_add_u32 s43, s17, 8192
    v_mfma_f32_16x16x32_bf16 v[88:91], a[84:87], a[136:139], v[88:91]
    ds_read_b128 a[36:39], v5 offset:58368
    v_mfma_f32_16x16x32_bf16 v[92:95], a[84:87], a[140:143], v[92:95]
    buffer_load_dwordx4 a[132:135], v1, s[4:7], s43 offen offset:2048 sc1
    v_mfma_f32_16x16x32_bf16 v[96:99], a[88:91], a[136:139], v[96:99]
    ds_read_b128 a[40:43], v5 offset:59392
    v_mfma_f32_16x16x32_bf16 v[100:103], a[88:91], a[140:143], v[100:103]
    v_mfma_f32_16x16x32_bf16 v[104:107], a[92:95], a[136:139], v[104:107]
    ds_read_b128 a[44:47], v5 offset:60416
    v_mfma_f32_16x16x32_bf16 v[108:111], a[92:95], a[140:143], v[108:111]
    s_waitcnt vmcnt(34)
    s_barrier
    v_mfma_f32_16x16x32_bf16 v[16:19], a[0:3], a[96:99], v[16:19]
    ds_read_b128 a[48:51], v6 offset:0
    v_mfma_f32_16x16x32_bf16 v[20:23], a[0:3], a[100:103], v[20:23]
    s_add_u32 m0, s19, 36864
    s_add_u32 s58, s18, 147456
    v_mfma_f32_16x16x32_bf16 v[24:27], a[4:7], a[96:99], v[24:27]
    ds_read_b128 a[52:55], v6 offset:1024
    v_mfma_f32_16x16x32_bf16 v[28:31], a[4:7], a[100:103], v[28:31]
    buffer_load_dwordx4 v1, s[4:7], s58 offen offset:0 sc1 lds
    v_mfma_f32_16x16x32_bf16 v[32:35], a[8:11], a[96:99], v[32:35]
    ds_read_b128 a[56:59], v6 offset:2048
    v_mfma_f32_16x16x32_bf16 v[36:39], a[8:11], a[100:103], v[36:39]
    s_waitcnt lgkmcnt(4)
    v_mfma_f32_16x16x32_bf16 v[40:43], a[12:15], a[96:99], v[40:43]
    ds_read_b128 a[60:63], v6 offset:3072
    v_mfma_f32_16x16x32_bf16 v[44:47], a[12:15], a[100:103], v[44:47]
    buffer_load_dwordx4 v1, s[4:7], s58 offen offset:1024 sc1 lds
    v_mfma_f32_16x16x32_bf16 v[48:51], a[16:19], a[96:99], v[48:51]
    ds_read_b128 a[64:67], v6 offset:4096
    v_mfma_f32_16x16x32_bf16 v[52:55], a[16:19], a[100:103], v[52:55]
    v_mfma_f32_16x16x32_bf16 v[56:59], a[20:23], a[96:99], v[56:59]
    ds_read_b128 a[68:71], v6 offset:5120
    v_mfma_f32_16x16x32_bf16 v[60:63], a[20:23], a[100:103], v[60:63]
    buffer_load_dwordx4 v1, s[4:7], s58 offen offset:2048 sc1 lds
    v_mfma_f32_16x16x32_bf16 v[64:67], a[24:27], a[96:99], v[64:67]
    ds_read_b128 a[72:75], v6 offset:6144
    v_mfma_f32_16x16x32_bf16 v[68:71], a[24:27], a[100:103], v[68:71]
    s_add_u32 s43, s16, 8192
    v_mfma_f32_16x16x32_bf16 v[72:75], a[28:31], a[96:99], v[72:75]
    ds_read_b128 a[76:79], v6 offset:7168
    v_mfma_f32_16x16x32_bf16 v[76:79], a[28:31], a[100:103], v[76:79]
    buffer_load_dwordx4 a[136:139], v1, s[4:7], s43 offen offset:3072 sc1
    v_mfma_f32_16x16x32_bf16 v[80:83], a[32:35], a[96:99], v[80:83]
    ds_read_b128 a[80:83], v6 offset:8192
    v_mfma_f32_16x16x32_bf16 v[84:87], a[32:35], a[100:103], v[84:87]
    s_add_u32 s43, s17, 8192
    v_mfma_f32_16x16x32_bf16 v[88:91], a[36:39], a[96:99], v[88:91]
    ds_read_b128 a[84:87], v6 offset:9216
    v_mfma_f32_16x16x32_bf16 v[92:95], a[36:39], a[100:103], v[92:95]
    buffer_load_dwordx4 a[140:143], v1, s[4:7], s43 offen offset:3072 sc1
    v_mfma_f32_16x16x32_bf16 v[96:99], a[40:43], a[96:99], v[96:99]
    ds_read_b128 a[88:91], v6 offset:10240
    v_mfma_f32_16x16x32_bf16 v[100:103], a[40:43], a[100:103], v[100:103]
    s_waitcnt lgkmcnt(4)
    v_mfma_f32_16x16x32_bf16 v[104:107], a[44:47], a[96:99], v[104:107]
    ds_read_b128 a[92:95], v6 offset:11264
    v_mfma_f32_16x16x32_bf16 v[108:111], a[44:47], a[100:103], v[108:111]
    s_waitcnt vmcnt(30)
    s_barrier
    v_mfma_f32_16x16x32_bf16 v[16:19], a[48:51], a[104:107], v[16:19]
    ds_read_b128 a[0:3], v6 offset:12288
    s_waitcnt vmcnt(20)
    v_add_f32 v160, v160, v162
    v_mfma_f32_16x16x32_bf16 v[20:23], a[48:51], a[108:111], v[20:23]
    s_add_u32 m0, s19, 49152
    s_add_u32 s58, s18, 159744
    s_waitcnt vmcnt(19)
    v_add_f32 v161, v161, v163
    v_mfma_f32_16x16x32_bf16 v[24:27], a[52:55], a[104:107], v[24:27]
    ds_read_b128 a[4:7], v6 offset:13312
    s_waitcnt vmcnt(11)
    v_add_f32 v164, v164, v166
    v_mfma_f32_16x16x32_bf16 v[28:31], a[52:55], a[108:111], v[28:31]
    buffer_load_dwordx4 v1, s[4:7], s58 offen offset:0 sc1 lds
    v_mfma_f32_16x16x32_bf16 v[32:35], a[56:59], a[104:107], v[32:35]
    ds_read_b128 a[8:11], v6 offset:14336
    s_waitcnt vmcnt(11)
    v_add_f32 v165, v165, v167
    v_mfma_f32_16x16x32_bf16 v[36:39], a[56:59], a[108:111], v[36:39]
    v_mov_b32 v162, v160
    v_mov_b32 v163, v161
    v_mfma_f32_16x16x32_bf16 v[40:43], a[60:63], a[104:107], v[40:43]
    ds_read_b128 a[12:15], v6 offset:15360
    v_mov_b32 v166, v164
    v_mfma_f32_16x16x32_bf16 v[44:47], a[60:63], a[108:111], v[44:47]
    buffer_load_dwordx4 v1, s[4:7], s58 offen offset:1024 sc1 lds
    v_mfma_f32_16x16x32_bf16 v[48:51], a[64:67], a[104:107], v[48:51]
    ds_read_b128 a[16:19], v6 offset:16384
    v_mov_b32 v167, v165
    v_mfma_f32_16x16x32_bf16 v[52:55], a[64:67], a[108:111], v[52:55]
    v_permlane32_swap_b32 v160, v162
    v_permlane32_swap_b32 v161, v163
    v_mfma_f32_16x16x32_bf16 v[56:59], a[68:71], a[104:107], v[56:59]
    ds_read_b128 a[20:23], v6 offset:17408
    v_permlane32_swap_b32 v164, v166
    v_mfma_f32_16x16x32_bf16 v[60:63], a[68:71], a[108:111], v[60:63]
    buffer_load_dwordx4 v1, s[4:7], s58 offen offset:2048 sc1 lds
    v_mfma_f32_16x16x32_bf16 v[64:67], a[72:75], a[104:107], v[64:67]
    ds_read_b128 a[24:27], v6 offset:18432
    v_permlane32_swap_b32 v165, v167
    v_mfma_f32_16x16x32_bf16 v[68:71], a[72:75], a[108:111], v[68:71]
    s_add_u32 s43, s16, 12288
    v_add_f32 v160, v160, v162
    v_add_f32 v161, v161, v163
    s_waitcnt lgkmcnt(4)
    v_mfma_f32_16x16x32_bf16 v[72:75], a[76:79], a[104:107], v[72:75]
    ds_read_b128 a[28:31], v6 offset:19456
    v_add_f32 v164, v164, v166
    v_mfma_f32_16x16x32_bf16 v[76:79], a[76:79], a[108:111], v[76:79]
    buffer_load_dwordx4 a[96:99], v1, s[4:7], s43 offen offset:0 sc1
    v_mfma_f32_16x16x32_bf16 v[80:83], a[80:83], a[104:107], v[80:83]
    ds_read_b128 a[32:35], v6 offset:20480
    v_add_f32 v165, v165, v167
    v_mfma_f32_16x16x32_bf16 v[84:87], a[80:83], a[108:111], v[84:87]
    s_add_u32 s43, s17, 12288
    v_mov_b32 v162, v160
    v_mov_b32 v163, v161
    v_mfma_f32_16x16x32_bf16 v[88:91], a[84:87], a[104:107], v[88:91]
    ds_read_b128 a[36:39], v6 offset:21504
    v_mov_b32 v166, v164
    v_mfma_f32_16x16x32_bf16 v[92:95], a[84:87], a[108:111], v[92:95]
    buffer_load_dwordx4 a[100:103], v1, s[4:7], s43 offen offset:0 sc1
    v_mfma_f32_16x16x32_bf16 v[96:99], a[88:91], a[104:107], v[96:99]
    ds_read_b128 a[40:43], v6 offset:22528
    v_mov_b32 v167, v165
    v_mfma_f32_16x16x32_bf16 v[100:103], a[88:91], a[108:111], v[100:103]
    v_permlane16_swap_b32 v160, v162
    v_permlane16_swap_b32 v161, v163
    v_mfma_f32_16x16x32_bf16 v[104:107], a[92:95], a[104:107], v[104:107]
    ds_read_b128 a[44:47], v6 offset:23552
    v_permlane16_swap_b32 v164, v166
    v_mfma_f32_16x16x32_bf16 v[108:111], a[92:95], a[108:111], v[108:111]
    v_permlane16_swap_b32 v165, v167
    v_add_f32 v160, v160, v162
    s_barrier
    v_mfma_f32_16x16x32_bf16 v[16:19], a[0:3], a[112:115], v[16:19]
    ds_read_b128 a[48:51], v5 offset:0
    v_add_f32 v161, v161, v163
    v_mfma_f32_16x16x32_bf16 v[20:23], a[0:3], a[116:119], v[20:23]
    s_add_u32 m0, s19, 61440
    s_add_u32 s58, s18, 172032
    v_add_f32 v164, v164, v166
    v_mfma_f32_16x16x32_bf16 v[24:27], a[4:7], a[112:115], v[24:27]
    ds_read_b128 a[52:55], v5 offset:1024
    v_add_f32 v165, v165, v167
    v_mfma_f32_16x16x32_bf16 v[28:31], a[4:7], a[116:119], v[28:31]
    buffer_load_dwordx4 v1, s[4:7], s58 offen offset:0 sc1 lds
    v_mfma_f32_16x16x32_bf16 v[32:35], a[8:11], a[112:115], v[32:35]
    ds_read_b128 a[56:59], v5 offset:2048
    v_mul_f32 v168, 0xbb000000, v160
    v_mfma_f32_16x16x32_bf16 v[36:39], a[8:11], a[116:119], v[36:39]
    s_waitcnt lgkmcnt(4)
    v_mul_f32 v161, 0x3b000000, v161
    v_fma_f32 v161, -v168, v168, v161
    v_mfma_f32_16x16x32_bf16 v[40:43], a[12:15], a[112:115], v[40:43]
    ds_read_b128 a[60:63], v5 offset:3072
    v_max_f32 v161, 0, v161
    v_mfma_f32_16x16x32_bf16 v[44:47], a[12:15], a[116:119], v[44:47]
    buffer_load_dwordx4 v1, s[4:7], s58 offen offset:1024 sc1 lds
    v_mfma_f32_16x16x32_bf16 v[48:51], a[16:19], a[112:115], v[48:51]
    ds_read_b128 a[64:67], v5 offset:4096
    v_add_f32 v172, 0x3727c5ac, v161
    v_mfma_f32_16x16x32_bf16 v[52:55], a[16:19], a[116:119], v[52:55]
    v_rsq_f32 v160, v172
    v_mfma_f32_16x16x32_bf16 v[56:59], a[20:23], a[112:115], v[56:59]
    ds_read_b128 a[68:71], v5 offset:5120
    v_mul_f32 v170, 0xbfb8aa3b, v160
    v_mfma_f32_16x16x32_bf16 v[60:63], a[20:23], a[116:119], v[60:63]
    buffer_load_dwordx4 v1, s[4:7], s58 offen offset:2048 sc1 lds
    v_mfma_f32_16x16x32_bf16 v[64:67], a[24:27], a[112:115], v[64:67]
    ds_read_b128 a[72:75], v5 offset:6144
    v_mul_f32 v169, 0xbb000000, v164
    v_mfma_f32_16x16x32_bf16 v[68:71], a[24:27], a[116:119], v[68:71]
    s_add_u32 s43, s16, 12288
    v_mul_f32 v165, 0x3b000000, v165
    v_fma_f32 v165, -v169, v169, v165
    v_mfma_f32_16x16x32_bf16 v[72:75], a[28:31], a[112:115], v[72:75]
    ds_read_b128 a[76:79], v5 offset:7168
    v_max_f32 v165, 0, v165
    v_mfma_f32_16x16x32_bf16 v[76:79], a[28:31], a[116:119], v[76:79]
    buffer_load_dwordx4 a[104:107], v1, s[4:7], s43 offen offset:1024 sc1
    v_mfma_f32_16x16x32_bf16 v[80:83], a[32:35], a[112:115], v[80:83]
    ds_read_b128 a[80:83], v5 offset:8192
    v_add_f32 v173, 0x3727c5ac, v165
    v_mfma_f32_16x16x32_bf16 v[84:87], a[32:35], a[116:119], v[84:87]
    s_add_u32 s43, s17, 12288
    v_rsq_f32 v164, v173
    v_mfma_f32_16x16x32_bf16 v[88:91], a[36:39], a[112:115], v[88:91]
    ds_read_b128 a[84:87], v5 offset:9216
    v_mul_f32 v171, 0xbfb8aa3b, v164
    v_mfma_f32_16x16x32_bf16 v[92:95], a[36:39], a[116:119], v[92:95]
    buffer_load_dwordx4 a[108:111], v1, s[4:7], s43 offen offset:1024 sc1
    v_mfma_f32_16x16x32_bf16 v[96:99], a[40:43], a[112:115], v[96:99]
    ds_read_b128 a[88:91], v5 offset:10240
    v_mfma_f32_16x16x32_bf16 v[100:103], a[40:43], a[116:119], v[100:103]
    s_waitcnt lgkmcnt(4)
    v_mfma_f32_16x16x32_bf16 v[104:107], a[44:47], a[112:115], v[104:107]
    ds_read_b128 a[92:95], v5 offset:11264
    v_mfma_f32_16x16x32_bf16 v[108:111], a[44:47], a[116:119], v[108:111]
    s_barrier
    v_mfma_f32_16x16x32_bf16 v[16:19], a[48:51], a[120:123], v[16:19]
    ds_read_b128 a[0:3], v5 offset:12288
    v_fmac_f32 v80, v168, v144
    v_mfma_f32_16x16x32_bf16 v[20:23], a[48:51], a[124:127], v[20:23]
    s_add_u32 m0, s19, 73728
    s_add_u32 s58, s18, 184320
    v_fmac_f32 v84, v169, v144
    v_mfma_f32_16x16x32_bf16 v[24:27], a[52:55], a[120:123], v[24:27]
    ds_read_b128 a[4:7], v5 offset:13312
    v_fmac_f32 v88, v168, v148
    v_mfma_f32_16x16x32_bf16 v[28:31], a[52:55], a[124:127], v[28:31]
    buffer_load_dwordx4 v1, s[4:7], s58 offen offset:0 sc1 lds
    v_mfma_f32_16x16x32_bf16 v[32:35], a[56:59], a[120:123], v[32:35]
    ds_read_b128 a[8:11], v5 offset:14336
    v_fmac_f32 v92, v169, v148
    v_mfma_f32_16x16x32_bf16 v[36:39], a[56:59], a[124:127], v[36:39]
    v_fmac_f32 v96, v168, v152
    v_fmac_f32 v100, v169, v152
    v_mfma_f32_16x16x32_bf16 v[40:43], a[60:63], a[120:123], v[40:43]
    ds_read_b128 a[12:15], v5 offset:15360
    v_fmac_f32 v104, v168, v156
    v_mfma_f32_16x16x32_bf16 v[44:47], a[60:63], a[124:127], v[44:47]
    buffer_load_dwordx4 v1, s[4:7], s58 offen offset:1024 sc1 lds
    v_mfma_f32_16x16x32_bf16 v[48:51], a[64:67], a[120:123], v[48:51]
    ds_read_b128 a[16:19], v5 offset:16384
    v_fmac_f32 v16, v168, v112
    v_mfma_f32_16x16x32_bf16 v[52:55], a[64:67], a[124:127], v[52:55]
    v_fmac_f32 v20, v169, v112
    v_fmac_f32 v108, v169, v156
    v_mfma_f32_16x16x32_bf16 v[56:59], a[68:71], a[120:123], v[56:59]
    ds_read_b128 a[20:23], v5 offset:17408
    v_fmac_f32 v24, v168, v116
    v_mfma_f32_16x16x32_bf16 v[60:63], a[68:71], a[124:127], v[60:63]
    buffer_load_dwordx4 v1, s[4:7], s58 offen offset:2048 sc1 lds
    v_mfma_f32_16x16x32_bf16 v[64:67], a[72:75], a[120:123], v[64:67]
    ds_read_b128 a[24:27], v5 offset:18432
    v_fmac_f32 v28, v169, v116
    v_mfma_f32_16x16x32_bf16 v[68:71], a[72:75], a[124:127], v[68:71]
    s_add_u32 s43, s16, 12288
    v_fmac_f32 v32, v168, v120
    v_fmac_f32 v36, v169, v120
    s_waitcnt lgkmcnt(4)
    v_mfma_f32_16x16x32_bf16 v[72:75], a[76:79], a[120:123], v[72:75]
    ds_read_b128 a[28:31], v5 offset:19456
    v_fmac_f32 v40, v168, v124
    v_mfma_f32_16x16x32_bf16 v[76:79], a[76:79], a[124:127], v[76:79]
    buffer_load_dwordx4 a[112:115], v1, s[4:7], s43 offen offset:2048 sc1
    v_mfma_f32_16x16x32_bf16 v[80:83], a[80:83], a[120:123], v[80:83]
    ds_read_b128 a[32:35], v5 offset:20480
    v_fmac_f32 v44, v169, v124
    v_mfma_f32_16x16x32_bf16 v[84:87], a[80:83], a[124:127], v[84:87]
    s_add_u32 s43, s17, 12288
    v_fmac_f32 v48, v168, v128
    v_fmac_f32 v52, v169, v128
    v_mfma_f32_16x16x32_bf16 v[88:91], a[84:87], a[120:123], v[88:91]
    ds_read_b128 a[36:39], v5 offset:21504
    v_fmac_f32 v56, v168, v132
    v_mfma_f32_16x16x32_bf16 v[92:95], a[84:87], a[124:127], v[92:95]
    buffer_load_dwordx4 a[116:119], v1, s[4:7], s43 offen offset:2048 sc1
    v_mfma_f32_16x16x32_bf16 v[96:99], a[88:91], a[120:123], v[96:99]
    ds_read_b128 a[40:43], v5 offset:22528
    v_fmac_f32 v60, v169, v132
    v_mfma_f32_16x16x32_bf16 v[100:103], a[88:91], a[124:127], v[100:103]
    v_fmac_f32 v64, v168, v136
    v_fmac_f32 v68, v169, v136
    v_mfma_f32_16x16x32_bf16 v[104:107], a[92:95], a[120:123], v[104:107]
    ds_read_b128 a[44:47], v5 offset:23552
    v_fmac_f32 v72, v168, v140
    v_mfma_f32_16x16x32_bf16 v[108:111], a[92:95], a[124:127], v[108:111]
    v_fmac_f32 v76, v169, v140
    s_waitcnt vmcnt(20)
    s_barrier
    v_mfma_f32_16x16x32_bf16 v[16:19], a[0:3], a[128:131], v[16:19]
    ds_read_b128 a[48:51], v5 offset:24576
    v_fmac_f32 v77, v169, v141
    v_mfma_f32_16x16x32_bf16 v[20:23], a[0:3], a[132:135], v[20:23]
    v_fmac_f32 v81, v168, v145
    v_fmac_f32 v85, v169, v145
    v_mfma_f32_16x16x32_bf16 v[24:27], a[4:7], a[128:131], v[24:27]
    ds_read_b128 a[52:55], v5 offset:25600
    v_fmac_f32 v89, v168, v149
    v_mfma_f32_16x16x32_bf16 v[28:31], a[4:7], a[132:135], v[28:31]
    v_fmac_f32 v93, v169, v149
    v_mfma_f32_16x16x32_bf16 v[32:35], a[8:11], a[128:131], v[32:35]
    ds_read_b128 a[56:59], v5 offset:26624
    v_fmac_f32 v97, v168, v153
    v_mfma_f32_16x16x32_bf16 v[36:39], a[8:11], a[132:135], v[36:39]
    s_waitcnt lgkmcnt(4)
    v_fmac_f32 v101, v169, v153
    v_mfma_f32_16x16x32_bf16 v[40:43], a[12:15], a[128:131], v[40:43]
    ds_read_b128 a[60:63], v5 offset:27648
    v_fmac_f32 v105, v168, v157
    v_mfma_f32_16x16x32_bf16 v[44:47], a[12:15], a[132:135], v[44:47]
    v_fmac_f32 v109, v169, v157
    v_mfma_f32_16x16x32_bf16 v[48:51], a[16:19], a[128:131], v[48:51]
    ds_read_b128 a[64:67], v5 offset:28672
    v_fmac_f32 v17, v168, v113
    v_mfma_f32_16x16x32_bf16 v[52:55], a[16:19], a[132:135], v[52:55]
    v_fmac_f32 v21, v169, v113
    v_mfma_f32_16x16x32_bf16 v[56:59], a[20:23], a[128:131], v[56:59]
    ds_read_b128 a[68:71], v5 offset:29696
    v_fmac_f32 v25, v168, v117
    v_mfma_f32_16x16x32_bf16 v[60:63], a[20:23], a[132:135], v[60:63]
    v_fmac_f32 v29, v169, v117
    v_mfma_f32_16x16x32_bf16 v[64:67], a[24:27], a[128:131], v[64:67]
    ds_read_b128 a[72:75], v5 offset:30720
    v_fmac_f32 v33, v168, v121
    v_mfma_f32_16x16x32_bf16 v[68:71], a[24:27], a[132:135], v[68:71]
    s_add_u32 s43, s16, 12288
    v_fmac_f32 v37, v169, v121
    v_mfma_f32_16x16x32_bf16 v[72:75], a[28:31], a[128:131], v[72:75]
    ds_read_b128 a[76:79], v5 offset:31744
    v_fmac_f32 v41, v168, v125
    v_mfma_f32_16x16x32_bf16 v[76:79], a[28:31], a[132:135], v[76:79]
    buffer_load_dwordx4 a[120:123], v1, s[4:7], s43 offen offset:3072 sc1
    v_mfma_f32_16x16x32_bf16 v[80:83], a[32:35], a[128:131], v[80:83]
    ds_read_b128 a[80:83], v5 offset:32768
    v_fmac_f32 v45, v169, v125
    v_mfma_f32_16x16x32_bf16 v[84:87], a[32:35], a[132:135], v[84:87]
    s_add_u32 s43, s17, 12288
    v_fmac_f32 v49, v168, v129
    v_fmac_f32 v53, v169, v129
    v_mfma_f32_16x16x32_bf16 v[88:91], a[36:39], a[128:131], v[88:91]
    ds_read_b128 a[84:87], v5 offset:33792
    v_fmac_f32 v57, v168, v133
    v_mfma_f32_16x16x32_bf16 v[92:95], a[36:39], a[132:135], v[92:95]
    buffer_load_dwordx4 a[124:127], v1, s[4:7], s43 offen offset:3072 sc1
    v_mfma_f32_16x16x32_bf16 v[96:99], a[40:43], a[128:131], v[96:99]
    ds_read_b128 a[88:91], v5 offset:34816
    v_fmac_f32 v61, v169, v133
    v_mfma_f32_16x16x32_bf16 v[100:103], a[40:43], a[132:135], v[100:103]
    s_mov_b32 s8, s14
    s_mov_b32 s9, s15
    s_mov_b32 s10, 1409024
    s_mov_b32 s11, 0x20000
    s_mul_i32 s55, s3, 360448
    s_bfe_u32 s58, s2, 0x30003
    s_lshl_b32 s58, s58, 7
    s_add_u32 s55, s55, s58
    s_waitcnt lgkmcnt(4)
    v_mfma_f32_16x16x32_bf16 v[104:107], a[44:47], a[128:131], v[104:107]
    ds_read_b128 a[92:95], v5 offset:35840
    v_fmac_f32 v65, v168, v137
    v_mfma_f32_16x16x32_bf16 v[108:111], a[44:47], a[132:135], v[108:111]
    v_fmac_f32 v69, v169, v137
    v_fmac_f32 v73, v168, v141
    s_waitcnt vmcnt(17)
    s_barrier
    v_mfma_f32_16x16x32_bf16 v[16:19], a[48:51], a[136:139], v[16:19]
    ds_read_b128 a[0:3], v5 offset:36864
    v_fmac_f32 v82, v168, v146
    v_mfma_f32_16x16x32_bf16 v[20:23], a[48:51], a[140:143], v[20:23]
    v_fmac_f32 v86, v169, v146
    v_mfma_f32_16x16x32_bf16 v[24:27], a[52:55], a[136:139], v[24:27]
    ds_read_b128 a[4:7], v5 offset:37888
    v_fmac_f32 v90, v168, v150
    v_mfma_f32_16x16x32_bf16 v[28:31], a[52:55], a[140:143], v[28:31]
    v_fmac_f32 v94, v169, v150
    v_mfma_f32_16x16x32_bf16 v[32:35], a[56:59], a[136:139], v[32:35]
    ds_read_b128 a[8:11], v5 offset:38912
    v_fmac_f32 v98, v168, v154
    v_mfma_f32_16x16x32_bf16 v[36:39], a[56:59], a[140:143], v[36:39]
    v_fmac_f32 v102, v169, v154
    v_mfma_f32_16x16x32_bf16 v[40:43], a[60:63], a[136:139], v[40:43]
    ds_read_b128 a[12:15], v5 offset:39936
    v_fmac_f32 v106, v168, v158
    v_mfma_f32_16x16x32_bf16 v[44:47], a[60:63], a[140:143], v[44:47]
    v_fmac_f32 v110, v169, v158
    v_mfma_f32_16x16x32_bf16 v[48:51], a[64:67], a[136:139], v[48:51]
    ds_read_b128 a[16:19], v5 offset:40960
    v_fmac_f32 v18, v168, v114
    v_mfma_f32_16x16x32_bf16 v[52:55], a[64:67], a[140:143], v[52:55]
    v_fmac_f32 v22, v169, v114
    v_mfma_f32_16x16x32_bf16 v[56:59], a[68:71], a[136:139], v[56:59]
    ds_read_b128 a[20:23], v5 offset:41984
    v_fmac_f32 v26, v168, v118
    v_mfma_f32_16x16x32_bf16 v[60:63], a[68:71], a[140:143], v[60:63]
    v_fmac_f32 v30, v169, v118
    v_mfma_f32_16x16x32_bf16 v[64:67], a[72:75], a[136:139], v[64:67]
    ds_read_b128 a[24:27], v5 offset:43008
    v_fmac_f32 v34, v168, v122
    v_mfma_f32_16x16x32_bf16 v[68:71], a[72:75], a[140:143], v[68:71]
    s_waitcnt lgkmcnt(4)
    v_fmac_f32 v38, v169, v122
    v_mfma_f32_16x16x32_bf16 v[72:75], a[76:79], a[136:139], v[72:75]
    ds_read_b128 a[28:31], v5 offset:44032
    v_fmac_f32 v42, v168, v126
    v_mfma_f32_16x16x32_bf16 v[76:79], a[76:79], a[140:143], v[76:79]
    v_fmac_f32 v46, v169, v126
    v_mfma_f32_16x16x32_bf16 v[80:83], a[80:83], a[136:139], v[80:83]
    ds_read_b128 a[32:35], v5 offset:45056
    v_fmac_f32 v50, v168, v130
    v_mfma_f32_16x16x32_bf16 v[84:87], a[80:83], a[140:143], v[84:87]
    v_fmac_f32 v54, v169, v130
    v_mfma_f32_16x16x32_bf16 v[88:91], a[84:87], a[136:139], v[88:91]
    ds_read_b128 a[36:39], v5 offset:46080
    v_fmac_f32 v58, v168, v134
    v_mfma_f32_16x16x32_bf16 v[92:95], a[84:87], a[140:143], v[92:95]
    v_fmac_f32 v62, v169, v134
    v_mfma_f32_16x16x32_bf16 v[96:99], a[88:91], a[136:139], v[96:99]
    ds_read_b128 a[40:43], v5 offset:47104
    v_fmac_f32 v66, v168, v138
    v_mfma_f32_16x16x32_bf16 v[100:103], a[88:91], a[140:143], v[100:103]
    v_fmac_f32 v70, v169, v138
    v_mfma_f32_16x16x32_bf16 v[104:107], a[92:95], a[136:139], v[104:107]
    ds_read_b128 a[44:47], v5 offset:48128
    v_fmac_f32 v74, v168, v142
    v_mfma_f32_16x16x32_bf16 v[108:111], a[92:95], a[140:143], v[108:111]
    v_fmac_f32 v78, v169, v142
    s_waitcnt vmcnt(12)
    s_barrier
    v_mfma_f32_16x16x32_bf16 v[16:19], a[0:3], a[96:99], v[16:19]
    ds_read_b128 a[48:51], v5 offset:49152
    v_fmac_f32 v83, v168, v147
    v_mfma_f32_16x16x32_bf16 v[20:23], a[0:3], a[100:103], v[20:23]
    s_add_u32 m0, s56, 0
    s_add_u32 s58, s55, 0
    v_fmac_f32 v87, v169, v147
    v_mfma_f32_16x16x32_bf16 v[24:27], a[4:7], a[96:99], v[24:27]
    ds_read_b128 a[52:55], v5 offset:50176
    v_fmac_f32 v91, v168, v151
    v_mfma_f32_16x16x32_bf16 v[28:31], a[4:7], a[100:103], v[28:31]
    buffer_load_dwordx4 v176, s[8:11], s58 offen offset:0 lds
    v_mfma_f32_16x16x32_bf16 v[32:35], a[8:11], a[96:99], v[32:35]
    ds_read_b128 a[56:59], v5 offset:51200
    v_fmac_f32 v95, v169, v151
    v_mfma_f32_16x16x32_bf16 v[36:39], a[8:11], a[100:103], v[36:39]
    s_waitcnt lgkmcnt(4)
    v_fmac_f32 v99, v168, v155
    v_fmac_f32 v103, v169, v155
    v_mfma_f32_16x16x32_bf16 v[40:43], a[12:15], a[96:99], v[40:43]
    ds_read_b128 a[60:63], v5 offset:52224
    v_fmac_f32 v107, v168, v159
    v_mfma_f32_16x16x32_bf16 v[44:47], a[12:15], a[100:103], v[44:47]
    buffer_load_dwordx4 v177, s[8:11], s58 offen offset:1024 lds
    v_mfma_f32_16x16x32_bf16 v[48:51], a[16:19], a[96:99], v[48:51]
    ds_read_b128 a[64:67], v5 offset:53248
    v_fmac_f32 v19, v168, v115
    v_mfma_f32_16x16x32_bf16 v[52:55], a[16:19], a[100:103], v[52:55]
    v_fmac_f32 v23, v169, v115
    v_fmac_f32 v111, v169, v159
    v_mfma_f32_16x16x32_bf16 v[56:59], a[20:23], a[96:99], v[56:59]
    ds_read_b128 a[68:71], v5 offset:54272
    v_fmac_f32 v27, v168, v119
    v_mfma_f32_16x16x32_bf16 v[60:63], a[20:23], a[100:103], v[60:63]
    buffer_load_dwordx4 v178, s[8:11], s58 offen offset:2048 lds
    v_mfma_f32_16x16x32_bf16 v[64:67], a[24:27], a[96:99], v[64:67]
    ds_read_b128 a[72:75], v5 offset:55296
    v_fmac_f32 v31, v169, v119
    v_mfma_f32_16x16x32_bf16 v[68:71], a[24:27], a[100:103], v[68:71]
    v_fmac_f32 v35, v168, v123
    v_fmac_f32 v39, v169, v123
    v_mfma_f32_16x16x32_bf16 v[72:75], a[28:31], a[96:99], v[72:75]
    ds_read_b128 a[76:79], v5 offset:56320
    v_fmac_f32 v43, v168, v127
    v_mfma_f32_16x16x32_bf16 v[76:79], a[28:31], a[100:103], v[76:79]
    buffer_load_dwordx4 v179, s[8:11], s58 offen offset:3072 lds
    v_mfma_f32_16x16x32_bf16 v[80:83], a[32:35], a[96:99], v[80:83]
    ds_read_b128 a[80:83], v5 offset:57344
    v_fmac_f32 v47, v169, v127
    v_mfma_f32_16x16x32_bf16 v[84:87], a[32:35], a[100:103], v[84:87]
    v_fmac_f32 v51, v168, v131
    v_fmac_f32 v55, v169, v131
    v_mfma_f32_16x16x32_bf16 v[88:91], a[36:39], a[96:99], v[88:91]
    ds_read_b128 a[84:87], v5 offset:58368
    v_fmac_f32 v59, v168, v135
    v_mfma_f32_16x16x32_bf16 v[92:95], a[36:39], a[100:103], v[92:95]
    v_fmac_f32 v63, v169, v135
    v_mfma_f32_16x16x32_bf16 v[96:99], a[40:43], a[96:99], v[96:99]
    ds_read_b128 a[88:91], v5 offset:59392
    v_fmac_f32 v67, v168, v139
    v_mfma_f32_16x16x32_bf16 v[100:103], a[40:43], a[100:103], v[100:103]
    s_waitcnt lgkmcnt(4)
    v_fmac_f32 v71, v169, v139
    v_mfma_f32_16x16x32_bf16 v[104:107], a[44:47], a[96:99], v[104:107]
    ds_read_b128 a[92:95], v5 offset:60416
    v_fmac_f32 v75, v168, v143
    v_mfma_f32_16x16x32_bf16 v[108:111], a[44:47], a[100:103], v[108:111]
    v_fmac_f32 v79, v169, v143
    s_waitcnt vmcnt(11)
    s_barrier
    v_mfma_f32_16x16x32_bf16 v[16:19], a[48:51], a[104:107], v[16:19]
    ds_read_b128 a[0:3], v6 offset:0
    v_mfma_f32_16x16x32_bf16 v[20:23], a[48:51], a[108:111], v[20:23]
    s_add_u32 m0, s56, 4096
    s_add_u32 s58, s55, 32768
    v_mfma_f32_16x16x32_bf16 v[24:27], a[52:55], a[104:107], v[24:27]
    ds_read_b128 a[4:7], v6 offset:1024
    v_mfma_f32_16x16x32_bf16 v[28:31], a[52:55], a[108:111], v[28:31]
    buffer_load_dwordx4 v176, s[8:11], s58 offen offset:0 lds
    v_mfma_f32_16x16x32_bf16 v[32:35], a[56:59], a[104:107], v[32:35]
    ds_read_b128 a[8:11], v6 offset:2048
    v_mfma_f32_16x16x32_bf16 v[36:39], a[56:59], a[108:111], v[36:39]
    v_mfma_f32_16x16x32_bf16 v[40:43], a[60:63], a[104:107], v[40:43]
    ds_read_b128 a[12:15], v6 offset:3072
    v_mfma_f32_16x16x32_bf16 v[44:47], a[60:63], a[108:111], v[44:47]
    buffer_load_dwordx4 v177, s[8:11], s58 offen offset:1024 lds
    v_mfma_f32_16x16x32_bf16 v[48:51], a[64:67], a[104:107], v[48:51]
    ds_read_b128 a[16:19], v6 offset:4096
    v_mfma_f32_16x16x32_bf16 v[52:55], a[64:67], a[108:111], v[52:55]
    v_mfma_f32_16x16x32_bf16 v[56:59], a[68:71], a[104:107], v[56:59]
    ds_read_b128 a[20:23], v6 offset:5120
    v_mfma_f32_16x16x32_bf16 v[60:63], a[68:71], a[108:111], v[60:63]
    buffer_load_dwordx4 v178, s[8:11], s58 offen offset:2048 lds
    v_mfma_f32_16x16x32_bf16 v[64:67], a[72:75], a[104:107], v[64:67]
    ds_read_b128 a[24:27], v6 offset:6144
    v_mfma_f32_16x16x32_bf16 v[68:71], a[72:75], a[108:111], v[68:71]
    s_waitcnt lgkmcnt(4)
    v_mfma_f32_16x16x32_bf16 v[72:75], a[76:79], a[104:107], v[72:75]
    ds_read_b128 a[28:31], v6 offset:7168
    v_mfma_f32_16x16x32_bf16 v[76:79], a[76:79], a[108:111], v[76:79]
    buffer_load_dwordx4 v179, s[8:11], s58 offen offset:3072 lds
    v_mfma_f32_16x16x32_bf16 v[80:83], a[80:83], a[104:107], v[80:83]
    ds_read_b128 a[32:35], v6 offset:8192
    v_mfma_f32_16x16x32_bf16 v[84:87], a[80:83], a[108:111], v[84:87]
    v_mfma_f32_16x16x32_bf16 v[88:91], a[84:87], a[104:107], v[88:91]
    ds_read_b128 a[36:39], v6 offset:9216
    v_mfma_f32_16x16x32_bf16 v[92:95], a[84:87], a[108:111], v[92:95]
    v_mfma_f32_16x16x32_bf16 v[96:99], a[88:91], a[104:107], v[96:99]
    ds_read_b128 a[40:43], v6 offset:10240
    v_mfma_f32_16x16x32_bf16 v[100:103], a[88:91], a[108:111], v[100:103]
    v_mfma_f32_16x16x32_bf16 v[104:107], a[92:95], a[104:107], v[104:107]
    ds_read_b128 a[44:47], v6 offset:11264
    v_mfma_f32_16x16x32_bf16 v[108:111], a[92:95], a[108:111], v[108:111]
    s_waitcnt vmcnt(10)
    s_barrier
    v_mfma_f32_16x16x32_bf16 v[16:19], a[0:3], a[112:115], v[16:19]
    ds_read_b128 a[48:51], v6 offset:12288
    v_mfma_f32_16x16x32_bf16 v[20:23], a[0:3], a[116:119], v[20:23]
    s_add_u32 m0, s56, 8192
    s_add_u32 s58, s55, 65536
    v_mfma_f32_16x16x32_bf16 v[24:27], a[4:7], a[112:115], v[24:27]
    ds_read_b128 a[52:55], v6 offset:13312
    v_mfma_f32_16x16x32_bf16 v[28:31], a[4:7], a[116:119], v[28:31]
    buffer_load_dwordx4 v176, s[8:11], s58 offen offset:0 lds
    v_mfma_f32_16x16x32_bf16 v[32:35], a[8:11], a[112:115], v[32:35]
    ds_read_b128 a[56:59], v6 offset:14336
    v_mfma_f32_16x16x32_bf16 v[36:39], a[8:11], a[116:119], v[36:39]
    s_waitcnt lgkmcnt(4)
    v_mfma_f32_16x16x32_bf16 v[40:43], a[12:15], a[112:115], v[40:43]
    ds_read_b128 a[60:63], v6 offset:15360
    v_mfma_f32_16x16x32_bf16 v[44:47], a[12:15], a[116:119], v[44:47]
    buffer_load_dwordx4 v177, s[8:11], s58 offen offset:1024 lds
    v_mfma_f32_16x16x32_bf16 v[48:51], a[16:19], a[112:115], v[48:51]
    ds_read_b128 a[64:67], v6 offset:16384
    v_mfma_f32_16x16x32_bf16 v[52:55], a[16:19], a[116:119], v[52:55]
    v_mfma_f32_16x16x32_bf16 v[56:59], a[20:23], a[112:115], v[56:59]
    ds_read_b128 a[68:71], v6 offset:17408
    v_mfma_f32_16x16x32_bf16 v[60:63], a[20:23], a[116:119], v[60:63]
    buffer_load_dwordx4 v178, s[8:11], s58 offen offset:2048 lds
    v_mfma_f32_16x16x32_bf16 v[64:67], a[24:27], a[112:115], v[64:67]
    ds_read_b128 a[72:75], v6 offset:18432
    v_mfma_f32_16x16x32_bf16 v[68:71], a[24:27], a[116:119], v[68:71]
    v_mfma_f32_16x16x32_bf16 v[72:75], a[28:31], a[112:115], v[72:75]
    ds_read_b128 a[76:79], v6 offset:19456
    v_mfma_f32_16x16x32_bf16 v[76:79], a[28:31], a[116:119], v[76:79]
    buffer_load_dwordx4 v179, s[8:11], s58 offen offset:3072 lds
    v_mfma_f32_16x16x32_bf16 v[80:83], a[32:35], a[112:115], v[80:83]
    ds_read_b128 a[80:83], v6 offset:20480
    v_mfma_f32_16x16x32_bf16 v[84:87], a[32:35], a[116:119], v[84:87]
    v_mfma_f32_16x16x32_bf16 v[88:91], a[36:39], a[112:115], v[88:91]
    ds_read_b128 a[84:87], v6 offset:21504
    v_mfma_f32_16x16x32_bf16 v[92:95], a[36:39], a[116:119], v[92:95]
    v_mfma_f32_16x16x32_bf16 v[96:99], a[40:43], a[112:115], v[96:99]
    ds_read_b128 a[88:91], v6 offset:22528
    v_mfma_f32_16x16x32_bf16 v[100:103], a[40:43], a[116:119], v[100:103]
    s_waitcnt lgkmcnt(4)
    v_mfma_f32_16x16x32_bf16 v[104:107], a[44:47], a[112:115], v[104:107]
    ds_read_b128 a[92:95], v6 offset:23552
    v_mfma_f32_16x16x32_bf16 v[108:111], a[44:47], a[116:119], v[108:111]
    s_waitcnt vmcnt(12)
    s_barrier
    v_mfma_f32_16x16x32_bf16 v[16:19], a[48:51], a[120:123], v[16:19]
    v_mfma_f32_16x16x32_bf16 v[20:23], a[48:51], a[124:127], v[20:23]
    s_add_u32 m0, s56, 12288
    s_add_u32 s58, s55, 98304
    v_mfma_f32_16x16x32_bf16 v[24:27], a[52:55], a[120:123], v[24:27]
    v_mfma_f32_16x16x32_bf16 v[28:31], a[52:55], a[124:127], v[28:31]
    buffer_load_dwordx4 v176, s[8:11], s58 offen offset:0 lds
    v_mfma_f32_16x16x32_bf16 v[32:35], a[56:59], a[120:123], v[32:35]
    v_mfma_f32_16x16x32_bf16 v[36:39], a[56:59], a[124:127], v[36:39]
    v_mfma_f32_16x16x32_bf16 v[40:43], a[60:63], a[120:123], v[40:43]
    v_mfma_f32_16x16x32_bf16 v[44:47], a[60:63], a[124:127], v[44:47]
    buffer_load_dwordx4 v177, s[8:11], s58 offen offset:1024 lds
    v_mfma_f32_16x16x32_bf16 v[48:51], a[64:67], a[120:123], v[48:51]
    v_mfma_f32_16x16x32_bf16 v[52:55], a[64:67], a[124:127], v[52:55]
    v_mfma_f32_16x16x32_bf16 v[56:59], a[68:71], a[120:123], v[56:59]
    s_waitcnt lgkmcnt(0)
    s_barrier
    v_mfma_f32_16x16x32_bf16 v[60:63], a[68:71], a[124:127], v[60:63]
    buffer_load_dwordx4 v178, s[8:11], s58 offen offset:2048 lds
    v_mfma_f32_16x16x32_bf16 v[64:67], a[72:75], a[120:123], v[64:67]
    v_mfma_f32_16x16x32_bf16 v[68:71], a[72:75], a[124:127], v[68:71]
    v_mfma_f32_16x16x32_bf16 v[72:75], a[76:79], a[120:123], v[72:75]
    v_mfma_f32_16x16x32_bf16 v[76:79], a[76:79], a[124:127], v[76:79]
    buffer_load_dwordx4 v179, s[8:11], s58 offen offset:3072 lds
    v_mfma_f32_16x16x32_bf16 v[80:83], a[80:83], a[120:123], v[80:83]
    s_mul_i32 s37, s3, 11264
    s_add_u32 s37, s37, 66060288
    s_add_u32 s58, s3, 0
    s_and_b32 s58, s58, 3
    v_mfma_f32_16x16x32_bf16 v[84:87], a[80:83], a[124:127], v[84:87]
    s_lshl_b32 s38, s34, 2
    s_add_u32 s38, s38, s58
    s_mul_i32 s38, s38, 44032
    v_mfma_f32_16x16x32_bf16 v[88:91], a[84:87], a[120:123], v[88:91]
    s_add_u32 s38, s38, s37
    s_add_u32 s58, s3, 1
    s_and_b32 s58, s58, 3
    v_mfma_f32_16x16x32_bf16 v[92:95], a[84:87], a[124:127], v[92:95]
    s_lshl_b32 s39, s34, 2
    s_add_u32 s39, s39, s58
    s_mul_i32 s39, s39, 44032
    v_mfma_f32_16x16x32_bf16 v[96:99], a[88:91], a[120:123], v[96:99]
    s_add_u32 s39, s39, s37
    s_add_u32 s58, s3, 2
    s_and_b32 s58, s58, 3
    s_lshl_b32 s40, s34, 2
    v_mfma_f32_16x16x32_bf16 v[100:103], a[88:91], a[124:127], v[100:103]
    s_add_u32 s40, s40, s58
    s_mul_i32 s40, s40, 44032
    s_add_u32 s40, s40, s37
    v_mfma_f32_16x16x32_bf16 v[104:107], a[92:95], a[120:123], v[104:107]
    s_add_u32 s58, s3, 3
    s_and_b32 s58, s58, 3
    s_lshl_b32 s41, s34, 2
    v_mfma_f32_16x16x32_bf16 v[108:111], a[92:95], a[124:127], v[108:111]
    s_add_u32 s41, s41, s58
    s_mul_i32 s41, s41, 44032
    s_add_u32 s41, s41, s37
    s_mul_i32 s16, s42, 43
    s_mul_i32 s58, s36, 3
    s_add_u32 s16, s16, s58
    s_lshl_b32 s16, s16, 10
    s_add_u32 s16, s16, 66060288
    s_add_u32 s17, s16, 44032
    s_add_u32 m0, s56, 65536
    s_add_u32 s58, s55, 131072
    buffer_load_dwordx4 v176, s[8:11], s58 offen offset:0 lds
    v_mul_f32 v224, v16, v170
    v_mul_f32 v225, v17, v170
    v_mul_f32 v226, v18, v170
    v_mul_f32 v227, v19, v170
    v_mul_f32 v228, v24, v170
    v_mul_f32 v229, v25, v170
    v_mul_f32 v230, v26, v170
    v_mul_f32 v231, v27, v170
    buffer_load_dwordx4 v177, s[8:11], s58 offen offset:1024 lds
    v_exp_f32 v224, v224
    v_exp_f32 v225, v225
    v_exp_f32 v226, v226
    v_exp_f32 v227, v227
    v_exp_f32 v228, v228
    v_exp_f32 v229, v229
    v_exp_f32 v230, v230
    v_exp_f32 v231, v231
    buffer_load_dwordx4 v178, s[8:11], s58 offen offset:2048 lds
    v_fma_f32 v224, v224, v172, v172
    v_fma_f32 v225, v225, v172, v172
    v_fma_f32 v226, v226, v172, v172
    v_fma_f32 v227, v227, v172, v172
    v_fma_f32 v228, v228, v172, v172
    v_fma_f32 v229, v229, v172, v172
    v_fma_f32 v230, v230, v172, v172
    v_fma_f32 v231, v231, v172, v172
    buffer_load_dwordx4 v179, s[8:11], s58 offen offset:3072 lds
    v_rcp_f32 v224, v224
    v_rcp_f32 v225, v225
    v_rcp_f32 v226, v226
    v_rcp_f32 v227, v227
    v_rcp_f32 v228, v228
    v_rcp_f32 v229, v229
    v_rcp_f32 v230, v230
    v_rcp_f32 v231, v231
    v_pk_mul_f32 v[16:17], v[16:17], v[64:65]
    v_pk_mul_f32 v[18:19], v[18:19], v[66:67]
    v_pk_mul_f32 v[24:25], v[24:25], v[72:73]
    v_pk_mul_f32 v[26:27], v[26:27], v[74:75]
    v_pk_mul_f32 v[224:225], v[224:225], v[16:17]
    v_pk_mul_f32 v[226:227], v[226:227], v[18:19]
    v_pk_mul_f32 v[228:229], v[228:229], v[24:25]
    v_pk_mul_f32 v[230:231], v[230:231], v[26:27]
    v_cvt_pk_bf16_f32 v192, v224, v225
    v_cvt_pk_bf16_f32 v193, v226, v227
    v_cvt_pk_bf16_f32 v194, v228, v229
    v_cvt_pk_bf16_f32 v195, v230, v231
    buffer_store_dwordx4 v[192:195], v1, s[4:7], s16 offen offset:0 sc1
    s_add_u32 m0, s56, 69632
    s_add_u32 s58, s55, 163840
    buffer_load_dwordx4 v176, s[8:11], s58 offen offset:0 lds
    v_mul_f32 v232, v20, v171
    v_mul_f32 v233, v21, v171
    v_mul_f32 v234, v22, v171
    v_mul_f32 v235, v23, v171
    v_mul_f32 v236, v28, v171
    v_mul_f32 v237, v29, v171
    v_mul_f32 v238, v30, v171
    v_mul_f32 v239, v31, v171
    buffer_load_dwordx4 v177, s[8:11], s58 offen offset:1024 lds
    v_exp_f32 v232, v232
    v_exp_f32 v233, v233
    v_exp_f32 v234, v234
    v_exp_f32 v235, v235
    v_exp_f32 v236, v236
    v_exp_f32 v237, v237
    v_exp_f32 v238, v238
    v_exp_f32 v239, v239
    buffer_load_dwordx4 v178, s[8:11], s58 offen offset:2048 lds
    v_fma_f32 v232, v232, v173, v173
    v_fma_f32 v233, v233, v173, v173
    v_fma_f32 v234, v234, v173, v173
    v_fma_f32 v235, v235, v173, v173
    v_fma_f32 v236, v236, v173, v173
    v_fma_f32 v237, v237, v173, v173
    v_fma_f32 v238, v238, v173, v173
    v_fma_f32 v239, v239, v173, v173
    buffer_load_dwordx4 v179, s[8:11], s58 offen offset:3072 lds
    v_rcp_f32 v232, v232
    v_rcp_f32 v233, v233
    v_rcp_f32 v234, v234
    v_rcp_f32 v235, v235
    v_rcp_f32 v236, v236
    v_rcp_f32 v237, v237
    v_rcp_f32 v238, v238
    v_rcp_f32 v239, v239
    v_pk_mul_f32 v[20:21], v[20:21], v[68:69]
    v_pk_mul_f32 v[22:23], v[22:23], v[70:71]
    v_pk_mul_f32 v[28:29], v[28:29], v[76:77]
    v_pk_mul_f32 v[30:31], v[30:31], v[78:79]
    v_pk_mul_f32 v[232:233], v[232:233], v[20:21]
    v_pk_mul_f32 v[234:235], v[234:235], v[22:23]
    v_pk_mul_f32 v[236:237], v[236:237], v[28:29]
    v_pk_mul_f32 v[238:239], v[238:239], v[30:31]
    v_cvt_pk_bf16_f32 v196, v232, v233
    v_cvt_pk_bf16_f32 v197, v234, v235
    v_cvt_pk_bf16_f32 v198, v236, v237
    v_cvt_pk_bf16_f32 v199, v238, v239
    buffer_store_dwordx4 v[196:199], v1, s[4:7], s17 offen offset:0 sc1
    s_cmp_eq_u32 s36, 14
    s_cbranch_scc1 L_p4_short
    s_add_u32 m0, s56, 73728
    s_add_u32 s58, s55, 196608
    buffer_load_dwordx4 v176, s[8:11], s58 offen offset:0 lds
    v_mul_f32 v224, v32, v170
    v_mul_f32 v225, v33, v170
    v_mul_f32 v226, v34, v170
    v_mul_f32 v227, v35, v170
    v_mul_f32 v228, v40, v170
    v_mul_f32 v229, v41, v170
    v_mul_f32 v230, v42, v170
    v_mul_f32 v231, v43, v170
    buffer_load_dwordx4 v177, s[8:11], s58 offen offset:1024 lds
    v_exp_f32 v224, v224
    v_exp_f32 v225, v225
    v_exp_f32 v226, v226
    v_exp_f32 v227, v227
    v_exp_f32 v228, v228
    v_exp_f32 v229, v229
    v_exp_f32 v230, v230
    v_exp_f32 v231, v231
    buffer_load_dwordx4 v178, s[8:11], s58 offen offset:2048 lds
    v_fma_f32 v224, v224, v172, v172
    v_fma_f32 v225, v225, v172, v172
    v_fma_f32 v226, v226, v172, v172
    v_fma_f32 v227, v227, v172, v172
    v_fma_f32 v228, v228, v172, v172
    v_fma_f32 v229, v229, v172, v172
    v_fma_f32 v230, v230, v172, v172
    v_fma_f32 v231, v231, v172, v172
    buffer_load_dwordx4 v179, s[8:11], s58 offen offset:3072 lds
    v_rcp_f32 v224, v224
    v_rcp_f32 v225, v225
    v_rcp_f32 v226, v226
    v_rcp_f32 v227, v227
    v_rcp_f32 v228, v228
    v_rcp_f32 v229, v229
    v_rcp_f32 v230, v230
    v_rcp_f32 v231, v231
    v_pk_mul_f32 v[32:33], v[32:33], v[80:81]
    v_pk_mul_f32 v[34:35], v[34:35], v[82:83]
    v_pk_mul_f32 v[40:41], v[40:41], v[88:89]
    v_pk_mul_f32 v[42:43], v[42:43], v[90:91]
    v_pk_mul_f32 v[224:225], v[224:225], v[32:33]
    v_pk_mul_f32 v[226:227], v[226:227], v[34:35]
    v_pk_mul_f32 v[228:229], v[228:229], v[40:41]
    v_pk_mul_f32 v[230:231], v[230:231], v[42:43]
    v_cvt_pk_bf16_f32 v200, v224, v225
    v_cvt_pk_bf16_f32 v201, v226, v227
    v_cvt_pk_bf16_f32 v202, v228, v229
    v_cvt_pk_bf16_f32 v203, v230, v231
    buffer_store_dwordx4 v[200:203], v1, s[4:7], s16 offen offset:1024 sc1
    s_add_u32 m0, s56, 77824
    s_add_u32 s58, s55, 229376
    buffer_load_dwordx4 v176, s[8:11], s58 offen offset:0 lds
    v_mul_f32 v232, v36, v171
    v_mul_f32 v233, v37, v171
    v_mul_f32 v234, v38, v171
    v_mul_f32 v235, v39, v171
    v_mul_f32 v236, v44, v171
    v_mul_f32 v237, v45, v171
    v_mul_f32 v238, v46, v171
    v_mul_f32 v239, v47, v171
    buffer_load_dwordx4 v177, s[8:11], s58 offen offset:1024 lds
    v_exp_f32 v232, v232
    v_exp_f32 v233, v233
    v_exp_f32 v234, v234
    v_exp_f32 v235, v235
    v_exp_f32 v236, v236
    v_exp_f32 v237, v237
    v_exp_f32 v238, v238
    v_exp_f32 v239, v239
    buffer_load_dwordx4 v178, s[8:11], s58 offen offset:2048 lds
    v_fma_f32 v232, v232, v173, v173
    v_fma_f32 v233, v233, v173, v173
    v_fma_f32 v234, v234, v173, v173
    v_fma_f32 v235, v235, v173, v173
    v_fma_f32 v236, v236, v173, v173
    v_fma_f32 v237, v237, v173, v173
    v_fma_f32 v238, v238, v173, v173
    v_fma_f32 v239, v239, v173, v173
    buffer_load_dwordx4 v179, s[8:11], s58 offen offset:3072 lds
    v_rcp_f32 v232, v232
    v_rcp_f32 v233, v233
    v_rcp_f32 v234, v234
    v_rcp_f32 v235, v235
    v_rcp_f32 v236, v236
    v_rcp_f32 v237, v237
    v_rcp_f32 v238, v238
    v_rcp_f32 v239, v239
    v_pk_mul_f32 v[36:37], v[36:37], v[84:85]
    v_pk_mul_f32 v[38:39], v[38:39], v[86:87]
    v_pk_mul_f32 v[44:45], v[44:45], v[92:93]
    v_pk_mul_f32 v[46:47], v[46:47], v[94:95]
    v_pk_mul_f32 v[232:233], v[232:233], v[36:37]
    v_pk_mul_f32 v[234:235], v[234:235], v[38:39]
    v_pk_mul_f32 v[236:237], v[236:237], v[44:45]
    v_pk_mul_f32 v[238:239], v[238:239], v[46:47]
    v_cvt_pk_bf16_f32 v204, v232, v233
    v_cvt_pk_bf16_f32 v205, v234, v235
    v_cvt_pk_bf16_f32 v206, v236, v237
    v_cvt_pk_bf16_f32 v207, v238, v239
    buffer_store_dwordx4 v[204:207], v1, s[4:7], s17 offen offset:1024 sc1
    v_mul_f32 v224, v48, v170
    v_mul_f32 v225, v49, v170
    v_mul_f32 v226, v50, v170
    v_mul_f32 v227, v51, v170
    v_mul_f32 v228, v56, v170
    v_mul_f32 v229, v57, v170
    v_mul_f32 v230, v58, v170
    v_mul_f32 v231, v59, v170
    v_exp_f32 v224, v224
    v_exp_f32 v225, v225
    v_exp_f32 v226, v226
    v_exp_f32 v227, v227
    v_exp_f32 v228, v228
    v_exp_f32 v229, v229
    v_exp_f32 v230, v230
    v_exp_f32 v231, v231
    v_fma_f32 v224, v224, v172, v172
    v_fma_f32 v225, v225, v172, v172
    v_fma_f32 v226, v226, v172, v172
    v_fma_f32 v227, v227, v172, v172
    v_fma_f32 v228, v228, v172, v172
    v_fma_f32 v229, v229, v172, v172
    v_fma_f32 v230, v230, v172, v172
    v_fma_f32 v231, v231, v172, v172
    v_rcp_f32 v224, v224
    v_rcp_f32 v225, v225
    v_rcp_f32 v226, v226
    v_rcp_f32 v227, v227
    v_rcp_f32 v228, v228
    v_rcp_f32 v229, v229
    v_rcp_f32 v230, v230
    v_rcp_f32 v231, v231
    v_pk_mul_f32 v[48:49], v[48:49], v[96:97]
    v_pk_mul_f32 v[50:51], v[50:51], v[98:99]
    v_pk_mul_f32 v[56:57], v[56:57], v[104:105]
    v_pk_mul_f32 v[58:59], v[58:59], v[106:107]
    v_pk_mul_f32 v[224:225], v[224:225], v[48:49]
    v_pk_mul_f32 v[226:227], v[226:227], v[50:51]
    v_pk_mul_f32 v[228:229], v[228:229], v[56:57]
    v_pk_mul_f32 v[230:231], v[230:231], v[58:59]
    v_cvt_pk_bf16_f32 v192, v224, v225
    v_cvt_pk_bf16_f32 v193, v226, v227
    v_cvt_pk_bf16_f32 v194, v228, v229
    v_cvt_pk_bf16_f32 v195, v230, v231
    buffer_store_dwordx4 v[192:195], v1, s[4:7], s16 offen offset:2048 sc1
    v_mul_f32 v232, v52, v171
    v_mul_f32 v233, v53, v171
    v_mul_f32 v234, v54, v171
    v_mul_f32 v235, v55, v171
    v_mul_f32 v236, v60, v171
    v_mul_f32 v237, v61, v171
    v_mul_f32 v238, v62, v171
    v_mul_f32 v239, v63, v171
    v_exp_f32 v232, v232
    v_exp_f32 v233, v233
    v_exp_f32 v234, v234
    v_exp_f32 v235, v235
    v_exp_f32 v236, v236
    v_exp_f32 v237, v237
    v_exp_f32 v238, v238
    v_exp_f32 v239, v239
    v_fma_f32 v232, v232, v173, v173
    v_fma_f32 v233, v233, v173, v173
    v_fma_f32 v234, v234, v173, v173
    v_fma_f32 v235, v235, v173, v173
    v_fma_f32 v236, v236, v173, v173
    v_fma_f32 v237, v237, v173, v173
    v_fma_f32 v238, v238, v173, v173
    v_fma_f32 v239, v239, v173, v173
    v_rcp_f32 v232, v232
    v_rcp_f32 v233, v233
    v_rcp_f32 v234, v234
    v_rcp_f32 v235, v235
    v_rcp_f32 v236, v236
    v_rcp_f32 v237, v237
    v_rcp_f32 v238, v238
    v_rcp_f32 v239, v239
    v_pk_mul_f32 v[52:53], v[52:53], v[100:101]
    v_pk_mul_f32 v[54:55], v[54:55], v[102:103]
    v_pk_mul_f32 v[60:61], v[60:61], v[108:109]
    v_pk_mul_f32 v[62:63], v[62:63], v[110:111]
    v_pk_mul_f32 v[232:233], v[232:233], v[52:53]
    v_pk_mul_f32 v[234:235], v[234:235], v[54:55]
    v_pk_mul_f32 v[236:237], v[236:237], v[60:61]
    v_pk_mul_f32 v[238:239], v[238:239], v[62:63]
    v_cvt_pk_bf16_f32 v196, v232, v233
    v_cvt_pk_bf16_f32 v197, v234, v235
    v_cvt_pk_bf16_f32 v198, v236, v237
    v_cvt_pk_bf16_f32 v199, v238, v239
    buffer_store_dwordx4 v[196:199], v1, s[4:7], s17 offen offset:2048 sc1
L_p4_fin:
    s_lshl_b32 s37, s32, 5
    s_add_u32 s37, s37, s36
    s_lshl_b32 s37, s37, 2
    s_add_u32 s37, s37, 74459136
    s_waitcnt vmcnt(0)
    s_barrier
    s_add_u32 s58, s37, s69
    buffer_store_dword v253, v252, s[4:7], s58 offen sc1
L_p5:
    s_lshl_b32 s58, s32, 7
    s_add_u32 s58, s58, 74459136
    s_mul_i32 s37, s3, 480601
    s_lshr_b32 s37, s37, 17
    v_min_u32 v255, 4, v0
    v_add_u32 v255, s37, v255
    v_min_u32 v255, 14, v255
    v_lshl_add_u32 v255, v255, 2, s58
    buffer_load_dword v254, v255, s[4:7], 0 offen sc1
    v_and_b32 v188, 15, v0
    v_lshrrev_b32 v189, 4, v0
    v_lshlrev_b32 v190, 10, v189
    v_lshl_add_u32 v190, v188, 4, v190
    s_lshl_b32 s58, s3, 12
    v_add_u32 v190, s58, v190
    v_lshlrev_b32 v189, 5, v189
    v_lshl_add_u32 v188, v188, 12, v189
    s_lshl_b32 s45, s34, 6
    s_add_u32 s45, s45, s3
    s_lshl_b32 s45, s45, 10
    s_lshl_b32 s37, s35, 7
    s_add_u32 s45, s45, s37
    s_mov_b32 s47, 131072
    s_waitcnt vmcnt(0)
    v_cmp_ne_u32 vcc, 1, v254
    s_cbranch_vccz L_ok_act
L_spin_act:
    buffer_load_dword v254, v255, s[4:7], 0 offen sc1
    s_sub_u32 s47, s47, 1
    s_cbranch_scc1 L_ok_act
    s_waitcnt vmcnt(0)
    v_cmp_ne_u32 vcc, 1, v254
    s_cbranch_vccnz L_spin_act
L_ok_act:
    buffer_load_dwordx4 v[16:19], v1, s[4:7], s38 offen offset:0 sc1
    buffer_load_dwordx4 v[20:23], v1, s[4:7], s39 offen offset:0 sc1
    buffer_load_dwordx4 v[24:27], v1, s[4:7], s40 offen offset:0 sc1
    buffer_load_dwordx4 v[28:31], v1, s[4:7], s41 offen offset:0 sc1
    ds_read_b64_tr_b16 v[192:193], v180 offset:0
    ds_read_b64_tr_b16 v[194:195], v180 offset:2048
    ds_read_b64_tr_b16 v[196:197], v181 offset:0
    ds_read_b64_tr_b16 v[198:199], v181 offset:2048
    ds_read_b64_tr_b16 v[200:201], v182 offset:0
    ds_read_b64_tr_b16 v[202:203], v182 offset:2048
    ds_read_b64_tr_b16 v[204:205], v183 offset:0
    ds_read_b64_tr_b16 v[206:207], v183 offset:2048
    buffer_load_dwordx4 v[32:35], v1, s[4:7], s38 offen offset:1024 sc1
    buffer_load_dwordx4 v[36:39], v1, s[4:7], s39 offen offset:1024 sc1
    buffer_load_dwordx4 v[40:43], v1, s[4:7], s40 offen offset:1024 sc1
    buffer_load_dwordx4 v[44:47], v1, s[4:7], s41 offen offset:1024 sc1
    buffer_load_dwordx4 v[48:51], v1, s[4:7], s38 offen offset:2048 sc1
    buffer_load_dwordx4 v[52:55], v1, s[4:7], s39 offen offset:2048 sc1
    buffer_load_dwordx4 v[56:59], v1, s[4:7], s40 offen offset:2048 sc1
    buffer_load_dwordx4 v[60:63], v1, s[4:7], s41 offen offset:2048 sc1
    buffer_load_dwordx4 v[64:67], v1, s[4:7], s38 offen offset:3072 sc1
    buffer_load_dwordx4 v[68:71], v1, s[4:7], s39 offen offset:3072 sc1
    buffer_load_dwordx4 v[72:75], v1, s[4:7], s40 offen offset:3072 sc1
    buffer_load_dwordx4 v[76:79], v1, s[4:7], s41 offen offset:3072 sc1
    s_waitcnt vmcnt(12) lgkmcnt(0)
    v_mfma_f32_16x16x32_bf16 v[80:83], v[192:195], v[16:19], 0
    ds_read_b64_tr_b16 v[208:209], v180 offset:4096
    v_mfma_f32_16x16x32_bf16 v[84:87], v[196:199], v[16:19], 0
    ds_read_b64_tr_b16 v[210:211], v180 offset:6144
    v_mfma_f32_16x16x32_bf16 v[88:91], v[200:203], v[16:19], 0
    ds_read_b64_tr_b16 v[212:213], v181 offset:4096
    v_mfma_f32_16x16x32_bf16 v[92:95], v[204:207], v[16:19], 0
    ds_read_b64_tr_b16 v[214:215], v181 offset:6144
    v_mfma_f32_16x16x32_bf16 v[96:99], v[192:195], v[20:23], 0
    ds_read_b64_tr_b16 v[216:217], v182 offset:4096
    v_mfma_f32_16x16x32_bf16 v[100:103], v[196:199], v[20:23], 0
    ds_read_b64_tr_b16 v[218:219], v182 offset:6144
    v_mfma_f32_16x16x32_bf16 v[104:107], v[200:203], v[20:23], 0
    ds_read_b64_tr_b16 v[220:221], v183 offset:4096
    v_mfma_f32_16x16x32_bf16 v[108:111], v[204:207], v[20:23], 0
    ds_read_b64_tr_b16 v[222:223], v183 offset:6144
    v_mfma_f32_16x16x32_bf16 v[112:115], v[192:195], v[24:27], 0
    s_add_u32 m0, s56, 0
    s_add_u32 s58, s55, 262144
    buffer_load_dwordx4 v176, s[8:11], s58 offen offset:0 lds
    v_mfma_f32_16x16x32_bf16 v[116:119], v[196:199], v[24:27], 0
    s_add_u32 s38, s38, 4096
    buffer_load_dwordx4 v[16:19], v1, s[4:7], s38 offen offset:0 sc1
    v_mfma_f32_16x16x32_bf16 v[120:123], v[200:203], v[24:27], 0
    buffer_load_dwordx4 v177, s[8:11], s58 offen offset:1024 lds
    v_mfma_f32_16x16x32_bf16 v[124:127], v[204:207], v[24:27], 0
    s_add_u32 s39, s39, 4096
    buffer_load_dwordx4 v[20:23], v1, s[4:7], s39 offen offset:0 sc1
    v_mfma_f32_16x16x32_bf16 v[128:131], v[192:195], v[28:31], 0
    buffer_load_dwordx4 v178, s[8:11], s58 offen offset:2048 lds
    v_mfma_f32_16x16x32_bf16 v[132:135], v[196:199], v[28:31], 0
    s_add_u32 s40, s40, 4096
    buffer_load_dwordx4 v[24:27], v1, s[4:7], s40 offen offset:0 sc1
    v_mfma_f32_16x16x32_bf16 v[136:139], v[200:203], v[28:31], 0
    buffer_load_dwordx4 v179, s[8:11], s58 offen offset:3072 lds
    v_mfma_f32_16x16x32_bf16 v[140:143], v[204:207], v[28:31], 0
    s_add_u32 s41, s41, 4096
    buffer_load_dwordx4 v[28:31], v1, s[4:7], s41 offen offset:0 sc1
    s_waitcnt vmcnt(16) lgkmcnt(0)
    v_mfma_f32_16x16x32_bf16 v[80:83], v[208:211], v[32:35], v[80:83]
    ds_read_b64_tr_b16 v[192:193], v180 offset:8192
    v_mfma_f32_16x16x32_bf16 v[84:87], v[212:215], v[32:35], v[84:87]
    ds_read_b64_tr_b16 v[194:195], v180 offset:10240
    v_mfma_f32_16x16x32_bf16 v[88:91], v[216:219], v[32:35], v[88:91]
    ds_read_b64_tr_b16 v[196:197], v181 offset:8192
    v_mfma_f32_16x16x32_bf16 v[92:95], v[220:223], v[32:35], v[92:95]
    ds_read_b64_tr_b16 v[198:199], v181 offset:10240
    v_mfma_f32_16x16x32_bf16 v[96:99], v[208:211], v[36:39], v[96:99]
    ds_read_b64_tr_b16 v[200:201], v182 offset:8192
    v_mfma_f32_16x16x32_bf16 v[100:103], v[212:215], v[36:39], v[100:103]
    ds_read_b64_tr_b16 v[202:203], v182 offset:10240
    v_mfma_f32_16x16x32_bf16 v[104:107], v[216:219], v[36:39], v[104:107]
    ds_read_b64_tr_b16 v[204:205], v183 offset:8192
    v_mfma_f32_16x16x32_bf16 v[108:111], v[220:223], v[36:39], v[108:111]
    ds_read_b64_tr_b16 v[206:207], v183 offset:10240
    v_mfma_f32_16x16x32_bf16 v[112:115], v[208:211], v[40:43], v[112:115]
    s_add_u32 m0, s56, 4096
    s_add_u32 s58, s55, 294912
    buffer_load_dwordx4 v176, s[8:11], s58 offen offset:0 lds
    v_mfma_f32_16x16x32_bf16 v[116:119], v[212:215], v[40:43], v[116:119]
    buffer_load_dwordx4 v[32:35], v1, s[4:7], s38 offen offset:1024 sc1
    v_mfma_f32_16x16x32_bf16 v[120:123], v[216:219], v[40:43], v[120:123]
    buffer_load_dwordx4 v177, s[8:11], s58 offen offset:1024 lds
    v_mfma_f32_16x16x32_bf16 v[124:127], v[220:223], v[40:43], v[124:127]
    buffer_load_dwordx4 v[36:39], v1, s[4:7], s39 offen offset:1024 sc1
    v_mfma_f32_16x16x32_bf16 v[128:131], v[208:211], v[44:47], v[128:131]
    buffer_load_dwordx4 v178, s[8:11], s58 offen offset:2048 lds
    v_mfma_f32_16x16x32_bf16 v[132:135], v[212:215], v[44:47], v[132:135]
    buffer_load_dwordx4 v[40:43], v1, s[4:7], s40 offen offset:1024 sc1
    v_mfma_f32_16x16x32_bf16 v[136:139], v[216:219], v[44:47], v[136:139]
    buffer_load_dwordx4 v179, s[8:11], s58 offen offset:3072 lds
    v_mfma_f32_16x16x32_bf16 v[140:143], v[220:223], v[44:47], v[140:143]
    buffer_load_dwordx4 v[44:47], v1, s[4:7], s41 offen offset:1024 sc1
    s_waitcnt vmcnt(20) lgkmcnt(0)
    v_mfma_f32_16x16x32_bf16 v[80:83], v[192:195], v[48:51], v[80:83]
    ds_read_b64_tr_b16 v[208:209], v180 offset:12288
    v_mfma_f32_16x16x32_bf16 v[84:87], v[196:199], v[48:51], v[84:87]
    ds_read_b64_tr_b16 v[210:211], v180 offset:14336
    v_mfma_f32_16x16x32_bf16 v[88:91], v[200:203], v[48:51], v[88:91]
    ds_read_b64_tr_b16 v[212:213], v181 offset:12288
    v_mfma_f32_16x16x32_bf16 v[92:95], v[204:207], v[48:51], v[92:95]
    ds_read_b64_tr_b16 v[214:215], v181 offset:14336
    v_mfma_f32_16x16x32_bf16 v[96:99], v[192:195], v[52:55], v[96:99]
    ds_read_b64_tr_b16 v[216:217], v182 offset:12288
    v_mfma_f32_16x16x32_bf16 v[100:103], v[196:199], v[52:55], v[100:103]
    ds_read_b64_tr_b16 v[218:219], v182 offset:14336
    v_mfma_f32_16x16x32_bf16 v[104:107], v[200:203], v[52:55], v[104:107]
    ds_read_b64_tr_b16 v[220:221], v183 offset:12288
    v_mfma_f32_16x16x32_bf16 v[108:111], v[204:207], v[52:55], v[108:111]
    ds_read_b64_tr_b16 v[222:223], v183 offset:14336
    v_mfma_f32_16x16x32_bf16 v[112:115], v[192:195], v[56:59], v[112:115]
    s_add_u32 m0, s56, 8192
    s_add_u32 s58, s55, 327680
    buffer_load_dwordx4 v176, s[8:11], s58 offen offset:0 lds
    v_mfma_f32_16x16x32_bf16 v[116:119], v[196:199], v[56:59], v[116:119]
    buffer_load_dwordx4 v[48:51], v1, s[4:7], s38 offen offset:2048 sc1
    v_mfma_f32_16x16x32_bf16 v[120:123], v[200:203], v[56:59], v[120:123]
    buffer_load_dwordx4 v177, s[8:11], s58 offen offset:1024 lds
    v_mfma_f32_16x16x32_bf16 v[124:127], v[204:207], v[56:59], v[124:127]
    buffer_load_dwordx4 v[52:55], v1, s[4:7], s39 offen offset:2048 sc1
    v_mfma_f32_16x16x32_bf16 v[128:131], v[192:195], v[60:63], v[128:131]
    buffer_load_dwordx4 v178, s[8:11], s58 offen offset:2048 lds
    v_mfma_f32_16x16x32_bf16 v[132:135], v[196:199], v[60:63], v[132:135]
    buffer_load_dwordx4 v[56:59], v1, s[4:7], s40 offen offset:2048 sc1
    v_mfma_f32_16x16x32_bf16 v[136:139], v[200:203], v[60:63], v[136:139]
    buffer_load_dwordx4 v179, s[8:11], s58 offen offset:3072 lds
    v_mfma_f32_16x16x32_bf16 v[140:143], v[204:207], v[60:63], v[140:143]
    buffer_load_dwordx4 v[60:63], v1, s[4:7], s41 offen offset:2048 sc1
    s_waitcnt vmcnt(24) lgkmcnt(0)
    v_mfma_f32_16x16x32_bf16 v[80:83], v[208:211], v[64:67], v[80:83]
    ds_read_b64_tr_b16 v[192:193], v248 offset:0
    v_mfma_f32_16x16x32_bf16 v[84:87], v[212:215], v[64:67], v[84:87]
    ds_read_b64_tr_b16 v[194:195], v248 offset:2048
    v_mfma_f32_16x16x32_bf16 v[88:91], v[216:219], v[64:67], v[88:91]
    ds_read_b64_tr_b16 v[196:197], v249 offset:0
    v_mfma_f32_16x16x32_bf16 v[92:95], v[220:223], v[64:67], v[92:95]
    ds_read_b64_tr_b16 v[198:199], v249 offset:2048
    v_mfma_f32_16x16x32_bf16 v[96:99], v[208:211], v[68:71], v[96:99]
    ds_read_b64_tr_b16 v[200:201], v250 offset:0
    v_mfma_f32_16x16x32_bf16 v[100:103], v[212:215], v[68:71], v[100:103]
    ds_read_b64_tr_b16 v[202:203], v250 offset:2048
    v_mfma_f32_16x16x32_bf16 v[104:107], v[216:219], v[68:71], v[104:107]
    ds_read_b64_tr_b16 v[204:205], v251 offset:0
    v_mfma_f32_16x16x32_bf16 v[108:111], v[220:223], v[68:71], v[108:111]
    ds_read_b64_tr_b16 v[206:207], v251 offset:2048
    v_mfma_f32_16x16x32_bf16 v[112:115], v[208:211], v[72:75], v[112:115]
    v_mfma_f32_16x16x32_bf16 v[116:119], v[212:215], v[72:75], v[116:119]
    buffer_load_dwordx4 v[64:67], v1, s[4:7], s38 offen offset:3072 sc1
    v_mfma_f32_16x16x32_bf16 v[120:123], v[216:219], v[72:75], v[120:123]
    v_mfma_f32_16x16x32_bf16 v[124:127], v[220:223], v[72:75], v[124:127]
    buffer_load_dwordx4 v[68:71], v1, s[4:7], s39 offen offset:3072 sc1
    v_mfma_f32_16x16x32_bf16 v[128:131], v[208:211], v[76:79], v[128:131]
    v_mfma_f32_16x16x32_bf16 v[132:135], v[212:215], v[76:79], v[132:135]
    buffer_load_dwordx4 v[72:75], v1, s[4:7], s40 offen offset:3072 sc1
    v_mfma_f32_16x16x32_bf16 v[136:139], v[216:219], v[76:79], v[136:139]
    v_mfma_f32_16x16x32_bf16 v[140:143], v[220:223], v[76:79], v[140:143]
    buffer_load_dwordx4 v[76:79], v1, s[4:7], s41 offen offset:3072 sc1
    s_waitcnt vmcnt(20) lgkmcnt(0)
    v_mfma_f32_16x16x32_bf16 v[80:83], v[192:195], v[16:19], v[80:83]
    ds_read_b64_tr_b16 v[208:209], v248 offset:4096
    v_mfma_f32_16x16x32_bf16 v[84:87], v[196:199], v[16:19], v[84:87]
    ds_read_b64_tr_b16 v[210:211], v248 offset:6144
    v_mfma_f32_16x16x32_bf16 v[88:91], v[200:203], v[16:19], v[88:91]
    ds_read_b64_tr_b16 v[212:213], v249 offset:4096
    v_mfma_f32_16x16x32_bf16 v[92:95], v[204:207], v[16:19], v[92:95]
    ds_read_b64_tr_b16 v[214:215], v249 offset:6144
    v_mfma_f32_16x16x32_bf16 v[96:99], v[192:195], v[20:23], v[96:99]
    ds_read_b64_tr_b16 v[216:217], v250 offset:4096
    v_mfma_f32_16x16x32_bf16 v[100:103], v[196:199], v[20:23], v[100:103]
    ds_read_b64_tr_b16 v[218:219], v250 offset:6144
    v_mfma_f32_16x16x32_bf16 v[104:107], v[200:203], v[20:23], v[104:107]
    ds_read_b64_tr_b16 v[220:221], v251 offset:4096
    v_mfma_f32_16x16x32_bf16 v[108:111], v[204:207], v[20:23], v[108:111]
    ds_read_b64_tr_b16 v[222:223], v251 offset:6144
    v_mfma_f32_16x16x32_bf16 v[112:115], v[192:195], v[24:27], v[112:115]
    v_mfma_f32_16x16x32_bf16 v[116:119], v[196:199], v[24:27], v[116:119]
    s_add_u32 s38, s38, 4096
    buffer_load_dwordx4 v[16:19], v1, s[4:7], s38 offen offset:0 sc1
    v_mfma_f32_16x16x32_bf16 v[120:123], v[200:203], v[24:27], v[120:123]
    v_mfma_f32_16x16x32_bf16 v[124:127], v[204:207], v[24:27], v[124:127]
    s_add_u32 s39, s39, 4096
    buffer_load_dwordx4 v[20:23], v1, s[4:7], s39 offen offset:0 sc1
    v_mfma_f32_16x16x32_bf16 v[128:131], v[192:195], v[28:31], v[128:131]
    v_mfma_f32_16x16x32_bf16 v[132:135], v[196:199], v[28:31], v[132:135]
    s_add_u32 s40, s40, 4096
    buffer_load_dwordx4 v[24:27], v1, s[4:7], s40 offen offset:0 sc1
    v_mfma_f32_16x16x32_bf16 v[136:139], v[200:203], v[28:31], v[136:139]
    v_mfma_f32_16x16x32_bf16 v[140:143], v[204:207], v[28:31], v[140:143]
    s_add_u32 s41, s41, 4096
    buffer_load_dwordx4 v[28:31], v1, s[4:7], s41 offen offset:0 sc1
    s_waitcnt vmcnt(16) lgkmcnt(0)
    v_mfma_f32_16x16x32_bf16 v[80:83], v[208:211], v[32:35], v[80:83]
    ds_read_b64_tr_b16 v[192:193], v248 offset:8192
    v_mfma_f32_16x16x32_bf16 v[84:87], v[212:215], v[32:35], v[84:87]
    ds_read_b64_tr_b16 v[194:195], v248 offset:10240
    v_mfma_f32_16x16x32_bf16 v[88:91], v[216:219], v[32:35], v[88:91]
    ds_read_b64_tr_b16 v[196:197], v249 offset:8192
    v_mfma_f32_16x16x32_bf16 v[92:95], v[220:223], v[32:35], v[92:95]
    ds_read_b64_tr_b16 v[198:199], v249 offset:10240
    v_mfma_f32_16x16x32_bf16 v[96:99], v[208:211], v[36:39], v[96:99]
    ds_read_b64_tr_b16 v[200:201], v250 offset:8192
    v_mfma_f32_16x16x32_bf16 v[100:103], v[212:215], v[36:39], v[100:103]
    ds_read_b64_tr_b16 v[202:203], v250 offset:10240
    v_mfma_f32_16x16x32_bf16 v[104:107], v[216:219], v[36:39], v[104:107]
    ds_read_b64_tr_b16 v[204:205], v251 offset:8192
    v_mfma_f32_16x16x32_bf16 v[108:111], v[220:223], v[36:39], v[108:111]
    ds_read_b64_tr_b16 v[206:207], v251 offset:10240
    v_mfma_f32_16x16x32_bf16 v[112:115], v[208:211], v[40:43], v[112:115]
    v_mfma_f32_16x16x32_bf16 v[116:119], v[212:215], v[40:43], v[116:119]
    buffer_load_dwordx4 v[32:35], v1, s[4:7], s38 offen offset:1024 sc1
    v_mfma_f32_16x16x32_bf16 v[120:123], v[216:219], v[40:43], v[120:123]
    v_mfma_f32_16x16x32_bf16 v[124:127], v[220:223], v[40:43], v[124:127]
    buffer_load_dwordx4 v[36:39], v1, s[4:7], s39 offen offset:1024 sc1
    v_mfma_f32_16x16x32_bf16 v[128:131], v[208:211], v[44:47], v[128:131]
    v_mfma_f32_16x16x32_bf16 v[132:135], v[212:215], v[44:47], v[132:135]
    buffer_load_dwordx4 v[40:43], v1, s[4:7], s40 offen offset:1024 sc1
    v_mfma_f32_16x16x32_bf16 v[136:139], v[216:219], v[44:47], v[136:139]
    v_mfma_f32_16x16x32_bf16 v[140:143], v[220:223], v[44:47], v[140:143]
    buffer_load_dwordx4 v[44:47], v1, s[4:7], s41 offen offset:1024 sc1
    s_waitcnt vmcnt(12) lgkmcnt(0)
    v_mfma_f32_16x16x32_bf16 v[80:83], v[192:195], v[48:51], v[80:83]
    ds_read_b64_tr_b16 v[208:209], v248 offset:12288
    v_mfma_f32_16x16x32_bf16 v[84:87], v[196:199], v[48:51], v[84:87]
    ds_read_b64_tr_b16 v[210:211], v248 offset:14336
    v_mfma_f32_16x16x32_bf16 v[88:91], v[200:203], v[48:51], v[88:91]
    ds_read_b64_tr_b16 v[212:213], v249 offset:12288
    v_mfma_f32_16x16x32_bf16 v[92:95], v[204:207], v[48:51], v[92:95]
    ds_read_b64_tr_b16 v[214:215], v249 offset:14336
    v_mfma_f32_16x16x32_bf16 v[96:99], v[192:195], v[52:55], v[96:99]
    ds_read_b64_tr_b16 v[216:217], v250 offset:12288
    v_mfma_f32_16x16x32_bf16 v[100:103], v[196:199], v[52:55], v[100:103]
    ds_read_b64_tr_b16 v[218:219], v250 offset:14336
    v_mfma_f32_16x16x32_bf16 v[104:107], v[200:203], v[52:55], v[104:107]
    ds_read_b64_tr_b16 v[220:221], v251 offset:12288
    v_mfma_f32_16x16x32_bf16 v[108:111], v[204:207], v[52:55], v[108:111]
    ds_read_b64_tr_b16 v[222:223], v251 offset:14336
    v_mfma_f32_16x16x32_bf16 v[112:115], v[192:195], v[56:59], v[112:115]
    v_mfma_f32_16x16x32_bf16 v[116:119], v[196:199], v[56:59], v[116:119]
    s_cmp_eq_u32 s3, 3
    s_cselect_b32 s38, 0x40000000, s38
    buffer_load_dwordx4 v[48:51], v1, s[4:7], s38 offen offset:2048 sc1
    v_mfma_f32_16x16x32_bf16 v[120:123], v[200:203], v[56:59], v[120:123]
    v_mfma_f32_16x16x32_bf16 v[124:127], v[204:207], v[56:59], v[124:127]
    s_cmp_eq_u32 s3, 3
    s_cselect_b32 s39, 0x40000000, s39
    buffer_load_dwordx4 v[52:55], v1, s[4:7], s39 offen offset:2048 sc1
    v_mfma_f32_16x16x32_bf16 v[128:131], v[192:195], v[60:63], v[128:131]
    v_mfma_f32_16x16x32_bf16 v[132:135], v[196:199], v[60:63], v[132:135]
    s_cmp_eq_u32 s3, 3
    s_cselect_b32 s40, 0x40000000, s40
    buffer_load_dwordx4 v[56:59], v1, s[4:7], s40 offen offset:2048 sc1
    v_mfma_f32_16x16x32_bf16 v[136:139], v[200:203], v[60:63], v[136:139]
    v_mfma_f32_16x16x32_bf16 v[140:143], v[204:207], v[60:63], v[140:143]
    s_cmp_eq_u32 s3, 3
    s_cselect_b32 s41, 0x40000000, s41
    buffer_load_dwordx4 v[60:63], v1, s[4:7], s41 offen offset:2048 sc1
    s_waitcnt vmcnt(12) lgkmcnt(0)
    v_mfma_f32_16x16x32_bf16 v[80:83], v[208:211], v[64:67], v[80:83]
    ds_read_b64_tr_b16 v[192:193], v180 offset:0
    v_mfma_f32_16x16x32_bf16 v[84:87], v[212:215], v[64:67], v[84:87]
    ds_read_b64_tr_b16 v[194:195], v180 offset:2048
    v_mfma_f32_16x16x32_bf16 v[88:91], v[216:219], v[64:67], v[88:91]
    ds_read_b64_tr_b16 v[196:197], v181 offset:0
    v_mfma_f32_16x16x32_bf16 v[92:95], v[220:223], v[64:67], v[92:95]
    ds_read_b64_tr_b16 v[198:199], v181 offset:2048
    v_mfma_f32_16x16x32_bf16 v[96:99], v[208:211], v[68:71], v[96:99]
    ds_read_b64_tr_b16 v[200:201], v182 offset:0
    v_mfma_f32_16x16x32_bf16 v[100:103], v[212:215], v[68:71], v[100:103]
    ds_read_b64_tr_b16 v[202:203], v182 offset:2048
    v_mfma_f32_16x16x32_bf16 v[104:107], v[216:219], v[68:71], v[104:107]
    ds_read_b64_tr_b16 v[204:205], v183 offset:0
    v_mfma_f32_16x16x32_bf16 v[108:111], v[220:223], v[68:71], v[108:111]
    ds_read_b64_tr_b16 v[206:207], v183 offset:2048
    v_mfma_f32_16x16x32_bf16 v[112:115], v[208:211], v[72:75], v[112:115]
    v_mfma_f32_16x16x32_bf16 v[116:119], v[212:215], v[72:75], v[116:119]
    v_mfma_f32_16x16x32_bf16 v[120:123], v[216:219], v[72:75], v[120:123]
    v_mfma_f32_16x16x32_bf16 v[124:127], v[220:223], v[72:75], v[124:127]
    v_mfma_f32_16x16x32_bf16 v[128:131], v[208:211], v[76:79], v[128:131]
    v_mfma_f32_16x16x32_bf16 v[132:135], v[212:215], v[76:79], v[132:135]
    v_mfma_f32_16x16x32_bf16 v[136:139], v[216:219], v[76:79], v[136:139]
    v_mfma_f32_16x16x32_bf16 v[140:143], v[220:223], v[76:79], v[140:143]
    s_waitcnt vmcnt(8) lgkmcnt(0)
    v_mfma_f32_16x16x32_bf16 v[80:83], v[192:195], v[16:19], v[80:83]
    ds_read_b64_tr_b16 v[208:209], v180 offset:4096
    v_mfma_f32_16x16x32_bf16 v[84:87], v[196:199], v[16:19], v[84:87]
    ds_read_b64_tr_b16 v[210:211], v180 offset:6144
    v_mfma_f32_16x16x32_bf16 v[88:91], v[200:203], v[16:19], v[88:91]
    ds_read_b64_tr_b16 v[212:213], v181 offset:4096
    v_mfma_f32_16x16x32_bf16 v[92:95], v[204:207], v[16:19], v[92:95]
    ds_read_b64_tr_b16 v[214:215], v181 offset:6144
    v_mfma_f32_16x16x32_bf16 v[96:99], v[192:195], v[20:23], v[96:99]
    ds_read_b64_tr_b16 v[216:217], v182 offset:4096
    v_mfma_f32_16x16x32_bf16 v[100:103], v[196:199], v[20:23], v[100:103]
    ds_read_b64_tr_b16 v[218:219], v182 offset:6144
    v_mfma_f32_16x16x32_bf16 v[104:107], v[200:203], v[20:23], v[104:107]
    ds_read_b64_tr_b16 v[220:221], v183 offset:4096
    v_mfma_f32_16x16x32_bf16 v[108:111], v[204:207], v[20:23], v[108:111]
    ds_read_b64_tr_b16 v[222:223], v183 offset:6144
    v_mfma_f32_16x16x32_bf16 v[112:115], v[192:195], v[24:27], v[112:115]
    v_mfma_f32_16x16x32_bf16 v[116:119], v[196:199], v[24:27], v[116:119]
    v_mfma_f32_16x16x32_bf16 v[120:123], v[200:203], v[24:27], v[120:123]
    v_mfma_f32_16x16x32_bf16 v[124:127], v[204:207], v[24:27], v[124:127]
    v_mfma_f32_16x16x32_bf16 v[128:131], v[192:195], v[28:31], v[128:131]
    v_mfma_f32_16x16x32_bf16 v[132:135], v[196:199], v[28:31], v[132:135]
    v_mfma_f32_16x16x32_bf16 v[136:139], v[200:203], v[28:31], v[136:139]
    v_mfma_f32_16x16x32_bf16 v[140:143], v[204:207], v[28:31], v[140:143]
    s_waitcnt vmcnt(4) lgkmcnt(0)
    v_mfma_f32_16x16x32_bf16 v[80:83], v[208:211], v[32:35], v[80:83]
    ds_read_b64_tr_b16 v[192:193], v180 offset:8192
    v_mfma_f32_16x16x32_bf16 v[84:87], v[212:215], v[32:35], v[84:87]
    ds_read_b64_tr_b16 v[194:195], v180 offset:10240
    v_mfma_f32_16x16x32_bf16 v[88:91], v[216:219], v[32:35], v[88:91]
    ds_read_b64_tr_b16 v[196:197], v181 offset:8192
    v_mfma_f32_16x16x32_bf16 v[92:95], v[220:223], v[32:35], v[92:95]
    ds_read_b64_tr_b16 v[198:199], v181 offset:10240
    v_mfma_f32_16x16x32_bf16 v[96:99], v[208:211], v[36:39], v[96:99]
    ds_read_b64_tr_b16 v[200:201], v182 offset:8192
    v_mfma_f32_16x16x32_bf16 v[100:103], v[212:215], v[36:39], v[100:103]
    ds_read_b64_tr_b16 v[202:203], v182 offset:10240
    v_mfma_f32_16x16x32_bf16 v[104:107], v[216:219], v[36:39], v[104:107]
    ds_read_b64_tr_b16 v[204:205], v183 offset:8192
    v_mfma_f32_16x16x32_bf16 v[108:111], v[220:223], v[36:39], v[108:111]
    ds_read_b64_tr_b16 v[206:207], v183 offset:10240
    v_mfma_f32_16x16x32_bf16 v[112:115], v[208:211], v[40:43], v[112:115]
    v_mfma_f32_16x16x32_bf16 v[116:119], v[212:215], v[40:43], v[116:119]
    v_mfma_f32_16x16x32_bf16 v[120:123], v[216:219], v[40:43], v[120:123]
    v_mfma_f32_16x16x32_bf16 v[124:127], v[220:223], v[40:43], v[124:127]
    v_mfma_f32_16x16x32_bf16 v[128:131], v[208:211], v[44:47], v[128:131]
    v_mfma_f32_16x16x32_bf16 v[132:135], v[212:215], v[44:47], v[132:135]
    v_mfma_f32_16x16x32_bf16 v[136:139], v[216:219], v[44:47], v[136:139]
    v_mfma_f32_16x16x32_bf16 v[140:143], v[220:223], v[44:47], v[140:143]
    s_waitcnt vmcnt(0) lgkmcnt(0)
    v_mfma_f32_16x16x32_bf16 v[80:83], v[192:195], v[48:51], v[80:83]
    v_mfma_f32_16x16x32_bf16 v[84:87], v[196:199], v[48:51], v[84:87]
    v_mfma_f32_16x16x32_bf16 v[88:91], v[200:203], v[48:51], v[88:91]
    v_mfma_f32_16x16x32_bf16 v[92:95], v[204:207], v[48:51], v[92:95]
    v_mfma_f32_16x16x32_bf16 v[96:99], v[192:195], v[52:55], v[96:99]
    v_mfma_f32_16x16x32_bf16 v[100:103], v[196:199], v[52:55], v[100:103]
    v_mfma_f32_16x16x32_bf16 v[104:107], v[200:203], v[52:55], v[104:107]
    v_mfma_f32_16x16x32_bf16 v[108:111], v[204:207], v[52:55], v[108:111]
    v_mfma_f32_16x16x32_bf16 v[112:115], v[192:195], v[56:59], v[112:115]
    v_mfma_f32_16x16x32_bf16 v[116:119], v[196:199], v[56:59], v[116:119]
    v_mfma_f32_16x16x32_bf16 v[120:123], v[200:203], v[56:59], v[120:123]
    v_mfma_f32_16x16x32_bf16 v[124:127], v[204:207], v[56:59], v[124:127]
    v_mfma_f32_16x16x32_bf16 v[128:131], v[192:195], v[60:63], v[128:131]
    v_mfma_f32_16x16x32_bf16 v[132:135], v[196:199], v[60:63], v[132:135]
    v_mfma_f32_16x16x32_bf16 v[136:139], v[200:203], v[60:63], v[136:139]
    v_mfma_f32_16x16x32_bf16 v[140:143], v[204:207], v[60:63], v[140:143]
    ds_write_b128 v185, v[96:99] offset:0
    ds_write_b128 v185, v[100:103] offset:1024
    ds_write_b128 v185, v[104:107] offset:2048
    ds_write_b128 v185, v[108:111] offset:3072
    ds_write_b128 v186, v[112:115] offset:0
    ds_write_b128 v186, v[116:119] offset:1024
    ds_write_b128 v186, v[120:123] offset:2048
    ds_write_b128 v186, v[124:127] offset:3072
    ds_write_b128 v187, v[128:131] offset:0
    ds_write_b128 v187, v[132:135] offset:1024
    ds_write_b128 v187, v[136:139] offset:2048
    ds_write_b128 v187, v[140:143] offset:3072
    v_lshlrev_b32 v16, 16, v240
    v_and_b32 v17, 0xffff0000, v240
    v_add_f32 v80, v80, v16
    v_add_f32 v81, v81, v17
    v_lshlrev_b32 v16, 16, v241
    v_and_b32 v17, 0xffff0000, v241
    v_add_f32 v82, v82, v16
    v_add_f32 v83, v83, v17
    v_lshlrev_b32 v16, 16, v242
    v_and_b32 v17, 0xffff0000, v242
    v_add_f32 v84, v84, v16
    v_add_f32 v85, v85, v17
    v_lshlrev_b32 v16, 16, v243
    v_and_b32 v17, 0xffff0000, v243
    v_add_f32 v86, v86, v16
    v_add_f32 v87, v87, v17
    v_lshlrev_b32 v16, 16, v244
    v_and_b32 v17, 0xffff0000, v244
    v_add_f32 v88, v88, v16
    v_add_f32 v89, v89, v17
    v_lshlrev_b32 v16, 16, v245
    v_and_b32 v17, 0xffff0000, v245
    v_add_f32 v90, v90, v16
    v_add_f32 v91, v91, v17
    v_lshlrev_b32 v16, 16, v246
    v_and_b32 v17, 0xffff0000, v246
    v_add_f32 v92, v92, v16
    v_add_f32 v93, v93, v17
    v_lshlrev_b32 v16, 16, v247
    v_and_b32 v17, 0xffff0000, v247
    v_add_f32 v94, v94, v16
    v_add_f32 v95, v95, v17
    ds_write_b128 v184, v[80:83] offset:0
    ds_write_b128 v184, v[84:87] offset:1024
    ds_write_b128 v184, v[88:91] offset:2048
    ds_write_b128 v184, v[92:95] offset:3072
    s_waitcnt lgkmcnt(0)
    s_barrier
    ds_read_b128 v[16:19], v190 offset:0
    ds_read_b128 v[20:23], v190 offset:256
    ds_read_b128 v[24:27], v190 offset:512
    ds_read_b128 v[28:31], v190 offset:768
    ds_read_b128 v[32:35], v190 offset:16384
    ds_read_b128 v[36:39], v190 offset:16640
    ds_read_b128 v[40:43], v190 offset:16896
    ds_read_b128 v[44:47], v190 offset:17152
    ds_read_b128 v[48:51], v190 offset:32768
    ds_read_b128 v[52:55], v190 offset:33024
    ds_read_b128 v[56:59], v190 offset:33280
    ds_read_b128 v[60:63], v190 offset:33536
    ds_read_b128 v[64:67], v190 offset:49152
    ds_read_b128 v[68:71], v190 offset:49408
    ds_read_b128 v[72:75], v190 offset:49664
    ds_read_b128 v[76:79], v190 offset:49920
    s_waitcnt lgkmcnt(11)
    v_pk_add_f32 v[16:17], v[16:17], v[32:33]
    v_pk_add_f32 v[18:19], v[18:19], v[34:35]
    s_waitcnt lgkmcnt(10)
    v_pk_add_f32 v[20:21], v[20:21], v[36:37]
    v_pk_add_f32 v[22:23], v[22:23], v[38:39]
    s_waitcnt lgkmcnt(9)
    v_pk_add_f32 v[24:25], v[24:25], v[40:41]
    v_pk_add_f32 v[26:27], v[26:27], v[42:43]
    s_waitcnt lgkmcnt(8)
    v_pk_add_f32 v[28:29], v[28:29], v[44:45]
    v_pk_add_f32 v[30:31], v[30:31], v[46:47]
    s_waitcnt lgkmcnt(3)
    v_pk_add_f32 v[48:49], v[48:49], v[64:65]
    v_pk_add_f32 v[50:51], v[50:51], v[66:67]
    s_waitcnt lgkmcnt(2)
    v_pk_add_f32 v[52:53], v[52:53], v[68:69]
    v_pk_add_f32 v[54:55], v[54:55], v[70:71]
    s_waitcnt lgkmcnt(1)
    v_pk_add_f32 v[56:57], v[56:57], v[72:73]
    v_pk_add_f32 v[58:59], v[58:59], v[74:75]
    s_waitcnt lgkmcnt(0)
    v_pk_add_f32 v[60:61], v[60:61], v[76:77]
    v_pk_add_f32 v[62:63], v[62:63], v[78:79]
    v_pk_add_f32 v[16:17], v[16:17], v[48:49]
    v_pk_add_f32 v[18:19], v[18:19], v[50:51]
    v_pk_add_f32 v[20:21], v[20:21], v[52:53]
    v_pk_add_f32 v[22:23], v[22:23], v[54:55]
    v_pk_add_f32 v[24:25], v[24:25], v[56:57]
    v_pk_add_f32 v[26:27], v[26:27], v[58:59]
    v_pk_add_f32 v[28:29], v[28:29], v[60:61]
    v_pk_add_f32 v[30:31], v[30:31], v[62:63]
    v_cvt_pk_bf16_f32 v224, v16, v17
    v_cvt_pk_bf16_f32 v225, v18, v19
    v_cvt_pk_bf16_f32 v226, v20, v21
    v_cvt_pk_bf16_f32 v227, v22, v23
    v_cvt_pk_bf16_f32 v228, v24, v25
    v_cvt_pk_bf16_f32 v229, v26, v27
    v_cvt_pk_bf16_f32 v230, v28, v29
    v_cvt_pk_bf16_f32 v231, v30, v31
    buffer_store_dwordx4 v[224:227], v188, s[24:27], s45 offen
    buffer_store_dwordx4 v[228:231], v188, s[24:27], s45 offen offset:16
L_sequential_preLN__compressed_kv_cla__glu_gated_swiglu__prompt_kernel_end:
    s_endpgm
L_att_P1:
    s_waitcnt lgkmcnt(15)
    v_mfma_f32_16x16x32_bf16 v[80:83], a[128:131], v[16:19], 0
    s_add_u32 m0, s68, 81920
    s_add_u32 s51, s68, 54272
    v_add_u32 v2, 16384, v1
    v_mov_b32 v192, 0
    s_waitcnt lgkmcnt(14)
    v_mfma_f32_16x16x32_bf16 v[80:83], a[132:135], v[20:23], v[80:83]
    buffer_load_dwordx4 v1, s[8:11], s51 offen offset:0 sc1 lds
    v_mov_b32 v193, 0
    v_mov_b32 v194, 0
    s_waitcnt lgkmcnt(13)
    v_mfma_f32_16x16x32_bf16 v[80:83], a[136:139], v[24:27], v[80:83]
    s_waitcnt lgkmcnt(12)
    v_mov_b32 v195, 0
    v_mov_b32 v196, 0
    v_mfma_f32_16x16x32_bf16 v[80:83], a[140:143], v[28:31], v[80:83]
    v_mov_b32 v197, 0
    v_mov_b32 v198, 0
    v_mfma_f32_16x16x32_bf16 v[84:87], a[128:131], v[32:35], 0
    v_mov_b32 v199, 0
    v_mov_b32 v200, 0
    v_mfma_f32_16x16x32_bf16 v[84:87], a[132:135], v[36:39], v[84:87]
    buffer_load_dwordx4 v1, s[8:11], s51 offen offset:1024 sc1 lds
    v_mov_b32 v201, 0
    v_mov_b32 v202, 0
    v_mfma_f32_16x16x32_bf16 v[84:87], a[136:139], v[40:43], v[84:87]
    v_mov_b32 v203, 0
    v_mov_b32 v204, 0
    v_mfma_f32_16x16x32_bf16 v[84:87], a[140:143], v[44:47], v[84:87]
    v_mov_b32 v205, 0
    v_mov_b32 v206, 0
    v_mfma_f32_16x16x32_bf16 v[88:91], a[128:131], v[48:51], 0
    v_mov_b32 v207, 0
    v_max3_f32 v208, v80, v81, v82
    v_mfma_f32_16x16x32_bf16 v[88:91], a[132:135], v[52:55], v[88:91]
    buffer_load_dwordx4 v1, s[8:11], s51 offen offset:2048 sc1 lds
    v_max_f32 v208, v208, v83
    v_mov_b32 v212, v208
    v_mfma_f32_16x16x32_bf16 v[88:91], a[136:139], v[56:59], v[88:91]
    s_nop 0
    v_permlane32_swap_b32 v208, v212
    v_max_f32 v208, v208, v212
    v_mfma_f32_16x16x32_bf16 v[88:91], a[140:143], v[60:63], v[88:91]
    v_mov_b32 v212, v208
    v_mov_b32 v3, v12
    v_mfma_f32_16x16x32_bf16 v[92:95], a[128:131], v[64:67], 0
    ds_read_b128 a[128:131], v2 offset:0
    v_permlane16_swap_b32 v208, v212
    v_mfma_f32_16x16x32_bf16 v[92:95], a[132:135], v[68:71], v[92:95]
    buffer_load_dwordx4 v1, s[8:11], s51 offen offset:3072 sc1 lds
    v_max_f32 v208, v208, v212
    v_xor_b32 v176, 0x80000000, v208
    v_mfma_f32_16x16x32_bf16 v[92:95], a[136:139], v[72:75], v[92:95]
    ds_read_b128 a[132:135], v2 offset:1024
    v_xor_b32 v177, 0x80000000, v208
    v_mfma_f32_16x16x32_bf16 v[92:95], a[140:143], v[76:79], v[92:95]
    ds_read_b128 a[136:139], v2 offset:2048
    v_xor_b32 v178, 0x80000000, v208
    s_waitcnt lgkmcnt(3)
    v_mfma_f32_16x16x32_bf16 v[96:99], a[144:147], v[16:19], 0
    s_add_u32 m0, s68, 49152
    s_add_u32 s51, s68, 113664
    v_xor_b32 v179, 0x80000000, v208
    v_max3_f32 v209, v84, v85, v86
    v_mfma_f32_16x16x32_bf16 v[96:99], a[148:151], v[20:23], v[96:99]
    buffer_load_dwordx4 v1, s[8:11], s51 offen offset:0 sc1 lds
    v_max_f32 v209, v209, v87
    v_mov_b32 v213, v209
    v_mfma_f32_16x16x32_bf16 v[96:99], a[152:155], v[24:27], v[96:99]
    ds_read_b128 a[140:143], v2 offset:3072
    v_permlane32_swap_b32 v209, v213
    v_mfma_f32_16x16x32_bf16 v[96:99], a[156:159], v[28:31], v[96:99]
    v_max_f32 v209, v209, v213
    v_mov_b32 v213, v209
    v_mfma_f32_16x16x32_bf16 v[100:103], a[144:147], v[32:35], 0
    s_nop 0
    v_permlane16_swap_b32 v209, v213
    v_max_f32 v209, v209, v213
    v_mfma_f32_16x16x32_bf16 v[100:103], a[148:151], v[36:39], v[100:103]
    buffer_load_dwordx4 v1, s[8:11], s51 offen offset:1024 sc1 lds
    v_xor_b32 v180, 0x80000000, v209
    v_xor_b32 v181, 0x80000000, v209
    v_mfma_f32_16x16x32_bf16 v[100:103], a[152:155], v[40:43], v[100:103]
    v_xor_b32 v182, 0x80000000, v209
    v_xor_b32 v183, 0x80000000, v209
    v_mfma_f32_16x16x32_bf16 v[100:103], a[156:159], v[44:47], v[100:103]
    v_cndmask_b32 v88, v88, v8, s[16:17]
    v_cndmask_b32 v89, v89, v8, s[18:19]
    v_mfma_f32_16x16x32_bf16 v[104:107], a[144:147], v[48:51], 0
    v_cndmask_b32 v90, v90, v8, s[20:21]
    v_cndmask_b32 v91, v91, v8, s[22:23]
    v_mfma_f32_16x16x32_bf16 v[104:107], a[148:151], v[52:55], v[104:107]
    buffer_load_dwordx4 v1, s[8:11], s51 offen offset:2048 sc1 lds
    v_max3_f32 v210, v88, v89, v90
    v_max_f32 v210, v210, v91
    v_mfma_f32_16x16x32_bf16 v[104:107], a[152:155], v[56:59], v[104:107]
    v_mov_b32 v214, v210
    v_max3_f32 v211, v92, v93, v94
    v_mfma_f32_16x16x32_bf16 v[104:107], a[156:159], v[60:63], v[104:107]
    v_permlane32_swap_b32 v210, v214
    v_max_f32 v210, v210, v214
    v_mfma_f32_16x16x32_bf16 v[108:111], a[144:147], v[64:67], 0
    ds_read_b128 a[144:147], v2 offset:4096
    v_mov_b32 v214, v210
    v_mfma_f32_16x16x32_bf16 v[108:111], a[148:151], v[68:71], v[108:111]
    buffer_load_dwordx4 v1, s[8:11], s51 offen offset:3072 sc1 lds
    v_permlane16_swap_b32 v210, v214
    v_max_f32 v210, v210, v214
    v_mfma_f32_16x16x32_bf16 v[108:111], a[152:155], v[72:75], v[108:111]
    ds_read_b128 a[148:151], v2 offset:5120
    v_xor_b32 v184, 0x80000000, v210
    v_mfma_f32_16x16x32_bf16 v[108:111], a[156:159], v[76:79], v[108:111]
    ds_read_b128 a[152:155], v2 offset:6144
    v_xor_b32 v185, 0x80000000, v210
    v_mfma_f32_16x16x32_bf16 v[112:115], a[160:163], v[16:19], v[176:179]
    s_add_u32 m0, s68, 98304
    s_add_u32 s51, s68, 92160
    v_xor_b32 v186, 0x80000000, v210
    v_xor_b32 v187, 0x80000000, v210
    v_mfma_f32_16x16x32_bf16 v[112:115], a[164:167], v[20:23], v[112:115]
    buffer_load_dwordx4 v1, s[8:11], s51 offen offset:0 sc1 lds
    v_max_f32 v211, v211, v95
    v_mov_b32 v215, v211
    v_mfma_f32_16x16x32_bf16 v[112:115], a[168:171], v[24:27], v[112:115]
    ds_read_b128 a[156:159], v2 offset:7168
    v_permlane32_swap_b32 v211, v215
    v_mfma_f32_16x16x32_bf16 v[112:115], a[172:175], v[28:31], v[112:115]
    v_max_f32 v211, v211, v215
    v_mov_b32 v215, v211
    v_mfma_f32_16x16x32_bf16 v[116:119], a[160:163], v[32:35], v[180:183]
    s_nop 0
    v_permlane16_swap_b32 v211, v215
    v_max_f32 v211, v211, v215
    v_mfma_f32_16x16x32_bf16 v[116:119], a[164:167], v[36:39], v[116:119]
    buffer_load_dwordx4 v1, s[8:11], s51 offen offset:1024 sc1 lds
    v_xor_b32 v188, 0x80000000, v211
    v_xor_b32 v189, 0x80000000, v211
    v_mfma_f32_16x16x32_bf16 v[116:119], a[168:171], v[40:43], v[116:119]
    v_xor_b32 v190, 0x80000000, v211
    v_xor_b32 v191, 0x80000000, v211
    v_mfma_f32_16x16x32_bf16 v[116:119], a[172:175], v[44:47], v[116:119]
    v_add_f32 v80, v80, v176
    v_add_f32 v81, v81, v176
    v_mfma_f32_16x16x32_bf16 v[120:123], a[160:163], v[48:51], v[184:187]
    v_add_f32 v82, v82, v176
    v_add_f32 v83, v83, v176
    v_mfma_f32_16x16x32_bf16 v[120:123], a[164:167], v[52:55], v[120:123]
    buffer_load_dwordx4 v1, s[8:11], s51 offen offset:2048 sc1 lds
    v_exp_f32 v80, v80
    v_mfma_f32_16x16x32_bf16 v[120:123], a[168:171], v[56:59], v[120:123]
    v_exp_f32 v81, v81
    v_mfma_f32_16x16x32_bf16 v[120:123], a[172:175], v[60:63], v[120:123]
    v_exp_f32 v82, v82
    v_mfma_f32_16x16x32_bf16 v[124:127], a[160:163], v[64:67], v[188:191]
    ds_read_b128 a[160:163], v2 offset:8192
    v_cvt_pk_bf16_f32 v144, v80, v81
    v_mfma_f32_16x16x32_bf16 v[124:127], a[164:167], v[68:71], v[124:127]
    buffer_load_dwordx4 v1, s[8:11], s51 offen offset:3072 sc1 lds
    v_exp_f32 v83, v83
    v_mfma_f32_16x16x32_bf16 v[124:127], a[168:171], v[72:75], v[124:127]
    ds_read_b128 a[164:167], v2 offset:9216
    v_add_f32 v84, v84, v180
    v_mfma_f32_16x16x32_bf16 v[124:127], a[172:175], v[76:79], v[124:127]
    s_waitcnt lgkmcnt(4)
    s_barrier
    v_cvt_pk_bf16_f32 v145, v82, v83
    v_add_f32 v85, v85, v180
    v_mfma_f32_16x16x32_bf16 v[128:131], a[176:179], v[16:19], v[176:179]
    s_add_u32 m0, s68, 0
    s_add_u32 s51, s68, 151552
    v_add_f32 v86, v86, v180
    v_add_f32 v87, v87, v180
    v_mfma_f32_16x16x32_bf16 v[128:131], a[180:183], v[20:23], v[128:131]
    buffer_load_dwordx4 v1, s[8:11], s51 offen offset:0 sc1 lds
    v_exp_f32 v84, v84
    v_mfma_f32_16x16x32_bf16 v[128:131], a[184:187], v[24:27], v[128:131]
    ds_read_b128 a[168:171], v2 offset:10240
    v_add_f32 v88, v88, v184
    v_mfma_f32_16x16x32_bf16 v[128:131], a[188:191], v[28:31], v[128:131]
    ds_read_b128 a[172:175], v2 offset:11264
    v_add_f32 v89, v89, v184
    v_mfma_f32_16x16x32_bf16 v[132:135], a[176:179], v[32:35], v[180:183]
    v_exp_f32 v85, v85
    v_mfma_f32_16x16x32_bf16 v[132:135], a[180:183], v[36:39], v[132:135]
    buffer_load_dwordx4 v1, s[8:11], s51 offen offset:1024 sc1 lds
    v_exp_f32 v86, v86
    v_mfma_f32_16x16x32_bf16 v[132:135], a[184:187], v[40:43], v[132:135]
    v_exp_f32 v87, v87
    v_mfma_f32_16x16x32_bf16 v[132:135], a[188:191], v[44:47], v[132:135]
    v_cvt_pk_bf16_f32 v152, v84, v85
    v_cvt_pk_bf16_f32 v153, v86, v87
    v_mfma_f32_16x16x32_bf16 v[136:139], a[176:179], v[48:51], v[184:187]
    v_add_f32 v90, v90, v184
    v_add_f32 v91, v91, v184
    v_mfma_f32_16x16x32_bf16 v[136:139], a[180:183], v[52:55], v[136:139]
    buffer_load_dwordx4 v1, s[8:11], s51 offen offset:2048 sc1 lds
    v_exp_f32 v88, v88
    v_mfma_f32_16x16x32_bf16 v[136:139], a[184:187], v[56:59], v[136:139]
    v_exp_f32 v89, v89
    v_mfma_f32_16x16x32_bf16 v[136:139], a[188:191], v[60:63], v[136:139]
    v_exp_f32 v90, v90
    v_mfma_f32_16x16x32_bf16 v[140:143], a[176:179], v[64:67], v[188:191]
    ds_read_b128 a[176:179], v2 offset:12288
    v_add_f32 v92, v92, v188
    v_mfma_f32_16x16x32_bf16 v[140:143], a[180:183], v[68:71], v[140:143]
    buffer_load_dwordx4 v1, s[8:11], s51 offen offset:3072 sc1 lds
    v_exp_f32 v91, v91
    v_mfma_f32_16x16x32_bf16 v[140:143], a[184:187], v[72:75], v[140:143]
    ds_read_b128 a[180:183], v2 offset:13312
    v_add_f32 v93, v93, v188
    v_mfma_f32_16x16x32_bf16 v[140:143], a[188:191], v[76:79], v[140:143]
    ds_read_b128 a[184:187], v2 offset:14336
    v_add_f32 v94, v94, v188
    ds_read_b128 a[188:191], v2 offset:15360
    v_add_f32 v95, v95, v188
    v_exp_f32 v92, v92
    v_exp_f32 v93, v93
    v_exp_f32 v94, v94
    v_exp_f32 v95, v95
    v_add_f32 v96, v96, v176
    v_add_f32 v97, v97, v176
    v_add_f32 v98, v98, v176
    v_add_f32 v99, v99, v176
    v_exp_f32 v96, v96
    v_exp_f32 v97, v97
    v_exp_f32 v98, v98
    v_exp_f32 v99, v99
    v_add_f32 v100, v100, v180
    v_add_f32 v101, v101, v180
    v_add_f32 v102, v102, v180
    v_add_f32 v103, v103, v180
    v_exp_f32 v100, v100
    v_exp_f32 v101, v101
    v_exp_f32 v102, v102
    v_exp_f32 v103, v103
    v_add_f32 v104, v104, v184
    v_add_f32 v105, v105, v184
    v_add_f32 v106, v106, v184
    v_add_f32 v107, v107, v184
    v_cndmask_b32 v104, v104, v8, s[24:25]
    v_exp_f32 v104, v104
    v_cndmask_b32 v105, v105, v8, s[26:27]
    v_exp_f32 v105, v105
    v_cndmask_b32 v106, v106, v8, s[28:29]
    v_exp_f32 v106, v106
    v_cndmask_b32 v107, v107, v8, s[30:31]
    v_exp_f32 v107, v107
    v_add_f32 v108, v108, v188
    v_add_f32 v109, v109, v188
    v_add_f32 v110, v110, v188
    v_add_f32 v111, v111, v188
    v_exp_f32 v108, v108
    v_exp_f32 v109, v109
    v_exp_f32 v110, v110
    v_exp_f32 v111, v111
    v_exp_f32 v112, v112
    v_exp_f32 v113, v113
    v_exp_f32 v114, v114
    v_exp_f32 v115, v115
    v_exp_f32 v116, v116
    v_exp_f32 v117, v117
    v_exp_f32 v118, v118
    v_exp_f32 v119, v119
    s_waitcnt vmcnt(16) lgkmcnt(0)
    s_barrier
    s_branch L_att_D2
L_att_T1:
    v_mfma_f32_16x16x32_bf16 v[80:83], a[128:131], v[16:19], v[176:179]
    v_cvt_pk_bf16_f32 v147, v98, v99
    v_cvt_pk_bf16_f32 v149, v114, v115
    v_exp_f32 v117, v117
    v_cndmask_b32 v140, v140, v8, s[40:41]
    v_mfma_f32_16x16x32_bf16 v[80:83], a[132:135], v[20:23], v[80:83]
    ds_read_b128 a[192:195], v3 offset:0
    v_exp_f32 v135, v135
    v_mfma_f32_16x16x32_bf16 v[80:83], a[136:139], v[24:27], v[80:83]
    s_add_u32 m0, s53, s68
    v_rcp_f32 v9, v200
    v_mfma_f32_16x16x32_bf16 v[80:83], a[140:143], v[28:31], v[80:83]
    ds_read_b128 a[196:199], v3 offset:1024
    v_cvt_pk_bf16_f32 v155, v102, v103
    v_exp_f32 v116, v116
    v_exp_f32 v130, v130
    v_mfma_f32_16x16x32_bf16 v[84:87], a[128:131], v[32:35], v[180:183]
    v_cndmask_b32 v125, v125, v8, s[34:35]
    v_cndmask_b32 v127, v127, v8, s[38:39]
    v_exp_f32 v128, v128
    v_accvgpr_read_b32 v217, a73
    v_accvgpr_read_b32 v222, a78
    v_mfma_f32_16x16x32_bf16 v[84:87], a[132:135], v[36:39], v[84:87]
    ds_read_b128 a[200:203], v3 offset:2048
    v_cndmask_b32 v142, v142, v8, s[44:45]
    v_mfma_f32_16x16x32_bf16 v[84:87], a[136:139], v[40:43], v[84:87]
    v_cndmask_b32 v124, v124, v8, s[32:33]
    v_accvgpr_read_b32 v214, a70
    v_mfma_f32_16x16x32_bf16 v[84:87], a[140:143], v[44:47], v[84:87]
    ds_read_b128 a[204:207], v3 offset:3072
    v_cvt_pk_bf16_f32 v146, v96, v97
    v_exp_f32 v118, v118
    v_exp_f32 v129, v129
    v_cndmask_b32 v141, v141, v8, s[42:43]
    v_accvgpr_read_b32 v211, a67
    v_accvgpr_read_b32 v220, a76
    v_mfma_f32_16x16x32_bf16 v[96:99], a[144:147], v[16:19], v[176:179]
    s_xor_b32 s55, s53, 0x8000
    v_cvt_pk_bf16_f32 v156, v116, v117
    v_exp_f32 v134, v134
    v_exp_f32 v140, v140
    v_mfma_f32_16x16x32_bf16 v[96:99], a[148:151], v[20:23], v[96:99]
    ds_read_b128 a[208:211], v3 offset:4096
    v_cvt_pk_bf16_f32 v154, v100, v101
    v_exp_f32 v127, v127
    v_cndmask_b32 v143, v143, v8, s[46:47]
    v_accvgpr_read_b32 v215, a71
    v_mfma_f32_16x16x32_bf16 v[96:99], a[152:155], v[24:27], v[96:99]
    v_exp_f32 v133, v133
    v_accvgpr_read_b32 v208, a64
    v_accvgpr_read_b32 v209, a65
    v_mfma_f32_16x16x32_bf16 v[96:99], a[156:159], v[28:31], v[96:99]
    ds_read_b128 a[212:215], v3 offset:5120
    v_exp_f32 v131, v131
    v_mfma_f32_16x16x32_bf16 v[100:103], a[144:147], v[32:35], v[180:183]
    buffer_load_dwordx4 v11, s[8:11], s52 offen offset:0 sc1 lds
    v_cvt_pk_bf16_f32 v171, v110, v111
    v_exp_f32 v119, v119
    v_accvgpr_read_b32 v210, a66
    v_mfma_f32_16x16x32_bf16 v[100:103], a[148:151], v[36:39], v[100:103]
    ds_read_b128 a[216:219], v3 offset:6144
    v_exp_f32 v132, v132
    v_mfma_f32_16x16x32_bf16 v[100:103], a[152:155], v[40:43], v[100:103]
    v_cvt_pk_bf16_f32 v148, v112, v113
    v_accvgpr_read_b32 v219, a75
    v_mfma_f32_16x16x32_bf16 v[100:103], a[156:159], v[44:47], v[100:103]
    ds_read_b128 a[220:223], v3 offset:7168
    v_exp_f32 v141, v141
    v_accvgpr_read_b32 v212, a68
    v_mfma_f32_16x16x32_bf16 v[112:115], a[160:163], v[16:19], v[176:179]
    v_exp_f32 v125, v125
    v_cndmask_b32 v126, v126, v8, s[36:37]
    v_mul_f32 v211, v211, v9
    v_mfma_f32_16x16x32_bf16 v[112:115], a[164:167], v[20:23], v[112:115]
    ds_read_b128 a[224:227], v3 offset:8192
    v_mul_f32 v209, v209, v9
    v_accvgpr_read_b32 v213, a69
    v_mfma_f32_16x16x32_bf16 v[112:115], a[168:171], v[24:27], v[112:115]
    buffer_load_dwordx4 v11, s[8:11], s52 offen offset:1024 sc1 lds
    v_cvt_pk_bf16_f32 v157, v118, v119
    v_exp_f32 v124, v124
    v_mul_f32 v220, v220, v9
    v_mfma_f32_16x16x32_bf16 v[112:115], a[172:175], v[28:31], v[112:115]
    ds_read_b128 a[228:231], v3 offset:9216
    v_cvt_pk_bf16_f32 v150, v128, v129
    v_mul_f32 v219, v219, v9
    v_mfma_f32_16x16x32_bf16 v[116:119], a[160:163], v[32:35], v[180:183]
    v_cvt_pk_bf16_f32 v151, v130, v131
    v_exp_f32 v142, v142
    v_mfma_f32_16x16x32_bf16 v[116:119], a[164:167], v[36:39], v[116:119]
    ds_read_b128 a[232:235], v3 offset:10240
    v_cvt_pk_bf16_f32 v158, v132, v133
    v_cndmask_b32 v81, v81, v8, s[18:19]
    v_accvgpr_read_b32 v218, a74
    v_mfma_f32_16x16x32_bf16 v[116:119], a[168:171], v[40:43], v[116:119]
    v_exp_f32 v81, v81
    v_exp_f32 v85, v85
    v_mfma_f32_16x16x32_bf16 v[116:119], a[172:175], v[44:47], v[116:119]
    ds_read_b128 a[236:239], v3 offset:11264
    v_cvt_pk_bf16_f32 v174, v140, v141
    v_add_u32 v2, s54, v1
    v_mul_f32 v214, v214, v9
    v_mul_f32 v217, v217, v9
    v_mfma_f32_16x16x32_bf16 v[128:131], a[176:179], v[16:19], v[176:179]
    buffer_load_dwordx4 v11, s[8:11], s52 offen offset:2048 sc1 lds
    v_accvgpr_read_b32 v223, a79
    v_mfma_f32_16x16x32_bf16 v[128:131], a[180:183], v[20:23], v[128:131]
    ds_read_b128 a[240:243], v3 offset:12288
    v_mul_f32 v210, v210, v9
    v_mfma_f32_16x16x32_bf16 v[128:131], a[184:187], v[24:27], v[128:131]
    v_exp_f32 v126, v126
    v_mfma_f32_16x16x32_bf16 v[128:131], a[188:191], v[28:31], v[128:131]
    ds_read_b128 a[244:247], v3 offset:13312
    v_cvt_pk_bf16_f32 v170, v108, v109
    v_cvt_pk_bf16_f32 v159, v134, v135
    v_mul_f32 v223, v223, v9
    v_mfma_f32_16x16x32_bf16 v[132:135], a[176:179], v[32:35], v[180:183]
    v_exp_f32 v143, v143
    v_mul_f32 v213, v213, v9
    v_mul_f32 v215, v215, v9
    v_accvgpr_read_b32 v221, a77
    v_mul_f32 v221, v221, v9
    v_mfma_f32_16x16x32_bf16 v[132:135], a[180:183], v[36:39], v[132:135]
    ds_read_b128 a[248:251], v3 offset:14336
    v_cvt_pk_bf16_f32 v172, v124, v125
    v_mfma_f32_16x16x32_bf16 v[132:135], a[184:187], v[40:43], v[132:135]
    ds_read_b128 a[252:255], v3 offset:15360
    v_cvt_pk_bf16_f32 v169, v94, v95
    v_exp_f32 v102, v102
    v_accvgpr_read_b32 v216, a72
    v_mul_f32 v216, v216, v9
    v_mfma_f32_16x16x32_bf16 v[132:135], a[188:191], v[44:47], v[132:135]
    v_cvt_pk_bf16_f32 v173, v126, v127
    v_cvt_pk_bf16_f32 v227, v214, v215
    v_add_u32 v3, s53, v12
    v_mfma_f32_16x16x32_bf16 v[192:195], v[4:7], v[144:147], v[192:195]
    ds_read_b64_tr_b16 v[240:241], v243 offset:0
    v_cvt_pk_bf16_f32 v175, v142, v143
    v_mul_f32 v208, v208, v9
    v_mfma_f32_16x16x32_bf16 v[192:195], v[4:7], v[148:151], v[192:195]
    buffer_load_dwordx4 v11, s[8:11], s52 offen offset:3072 sc1 lds
    v_cvt_pk_bf16_f32 v168, v92, v93
    v_cndmask_b32 v114, v114, v8, s[36:37]
    v_mul_f32 v222, v222, v9
    v_mfma_f32_16x16x32_bf16 v[196:199], v[4:7], v[152:155], v[196:199]
    ds_read_b64_tr_b16 v[242:243], v243 offset:3072
    v_cvt_pk_bf16_f32 v224, v208, v209
    v_cvt_pk_bf16_f32 v225, v210, v211
    v_mfma_f32_16x16x32_bf16 v[196:199], v[4:7], v[156:159], v[196:199]
    ds_read_b128 a[128:131], v2 offset:0
    v_cndmask_b32 v80, v80, v8, s[16:17]
    v_mfma_f32_16x16x32_bf16 v[204:207], v[4:7], v[168:171], v[204:207]
    s_add_u32 m0, s55, s56
    v_exp_f32 v87, v87
    v_mfma_f32_16x16x32_bf16 v[204:207], v[4:7], v[172:175], v[204:207]
    ds_read_b64_tr_b16 v[244:245], v247 offset:0
    v_cvt_pk_bf16_f32 v230, v220, v221
    s_waitcnt lgkmcnt(5)
    v_mfma_f32_16x16x32_bf16 a[0:3], a[192:195], v[144:147], a[0:3]
    buffer_load_dwordx4 v1, s[8:11], s52 offen offset:0 sc1 lds
    v_mul_f32 v218, v218, v9
    v_mfma_f32_16x16x32_bf16 a[0:3], a[196:199], v[148:151], a[0:3]
    ds_read_b64_tr_b16 v[246:247], v247 offset:3072
    v_cvt_pk_bf16_f32 v231, v222, v223
    v_mfma_f32_16x16x32_bf16 a[32:35], a[192:195], v[152:155], a[32:35]
    s_mov_b32 s53, s54
    v_cndmask_b32 v96, v96, v8, s[24:25]
    v_cvt_pk_bf16_f32 v228, v216, v217
    v_cvt_pk_bf16_f32 v229, v218, v219
    v_accvgpr_read_b32 v220, a92
    v_mfma_f32_16x16x32_bf16 a[32:35], a[196:199], v[156:159], a[32:35]
    ds_read_b128 a[132:135], v2 offset:1024
    v_mul_f32 v212, v212, v9
    v_accvgpr_read_b32 v217, a89
    v_mfma_f32_16x16x32_bf16 a[96:99], a[192:195], v[168:171], a[96:99]
    v_cndmask_b32 v82, v82, v8, s[20:21]
    v_cvt_pk_bf16_f32 v226, v212, v213
    v_accvgpr_read_b32 v209, a81
    v_mfma_f32_16x16x32_bf16 a[96:99], a[196:199], v[172:175], a[96:99]
    ds_read_b64_tr_b16 v[248:249], v251 offset:0
    v_exp_f32 v103, v103
    v_mfma_f32_16x16x32_bf16 a[4:7], a[200:203], v[144:147], a[4:7]
    v_cndmask_b32 v115, v115, v8, s[38:39]
    v_accvgpr_read_b32 v221, a93
    v_mfma_f32_16x16x32_bf16 a[4:7], a[204:207], v[148:151], a[4:7]
    v_exp_f32 v80, v80
    v_mfma_f32_16x16x32_bf16 a[36:39], a[200:203], v[152:155], a[36:39]
    ds_read_b64_tr_b16 v[250:251], v251 offset:3072
    v_exp_f32 v96, v96
    v_accvgpr_read_b32 v212, a84
    v_mfma_f32_16x16x32_bf16 a[36:39], a[204:207], v[156:159], a[36:39]
    v_cndmask_b32 v98, v98, v8, s[28:29]
    v_accvgpr_read_b32 v213, a85
    v_mfma_f32_16x16x32_bf16 a[100:103], a[200:203], v[168:171], a[100:103]
    ds_read_b128 a[136:139], v2 offset:2048
    v_accvgpr_read_b32 v208, a80
    v_mfma_f32_16x16x32_bf16 a[100:103], a[204:207], v[172:175], a[100:103]
    buffer_load_dwordx4 v1, s[8:11], s52 offen offset:1024 sc1 lds
    v_mfma_f32_16x16x32_bf16 a[8:11], a[208:211], v[144:147], a[8:11]
    ds_read_b128 a[140:143], v2 offset:3072
    v_accvgpr_read_b32 v222, a94
    v_mfma_f32_16x16x32_bf16 a[8:11], a[212:215], v[148:151], a[8:11]
    v_mul_f32 v222, v222, v9
    v_accvgpr_read_b32 v223, a95
    v_mfma_f32_16x16x32_bf16 a[40:43], a[208:211], v[152:155], a[40:43]
    ds_read_b128 a[144:147], v2 offset:4096
    v_accvgpr_read_b32 v210, a82
    v_mfma_f32_16x16x32_bf16 a[40:43], a[212:215], v[156:159], a[40:43]
    v_exp_f32 v82, v82
    v_cndmask_b32 v97, v97, v8, s[26:27]
    v_mfma_f32_16x16x32_bf16 a[104:107], a[208:211], v[168:171], a[104:107]
    ds_read_b128 a[148:151], v2 offset:5120
    v_cndmask_b32 v99, v99, v8, s[30:31]
    v_mfma_f32_16x16x32_bf16 a[104:107], a[212:215], v[172:175], a[104:107]
    s_waitcnt lgkmcnt(4)
    buffer_store_dwordx4 v[240:243], v1, s[4:7], s48 offen offset:0 sc1
    v_cndmask_b32 v83, v83, v8, s[22:23]
    v_exp_f32 v115, v115
    v_mfma_f32_16x16x32_bf16 a[12:15], a[216:219], v[144:147], a[12:15]
    v_exp_f32 v83, v83
    v_mfma_f32_16x16x32_bf16 a[12:15], a[220:223], v[148:151], a[12:15]
    v_accvgpr_read_b32 v216, a88
    v_mul_f32 v223, v223, v9
    v_mfma_f32_16x16x32_bf16 a[44:47], a[216:219], v[152:155], a[44:47]
    v_mul_f32 v209, v209, v9
    v_mul_f32 v221, v221, v9
    v_mfma_f32_16x16x32_bf16 a[44:47], a[220:223], v[156:159], a[44:47]
    ds_read_b128 a[152:155], v2 offset:6144
    v_cndmask_b32 v112, v112, v8, s[32:33]
    v_cvt_pk_bf16_f32 v239, v222, v223
    v_mfma_f32_16x16x32_bf16 a[108:111], a[216:219], v[168:171], a[108:111]
    global_load_dword v255, v14, s[14:15]
    v_mfma_f32_16x16x32_bf16 a[108:111], a[220:223], v[172:175], a[108:111]
    ds_read_b128 a[156:159], v2 offset:7168
    v_exp_f32 v98, v98
    v_mul_f32 v216, v216, v9
    v_mfma_f32_16x16x32_bf16 a[16:19], a[224:227], v[144:147], a[16:19]
    buffer_store_dwordx4 v[244:247], v1, s[4:7], s48 offen offset:1024 sc1
    v_mfma_f32_16x16x32_bf16 a[16:19], a[228:231], v[148:151], a[16:19]
    ds_read_b128 a[160:163], v2 offset:8192
    v_exp_f32 v101, v101
    v_mfma_f32_16x16x32_bf16 a[48:51], a[224:227], v[152:155], a[48:51]
    v_exp_f32 v99, v99
    v_mul_f32 v210, v210, v9
    v_mul_f32 v212, v212, v9
    v_mfma_f32_16x16x32_bf16 a[48:51], a[228:231], v[156:159], a[48:51]
    v_exp_f32 v100, v100
    v_exp_f32 v114, v114
    v_mfma_f32_16x16x32_bf16 a[112:115], a[224:227], v[168:171], a[112:115]
    buffer_store_dwordx4 v[248:251], v1, s[4:7], s48 offen offset:2048 sc1
    v_accvgpr_read_b32 v218, a90
    v_mfma_f32_16x16x32_bf16 a[112:115], a[228:231], v[172:175], a[112:115]
    ds_read_b128 a[164:167], v2 offset:9216
    v_mul_f32 v218, v218, v9
    v_accvgpr_read_b32 v219, a91
    v_mfma_f32_16x16x32_bf16 a[20:23], a[232:235], v[144:147], a[20:23]
    v_exp_f32 v84, v84
    v_cndmask_b32 v113, v113, v8, s[34:35]
    v_exp_f32 v113, v113
    v_mfma_f32_16x16x32_bf16 a[20:23], a[236:239], v[148:151], a[20:23]
    ds_read_b128 a[168:171], v2 offset:10240
    v_mul_f32 v213, v213, v9
    v_mfma_f32_16x16x32_bf16 a[52:55], a[232:235], v[152:155], a[52:55]
    v_exp_f32 v86, v86
    v_mfma_f32_16x16x32_bf16 a[52:55], a[236:239], v[156:159], a[52:55]
    ds_read_b128 a[172:175], v2 offset:11264
    v_exp_f32 v97, v97
    v_mul_f32 v208, v208, v9
    v_mfma_f32_16x16x32_bf16 a[116:119], a[232:235], v[168:171], a[116:119]
    global_load_dword v246, v15, s[12:13]
    v_mul_f32 v219, v219, v9
    v_mfma_f32_16x16x32_bf16 a[116:119], a[236:239], v[172:175], a[116:119]
    v_accvgpr_read_b32 v211, a83
    v_accvgpr_read_b32 v215, a87
    v_mfma_f32_16x16x32_bf16 a[24:27], a[240:243], v[144:147], a[24:27]
    ds_read_b128 a[176:179], v2 offset:12288
    v_accvgpr_read_b32 v214, a86
    v_mfma_f32_16x16x32_bf16 a[24:27], a[244:247], v[148:151], a[24:27]
    v_mul_f32 v214, v214, v9
    v_mul_f32 v220, v220, v9
    v_mfma_f32_16x16x32_bf16 a[56:59], a[240:243], v[152:155], a[56:59]
    ds_read_b128 a[180:183], v2 offset:13312
    v_mul_f32 v211, v211, v9
    v_cvt_pk_bf16_f32 v237, v218, v219
    v_mfma_f32_16x16x32_bf16 a[56:59], a[244:247], v[156:159], a[56:59]
    buffer_load_dwordx4 v1, s[8:11], s52 offen offset:2048 sc1 lds
    v_cvt_pk_bf16_f32 v234, v212, v213
    v_mfma_f32_16x16x32_bf16 a[120:123], a[240:243], v[168:171], a[120:123]
    ds_read_b128 a[184:187], v2 offset:14336
    v_mul_f32 v217, v217, v9
    v_mfma_f32_16x16x32_bf16 a[120:123], a[244:247], v[172:175], a[120:123]
    v_exp_f32 v112, v112
    v_mfma_f32_16x16x32_bf16 a[28:31], a[248:251], v[144:147], a[28:31]
    v_cvt_pk_bf16_f32 v232, v208, v209
    v_cvt_pk_bf16_f32 v238, v220, v221
    v_mfma_f32_16x16x32_bf16 a[28:31], a[252:255], v[148:151], a[28:31]
    ds_read_b128 a[188:191], v2 offset:15360
    v_cvt_pk_bf16_f32 v233, v210, v211
    v_mfma_f32_16x16x32_bf16 a[60:63], a[248:251], v[152:155], a[60:63]
    buffer_load_dwordx4 v1, s[8:11], s52 offen offset:3072 sc1 lds
    v_mfma_f32_16x16x32_bf16 a[60:63], a[252:255], v[156:159], a[60:63]
    s_mov_b32 s54, s55
    v_mul_f32 v215, v215, v9
    v_cvt_pk_bf16_f32 v235, v214, v215
    v_mfma_f32_16x16x32_bf16 a[124:127], a[248:251], v[168:171], a[124:127]
    s_add_u32 s52, s52, 37888
    v_cvt_pk_bf16_f32 v144, v80, v81
    v_cvt_pk_bf16_f32 v236, v216, v217
    v_mfma_f32_16x16x32_bf16 a[124:127], a[252:255], v[172:175], a[124:127]
    v_cvt_pk_bf16_f32 v145, v82, v83
    s_waitcnt vmcnt(13) lgkmcnt(0)
    s_barrier
    s_mul_i32 s51, s62, 136192
    s_add_u32 s51, s51, s57
    buffer_store_dwordx4 v[224:227], v1, s[4:7], s51 offen offset:0 sc1
    v_mfma_f32_16x16x32_bf16 v[240:243], v[224:227], v[4:7], 0
    buffer_store_dwordx4 v[228:231], v1, s[4:7], s51 offen offset:1024 sc1
    v_mfma_f32_16x16x32_bf16 v[240:243], v[228:231], v[4:7], v[240:243]
    buffer_store_dwordx4 v[232:235], v1, s[4:7], s51 offen offset:2048 sc1
    v_mfma_f32_16x16x32_bf16 v[240:243], v[232:235], v[4:7], v[240:243]
    buffer_store_dwordx4 v[236:239], v1, s[4:7], s51 offen offset:3072 sc1
    v_mfma_f32_16x16x32_bf16 v[240:243], v[236:239], v[4:7], v[240:243]
    v_cmp_ngt_f32 vcc, 0x71800000, v200
    s_or_b32 s59, s59, vcc_lo
    s_or_b32 s59, s59, vcc_hi
    v_rcp_f32 v10, v204
    v_cmp_ngt_f32 vcc, 0x71800000, v204
    s_or_b32 s59, s59, vcc_lo
    s_or_b32 s59, s59, vcc_hi
    s_mul_i32 s51, s63, 136192
    s_add_u32 s51, s51, s57
    v_accvgpr_read_b32 v208, a96
    v_accvgpr_read_b32 v209, a97
    v_accvgpr_read_b32 v210, a98
    v_accvgpr_read_b32 v211, a99
    v_accvgpr_read_b32 v212, a100
    v_accvgpr_read_b32 v213, a101
    v_accvgpr_read_b32 v214, a102
    v_accvgpr_read_b32 v215, a103
    v_pk_mul_f32 v[208:209], v[208:209], v[10:11] op_sel:[0,0] op_sel_hi:[1,0]
    v_pk_mul_f32 v[210:211], v[210:211], v[10:11] op_sel:[0,0] op_sel_hi:[1,0]
    v_pk_mul_f32 v[212:213], v[212:213], v[10:11] op_sel:[0,0] op_sel_hi:[1,0]
    v_pk_mul_f32 v[214:215], v[214:215], v[10:11] op_sel:[0,0] op_sel_hi:[1,0]
    v_cvt_pk_bf16_f32 v224, v208, v209
    v_cvt_pk_bf16_f32 v225, v210, v211
    v_cvt_pk_bf16_f32 v226, v212, v213
    v_cvt_pk_bf16_f32 v227, v214, v215
    buffer_store_dwordx4 v[224:227], v1, s[4:7], s51 offen offset:0 sc1
    s_nop 0
    v_mfma_f32_16x16x32_bf16 v[240:243], v[224:227], v[4:7], v[240:243]
    v_accvgpr_read_b32 v216, a104
    v_accvgpr_read_b32 v217, a105
    v_accvgpr_read_b32 v218, a106
    v_accvgpr_read_b32 v219, a107
    v_accvgpr_read_b32 v220, a108
    v_accvgpr_read_b32 v221, a109
    v_accvgpr_read_b32 v222, a110
    v_accvgpr_read_b32 v223, a111
    v_pk_mul_f32 v[216:217], v[216:217], v[10:11] op_sel:[0,0] op_sel_hi:[1,0]
    v_pk_mul_f32 v[218:219], v[218:219], v[10:11] op_sel:[0,0] op_sel_hi:[1,0]
    v_pk_mul_f32 v[220:221], v[220:221], v[10:11] op_sel:[0,0] op_sel_hi:[1,0]
    v_pk_mul_f32 v[222:223], v[222:223], v[10:11] op_sel:[0,0] op_sel_hi:[1,0]
    v_cvt_pk_bf16_f32 v228, v216, v217
    v_cvt_pk_bf16_f32 v229, v218, v219
    v_cvt_pk_bf16_f32 v230, v220, v221
    v_cvt_pk_bf16_f32 v231, v222, v223
    buffer_store_dwordx4 v[228:231], v1, s[4:7], s51 offen offset:1024 sc1
    s_nop 0
    v_mfma_f32_16x16x32_bf16 v[240:243], v[228:231], v[4:7], v[240:243]
    v_accvgpr_read_b32 v208, a112
    v_accvgpr_read_b32 v209, a113
    v_accvgpr_read_b32 v210, a114
    v_accvgpr_read_b32 v211, a115
    v_accvgpr_read_b32 v212, a116
    v_accvgpr_read_b32 v213, a117
    v_accvgpr_read_b32 v214, a118
    v_accvgpr_read_b32 v215, a119
    v_pk_mul_f32 v[208:209], v[208:209], v[10:11] op_sel:[0,0] op_sel_hi:[1,0]
    v_pk_mul_f32 v[210:211], v[210:211], v[10:11] op_sel:[0,0] op_sel_hi:[1,0]
    v_pk_mul_f32 v[212:213], v[212:213], v[10:11] op_sel:[0,0] op_sel_hi:[1,0]
    v_pk_mul_f32 v[214:215], v[214:215], v[10:11] op_sel:[0,0] op_sel_hi:[1,0]
    v_cvt_pk_bf16_f32 v232, v208, v209
    v_cvt_pk_bf16_f32 v233, v210, v211
    v_cvt_pk_bf16_f32 v234, v212, v213
    v_cvt_pk_bf16_f32 v235, v214, v215
    buffer_store_dwordx4 v[232:235], v1, s[4:7], s51 offen offset:2048 sc1
    s_nop 0
    v_mfma_f32_16x16x32_bf16 v[240:243], v[232:235], v[4:7], v[240:243]
    v_accvgpr_read_b32 v216, a120
    v_accvgpr_read_b32 v217, a121
    v_accvgpr_read_b32 v218, a122
    v_accvgpr_read_b32 v219, a123
    v_accvgpr_read_b32 v220, a124
    v_accvgpr_read_b32 v221, a125
    v_accvgpr_read_b32 v222, a126
    v_accvgpr_read_b32 v223, a127
    v_pk_mul_f32 v[216:217], v[216:217], v[10:11] op_sel:[0,0] op_sel_hi:[1,0]
    v_pk_mul_f32 v[218:219], v[218:219], v[10:11] op_sel:[0,0] op_sel_hi:[1,0]
    v_pk_mul_f32 v[220:221], v[220:221], v[10:11] op_sel:[0,0] op_sel_hi:[1,0]
    v_pk_mul_f32 v[222:223], v[222:223], v[10:11] op_sel:[0,0] op_sel_hi:[1,0]
    v_cvt_pk_bf16_f32 v236, v216, v217
    v_cvt_pk_bf16_f32 v237, v218, v219
    v_cvt_pk_bf16_f32 v238, v220, v221
    v_cvt_pk_bf16_f32 v239, v222, v223
    buffer_store_dwordx4 v[236:239], v1, s[4:7], s51 offen offset:3072 sc1
    s_nop 0
    v_mfma_f32_16x16x32_bf16 v[240:243], v[236:239], v[4:7], v[240:243]
    s_movk_i32 s51, 0x207
    s_nop 6
    v_cmp_class_f32 vcc, v240, s51
    s_or_b32 s59, s59, vcc_lo
    s_or_b32 s59, s59, vcc_hi
    v_cmp_class_f32 vcc, v241, s51
    s_or_b32 s59, s59, vcc_lo
    s_or_b32 s59, s59, vcc_hi
    v_cmp_class_f32 vcc, v242, s51
    s_or_b32 s59, s59, vcc_lo
    s_or_b32 s59, s59, vcc_hi
    v_cmp_class_f32 vcc, v243, s51
    s_or_b32 s59, s59, vcc_lo
    s_or_b32 s59, s59, vcc_hi
    s_branch L_att_S2
L_att_slow:
    s_waitcnt vmcnt(0)
    s_mul_i32 s51, s49, 1213440
    s_add_u32 s8, s4, s51
    s_addc_u32 s9, s5, 0
    s_mov_b32 s10, 1212416
    s_mov_b32 s11, 0x20000
    v_accvgpr_write_b32 a0, 0
    v_accvgpr_write_b32 a1, 0
    v_accvgpr_write_b32 a2, 0
    v_accvgpr_write_b32 a3, 0
    v_accvgpr_write_b32 a4, 0
    v_accvgpr_write_b32 a5, 0
    v_accvgpr_write_b32 a6, 0
    v_accvgpr_write_b32 a7, 0
    v_accvgpr_write_b32 a8, 0
    v_accvgpr_write_b32 a9, 0
    v_accvgpr_write_b32 a10, 0
    v_accvgpr_write_b32 a11, 0
    v_accvgpr_write_b32 a12, 0
    v_accvgpr_write_b32 a13, 0
    v_accvgpr_write_b32 a14, 0
    v_accvgpr_write_b32 a15, 0
    v_accvgpr_write_b32 a16, 0
    v_accvgpr_write_b32 a17, 0
    v_accvgpr_write_b32 a18, 0
    v_accvgpr_write_b32 a19, 0
    v_accvgpr_write_b32 a20, 0
    v_accvgpr_write_b32 a21, 0
    v_accvgpr_write_b32 a22, 0
    v_accvgpr_write_b32 a23, 0
    v_accvgpr_write_b32 a24, 0
    v_accvgpr_write_b32 a25, 0
    v_accvgpr_write_b32 a26, 0
    v_accvgpr_write_b32 a27, 0
    v_accvgpr_write_b32 a28, 0
    v_accvgpr_write_b32 a29, 0
    v_accvgpr_write_b32 a30, 0
    v_accvgpr_write_b32 a31, 0
    v_accvgpr_write_b32 a32, 0
    v_accvgpr_write_b32 a33, 0
    v_accvgpr_write_b32 a34, 0
    v_accvgpr_write_b32 a35, 0
    v_accvgpr_write_b32 a36, 0
    v_accvgpr_write_b32 a37, 0
    v_accvgpr_write_b32 a38, 0
    v_accvgpr_write_b32 a39, 0
    v_accvgpr_write_b32 a40, 0
    v_accvgpr_write_b32 a41, 0
    v_accvgpr_write_b32 a42, 0
    v_accvgpr_write_b32 a43, 0
    v_accvgpr_write_b32 a44, 0
    v_accvgpr_write_b32 a45, 0
    v_accvgpr_write_b32 a46, 0
    v_accvgpr_write_b32 a47, 0
    v_accvgpr_write_b32 a48, 0
    v_accvgpr_write_b32 a49, 0
    v_accvgpr_write_b32 a50, 0
    v_accvgpr_write_b32 a51, 0
    v_accvgpr_write_b32 a52, 0
    v_accvgpr_write_b32 a53, 0
    v_accvgpr_write_b32 a54, 0
    v_accvgpr_write_b32 a55, 0
    v_accvgpr_write_b32 a56, 0
    v_accvgpr_write_b32 a57, 0
    v_accvgpr_write_b32 a58, 0
    v_accvgpr_write_b32 a59, 0
    v_accvgpr_write_b32 a60, 0
    v_accvgpr_write_b32 a61, 0
    v_accvgpr_write_b32 a62, 0
    v_accvgpr_write_b32 a63, 0
    v_accvgpr_write_b32 a64, 0
    v_accvgpr_write_b32 a65, 0
    v_accvgpr_write_b32 a66, 0
    v_accvgpr_write_b32 a67, 0
    v_accvgpr_write_b32 a68, 0
    v_accvgpr_write_b32 a69, 0
    v_accvgpr_write_b32 a70, 0
    v_accvgpr_write_b32 a71, 0
    v_accvgpr_write_b32 a72, 0
    v_accvgpr_write_b32 a73, 0
    v_accvgpr_write_b32 a74, 0
    v_accvgpr_write_b32 a75, 0
    v_accvgpr_write_b32 a76, 0
    v_accvgpr_write_b32 a77, 0
    v_accvgpr_write_b32 a78, 0
    v_accvgpr_write_b32 a79, 0
    v_accvgpr_write_b32 a80, 0
    v_accvgpr_write_b32 a81, 0
    v_accvgpr_write_b32 a82, 0
    v_accvgpr_write_b32 a83, 0
    v_accvgpr_write_b32 a84, 0
    v_accvgpr_write_b32 a85, 0
    v_accvgpr_write_b32 a86, 0
    v_accvgpr_write_b32 a87, 0
    v_accvgpr_write_b32 a88, 0
    v_accvgpr_write_b32 a89, 0
    v_accvgpr_write_b32 a90, 0
    v_accvgpr_write_b32 a91, 0
    v_accvgpr_write_b32 a92, 0
    v_accvgpr_write_b32 a93, 0
    v_accvgpr_write_b32 a94, 0
    v_accvgpr_write_b32 a95, 0
    v_accvgpr_write_b32 a96, 0
    v_accvgpr_write_b32 a97, 0
    v_accvgpr_write_b32 a98, 0
    v_accvgpr_write_b32 a99, 0
    v_accvgpr_write_b32 a100, 0
    v_accvgpr_write_b32 a101, 0
    v_accvgpr_write_b32 a102, 0
    v_accvgpr_write_b32 a103, 0
    v_accvgpr_write_b32 a104, 0
    v_accvgpr_write_b32 a105, 0
    v_accvgpr_write_b32 a106, 0
    v_accvgpr_write_b32 a107, 0
    v_accvgpr_write_b32 a108, 0
    v_accvgpr_write_b32 a109, 0
    v_accvgpr_write_b32 a110, 0
    v_accvgpr_write_b32 a111, 0
    v_accvgpr_write_b32 a112, 0
    v_accvgpr_write_b32 a113, 0
    v_accvgpr_write_b32 a114, 0
    v_accvgpr_write_b32 a115, 0
    v_accvgpr_write_b32 a116, 0
    v_accvgpr_write_b32 a117, 0
    v_accvgpr_write_b32 a118, 0
    v_accvgpr_write_b32 a119, 0
    v_accvgpr_write_b32 a120, 0
    v_accvgpr_write_b32 a121, 0
    v_accvgpr_write_b32 a122, 0
    v_accvgpr_write_b32 a123, 0
    v_accvgpr_write_b32 a124, 0
    v_accvgpr_write_b32 a125, 0
    v_accvgpr_write_b32 a126, 0
    v_accvgpr_write_b32 a127, 0
    v_and_b32 v248, 15, v0
    v_lshrrev_b32 v249, 4, v0
    v_sub_u32 v248, v248, v249
    v_lshl_add_u32 v248, v248, 2, s3
    s_lshr_b32 s51, s60, 2
    s_lshl_b32 s51, s51, 6
    v_add_u32 v12, s51, v248
    v_mov_b32 v192, 0
    v_mov_b32 v240, 0xff800000
    s_lshr_b32 s51, s61, 2
    s_lshl_b32 s51, s51, 6
    v_add_u32 v13, s51, v248
    v_mov_b32 v196, 0
    v_mov_b32 v241, 0xff800000
    s_lshr_b32 s51, s62, 2
    s_lshl_b32 s51, s51, 6
    v_add_u32 v14, s51, v248
    v_mov_b32 v200, 0
    v_mov_b32 v242, 0xff800000
    s_lshr_b32 s51, s63, 2
    s_lshl_b32 s51, s51, 6
    v_add_u32 v15, s51, v248
    v_mov_b32 v204, 0
    v_mov_b32 v243, 0xff800000
    s_mov_b32 s52, s68
    s_lshl_b32 s58, s50, 1
    s_sub_u32 s58, 32, s58
L_att_slowloop:
    s_barrier
    s_mov_b32 m0, s68
    s_nop 0
    buffer_load_dwordx4 v1, s[8:11], s52 offen offset:0 sc1 lds
    buffer_load_dwordx4 v1, s[8:11], s52 offen offset:1024 sc1 lds
    buffer_load_dwordx4 v1, s[8:11], s52 offen offset:2048 sc1 lds
    buffer_load_dwordx4 v1, s[8:11], s52 offen offset:3072 sc1 lds
    s_add_u32 s52, s52, 16384
    s_add_u32 m0, s68, 16384
    s_nop 0
    buffer_load_dwordx4 v1, s[8:11], s52 offen offset:0 sc1 lds
    buffer_load_dwordx4 v1, s[8:11], s52 offen offset:1024 sc1 lds
    buffer_load_dwordx4 v1, s[8:11], s52 offen offset:2048 sc1 lds
    buffer_load_dwordx4 v1, s[8:11], s52 offen offset:3072 sc1 lds
    s_add_u32 s52, s52, 21504
    s_waitcnt vmcnt(0)
    s_barrier
    ds_read_b128 a[128:131], v1 offset:0
    ds_read_b128 a[132:135], v1 offset:1024
    ds_read_b128 a[136:139], v1 offset:2048
    ds_read_b128 a[140:143], v1 offset:3072
    ds_read_b128 a[144:147], v1 offset:4096
    ds_read_b128 a[148:151], v1 offset:5120
    ds_read_b128 a[152:155], v1 offset:6144
    ds_read_b128 a[156:159], v1 offset:7168
    s_waitcnt lgkmcnt(0)
    ds_read_b128 a[160:163], v1 offset:8192
    ds_read_b128 a[164:167], v1 offset:9216
    ds_read_b128 a[168:171], v1 offset:10240
    ds_read_b128 a[172:175], v1 offset:11264
    ds_read_b128 a[176:179], v1 offset:12288
    ds_read_b128 a[180:183], v1 offset:13312
    ds_read_b128 a[184:187], v1 offset:14336
    ds_read_b128 a[188:191], v1 offset:15360
    s_waitcnt lgkmcnt(0)
    ds_read_b128 a[192:195], v1 offset:16384
    ds_read_b128 a[196:199], v1 offset:17408
    ds_read_b128 a[200:203], v1 offset:18432
    ds_read_b128 a[204:207], v1 offset:19456
    ds_read_b128 a[208:211], v1 offset:20480
    ds_read_b128 a[212:215], v1 offset:21504
    ds_read_b128 a[216:219], v1 offset:22528
    ds_read_b128 a[220:223], v1 offset:23552
    s_waitcnt lgkmcnt(0)
    ds_read_b128 a[224:227], v1 offset:24576
    ds_read_b128 a[228:231], v1 offset:25600
    ds_read_b128 a[232:235], v1 offset:26624
    ds_read_b128 a[236:239], v1 offset:27648
    ds_read_b128 a[240:243], v1 offset:28672
    ds_read_b128 a[244:247], v1 offset:29696
    ds_read_b128 a[248:251], v1 offset:30720
    ds_read_b128 a[252:255], v1 offset:31744
    s_waitcnt lgkmcnt(0)
    v_mfma_f32_16x16x32_bf16 v[80:83], a[128:131], v[16:19], 0
    v_mfma_f32_16x16x32_bf16 v[80:83], a[132:135], v[20:23], v[80:83]
    v_mfma_f32_16x16x32_bf16 v[80:83], a[136:139], v[24:27], v[80:83]
    v_mfma_f32_16x16x32_bf16 v[80:83], a[140:143], v[28:31], v[80:83]
    v_mfma_f32_16x16x32_bf16 v[84:87], a[128:131], v[32:35], 0
    v_mfma_f32_16x16x32_bf16 v[84:87], a[132:135], v[36:39], v[84:87]
    v_mfma_f32_16x16x32_bf16 v[84:87], a[136:139], v[40:43], v[84:87]
    v_mfma_f32_16x16x32_bf16 v[84:87], a[140:143], v[44:47], v[84:87]
    v_mfma_f32_16x16x32_bf16 v[88:91], a[128:131], v[48:51], 0
    v_mfma_f32_16x16x32_bf16 v[88:91], a[132:135], v[52:55], v[88:91]
    v_mfma_f32_16x16x32_bf16 v[88:91], a[136:139], v[56:59], v[88:91]
    v_mfma_f32_16x16x32_bf16 v[88:91], a[140:143], v[60:63], v[88:91]
    v_mfma_f32_16x16x32_bf16 v[92:95], a[128:131], v[64:67], 0
    v_mfma_f32_16x16x32_bf16 v[92:95], a[132:135], v[68:71], v[92:95]
    v_mfma_f32_16x16x32_bf16 v[92:95], a[136:139], v[72:75], v[92:95]
    v_mfma_f32_16x16x32_bf16 v[92:95], a[140:143], v[76:79], v[92:95]
    v_mfma_f32_16x16x32_bf16 v[96:99], a[144:147], v[16:19], 0
    v_mfma_f32_16x16x32_bf16 v[96:99], a[148:151], v[20:23], v[96:99]
    v_mfma_f32_16x16x32_bf16 v[96:99], a[152:155], v[24:27], v[96:99]
    v_mfma_f32_16x16x32_bf16 v[96:99], a[156:159], v[28:31], v[96:99]
    v_mfma_f32_16x16x32_bf16 v[100:103], a[144:147], v[32:35], 0
    v_mfma_f32_16x16x32_bf16 v[100:103], a[148:151], v[36:39], v[100:103]
    v_mfma_f32_16x16x32_bf16 v[100:103], a[152:155], v[40:43], v[100:103]
    v_mfma_f32_16x16x32_bf16 v[100:103], a[156:159], v[44:47], v[100:103]
    v_mfma_f32_16x16x32_bf16 v[104:107], a[144:147], v[48:51], 0
    v_mfma_f32_16x16x32_bf16 v[104:107], a[148:151], v[52:55], v[104:107]
    v_mfma_f32_16x16x32_bf16 v[104:107], a[152:155], v[56:59], v[104:107]
    v_mfma_f32_16x16x32_bf16 v[104:107], a[156:159], v[60:63], v[104:107]
    v_mfma_f32_16x16x32_bf16 v[108:111], a[144:147], v[64:67], 0
    v_mfma_f32_16x16x32_bf16 v[108:111], a[148:151], v[68:71], v[108:111]
    v_mfma_f32_16x16x32_bf16 v[108:111], a[152:155], v[72:75], v[108:111]
    v_mfma_f32_16x16x32_bf16 v[108:111], a[156:159], v[76:79], v[108:111]
    v_mfma_f32_16x16x32_bf16 v[112:115], a[160:163], v[16:19], 0
    v_mfma_f32_16x16x32_bf16 v[112:115], a[164:167], v[20:23], v[112:115]
    v_mfma_f32_16x16x32_bf16 v[112:115], a[168:171], v[24:27], v[112:115]
    v_mfma_f32_16x16x32_bf16 v[112:115], a[172:175], v[28:31], v[112:115]
    v_mfma_f32_16x16x32_bf16 v[116:119], a[160:163], v[32:35], 0
    v_mfma_f32_16x16x32_bf16 v[116:119], a[164:167], v[36:39], v[116:119]
    v_mfma_f32_16x16x32_bf16 v[116:119], a[168:171], v[40:43], v[116:119]
    v_mfma_f32_16x16x32_bf16 v[116:119], a[172:175], v[44:47], v[116:119]
    v_mfma_f32_16x16x32_bf16 v[120:123], a[160:163], v[48:51], 0
    v_mfma_f32_16x16x32_bf16 v[120:123], a[164:167], v[52:55], v[120:123]
    v_mfma_f32_16x16x32_bf16 v[120:123], a[168:171], v[56:59], v[120:123]
    v_mfma_f32_16x16x32_bf16 v[120:123], a[172:175], v[60:63], v[120:123]
    v_mfma_f32_16x16x32_bf16 v[124:127], a[160:163], v[64:67], 0
    v_mfma_f32_16x16x32_bf16 v[124:127], a[164:167], v[68:71], v[124:127]
    v_mfma_f32_16x16x32_bf16 v[124:127], a[168:171], v[72:75], v[124:127]
    v_mfma_f32_16x16x32_bf16 v[124:127], a[172:175], v[76:79], v[124:127]
    v_mfma_f32_16x16x32_bf16 v[128:131], a[176:179], v[16:19], 0
    v_mfma_f32_16x16x32_bf16 v[128:131], a[180:183], v[20:23], v[128:131]
    v_mfma_f32_16x16x32_bf16 v[128:131], a[184:187], v[24:27], v[128:131]
    v_mfma_f32_16x16x32_bf16 v[128:131], a[188:191], v[28:31], v[128:131]
    v_mfma_f32_16x16x32_bf16 v[132:135], a[176:179], v[32:35], 0
    v_mfma_f32_16x16x32_bf16 v[132:135], a[180:183], v[36:39], v[132:135]
    v_mfma_f32_16x16x32_bf16 v[132:135], a[184:187], v[40:43], v[132:135]
    v_mfma_f32_16x16x32_bf16 v[132:135], a[188:191], v[44:47], v[132:135]
    v_mfma_f32_16x16x32_bf16 v[136:139], a[176:179], v[48:51], 0
    v_mfma_f32_16x16x32_bf16 v[136:139], a[180:183], v[52:55], v[136:139]
    v_mfma_f32_16x16x32_bf16 v[136:139], a[184:187], v[56:59], v[136:139]
    v_mfma_f32_16x16x32_bf16 v[136:139], a[188:191], v[60:63], v[136:139]
    v_mfma_f32_16x16x32_bf16 v[140:143], a[176:179], v[64:67], 0
    v_mfma_f32_16x16x32_bf16 v[140:143], a[180:183], v[68:71], v[140:143]
    v_mfma_f32_16x16x32_bf16 v[140:143], a[184:187], v[72:75], v[140:143]
    v_mfma_f32_16x16x32_bf16 v[140:143], a[188:191], v[76:79], v[140:143]
    v_cmp_gt_i32 vcc, 0, v12
    s_nop 1
    v_cndmask_b32 v80, v80, v8, vcc
    v_cmp_gt_i32 vcc, 1, v12
    s_nop 1
    v_cndmask_b32 v81, v81, v8, vcc
    v_cmp_gt_i32 vcc, 2, v12
    s_nop 1
    v_cndmask_b32 v82, v82, v8, vcc
    v_cmp_gt_i32 vcc, 3, v12
    s_nop 1
    v_cndmask_b32 v83, v83, v8, vcc
    v_cmp_gt_i32 vcc, 16, v12
    s_nop 1
    v_cndmask_b32 v96, v96, v8, vcc
    v_cmp_gt_i32 vcc, 17, v12
    s_nop 1
    v_cndmask_b32 v97, v97, v8, vcc
    v_cmp_gt_i32 vcc, 18, v12
    s_nop 1
    v_cndmask_b32 v98, v98, v8, vcc
    v_cmp_gt_i32 vcc, 19, v12
    s_nop 1
    v_cndmask_b32 v99, v99, v8, vcc
    v_cmp_gt_i32 vcc, 32, v12
    s_nop 1
    v_cndmask_b32 v112, v112, v8, vcc
    v_cmp_gt_i32 vcc, 33, v12
    s_nop 1
    v_cndmask_b32 v113, v113, v8, vcc
    v_cmp_gt_i32 vcc, 34, v12
    s_nop 1
    v_cndmask_b32 v114, v114, v8, vcc
    v_cmp_gt_i32 vcc, 35, v12
    s_nop 1
    v_cndmask_b32 v115, v115, v8, vcc
    v_cmp_gt_i32 vcc, 48, v12
    s_nop 1
    v_cndmask_b32 v128, v128, v8, vcc
    v_cmp_gt_i32 vcc, 49, v12
    s_nop 1
    v_cndmask_b32 v129, v129, v8, vcc
    v_cmp_gt_i32 vcc, 50, v12
    s_nop 1
    v_cndmask_b32 v130, v130, v8, vcc
    v_cmp_gt_i32 vcc, 51, v12
    s_nop 1
    v_cndmask_b32 v131, v131, v8, vcc
    v_mov_b32 v244, v240
    v_max3_f32 v240, v240, v80, v81
    v_max3_f32 v240, v240, v82, v83
    v_max3_f32 v240, v240, v96, v97
    v_max3_f32 v240, v240, v98, v99
    v_max3_f32 v240, v240, v112, v113
    v_max3_f32 v240, v240, v114, v115
    v_max3_f32 v240, v240, v128, v129
    v_max3_f32 v240, v240, v130, v131
    v_mov_b32 v248, v240
    s_nop 1
    v_permlane32_swap_b32 v240, v248
    v_max_f32 v240, v240, v248
    v_mov_b32 v248, v240
    s_nop 1
    v_permlane16_swap_b32 v240, v248
    v_max_f32 v240, v240, v248
    v_sub_f32 v244, v244, v240
    v_exp_f32 v244, v244
    v_subrev_u32 v12, 64, v12
    v_mul_f32 v192, v192, v244
    v_sub_f32 v80, v80, v240
    v_exp_f32 v80, v80
    v_sub_f32 v81, v81, v240
    v_exp_f32 v81, v81
    v_sub_f32 v82, v82, v240
    v_exp_f32 v82, v82
    v_sub_f32 v83, v83, v240
    v_exp_f32 v83, v83
    v_sub_f32 v96, v96, v240
    v_exp_f32 v96, v96
    v_sub_f32 v97, v97, v240
    v_exp_f32 v97, v97
    v_sub_f32 v98, v98, v240
    v_exp_f32 v98, v98
    v_sub_f32 v99, v99, v240
    v_exp_f32 v99, v99
    v_sub_f32 v112, v112, v240
    v_exp_f32 v112, v112
    v_sub_f32 v113, v113, v240
    v_exp_f32 v113, v113
    v_sub_f32 v114, v114, v240
    v_exp_f32 v114, v114
    v_sub_f32 v115, v115, v240
    v_exp_f32 v115, v115
    v_sub_f32 v128, v128, v240
    v_exp_f32 v128, v128
    v_sub_f32 v129, v129, v240
    v_exp_f32 v129, v129
    v_sub_f32 v130, v130, v240
    v_exp_f32 v130, v130
    v_sub_f32 v131, v131, v240
    v_exp_f32 v131, v131
    v_cvt_pk_bf16_f32 v144, v80, v81
    v_cvt_pk_bf16_f32 v145, v82, v83
    v_cvt_pk_bf16_f32 v146, v96, v97
    v_cvt_pk_bf16_f32 v147, v98, v99
    v_cvt_pk_bf16_f32 v148, v112, v113
    v_cvt_pk_bf16_f32 v149, v114, v115
    v_cvt_pk_bf16_f32 v150, v128, v129
    v_cvt_pk_bf16_f32 v151, v130, v131
    v_accvgpr_read_b32 v248, a0
    v_mul_f32 v248, v248, v244
    v_accvgpr_write_b32 a0, v248
    v_accvgpr_read_b32 v248, a1
    v_mul_f32 v248, v248, v244
    v_accvgpr_write_b32 a1, v248
    v_accvgpr_read_b32 v248, a2
    v_mul_f32 v248, v248, v244
    v_accvgpr_write_b32 a2, v248
    v_accvgpr_read_b32 v248, a3
    v_mul_f32 v248, v248, v244
    v_accvgpr_write_b32 a3, v248
    v_accvgpr_read_b32 v248, a4
    v_mul_f32 v248, v248, v244
    v_accvgpr_write_b32 a4, v248
    v_accvgpr_read_b32 v248, a5
    v_mul_f32 v248, v248, v244
    v_accvgpr_write_b32 a5, v248
    v_accvgpr_read_b32 v248, a6
    v_mul_f32 v248, v248, v244
    v_accvgpr_write_b32 a6, v248
    v_accvgpr_read_b32 v248, a7
    v_mul_f32 v248, v248, v244
    v_accvgpr_write_b32 a7, v248
    v_accvgpr_read_b32 v248, a8
    v_mul_f32 v248, v248, v244
    v_accvgpr_write_b32 a8, v248
    v_accvgpr_read_b32 v248, a9
    v_mul_f32 v248, v248, v244
    v_accvgpr_write_b32 a9, v248
    v_accvgpr_read_b32 v248, a10
    v_mul_f32 v248, v248, v244
    v_accvgpr_write_b32 a10, v248
    v_accvgpr_read_b32 v248, a11
    v_mul_f32 v248, v248, v244
    v_accvgpr_write_b32 a11, v248
    v_accvgpr_read_b32 v248, a12
    v_mul_f32 v248, v248, v244
    v_accvgpr_write_b32 a12, v248
    v_accvgpr_read_b32 v248, a13
    v_mul_f32 v248, v248, v244
    v_accvgpr_write_b32 a13, v248
    v_accvgpr_read_b32 v248, a14
    v_mul_f32 v248, v248, v244
    v_accvgpr_write_b32 a14, v248
    v_accvgpr_read_b32 v248, a15
    v_mul_f32 v248, v248, v244
    v_accvgpr_write_b32 a15, v248
    v_accvgpr_read_b32 v248, a16
    v_mul_f32 v248, v248, v244
    v_accvgpr_write_b32 a16, v248
    v_accvgpr_read_b32 v248, a17
    v_mul_f32 v248, v248, v244
    v_accvgpr_write_b32 a17, v248
    v_accvgpr_read_b32 v248, a18
    v_mul_f32 v248, v248, v244
    v_accvgpr_write_b32 a18, v248
    v_accvgpr_read_b32 v248, a19
    v_mul_f32 v248, v248, v244
    v_accvgpr_write_b32 a19, v248
    v_accvgpr_read_b32 v248, a20
    v_mul_f32 v248, v248, v244
    v_accvgpr_write_b32 a20, v248
    v_accvgpr_read_b32 v248, a21
    v_mul_f32 v248, v248, v244
    v_accvgpr_write_b32 a21, v248
    v_accvgpr_read_b32 v248, a22
    v_mul_f32 v248, v248, v244
    v_accvgpr_write_b32 a22, v248
    v_accvgpr_read_b32 v248, a23
    v_mul_f32 v248, v248, v244
    v_accvgpr_write_b32 a23, v248
    v_accvgpr_read_b32 v248, a24
    v_mul_f32 v248, v248, v244
    v_accvgpr_write_b32 a24, v248
    v_accvgpr_read_b32 v248, a25
    v_mul_f32 v248, v248, v244
    v_accvgpr_write_b32 a25, v248
    v_accvgpr_read_b32 v248, a26
    v_mul_f32 v248, v248, v244
    v_accvgpr_write_b32 a26, v248
    v_accvgpr_read_b32 v248, a27
    v_mul_f32 v248, v248, v244
    v_accvgpr_write_b32 a27, v248
    v_accvgpr_read_b32 v248, a28
    v_mul_f32 v248, v248, v244
    v_accvgpr_write_b32 a28, v248
    v_accvgpr_read_b32 v248, a29
    v_mul_f32 v248, v248, v244
    v_accvgpr_write_b32 a29, v248
    v_accvgpr_read_b32 v248, a30
    v_mul_f32 v248, v248, v244
    v_accvgpr_write_b32 a30, v248
    v_accvgpr_read_b32 v248, a31
    v_mul_f32 v248, v248, v244
    v_accvgpr_write_b32 a31, v248
    v_cmp_gt_i32 vcc, 0, v13
    s_nop 1
    v_cndmask_b32 v84, v84, v8, vcc
    v_cmp_gt_i32 vcc, 1, v13
    s_nop 1
    v_cndmask_b32 v85, v85, v8, vcc
    v_cmp_gt_i32 vcc, 2, v13
    s_nop 1
    v_cndmask_b32 v86, v86, v8, vcc
    v_cmp_gt_i32 vcc, 3, v13
    s_nop 1
    v_cndmask_b32 v87, v87, v8, vcc
    v_cmp_gt_i32 vcc, 16, v13
    s_nop 1
    v_cndmask_b32 v100, v100, v8, vcc
    v_cmp_gt_i32 vcc, 17, v13
    s_nop 1
    v_cndmask_b32 v101, v101, v8, vcc
    v_cmp_gt_i32 vcc, 18, v13
    s_nop 1
    v_cndmask_b32 v102, v102, v8, vcc
    v_cmp_gt_i32 vcc, 19, v13
    s_nop 1
    v_cndmask_b32 v103, v103, v8, vcc
    v_cmp_gt_i32 vcc, 32, v13
    s_nop 1
    v_cndmask_b32 v116, v116, v8, vcc
    v_cmp_gt_i32 vcc, 33, v13
    s_nop 1
    v_cndmask_b32 v117, v117, v8, vcc
    v_cmp_gt_i32 vcc, 34, v13
    s_nop 1
    v_cndmask_b32 v118, v118, v8, vcc
    v_cmp_gt_i32 vcc, 35, v13
    s_nop 1
    v_cndmask_b32 v119, v119, v8, vcc
    v_cmp_gt_i32 vcc, 48, v13
    s_nop 1
    v_cndmask_b32 v132, v132, v8, vcc
    v_cmp_gt_i32 vcc, 49, v13
    s_nop 1
    v_cndmask_b32 v133, v133, v8, vcc
    v_cmp_gt_i32 vcc, 50, v13
    s_nop 1
    v_cndmask_b32 v134, v134, v8, vcc
    v_cmp_gt_i32 vcc, 51, v13
    s_nop 1
    v_cndmask_b32 v135, v135, v8, vcc
    v_mov_b32 v245, v241
    v_max3_f32 v241, v241, v84, v85
    v_max3_f32 v241, v241, v86, v87
    v_max3_f32 v241, v241, v100, v101
    v_max3_f32 v241, v241, v102, v103
    v_max3_f32 v241, v241, v116, v117
    v_max3_f32 v241, v241, v118, v119
    v_max3_f32 v241, v241, v132, v133
    v_max3_f32 v241, v241, v134, v135
    v_mov_b32 v248, v241
    s_nop 1
    v_permlane32_swap_b32 v241, v248
    v_max_f32 v241, v241, v248
    v_mov_b32 v248, v241
    s_nop 1
    v_permlane16_swap_b32 v241, v248
    v_max_f32 v241, v241, v248
    v_sub_f32 v245, v245, v241
    v_exp_f32 v245, v245
    v_subrev_u32 v13, 64, v13
    v_mul_f32 v196, v196, v245
    v_sub_f32 v84, v84, v241
    v_exp_f32 v84, v84
    v_sub_f32 v85, v85, v241
    v_exp_f32 v85, v85
    v_sub_f32 v86, v86, v241
    v_exp_f32 v86, v86
    v_sub_f32 v87, v87, v241
    v_exp_f32 v87, v87
    v_sub_f32 v100, v100, v241
    v_exp_f32 v100, v100
    v_sub_f32 v101, v101, v241
    v_exp_f32 v101, v101
    v_sub_f32 v102, v102, v241
    v_exp_f32 v102, v102
    v_sub_f32 v103, v103, v241
    v_exp_f32 v103, v103
    v_sub_f32 v116, v116, v241
    v_exp_f32 v116, v116
    v_sub_f32 v117, v117, v241
    v_exp_f32 v117, v117
    v_sub_f32 v118, v118, v241
    v_exp_f32 v118, v118
    v_sub_f32 v119, v119, v241
    v_exp_f32 v119, v119
    v_sub_f32 v132, v132, v241
    v_exp_f32 v132, v132
    v_sub_f32 v133, v133, v241
    v_exp_f32 v133, v133
    v_sub_f32 v134, v134, v241
    v_exp_f32 v134, v134
    v_sub_f32 v135, v135, v241
    v_exp_f32 v135, v135
    v_cvt_pk_bf16_f32 v152, v84, v85
    v_cvt_pk_bf16_f32 v153, v86, v87
    v_cvt_pk_bf16_f32 v154, v100, v101
    v_cvt_pk_bf16_f32 v155, v102, v103
    v_cvt_pk_bf16_f32 v156, v116, v117
    v_cvt_pk_bf16_f32 v157, v118, v119
    v_cvt_pk_bf16_f32 v158, v132, v133
    v_cvt_pk_bf16_f32 v159, v134, v135
    v_accvgpr_read_b32 v248, a32
    v_mul_f32 v248, v248, v245
    v_accvgpr_write_b32 a32, v248
    v_accvgpr_read_b32 v248, a33
    v_mul_f32 v248, v248, v245
    v_accvgpr_write_b32 a33, v248
    v_accvgpr_read_b32 v248, a34
    v_mul_f32 v248, v248, v245
    v_accvgpr_write_b32 a34, v248
    v_accvgpr_read_b32 v248, a35
    v_mul_f32 v248, v248, v245
    v_accvgpr_write_b32 a35, v248
    v_accvgpr_read_b32 v248, a36
    v_mul_f32 v248, v248, v245
    v_accvgpr_write_b32 a36, v248
    v_accvgpr_read_b32 v248, a37
    v_mul_f32 v248, v248, v245
    v_accvgpr_write_b32 a37, v248
    v_accvgpr_read_b32 v248, a38
    v_mul_f32 v248, v248, v245
    v_accvgpr_write_b32 a38, v248
    v_accvgpr_read_b32 v248, a39
    v_mul_f32 v248, v248, v245
    v_accvgpr_write_b32 a39, v248
    v_accvgpr_read_b32 v248, a40
    v_mul_f32 v248, v248, v245
    v_accvgpr_write_b32 a40, v248
    v_accvgpr_read_b32 v248, a41
    v_mul_f32 v248, v248, v245
    v_accvgpr_write_b32 a41, v248
    v_accvgpr_read_b32 v248, a42
    v_mul_f32 v248, v248, v245
    v_accvgpr_write_b32 a42, v248
    v_accvgpr_read_b32 v248, a43
    v_mul_f32 v248, v248, v245
    v_accvgpr_write_b32 a43, v248
    v_accvgpr_read_b32 v248, a44
    v_mul_f32 v248, v248, v245
    v_accvgpr_write_b32 a44, v248
    v_accvgpr_read_b32 v248, a45
    v_mul_f32 v248, v248, v245
    v_accvgpr_write_b32 a45, v248
    v_accvgpr_read_b32 v248, a46
    v_mul_f32 v248, v248, v245
    v_accvgpr_write_b32 a46, v248
    v_accvgpr_read_b32 v248, a47
    v_mul_f32 v248, v248, v245
    v_accvgpr_write_b32 a47, v248
    v_accvgpr_read_b32 v248, a48
    v_mul_f32 v248, v248, v245
    v_accvgpr_write_b32 a48, v248
    v_accvgpr_read_b32 v248, a49
    v_mul_f32 v248, v248, v245
    v_accvgpr_write_b32 a49, v248
    v_accvgpr_read_b32 v248, a50
    v_mul_f32 v248, v248, v245
    v_accvgpr_write_b32 a50, v248
    v_accvgpr_read_b32 v248, a51
    v_mul_f32 v248, v248, v245
    v_accvgpr_write_b32 a51, v248
    v_accvgpr_read_b32 v248, a52
    v_mul_f32 v248, v248, v245
    v_accvgpr_write_b32 a52, v248
    v_accvgpr_read_b32 v248, a53
    v_mul_f32 v248, v248, v245
    v_accvgpr_write_b32 a53, v248
    v_accvgpr_read_b32 v248, a54
    v_mul_f32 v248, v248, v245
    v_accvgpr_write_b32 a54, v248
    v_accvgpr_read_b32 v248, a55
    v_mul_f32 v248, v248, v245
    v_accvgpr_write_b32 a55, v248
    v_accvgpr_read_b32 v248, a56
    v_mul_f32 v248, v248, v245
    v_accvgpr_write_b32 a56, v248
    v_accvgpr_read_b32 v248, a57
    v_mul_f32 v248, v248, v245
    v_accvgpr_write_b32 a57, v248
    v_accvgpr_read_b32 v248, a58
    v_mul_f32 v248, v248, v245
    v_accvgpr_write_b32 a58, v248
    v_accvgpr_read_b32 v248, a59
    v_mul_f32 v248, v248, v245
    v_accvgpr_write_b32 a59, v248
    v_accvgpr_read_b32 v248, a60
    v_mul_f32 v248, v248, v245
    v_accvgpr_write_b32 a60, v248
    v_accvgpr_read_b32 v248, a61
    v_mul_f32 v248, v248, v245
    v_accvgpr_write_b32 a61, v248
    v_accvgpr_read_b32 v248, a62
    v_mul_f32 v248, v248, v245
    v_accvgpr_write_b32 a62, v248
    v_accvgpr_read_b32 v248, a63
    v_mul_f32 v248, v248, v245
    v_accvgpr_write_b32 a63, v248
    v_cmp_gt_i32 vcc, 0, v14
    s_nop 1
    v_cndmask_b32 v88, v88, v8, vcc
    v_cmp_gt_i32 vcc, 1, v14
    s_nop 1
    v_cndmask_b32 v89, v89, v8, vcc
    v_cmp_gt_i32 vcc, 2, v14
    s_nop 1
    v_cndmask_b32 v90, v90, v8, vcc
    v_cmp_gt_i32 vcc, 3, v14
    s_nop 1
    v_cndmask_b32 v91, v91, v8, vcc
    v_cmp_gt_i32 vcc, 16, v14
    s_nop 1
    v_cndmask_b32 v104, v104, v8, vcc
    v_cmp_gt_i32 vcc, 17, v14
    s_nop 1
    v_cndmask_b32 v105, v105, v8, vcc
    v_cmp_gt_i32 vcc, 18, v14
    s_nop 1
    v_cndmask_b32 v106, v106, v8, vcc
    v_cmp_gt_i32 vcc, 19, v14
    s_nop 1
    v_cndmask_b32 v107, v107, v8, vcc
    v_cmp_gt_i32 vcc, 32, v14
    s_nop 1
    v_cndmask_b32 v120, v120, v8, vcc
    v_cmp_gt_i32 vcc, 33, v14
    s_nop 1
    v_cndmask_b32 v121, v121, v8, vcc
    v_cmp_gt_i32 vcc, 34, v14
    s_nop 1
    v_cndmask_b32 v122, v122, v8, vcc
    v_cmp_gt_i32 vcc, 35, v14
    s_nop 1
    v_cndmask_b32 v123, v123, v8, vcc
    v_cmp_gt_i32 vcc, 48, v14
    s_nop 1
    v_cndmask_b32 v136, v136, v8, vcc
    v_cmp_gt_i32 vcc, 49, v14
    s_nop 1
    v_cndmask_b32 v137, v137, v8, vcc
    v_cmp_gt_i32 vcc, 50, v14
    s_nop 1
    v_cndmask_b32 v138, v138, v8, vcc
    v_cmp_gt_i32 vcc, 51, v14
    s_nop 1
    v_cndmask_b32 v139, v139, v8, vcc
    v_mov_b32 v246, v242
    v_max3_f32 v242, v242, v88, v89
    v_max3_f32 v242, v242, v90, v91
    v_max3_f32 v242, v242, v104, v105
    v_max3_f32 v242, v242, v106, v107
    v_max3_f32 v242, v242, v120, v121
    v_max3_f32 v242, v242, v122, v123
    v_max3_f32 v242, v242, v136, v137
    v_max3_f32 v242, v242, v138, v139
    v_mov_b32 v248, v242
    s_nop 1
    v_permlane32_swap_b32 v242, v248
    v_max_f32 v242, v242, v248
    v_mov_b32 v248, v242
    s_nop 1
    v_permlane16_swap_b32 v242, v248
    v_max_f32 v242, v242, v248
    v_sub_f32 v246, v246, v242
    v_exp_f32 v246, v246
    v_subrev_u32 v14, 64, v14
    v_mul_f32 v200, v200, v246
    v_sub_f32 v88, v88, v242
    v_exp_f32 v88, v88
    v_sub_f32 v89, v89, v242
    v_exp_f32 v89, v89
    v_sub_f32 v90, v90, v242
    v_exp_f32 v90, v90
    v_sub_f32 v91, v91, v242
    v_exp_f32 v91, v91
    v_sub_f32 v104, v104, v242
    v_exp_f32 v104, v104
    v_sub_f32 v105, v105, v242
    v_exp_f32 v105, v105
    v_sub_f32 v106, v106, v242
    v_exp_f32 v106, v106
    v_sub_f32 v107, v107, v242
    v_exp_f32 v107, v107
    v_sub_f32 v120, v120, v242
    v_exp_f32 v120, v120
    v_sub_f32 v121, v121, v242
    v_exp_f32 v121, v121
    v_sub_f32 v122, v122, v242
    v_exp_f32 v122, v122
    v_sub_f32 v123, v123, v242
    v_exp_f32 v123, v123
    v_sub_f32 v136, v136, v242
    v_exp_f32 v136, v136
    v_sub_f32 v137, v137, v242
    v_exp_f32 v137, v137
    v_sub_f32 v138, v138, v242
    v_exp_f32 v138, v138
    v_sub_f32 v139, v139, v242
    v_exp_f32 v139, v139
    v_cvt_pk_bf16_f32 v160, v88, v89
    v_cvt_pk_bf16_f32 v161, v90, v91
    v_cvt_pk_bf16_f32 v162, v104, v105
    v_cvt_pk_bf16_f32 v163, v106, v107
    v_cvt_pk_bf16_f32 v164, v120, v121
    v_cvt_pk_bf16_f32 v165, v122, v123
    v_cvt_pk_bf16_f32 v166, v136, v137
    v_cvt_pk_bf16_f32 v167, v138, v139
    v_accvgpr_read_b32 v248, a64
    v_mul_f32 v248, v248, v246
    v_accvgpr_write_b32 a64, v248
    v_accvgpr_read_b32 v248, a65
    v_mul_f32 v248, v248, v246
    v_accvgpr_write_b32 a65, v248
    v_accvgpr_read_b32 v248, a66
    v_mul_f32 v248, v248, v246
    v_accvgpr_write_b32 a66, v248
    v_accvgpr_read_b32 v248, a67
    v_mul_f32 v248, v248, v246
    v_accvgpr_write_b32 a67, v248
    v_accvgpr_read_b32 v248, a68
    v_mul_f32 v248, v248, v246
    v_accvgpr_write_b32 a68, v248
    v_accvgpr_read_b32 v248, a69
    v_mul_f32 v248, v248, v246
    v_accvgpr_write_b32 a69, v248
    v_accvgpr_read_b32 v248, a70
    v_mul_f32 v248, v248, v246
    v_accvgpr_write_b32 a70, v248
    v_accvgpr_read_b32 v248, a71
    v_mul_f32 v248, v248, v246
    v_accvgpr_write_b32 a71, v248
    v_accvgpr_read_b32 v248, a72
    v_mul_f32 v248, v248, v246
    v_accvgpr_write_b32 a72, v248
    v_accvgpr_read_b32 v248, a73
    v_mul_f32 v248, v248, v246
    v_accvgpr_write_b32 a73, v248
    v_accvgpr_read_b32 v248, a74
    v_mul_f32 v248, v248, v246
    v_accvgpr_write_b32 a74, v248
    v_accvgpr_read_b32 v248, a75
    v_mul_f32 v248, v248, v246
    v_accvgpr_write_b32 a75, v248
    v_accvgpr_read_b32 v248, a76
    v_mul_f32 v248, v248, v246
    v_accvgpr_write_b32 a76, v248
    v_accvgpr_read_b32 v248, a77
    v_mul_f32 v248, v248, v246
    v_accvgpr_write_b32 a77, v248
    v_accvgpr_read_b32 v248, a78
    v_mul_f32 v248, v248, v246
    v_accvgpr_write_b32 a78, v248
    v_accvgpr_read_b32 v248, a79
    v_mul_f32 v248, v248, v246
    v_accvgpr_write_b32 a79, v248
    v_accvgpr_read_b32 v248, a80
    v_mul_f32 v248, v248, v246
    v_accvgpr_write_b32 a80, v248
    v_accvgpr_read_b32 v248, a81
    v_mul_f32 v248, v248, v246
    v_accvgpr_write_b32 a81, v248
    v_accvgpr_read_b32 v248, a82
    v_mul_f32 v248, v248, v246
    v_accvgpr_write_b32 a82, v248
    v_accvgpr_read_b32 v248, a83
    v_mul_f32 v248, v248, v246
    v_accvgpr_write_b32 a83, v248
    v_accvgpr_read_b32 v248, a84
    v_mul_f32 v248, v248, v246
    v_accvgpr_write_b32 a84, v248
    v_accvgpr_read_b32 v248, a85
    v_mul_f32 v248, v248, v246
    v_accvgpr_write_b32 a85, v248
    v_accvgpr_read_b32 v248, a86
    v_mul_f32 v248, v248, v246
    v_accvgpr_write_b32 a86, v248
    v_accvgpr_read_b32 v248, a87
    v_mul_f32 v248, v248, v246
    v_accvgpr_write_b32 a87, v248
    v_accvgpr_read_b32 v248, a88
    v_mul_f32 v248, v248, v246
    v_accvgpr_write_b32 a88, v248
    v_accvgpr_read_b32 v248, a89
    v_mul_f32 v248, v248, v246
    v_accvgpr_write_b32 a89, v248
    v_accvgpr_read_b32 v248, a90
    v_mul_f32 v248, v248, v246
    v_accvgpr_write_b32 a90, v248
    v_accvgpr_read_b32 v248, a91
    v_mul_f32 v248, v248, v246
    v_accvgpr_write_b32 a91, v248
    v_accvgpr_read_b32 v248, a92
    v_mul_f32 v248, v248, v246
    v_accvgpr_write_b32 a92, v248
    v_accvgpr_read_b32 v248, a93
    v_mul_f32 v248, v248, v246
    v_accvgpr_write_b32 a93, v248
    v_accvgpr_read_b32 v248, a94
    v_mul_f32 v248, v248, v246
    v_accvgpr_write_b32 a94, v248
    v_accvgpr_read_b32 v248, a95
    v_mul_f32 v248, v248, v246
    v_accvgpr_write_b32 a95, v248
    v_cmp_gt_i32 vcc, 0, v15
    s_nop 1
    v_cndmask_b32 v92, v92, v8, vcc
    v_cmp_gt_i32 vcc, 1, v15
    s_nop 1
    v_cndmask_b32 v93, v93, v8, vcc
    v_cmp_gt_i32 vcc, 2, v15
    s_nop 1
    v_cndmask_b32 v94, v94, v8, vcc
    v_cmp_gt_i32 vcc, 3, v15
    s_nop 1
    v_cndmask_b32 v95, v95, v8, vcc
    v_cmp_gt_i32 vcc, 16, v15
    s_nop 1
    v_cndmask_b32 v108, v108, v8, vcc
    v_cmp_gt_i32 vcc, 17, v15
    s_nop 1
    v_cndmask_b32 v109, v109, v8, vcc
    v_cmp_gt_i32 vcc, 18, v15
    s_nop 1
    v_cndmask_b32 v110, v110, v8, vcc
    v_cmp_gt_i32 vcc, 19, v15
    s_nop 1
    v_cndmask_b32 v111, v111, v8, vcc
    v_cmp_gt_i32 vcc, 32, v15
    s_nop 1
    v_cndmask_b32 v124, v124, v8, vcc
    v_cmp_gt_i32 vcc, 33, v15
    s_nop 1
    v_cndmask_b32 v125, v125, v8, vcc
    v_cmp_gt_i32 vcc, 34, v15
    s_nop 1
    v_cndmask_b32 v126, v126, v8, vcc
    v_cmp_gt_i32 vcc, 35, v15
    s_nop 1
    v_cndmask_b32 v127, v127, v8, vcc
    v_cmp_gt_i32 vcc, 48, v15
    s_nop 1
    v_cndmask_b32 v140, v140, v8, vcc
    v_cmp_gt_i32 vcc, 49, v15
    s_nop 1
    v_cndmask_b32 v141, v141, v8, vcc
    v_cmp_gt_i32 vcc, 50, v15
    s_nop 1
    v_cndmask_b32 v142, v142, v8, vcc
    v_cmp_gt_i32 vcc, 51, v15
    s_nop 1
    v_cndmask_b32 v143, v143, v8, vcc
    v_mov_b32 v247, v243
    v_max3_f32 v243, v243, v92, v93
    v_max3_f32 v243, v243, v94, v95
    v_max3_f32 v243, v243, v108, v109
    v_max3_f32 v243, v243, v110, v111
    v_max3_f32 v243, v243, v124, v125
    v_max3_f32 v243, v243, v126, v127
    v_max3_f32 v243, v243, v140, v141
    v_max3_f32 v243, v243, v142, v143
    v_mov_b32 v248, v243
    s_nop 1
    v_permlane32_swap_b32 v243, v248
    v_max_f32 v243, v243, v248
    v_mov_b32 v248, v243
    s_nop 1
    v_permlane16_swap_b32 v243, v248
    v_max_f32 v243, v243, v248
    v_sub_f32 v247, v247, v243
    v_exp_f32 v247, v247
    v_subrev_u32 v15, 64, v15
    v_mul_f32 v204, v204, v247
    v_sub_f32 v92, v92, v243
    v_exp_f32 v92, v92
    v_sub_f32 v93, v93, v243
    v_exp_f32 v93, v93
    v_sub_f32 v94, v94, v243
    v_exp_f32 v94, v94
    v_sub_f32 v95, v95, v243
    v_exp_f32 v95, v95
    v_sub_f32 v108, v108, v243
    v_exp_f32 v108, v108
    v_sub_f32 v109, v109, v243
    v_exp_f32 v109, v109
    v_sub_f32 v110, v110, v243
    v_exp_f32 v110, v110
    v_sub_f32 v111, v111, v243
    v_exp_f32 v111, v111
    v_sub_f32 v124, v124, v243
    v_exp_f32 v124, v124
    v_sub_f32 v125, v125, v243
    v_exp_f32 v125, v125
    v_sub_f32 v126, v126, v243
    v_exp_f32 v126, v126
    v_sub_f32 v127, v127, v243
    v_exp_f32 v127, v127
    v_sub_f32 v140, v140, v243
    v_exp_f32 v140, v140
    v_sub_f32 v141, v141, v243
    v_exp_f32 v141, v141
    v_sub_f32 v142, v142, v243
    v_exp_f32 v142, v142
    v_sub_f32 v143, v143, v243
    v_exp_f32 v143, v143
    v_cvt_pk_bf16_f32 v168, v92, v93
    v_cvt_pk_bf16_f32 v169, v94, v95
    v_cvt_pk_bf16_f32 v170, v108, v109
    v_cvt_pk_bf16_f32 v171, v110, v111
    v_cvt_pk_bf16_f32 v172, v124, v125
    v_cvt_pk_bf16_f32 v173, v126, v127
    v_cvt_pk_bf16_f32 v174, v140, v141
    v_cvt_pk_bf16_f32 v175, v142, v143
    v_accvgpr_read_b32 v248, a96
    v_mul_f32 v248, v248, v247
    v_accvgpr_write_b32 a96, v248
    v_accvgpr_read_b32 v248, a97
    v_mul_f32 v248, v248, v247
    v_accvgpr_write_b32 a97, v248
    v_accvgpr_read_b32 v248, a98
    v_mul_f32 v248, v248, v247
    v_accvgpr_write_b32 a98, v248
    v_accvgpr_read_b32 v248, a99
    v_mul_f32 v248, v248, v247
    v_accvgpr_write_b32 a99, v248
    v_accvgpr_read_b32 v248, a100
    v_mul_f32 v248, v248, v247
    v_accvgpr_write_b32 a100, v248
    v_accvgpr_read_b32 v248, a101
    v_mul_f32 v248, v248, v247
    v_accvgpr_write_b32 a101, v248
    v_accvgpr_read_b32 v248, a102
    v_mul_f32 v248, v248, v247
    v_accvgpr_write_b32 a102, v248
    v_accvgpr_read_b32 v248, a103
    v_mul_f32 v248, v248, v247
    v_accvgpr_write_b32 a103, v248
    v_accvgpr_read_b32 v248, a104
    v_mul_f32 v248, v248, v247
    v_accvgpr_write_b32 a104, v248
    v_accvgpr_read_b32 v248, a105
    v_mul_f32 v248, v248, v247
    v_accvgpr_write_b32 a105, v248
    v_accvgpr_read_b32 v248, a106
    v_mul_f32 v248, v248, v247
    v_accvgpr_write_b32 a106, v248
    v_accvgpr_read_b32 v248, a107
    v_mul_f32 v248, v248, v247
    v_accvgpr_write_b32 a107, v248
    v_accvgpr_read_b32 v248, a108
    v_mul_f32 v248, v248, v247
    v_accvgpr_write_b32 a108, v248
    v_accvgpr_read_b32 v248, a109
    v_mul_f32 v248, v248, v247
    v_accvgpr_write_b32 a109, v248
    v_accvgpr_read_b32 v248, a110
    v_mul_f32 v248, v248, v247
    v_accvgpr_write_b32 a110, v248
    v_accvgpr_read_b32 v248, a111
    v_mul_f32 v248, v248, v247
    v_accvgpr_write_b32 a111, v248
    v_accvgpr_read_b32 v248, a112
    v_mul_f32 v248, v248, v247
    v_accvgpr_write_b32 a112, v248
    v_accvgpr_read_b32 v248, a113
    v_mul_f32 v248, v248, v247
    v_accvgpr_write_b32 a113, v248
    v_accvgpr_read_b32 v248, a114
    v_mul_f32 v248, v248, v247
    v_accvgpr_write_b32 a114, v248
    v_accvgpr_read_b32 v248, a115
    v_mul_f32 v248, v248, v247
    v_accvgpr_write_b32 a115, v248
    v_accvgpr_read_b32 v248, a116
    v_mul_f32 v248, v248, v247
    v_accvgpr_write_b32 a116, v248
    v_accvgpr_read_b32 v248, a117
    v_mul_f32 v248, v248, v247
    v_accvgpr_write_b32 a117, v248
    v_accvgpr_read_b32 v248, a118
    v_mul_f32 v248, v248, v247
    v_accvgpr_write_b32 a118, v248
    v_accvgpr_read_b32 v248, a119
    v_mul_f32 v248, v248, v247
    v_accvgpr_write_b32 a119, v248
    v_accvgpr_read_b32 v248, a120
    v_mul_f32 v248, v248, v247
    v_accvgpr_write_b32 a120, v248
    v_accvgpr_read_b32 v248, a121
    v_mul_f32 v248, v248, v247
    v_accvgpr_write_b32 a121, v248
    v_accvgpr_read_b32 v248, a122
    v_mul_f32 v248, v248, v247
    v_accvgpr_write_b32 a122, v248
    v_accvgpr_read_b32 v248, a123
    v_mul_f32 v248, v248, v247
    v_accvgpr_write_b32 a123, v248
    v_accvgpr_read_b32 v248, a124
    v_mul_f32 v248, v248, v247
    v_accvgpr_write_b32 a124, v248
    v_accvgpr_read_b32 v248, a125
    v_mul_f32 v248, v248, v247
    v_accvgpr_write_b32 a125, v248
    v_accvgpr_read_b32 v248, a126
    v_mul_f32 v248, v248, v247
    v_accvgpr_write_b32 a126, v248
    v_accvgpr_read_b32 v248, a127
    v_mul_f32 v248, v248, v247
    v_accvgpr_write_b32 a127, v248
    v_mfma_f32_16x16x32_bf16 v[192:195], v[4:7], v[144:147], v[192:195]
    v_mfma_f32_16x16x32_bf16 v[192:195], v[4:7], v[148:151], v[192:195]
    v_mfma_f32_16x16x32_bf16 v[196:199], v[4:7], v[152:155], v[196:199]
    v_mfma_f32_16x16x32_bf16 v[196:199], v[4:7], v[156:159], v[196:199]
    v_mfma_f32_16x16x32_bf16 v[200:203], v[4:7], v[160:163], v[200:203]
    v_mfma_f32_16x16x32_bf16 v[200:203], v[4:7], v[164:167], v[200:203]
    v_mfma_f32_16x16x32_bf16 v[204:207], v[4:7], v[168:171], v[204:207]
    v_mfma_f32_16x16x32_bf16 v[204:207], v[4:7], v[172:175], v[204:207]
    v_mfma_f32_16x16x32_bf16 a[0:3], a[192:195], v[144:147], a[0:3]
    v_mfma_f32_16x16x32_bf16 a[0:3], a[196:199], v[148:151], a[0:3]
    v_mfma_f32_16x16x32_bf16 a[32:35], a[192:195], v[152:155], a[32:35]
    v_mfma_f32_16x16x32_bf16 a[32:35], a[196:199], v[156:159], a[32:35]
    v_mfma_f32_16x16x32_bf16 a[64:67], a[192:195], v[160:163], a[64:67]
    v_mfma_f32_16x16x32_bf16 a[64:67], a[196:199], v[164:167], a[64:67]
    v_mfma_f32_16x16x32_bf16 a[96:99], a[192:195], v[168:171], a[96:99]
    v_mfma_f32_16x16x32_bf16 a[96:99], a[196:199], v[172:175], a[96:99]
    v_mfma_f32_16x16x32_bf16 a[4:7], a[200:203], v[144:147], a[4:7]
    v_mfma_f32_16x16x32_bf16 a[4:7], a[204:207], v[148:151], a[4:7]
    v_mfma_f32_16x16x32_bf16 a[36:39], a[200:203], v[152:155], a[36:39]
    v_mfma_f32_16x16x32_bf16 a[36:39], a[204:207], v[156:159], a[36:39]
    v_mfma_f32_16x16x32_bf16 a[68:71], a[200:203], v[160:163], a[68:71]
    v_mfma_f32_16x16x32_bf16 a[68:71], a[204:207], v[164:167], a[68:71]
    v_mfma_f32_16x16x32_bf16 a[100:103], a[200:203], v[168:171], a[100:103]
    v_mfma_f32_16x16x32_bf16 a[100:103], a[204:207], v[172:175], a[100:103]
    v_mfma_f32_16x16x32_bf16 a[8:11], a[208:211], v[144:147], a[8:11]
    v_mfma_f32_16x16x32_bf16 a[8:11], a[212:215], v[148:151], a[8:11]
    v_mfma_f32_16x16x32_bf16 a[40:43], a[208:211], v[152:155], a[40:43]
    v_mfma_f32_16x16x32_bf16 a[40:43], a[212:215], v[156:159], a[40:43]
    v_mfma_f32_16x16x32_bf16 a[72:75], a[208:211], v[160:163], a[72:75]
    v_mfma_f32_16x16x32_bf16 a[72:75], a[212:215], v[164:167], a[72:75]
    v_mfma_f32_16x16x32_bf16 a[104:107], a[208:211], v[168:171], a[104:107]
    v_mfma_f32_16x16x32_bf16 a[104:107], a[212:215], v[172:175], a[104:107]
    v_mfma_f32_16x16x32_bf16 a[12:15], a[216:219], v[144:147], a[12:15]
    v_mfma_f32_16x16x32_bf16 a[12:15], a[220:223], v[148:151], a[12:15]
    v_mfma_f32_16x16x32_bf16 a[44:47], a[216:219], v[152:155], a[44:47]
    v_mfma_f32_16x16x32_bf16 a[44:47], a[220:223], v[156:159], a[44:47]
    v_mfma_f32_16x16x32_bf16 a[76:79], a[216:219], v[160:163], a[76:79]
    v_mfma_f32_16x16x32_bf16 a[76:79], a[220:223], v[164:167], a[76:79]
    v_mfma_f32_16x16x32_bf16 a[108:111], a[216:219], v[168:171], a[108:111]
    v_mfma_f32_16x16x32_bf16 a[108:111], a[220:223], v[172:175], a[108:111]
    v_mfma_f32_16x16x32_bf16 a[16:19], a[224:227], v[144:147], a[16:19]
    v_mfma_f32_16x16x32_bf16 a[16:19], a[228:231], v[148:151], a[16:19]
    v_mfma_f32_16x16x32_bf16 a[48:51], a[224:227], v[152:155], a[48:51]
    v_mfma_f32_16x16x32_bf16 a[48:51], a[228:231], v[156:159], a[48:51]
    v_mfma_f32_16x16x32_bf16 a[80:83], a[224:227], v[160:163], a[80:83]
    v_mfma_f32_16x16x32_bf16 a[80:83], a[228:231], v[164:167], a[80:83]
    v_mfma_f32_16x16x32_bf16 a[112:115], a[224:227], v[168:171], a[112:115]
    v_mfma_f32_16x16x32_bf16 a[112:115], a[228:231], v[172:175], a[112:115]
    v_mfma_f32_16x16x32_bf16 a[20:23], a[232:235], v[144:147], a[20:23]
    v_mfma_f32_16x16x32_bf16 a[20:23], a[236:239], v[148:151], a[20:23]
    v_mfma_f32_16x16x32_bf16 a[52:55], a[232:235], v[152:155], a[52:55]
    v_mfma_f32_16x16x32_bf16 a[52:55], a[236:239], v[156:159], a[52:55]
    v_mfma_f32_16x16x32_bf16 a[84:87], a[232:235], v[160:163], a[84:87]
    v_mfma_f32_16x16x32_bf16 a[84:87], a[236:239], v[164:167], a[84:87]
    v_mfma_f32_16x16x32_bf16 a[116:119], a[232:235], v[168:171], a[116:119]
    v_mfma_f32_16x16x32_bf16 a[116:119], a[236:239], v[172:175], a[116:119]
    v_mfma_f32_16x16x32_bf16 a[24:27], a[240:243], v[144:147], a[24:27]
    v_mfma_f32_16x16x32_bf16 a[24:27], a[244:247], v[148:151], a[24:27]
    v_mfma_f32_16x16x32_bf16 a[56:59], a[240:243], v[152:155], a[56:59]
    v_mfma_f32_16x16x32_bf16 a[56:59], a[244:247], v[156:159], a[56:59]
    v_mfma_f32_16x16x32_bf16 a[88:91], a[240:243], v[160:163], a[88:91]
    v_mfma_f32_16x16x32_bf16 a[88:91], a[244:247], v[164:167], a[88:91]
    v_mfma_f32_16x16x32_bf16 a[120:123], a[240:243], v[168:171], a[120:123]
    v_mfma_f32_16x16x32_bf16 a[120:123], a[244:247], v[172:175], a[120:123]
    v_mfma_f32_16x16x32_bf16 a[28:31], a[248:251], v[144:147], a[28:31]
    v_mfma_f32_16x16x32_bf16 a[28:31], a[252:255], v[148:151], a[28:31]
    v_mfma_f32_16x16x32_bf16 a[60:63], a[248:251], v[152:155], a[60:63]
    v_mfma_f32_16x16x32_bf16 a[60:63], a[252:255], v[156:159], a[60:63]
    v_mfma_f32_16x16x32_bf16 a[92:95], a[248:251], v[160:163], a[92:95]
    v_mfma_f32_16x16x32_bf16 a[92:95], a[252:255], v[164:167], a[92:95]
    v_mfma_f32_16x16x32_bf16 a[124:127], a[248:251], v[168:171], a[124:127]
    v_mfma_f32_16x16x32_bf16 a[124:127], a[252:255], v[172:175], a[124:127]
    s_sub_u32 s58, s58, 1
    s_cmp_lg_u32 s58, 0
    s_cbranch_scc1 L_att_slowloop
    v_rcp_f32 v9, v192
    s_mul_i32 s51, s60, 136192
    s_add_u32 s51, s51, s57
    v_accvgpr_read_b32 v208, a0
    v_accvgpr_read_b32 v209, a1
    v_accvgpr_read_b32 v210, a2
    v_accvgpr_read_b32 v211, a3
    v_accvgpr_read_b32 v212, a4
    v_accvgpr_read_b32 v213, a5
    v_accvgpr_read_b32 v214, a6
    v_accvgpr_read_b32 v215, a7
    v_pk_mul_f32 v[208:209], v[208:209], v[8:9] op_sel:[0,1] op_sel_hi:[1,1]
    v_pk_mul_f32 v[210:211], v[210:211], v[8:9] op_sel:[0,1] op_sel_hi:[1,1]
    v_pk_mul_f32 v[212:213], v[212:213], v[8:9] op_sel:[0,1] op_sel_hi:[1,1]
    v_pk_mul_f32 v[214:215], v[214:215], v[8:9] op_sel:[0,1] op_sel_hi:[1,1]
    v_cvt_pk_bf16_f32 v224, v208, v209
    v_cvt_pk_bf16_f32 v225, v210, v211
    v_cvt_pk_bf16_f32 v226, v212, v213
    v_cvt_pk_bf16_f32 v227, v214, v215
    buffer_store_dwordx4 v[224:227], v1, s[4:7], s51 offen offset:0 sc1
    v_accvgpr_read_b32 v216, a8
    v_accvgpr_read_b32 v217, a9
    v_accvgpr_read_b32 v218, a10
    v_accvgpr_read_b32 v219, a11
    v_accvgpr_read_b32 v220, a12
    v_accvgpr_read_b32 v221, a13
    v_accvgpr_read_b32 v222, a14
    v_accvgpr_read_b32 v223, a15
    v_pk_mul_f32 v[216:217], v[216:217], v[8:9] op_sel:[0,1] op_sel_hi:[1,1]
    v_pk_mul_f32 v[218:219], v[218:219], v[8:9] op_sel:[0,1] op_sel_hi:[1,1]
    v_pk_mul_f32 v[220:221], v[220:221], v[8:9] op_sel:[0,1] op_sel_hi:[1,1]
    v_pk_mul_f32 v[222:223], v[222:223], v[8:9] op_sel:[0,1] op_sel_hi:[1,1]
    v_cvt_pk_bf16_f32 v228, v216, v217
    v_cvt_pk_bf16_f32 v229, v218, v219
    v_cvt_pk_bf16_f32 v230, v220, v221
    v_cvt_pk_bf16_f32 v231, v222, v223
    buffer_store_dwordx4 v[228:231], v1, s[4:7], s51 offen offset:1024 sc1
    v_accvgpr_read_b32 v208, a16
    v_accvgpr_read_b32 v209, a17
    v_accvgpr_read_b32 v210, a18
    v_accvgpr_read_b32 v211, a19
    v_accvgpr_read_b32 v212, a20
    v_accvgpr_read_b32 v213, a21
    v_accvgpr_read_b32 v214, a22
    v_accvgpr_read_b32 v215, a23
    v_pk_mul_f32 v[208:209], v[208:209], v[8:9] op_sel:[0,1] op_sel_hi:[1,1]
    v_pk_mul_f32 v[210:211], v[210:211], v[8:9] op_sel:[0,1] op_sel_hi:[1,1]
    v_pk_mul_f32 v[212:213], v[212:213], v[8:9] op_sel:[0,1] op_sel_hi:[1,1]
    v_pk_mul_f32 v[214:215], v[214:215], v[8:9] op_sel:[0,1] op_sel_hi:[1,1]
    v_cvt_pk_bf16_f32 v232, v208, v209
    v_cvt_pk_bf16_f32 v233, v210, v211
    v_cvt_pk_bf16_f32 v234, v212, v213
    v_cvt_pk_bf16_f32 v235, v214, v215
    buffer_store_dwordx4 v[232:235], v1, s[4:7], s51 offen offset:2048 sc1
    v_accvgpr_read_b32 v216, a24
    v_accvgpr_read_b32 v217, a25
    v_accvgpr_read_b32 v218, a26
    v_accvgpr_read_b32 v219, a27
    v_accvgpr_read_b32 v220, a28
    v_accvgpr_read_b32 v221, a29
    v_accvgpr_read_b32 v222, a30
    v_accvgpr_read_b32 v223, a31
    v_pk_mul_f32 v[216:217], v[216:217], v[8:9] op_sel:[0,1] op_sel_hi:[1,1]
    v_pk_mul_f32 v[218:219], v[218:219], v[8:9] op_sel:[0,1] op_sel_hi:[1,1]
    v_pk_mul_f32 v[220:221], v[220:221], v[8:9] op_sel:[0,1] op_sel_hi:[1,1]
    v_pk_mul_f32 v[222:223], v[222:223], v[8:9] op_sel:[0,1] op_sel_hi:[1,1]
    v_cvt_pk_bf16_f32 v236, v216, v217
    v_cvt_pk_bf16_f32 v237, v218, v219
    v_cvt_pk_bf16_f32 v238, v220, v221
    v_cvt_pk_bf16_f32 v239, v222, v223
    buffer_store_dwordx4 v[236:239], v1, s[4:7], s51 offen offset:3072 sc1
    v_rcp_f32 v10, v196
    s_mul_i32 s51, s61, 136192
    s_add_u32 s51, s51, s57
    v_accvgpr_read_b32 v208, a32
    v_accvgpr_read_b32 v209, a33
    v_accvgpr_read_b32 v210, a34
    v_accvgpr_read_b32 v211, a35
    v_accvgpr_read_b32 v212, a36
    v_accvgpr_read_b32 v213, a37
    v_accvgpr_read_b32 v214, a38
    v_accvgpr_read_b32 v215, a39
    v_pk_mul_f32 v[208:209], v[208:209], v[10:11] op_sel:[0,0] op_sel_hi:[1,0]
    v_pk_mul_f32 v[210:211], v[210:211], v[10:11] op_sel:[0,0] op_sel_hi:[1,0]
    v_pk_mul_f32 v[212:213], v[212:213], v[10:11] op_sel:[0,0] op_sel_hi:[1,0]
    v_pk_mul_f32 v[214:215], v[214:215], v[10:11] op_sel:[0,0] op_sel_hi:[1,0]
    v_cvt_pk_bf16_f32 v224, v208, v209
    v_cvt_pk_bf16_f32 v225, v210, v211
    v_cvt_pk_bf16_f32 v226, v212, v213
    v_cvt_pk_bf16_f32 v227, v214, v215
    buffer_store_dwordx4 v[224:227], v1, s[4:7], s51 offen offset:0 sc1
    v_accvgpr_read_b32 v216, a40
    v_accvgpr_read_b32 v217, a41
    v_accvgpr_read_b32 v218, a42
    v_accvgpr_read_b32 v219, a43
    v_accvgpr_read_b32 v220, a44
    v_accvgpr_read_b32 v221, a45
    v_accvgpr_read_b32 v222, a46
    v_accvgpr_read_b32 v223, a47
    v_pk_mul_f32 v[216:217], v[216:217], v[10:11] op_sel:[0,0] op_sel_hi:[1,0]
    v_pk_mul_f32 v[218:219], v[218:219], v[10:11] op_sel:[0,0] op_sel_hi:[1,0]
    v_pk_mul_f32 v[220:221], v[220:221], v[10:11] op_sel:[0,0] op_sel_hi:[1,0]
    v_pk_mul_f32 v[222:223], v[222:223], v[10:11] op_sel:[0,0] op_sel_hi:[1,0]
    v_cvt_pk_bf16_f32 v228, v216, v217
    v_cvt_pk_bf16_f32 v229, v218, v219
    v_cvt_pk_bf16_f32 v230, v220, v221
    v_cvt_pk_bf16_f32 v231, v222, v223
    buffer_store_dwordx4 v[228:231], v1, s[4:7], s51 offen offset:1024 sc1
    v_accvgpr_read_b32 v208, a48
    v_accvgpr_read_b32 v209, a49
    v_accvgpr_read_b32 v210, a50
    v_accvgpr_read_b32 v211, a51
    v_accvgpr_read_b32 v212, a52
    v_accvgpr_read_b32 v213, a53
    v_accvgpr_read_b32 v214, a54
    v_accvgpr_read_b32 v215, a55
    v_pk_mul_f32 v[208:209], v[208:209], v[10:11] op_sel:[0,0] op_sel_hi:[1,0]
    v_pk_mul_f32 v[210:211], v[210:211], v[10:11] op_sel:[0,0] op_sel_hi:[1,0]
    v_pk_mul_f32 v[212:213], v[212:213], v[10:11] op_sel:[0,0] op_sel_hi:[1,0]
    v_pk_mul_f32 v[214:215], v[214:215], v[10:11] op_sel:[0,0] op_sel_hi:[1,0]
    v_cvt_pk_bf16_f32 v232, v208, v209
    v_cvt_pk_bf16_f32 v233, v210, v211
    v_cvt_pk_bf16_f32 v234, v212, v213
    v_cvt_pk_bf16_f32 v235, v214, v215
    buffer_store_dwordx4 v[232:235], v1, s[4:7], s51 offen offset:2048 sc1
    v_accvgpr_read_b32 v216, a56
    v_accvgpr_read_b32 v217, a57
    v_accvgpr_read_b32 v218, a58
    v_accvgpr_read_b32 v219, a59
    v_accvgpr_read_b32 v220, a60
    v_accvgpr_read_b32 v221, a61
    v_accvgpr_read_b32 v222, a62
    v_accvgpr_read_b32 v223, a63
    v_pk_mul_f32 v[216:217], v[216:217], v[10:11] op_sel:[0,0] op_sel_hi:[1,0]
    v_pk_mul_f32 v[218:219], v[218:219], v[10:11] op_sel:[0,0] op_sel_hi:[1,0]
    v_pk_mul_f32 v[220:221], v[220:221], v[10:11] op_sel:[0,0] op_sel_hi:[1,0]
    v_pk_mul_f32 v[222:223], v[222:223], v[10:11] op_sel:[0,0] op_sel_hi:[1,0]
    v_cvt_pk_bf16_f32 v236, v216, v217
    v_cvt_pk_bf16_f32 v237, v218, v219
    v_cvt_pk_bf16_f32 v238, v220, v221
    v_cvt_pk_bf16_f32 v239, v222, v223
    buffer_store_dwordx4 v[236:239], v1, s[4:7], s51 offen offset:3072 sc1
    v_rcp_f32 v9, v200
    s_mul_i32 s51, s62, 136192
    s_add_u32 s51, s51, s57
    v_accvgpr_read_b32 v208, a64
    v_accvgpr_read_b32 v209, a65
    v_accvgpr_read_b32 v210, a66
    v_accvgpr_read_b32 v211, a67
    v_accvgpr_read_b32 v212, a68
    v_accvgpr_read_b32 v213, a69
    v_accvgpr_read_b32 v214, a70
    v_accvgpr_read_b32 v215, a71
    v_pk_mul_f32 v[208:209], v[208:209], v[8:9] op_sel:[0,1] op_sel_hi:[1,1]
    v_pk_mul_f32 v[210:211], v[210:211], v[8:9] op_sel:[0,1] op_sel_hi:[1,1]
    v_pk_mul_f32 v[212:213], v[212:213], v[8:9] op_sel:[0,1] op_sel_hi:[1,1]
    v_pk_mul_f32 v[214:215], v[214:215], v[8:9] op_sel:[0,1] op_sel_hi:[1,1]
    v_cvt_pk_bf16_f32 v224, v208, v209
    v_cvt_pk_bf16_f32 v225, v210, v211
    v_cvt_pk_bf16_f32 v226, v212, v213
    v_cvt_pk_bf16_f32 v227, v214, v215
    buffer_store_dwordx4 v[224:227], v1, s[4:7], s51 offen offset:0 sc1
    v_accvgpr_read_b32 v216, a72
    v_accvgpr_read_b32 v217, a73
    v_accvgpr_read_b32 v218, a74
    v_accvgpr_read_b32 v219, a75
    v_accvgpr_read_b32 v220, a76
    v_accvgpr_read_b32 v221, a77
    v_accvgpr_read_b32 v222, a78
    v_accvgpr_read_b32 v223, a79
    v_pk_mul_f32 v[216:217], v[216:217], v[8:9] op_sel:[0,1] op_sel_hi:[1,1]
    v_pk_mul_f32 v[218:219], v[218:219], v[8:9] op_sel:[0,1] op_sel_hi:[1,1]
    v_pk_mul_f32 v[220:221], v[220:221], v[8:9] op_sel:[0,1] op_sel_hi:[1,1]
    v_pk_mul_f32 v[222:223], v[222:223], v[8:9] op_sel:[0,1] op_sel_hi:[1,1]
    v_cvt_pk_bf16_f32 v228, v216, v217
    v_cvt_pk_bf16_f32 v229, v218, v219
    v_cvt_pk_bf16_f32 v230, v220, v221
    v_cvt_pk_bf16_f32 v231, v222, v223
    buffer_store_dwordx4 v[228:231], v1, s[4:7], s51 offen offset:1024 sc1
    v_accvgpr_read_b32 v208, a80
    v_accvgpr_read_b32 v209, a81
    v_accvgpr_read_b32 v210, a82
    v_accvgpr_read_b32 v211, a83
    v_accvgpr_read_b32 v212, a84
    v_accvgpr_read_b32 v213, a85
    v_accvgpr_read_b32 v214, a86
    v_accvgpr_read_b32 v215, a87
    v_pk_mul_f32 v[208:209], v[208:209], v[8:9] op_sel:[0,1] op_sel_hi:[1,1]
    v_pk_mul_f32 v[210:211], v[210:211], v[8:9] op_sel:[0,1] op_sel_hi:[1,1]
    v_pk_mul_f32 v[212:213], v[212:213], v[8:9] op_sel:[0,1] op_sel_hi:[1,1]
    v_pk_mul_f32 v[214:215], v[214:215], v[8:9] op_sel:[0,1] op_sel_hi:[1,1]
    v_cvt_pk_bf16_f32 v232, v208, v209
    v_cvt_pk_bf16_f32 v233, v210, v211
    v_cvt_pk_bf16_f32 v234, v212, v213
    v_cvt_pk_bf16_f32 v235, v214, v215
    buffer_store_dwordx4 v[232:235], v1, s[4:7], s51 offen offset:2048 sc1
    v_accvgpr_read_b32 v216, a88
    v_accvgpr_read_b32 v217, a89
    v_accvgpr_read_b32 v218, a90
    v_accvgpr_read_b32 v219, a91
    v_accvgpr_read_b32 v220, a92
    v_accvgpr_read_b32 v221, a93
    v_accvgpr_read_b32 v222, a94
    v_accvgpr_read_b32 v223, a95
    v_pk_mul_f32 v[216:217], v[216:217], v[8:9] op_sel:[0,1] op_sel_hi:[1,1]
    v_pk_mul_f32 v[218:219], v[218:219], v[8:9] op_sel:[0,1] op_sel_hi:[1,1]
    v_pk_mul_f32 v[220:221], v[220:221], v[8:9] op_sel:[0,1] op_sel_hi:[1,1]
    v_pk_mul_f32 v[222:223], v[222:223], v[8:9] op_sel:[0,1] op_sel_hi:[1,1]
    v_cvt_pk_bf16_f32 v236, v216, v217
    v_cvt_pk_bf16_f32 v237, v218, v219
    v_cvt_pk_bf16_f32 v238, v220, v221
    v_cvt_pk_bf16_f32 v239, v222, v223
    buffer_store_dwordx4 v[236:239], v1, s[4:7], s51 offen offset:3072 sc1
    v_rcp_f32 v10, v204
    s_mul_i32 s51, s63, 136192
    s_add_u32 s51, s51, s57
    v_accvgpr_read_b32 v208, a96
    v_accvgpr_read_b32 v209, a97
    v_accvgpr_read_b32 v210, a98
    v_accvgpr_read_b32 v211, a99
    v_accvgpr_read_b32 v212, a100
    v_accvgpr_read_b32 v213, a101
    v_accvgpr_read_b32 v214, a102
    v_accvgpr_read_b32 v215, a103
    v_pk_mul_f32 v[208:209], v[208:209], v[10:11] op_sel:[0,0] op_sel_hi:[1,0]
    v_pk_mul_f32 v[210:211], v[210:211], v[10:11] op_sel:[0,0] op_sel_hi:[1,0]
    v_pk_mul_f32 v[212:213], v[212:213], v[10:11] op_sel:[0,0] op_sel_hi:[1,0]
    v_pk_mul_f32 v[214:215], v[214:215], v[10:11] op_sel:[0,0] op_sel_hi:[1,0]
    v_cvt_pk_bf16_f32 v224, v208, v209
    v_cvt_pk_bf16_f32 v225, v210, v211
    v_cvt_pk_bf16_f32 v226, v212, v213
    v_cvt_pk_bf16_f32 v227, v214, v215
    buffer_store_dwordx4 v[224:227], v1, s[4:7], s51 offen offset:0 sc1
    v_accvgpr_read_b32 v216, a104
    v_accvgpr_read_b32 v217, a105
    v_accvgpr_read_b32 v218, a106
    v_accvgpr_read_b32 v219, a107
    v_accvgpr_read_b32 v220, a108
    v_accvgpr_read_b32 v221, a109
    v_accvgpr_read_b32 v222, a110
    v_accvgpr_read_b32 v223, a111
    v_pk_mul_f32 v[216:217], v[216:217], v[10:11] op_sel:[0,0] op_sel_hi:[1,0]
    v_pk_mul_f32 v[218:219], v[218:219], v[10:11] op_sel:[0,0] op_sel_hi:[1,0]
    v_pk_mul_f32 v[220:221], v[220:221], v[10:11] op_sel:[0,0] op_sel_hi:[1,0]
    v_pk_mul_f32 v[222:223], v[222:223], v[10:11] op_sel:[0,0] op_sel_hi:[1,0]
    v_cvt_pk_bf16_f32 v228, v216, v217
    v_cvt_pk_bf16_f32 v229, v218, v219
    v_cvt_pk_bf16_f32 v230, v220, v221
    v_cvt_pk_bf16_f32 v231, v222, v223
    buffer_store_dwordx4 v[228:231], v1, s[4:7], s51 offen offset:1024 sc1
    v_accvgpr_read_b32 v208, a112
    v_accvgpr_read_b32 v209, a113
    v_accvgpr_read_b32 v210, a114
    v_accvgpr_read_b32 v211, a115
    v_accvgpr_read_b32 v212, a116
    v_accvgpr_read_b32 v213, a117
    v_accvgpr_read_b32 v214, a118
    v_accvgpr_read_b32 v215, a119
    v_pk_mul_f32 v[208:209], v[208:209], v[10:11] op_sel:[0,0] op_sel_hi:[1,0]
    v_pk_mul_f32 v[210:211], v[210:211], v[10:11] op_sel:[0,0] op_sel_hi:[1,0]
    v_pk_mul_f32 v[212:213], v[212:213], v[10:11] op_sel:[0,0] op_sel_hi:[1,0]
    v_pk_mul_f32 v[214:215], v[214:215], v[10:11] op_sel:[0,0] op_sel_hi:[1,0]
    v_cvt_pk_bf16_f32 v232, v208, v209
    v_cvt_pk_bf16_f32 v233, v210, v211
    v_cvt_pk_bf16_f32 v234, v212, v213
    v_cvt_pk_bf16_f32 v235, v214, v215
    buffer_store_dwordx4 v[232:235], v1, s[4:7], s51 offen offset:2048 sc1
    v_accvgpr_read_b32 v216, a120
    v_accvgpr_read_b32 v217, a121
    v_accvgpr_read_b32 v218, a122
    v_accvgpr_read_b32 v219, a123
    v_accvgpr_read_b32 v220, a124
    v_accvgpr_read_b32 v221, a125
    v_accvgpr_read_b32 v222, a126
    v_accvgpr_read_b32 v223, a127
    v_pk_mul_f32 v[216:217], v[216:217], v[10:11] op_sel:[0,0] op_sel_hi:[1,0]
    v_pk_mul_f32 v[218:219], v[218:219], v[10:11] op_sel:[0,0] op_sel_hi:[1,0]
    v_pk_mul_f32 v[220:221], v[220:221], v[10:11] op_sel:[0,0] op_sel_hi:[1,0]
    v_pk_mul_f32 v[222:223], v[222:223], v[10:11] op_sel:[0,0] op_sel_hi:[1,0]
    v_cvt_pk_bf16_f32 v236, v216, v217
    v_cvt_pk_bf16_f32 v237, v218, v219
    v_cvt_pk_bf16_f32 v238, v220, v221
    v_cvt_pk_bf16_f32 v239, v222, v223
    buffer_store_dwordx4 v[236:239], v1, s[4:7], s51 offen offset:3072 sc1
    s_mov_b32 s59, 0
    s_barrier
    s_mov_b32 s8, s12
    s_mov_b32 s9, s13
    s_mov_b32 s10, 4194304
    s_mov_b32 s11, 0x20000
    s_mul_i32 s55, s3, 1048576
    s_bfe_u32 s58, s2, 0x30003
    s_lshl_b32 s58, s58, 7
    s_add_u32 s55, s55, s58
    s_lshl_b32 s56, s3, 14
    v_lshrrev_b32 v208, 3, v0
    v_and_b32 v209, 7, v0
    v_and_b32 v210, 6, v208
    v_xor_b32 v209, v209, v210
    v_lshlrev_b32 v208, 10, v208
    v_lshl_add_u32 v176, v209, 4, v208
    v_add_u32 v177, 7168, v176
    v_add_u32 v178, 14336, v176
    v_add_u32 v179, 21504, v176
    s_add_u32 m0, s56, 0
    s_add_u32 s58, s55, 0
    buffer_load_dwordx4 v176, s[8:11], s58 offen offset:0 lds
    buffer_load_dwordx4 v177, s[8:11], s58 offen offset:1024 lds
    buffer_load_dwordx4 v178, s[8:11], s58 offen offset:2048 lds
    buffer_load_dwordx4 v179, s[8:11], s58 offen offset:3072 lds
    s_add_u32 m0, s56, 4096
    s_add_u32 s58, s55, 32768
    buffer_load_dwordx4 v176, s[8:11], s58 offen offset:0 lds
    buffer_load_dwordx4 v177, s[8:11], s58 offen offset:1024 lds
    buffer_load_dwordx4 v178, s[8:11], s58 offen offset:2048 lds
    buffer_load_dwordx4 v179, s[8:11], s58 offen offset:3072 lds
    s_add_u32 m0, s56, 8192
    s_add_u32 s58, s55, 65536
    buffer_load_dwordx4 v176, s[8:11], s58 offen offset:0 lds
    buffer_load_dwordx4 v177, s[8:11], s58 offen offset:1024 lds
    buffer_load_dwordx4 v178, s[8:11], s58 offen offset:2048 lds
    buffer_load_dwordx4 v179, s[8:11], s58 offen offset:3072 lds
    s_add_u32 m0, s56, 12288
    s_add_u32 s58, s55, 98304
    buffer_load_dwordx4 v176, s[8:11], s58 offen offset:0 lds
    buffer_load_dwordx4 v177, s[8:11], s58 offen offset:1024 lds
    buffer_load_dwordx4 v178, s[8:11], s58 offen offset:2048 lds
    buffer_load_dwordx4 v179, s[8:11], s58 offen offset:3072 lds
    s_branch L_att_done
L_p4_skip:
    s_mov_b32 s8, s14
    s_mov_b32 s9, s15
    s_mov_b32 s10, 1409024
    s_mov_b32 s11, 0x20000
    s_mul_i32 s55, s3, 360448
    s_bfe_u32 s58, s2, 0x30003
    s_lshl_b32 s58, s58, 7
    s_add_u32 s55, s55, s58
    s_mul_i32 s37, s3, 11264
    s_add_u32 s37, s37, 66060288
    s_add_u32 s58, s3, 0
    s_and_b32 s58, s58, 3
    s_lshl_b32 s38, s34, 2
    s_add_u32 s38, s38, s58
    s_mul_i32 s38, s38, 44032
    s_add_u32 s38, s38, s37
    s_add_u32 s58, s3, 1
    s_and_b32 s58, s58, 3
    s_lshl_b32 s39, s34, 2
    s_add_u32 s39, s39, s58
    s_mul_i32 s39, s39, 44032
    s_add_u32 s39, s39, s37
    s_add_u32 s58, s3, 2
    s_and_b32 s58, s58, 3
    s_lshl_b32 s40, s34, 2
    s_add_u32 s40, s40, s58
    s_mul_i32 s40, s40, 44032
    s_add_u32 s40, s40, s37
    s_add_u32 s58, s3, 3
    s_and_b32 s58, s58, 3
    s_lshl_b32 s41, s34, 2
    s_add_u32 s41, s41, s58
    s_mul_i32 s41, s41, 44032
    s_add_u32 s41, s41, s37
    s_add_u32 m0, s56, 0
    s_add_u32 s58, s55, 0
    buffer_load_dwordx4 v176, s[8:11], s58 offen offset:0 lds
    buffer_load_dwordx4 v177, s[8:11], s58 offen offset:1024 lds
    buffer_load_dwordx4 v178, s[8:11], s58 offen offset:2048 lds
    buffer_load_dwordx4 v179, s[8:11], s58 offen offset:3072 lds
    s_add_u32 m0, s56, 4096
    s_add_u32 s58, s55, 32768
    buffer_load_dwordx4 v176, s[8:11], s58 offen offset:0 lds
    buffer_load_dwordx4 v177, s[8:11], s58 offen offset:1024 lds
    buffer_load_dwordx4 v178, s[8:11], s58 offen offset:2048 lds
    buffer_load_dwordx4 v179, s[8:11], s58 offen offset:3072 lds
    s_add_u32 m0, s56, 8192
    s_add_u32 s58, s55, 65536
    buffer_load_dwordx4 v176, s[8:11], s58 offen offset:0 lds
    buffer_load_dwordx4 v177, s[8:11], s58 offen offset:1024 lds
    buffer_load_dwordx4 v178, s[8:11], s58 offen offset:2048 lds
    buffer_load_dwordx4 v179, s[8:11], s58 offen offset:3072 lds
    s_add_u32 m0, s56, 12288
    s_add_u32 s58, s55, 98304
    buffer_load_dwordx4 v176, s[8:11], s58 offen offset:0 lds
    buffer_load_dwordx4 v177, s[8:11], s58 offen offset:1024 lds
    buffer_load_dwordx4 v178, s[8:11], s58 offen offset:2048 lds
    buffer_load_dwordx4 v179, s[8:11], s58 offen offset:3072 lds
    s_add_u32 m0, s56, 65536
    s_add_u32 s58, s55, 131072
    buffer_load_dwordx4 v176, s[8:11], s58 offen offset:0 lds
    buffer_load_dwordx4 v177, s[8:11], s58 offen offset:1024 lds
    buffer_load_dwordx4 v178, s[8:11], s58 offen offset:2048 lds
    buffer_load_dwordx4 v179, s[8:11], s58 offen offset:3072 lds
    s_add_u32 m0, s56, 69632
    s_add_u32 s58, s55, 163840
    buffer_load_dwordx4 v176, s[8:11], s58 offen offset:0 lds
    buffer_load_dwordx4 v177, s[8:11], s58 offen offset:1024 lds
    buffer_load_dwordx4 v178, s[8:11], s58 offen offset:2048 lds
    buffer_load_dwordx4 v179, s[8:11], s58 offen offset:3072 lds
    s_add_u32 m0, s56, 73728
    s_add_u32 s58, s55, 196608
    buffer_load_dwordx4 v176, s[8:11], s58 offen offset:0 lds
    buffer_load_dwordx4 v177, s[8:11], s58 offen offset:1024 lds
    buffer_load_dwordx4 v178, s[8:11], s58 offen offset:2048 lds
    buffer_load_dwordx4 v179, s[8:11], s58 offen offset:3072 lds
    s_add_u32 m0, s56, 77824
    s_add_u32 s58, s55, 229376
    buffer_load_dwordx4 v176, s[8:11], s58 offen offset:0 lds
    buffer_load_dwordx4 v177, s[8:11], s58 offen offset:1024 lds
    buffer_load_dwordx4 v178, s[8:11], s58 offen offset:2048 lds
    buffer_load_dwordx4 v179, s[8:11], s58 offen offset:3072 lds
    v_lshlrev_b32 v7, 10, v0
    s_add_u32 s58, s55, 262144
    buffer_load_dword v8, v7, s[8:11], s58 offen
    s_add_u32 s58, s55, 327680
    buffer_load_dword v9, v7, s[8:11], s58 offen
    s_branch L_p5
L_p4_short:
    s_add_u32 m0, s56, 73728
    s_add_u32 s58, s55, 196608
    buffer_load_dwordx4 v176, s[8:11], s58 offen offset:0 lds
    buffer_load_dwordx4 v177, s[8:11], s58 offen offset:1024 lds
    buffer_load_dwordx4 v178, s[8:11], s58 offen offset:2048 lds
    buffer_load_dwordx4 v179, s[8:11], s58 offen offset:3072 lds
    s_add_u32 m0, s56, 77824
    s_add_u32 s58, s55, 229376
    buffer_load_dwordx4 v176, s[8:11], s58 offen offset:0 lds
    buffer_load_dwordx4 v177, s[8:11], s58 offen offset:1024 lds
    buffer_load_dwordx4 v178, s[8:11], s58 offen offset:2048 lds
    buffer_load_dwordx4 v179, s[8:11], s58 offen offset:3072 lds
    s_branch L_p4_fin
L_spin_clr:
    s_mov_b32 s47, 131072
L_spin2_clr:
    buffer_load_dword v254, v252, s[24:27], 0 offen sc1
    s_sub_u32 s47, s47, 1
    s_waitcnt vmcnt(0)
    v_cmp_ne_u32 vcc, 1, v254
    s_cmp_eq_u32 s47, 0
    s_cbranch_scc1 L_ok_clr
    s_cbranch_vccnz L_spin2_clr
    s_branch L_ok_clr
L_spin_xn:
    s_mov_b32 s47, 131072
L_spin2_xn:
    buffer_load_dword v254, v255, s[4:7], 0 offen sc1
    s_sub_u32 s47, s47, 1
    s_waitcnt vmcnt(0)
    v_cmp_ne_u32 vcc, 1, v254
    s_cmp_eq_u32 s47, 0
    s_cbranch_scc1 L_ok_xn
    s_cbranch_vccnz L_spin2_xn
    s_branch L_ok_xn
L_spin_kv:
    s_mov_b32 s58, 131072
L_spin2_kv:
    buffer_load_dword v254, v255, s[4:7], 0 offen sc1
    s_sub_u32 s58, s58, 1
    s_waitcnt vmcnt(0)
    v_cmp_ne_u32 vcc, 1, v254
    s_cmp_eq_u32 s58, 0
    s_cbranch_scc1 L_ok_kv
    s_cbranch_vccnz L_spin2_kv
    s_branch L_ok_kv
L_spin_ctx2:
    s_mov_b32 s47, 131072
L_spin2_ctx2:
    buffer_load_dword v254, v255, s[4:7], 0 offen sc1
    s_sub_u32 s47, s47, 1
    s_waitcnt vmcnt(0)
    v_cmp_ne_u32 vcc, 1, v254
    s_cmp_eq_u32 s47, 0
    s_cbranch_scc1 L_ok_ctx2
    s_cbranch_vccnz L_spin2_ctx2
    s_branch L_ok_ctx2
L_spin_w:
    s_mov_b32 s47, 131072
L_spin2_w:
    buffer_load_dword v254, v2, s[4:7], 0 offen sc1
    s_sub_u32 s47, s47, 1
    s_waitcnt vmcnt(0)
    v_cmp_ne_u32 vcc, 1, v254
    s_cmp_eq_u32 s47, 0
    s_cbranch_scc1 L_ok_w
    s_cbranch_vccnz L_spin2_w
    s_branch L_ok_w
L_text_last:
    s_endpgm
.section .rodata,"a"
.p2align 6
.amdhsa_kernel sequential_preLN__compressed_kv_cla__glu_gated_swiglu__prompt_kernel
  .amdhsa_next_free_vgpr 512
  .amdhsa_next_free_sgpr 102
  .amdhsa_accum_offset 256
  .amdhsa_group_segment_fixed_size 0
  .amdhsa_kernarg_size 104
  .amdhsa_user_sgpr_count 2
  .amdhsa_user_sgpr_kernarg_segment_ptr 1
  .amdhsa_system_sgpr_workgroup_id_x 1
.end_amdhsa_kernel
```
